```python
import torch

def _softmax(x, axis=-1):
    return torch.softmax(x, dim=axis)
def _gelu(x):
    return torch.nn.functional.gelu(x, approximate="tanh")
def _silu(x):
    return torch.nn.functional.silu(x)
def _sigmoid(x):
    return torch.sigmoid(x)
def _layernorm(x, axis=-1, eps=1e-5):
    m = x.mean(dim=axis, keepdim=True)
    v = x.var(dim=axis, keepdim=True, unbiased=False)
    return (x - m) / torch.sqrt(v + eps)
def _scatter_add(tgt, idx, src, axis=0):
    return tgt.clone().index_add_(axis, idx, src)
def _segment_sum(src, seg, n):
    out = torch.zeros((n,) + src.shape[1:], dtype=src.dtype)
    return out.index_add_(0, seg, src)
def _pad(x, pw):
    flat = tuple(v for pair in reversed(pw) for v in pair)
    return torch.nn.functional.pad(x, flat)

kernel_name = 'parallel_sum__spectral_gfnet__mixer_channel_mlp__prompt'

def setup_inputs():

    _w = (lambda a: (lambda t: t.to(torch.bfloat16) if t.is_floating_point() else t)(torch.as_tensor(a)))
    def _A_setup():
        B, S, D = 1, 2048, 640
        Df = D // 2 + 1
        return {
            "x": _w((lambda *s: torch.randn(*s, dtype=torch.bfloat16) * 0.05)(B, S, D)),
            "w_r": _w((lambda *s: torch.randn(*s, dtype=torch.bfloat16) * 0.8)(S, Df) * 0.02),
            "w_i": _w((lambda *s: torch.randn(*s, dtype=torch.bfloat16) * 0.8)(S, Df) * 0.02),
        }
    _A_in = _A_setup()

    def _B_setup():
        B, S, D, F = 1, 2048, 640, 1728
        return {
            "x": _w((lambda *s: torch.randn(*s, dtype=torch.bfloat16) * 0.05)(B, S, D)),
            "w1": _w((lambda *s: torch.randn(*s, dtype=torch.bfloat16) * 0.8)(D, F) * (D ** -0.5)),
            "b1": _w((lambda *s: torch.randn(*s, dtype=torch.bfloat16) * 0.4)(F)),
            "w2": _w((lambda *s: torch.randn(*s, dtype=torch.bfloat16) * 0.05)(F, D) * (F ** -0.5)),
            "b2": _w((lambda *s: torch.randn(*s, dtype=torch.bfloat16) * 0.05)(D)),
        }
    _B_in = _B_setup()

    return {
        "A_x": _A_in["x"],
        "A_w_r": _A_in["w_r"],
        "A_w_i": _A_in["w_i"],
        "B_x": _B_in["x"],
        "B_w1": _B_in["w1"],
        "B_b1": _B_in["b1"],
        "B_w2": _B_in["w2"],
        "B_b2": _B_in["b2"],
    }

def reference(A_x, A_w_r, A_w_i, B_x, B_w1, B_b1, B_w2, B_b2):
    def _A_ref(x, w_r, w_i):
        B, S, D = x.shape
        X = (lambda x, axes=(-2,-1): torch.fft.rfft2(x.float(), dim=axes))(x, axes=(-2, -1))
        W = w_r + 1j * w_i
        X = X * W
        y = (lambda x, s, axes=(-2,-1): torch.fft.irfft2(x, s=s, dim=axes).to(torch.bfloat16))(X, (S, D), axes=(-2, -1))
        return y

    def _B_ref(x, w1, b1, w2, b2):
        y = _layernorm(x, axis=-1)
        h = _gelu(torch.einsum("bsd,df->bsf", y, w1) + b1)
        return torch.einsum("bsf,fd->bsd", h, w2) + b2

    x = A_x
    xn = _layernorm(x, axis=-1)
    return x + _A_ref(xn, A_w_r, A_w_i) + _B_ref(xn, B_w1, B_b1, B_w2, B_b2)
```

```asm
; @launch kernel=p1_kernel grid=(256,1,1) block=(256,1,1) lds=163840
; @launch kernel=p2_kernel grid=(256,1,1) block=(256,1,1) lds=147456
.amdgcn_target "amdgcn-amd-amdhsa--gfx950"
.text
.globl p1_kernel
.p2align 8
.type p1_kernel,@function
p1_kernel:
s_cmp_ge_u32 s2, 256
s_cbranch_scc1 EXIT_p1_kernel
s_load_dwordx16 s[8:23], s[0:1], 0
s_load_dwordx4 s[24:27], s[0:1], 64
s_load_dwordx2 s[28:29], s[0:1], 80
v_lshrrev_b32 v1, 6, v0
v_and_b32 v0, 63, v0
v_readfirstlane_b32 s3, v1
s_and_b32 s4, s2, 7
s_lshr_b32 s5, s2, 3
s_mov_b32 s60, 99
s_getpc_b64 s[32:33]
s_add_u32 s32, s32, p1_kernel@rel32@lo+4
s_addc_u32 s33, s33, p1_kernel@rel32@hi+12
s_mov_b32 s34, END_p1_kernel-p1_kernel
s_mov_b32 s35, 0x20000
s_lshl_b32 s48, s5, 2
s_add_u32 s48, s48, s3
s_mul_i32 s48, s48, 384
v_lshlrev_b32 v2, 7, v0
v_add_u32 v2, s48, v2
v_cmp_gt_u32 vcc, 3, v0
s_nop 1
v_cndmask_b32 v2, -1, v2, vcc
buffer_load_dword v31, v2, s[32:35], 0 offen
s_lshr_b32 s6, s4, 1
s_lshl_b32 s6, s6, 2
s_and_b32 s7, s5, 3
s_add_u32 s6, s6, s7
s_lshr_b32 s7, s5, 2
s_lshl_b32 s7, s7, 1
s_and_b32 s30, s4, 1
s_add_u32 s7, s7, s30
s_lshl_b32 s30, s6, 2
s_add_u32 s30, s30, s3
s_cmp_eq_u32 s7, 15
s_cbranch_scc1 P1X
s_cmp_lt_u32 s7, 4
s_cbranch_scc1 P1D
s_sub_u32 s31, s7, 4
s_mul_i32 s31, s31, 160
s_cmp_eq_u32 s2, 130
s_cselect_b32 s60, 1, s60
s_mul_i32 s54, s3, 30720
s_add_u32 s54, s54, 40960
v_lshrrev_b32 v3, 3, v0
v_and_b32 v4, 7, v0
v_add_u32 v5, 0, v3
v_and_b32 v2, 19, v5
v_and_b32 v6, 4, v5
v_lshl_or_b32 v2, v6, 1, v2
v_and_b32 v6, 8, v5
v_lshrrev_b32 v6, 1, v6
v_or_b32 v2, v2, v6
v_lshlrev_b32 v2, 6, v2
v_add_u32 v2, s30, v2
v_mul_u32_u24 v2, 1280, v2
v_bfe_u32 v5, v5, 1, 3
v_xor_b32 v5, v5, v4
v_lshl_add_u32 v16, v5, 4, v2
v_add_u32 v5, 8, v3
v_and_b32 v2, 19, v5
v_and_b32 v6, 4, v5
v_lshl_or_b32 v2, v6, 1, v2
v_and_b32 v6, 8, v5
v_lshrrev_b32 v6, 1, v6
v_or_b32 v2, v2, v6
v_lshlrev_b32 v2, 6, v2
v_add_u32 v2, s30, v2
v_mul_u32_u24 v2, 1280, v2
v_bfe_u32 v5, v5, 1, 3
v_xor_b32 v5, v5, v4
v_lshl_add_u32 v17, v5, 4, v2
v_add_u32 v5, 16, v3
v_and_b32 v2, 19, v5
v_and_b32 v6, 4, v5
v_lshl_or_b32 v2, v6, 1, v2
v_and_b32 v6, 8, v5
v_lshrrev_b32 v6, 1, v6
v_or_b32 v2, v2, v6
v_lshlrev_b32 v2, 6, v2
v_add_u32 v2, s30, v2
v_mul_u32_u24 v2, 1280, v2
v_bfe_u32 v5, v5, 1, 3
v_xor_b32 v5, v5, v4
v_lshl_add_u32 v18, v5, 4, v2
v_add_u32 v5, 24, v3
v_and_b32 v2, 19, v5
v_and_b32 v6, 4, v5
v_lshl_or_b32 v2, v6, 1, v2
v_and_b32 v6, 8, v5
v_lshrrev_b32 v6, 1, v6
v_or_b32 v2, v2, v6
v_lshlrev_b32 v2, 6, v2
v_add_u32 v2, s30, v2
v_mul_u32_u24 v2, 1280, v2
v_bfe_u32 v5, v5, 1, 3
v_xor_b32 v5, v5, v4
v_lshl_add_u32 v19, v5, 4, v2
s_and_b32 s55, s5, 3
s_mul_i32 s55, s55, 3
s_lshr_b32 s56, s5, 2
s_mul_i32 s56, s56, 1
s_add_u32 s56, s56, s55
s_lshr_b32 s55, s4, 0
s_mul_i32 s55, s55, 3
s_add_u32 s56, s56, s55
s_mul_i32 s55, s56, 205
s_lshr_b32 s55, s55, 11
s_mul_i32 s55, s55, 10
s_sub_u32 s56, s56, s55
s_lshl_b32 s55, s56, 7
s_waitcnt lgkmcnt(0)
s_mov_b32 s32, s8
s_mov_b32 s33, s9
s_mov_b32 s34, 2621440
s_mov_b32 s35, 0x20000
s_add_u32 m0, s54, 0
s_nop 0
buffer_load_dwordx4 v16, s[32:35], s55 offen lds
s_add_u32 m0, s54, 1024
s_nop 0
buffer_load_dwordx4 v17, s[32:35], s55 offen lds
s_add_u32 m0, s54, 2048
s_nop 0
buffer_load_dwordx4 v18, s[32:35], s55 offen lds
s_add_u32 m0, s54, 3072
s_nop 0
buffer_load_dwordx4 v19, s[32:35], s55 offen lds
s_add_u32 s55, s55, 128
s_cmp_eq_u32 s55, 1280
s_cselect_b32 s55, 0, s55
s_add_u32 m0, s54, 4096
s_nop 0
buffer_load_dwordx4 v16, s[32:35], s55 offen lds
s_add_u32 m0, s54, 5120
s_nop 0
buffer_load_dwordx4 v17, s[32:35], s55 offen lds
s_add_u32 m0, s54, 6144
s_nop 0
buffer_load_dwordx4 v18, s[32:35], s55 offen lds
s_add_u32 m0, s54, 7168
s_nop 0
buffer_load_dwordx4 v19, s[32:35], s55 offen lds
s_add_u32 s55, s55, 128
s_cmp_eq_u32 s55, 1280
s_cselect_b32 s55, 0, s55
s_add_u32 m0, s54, 8192
s_nop 0
buffer_load_dwordx4 v16, s[32:35], s55 offen lds
s_add_u32 m0, s54, 9216
s_nop 0
buffer_load_dwordx4 v17, s[32:35], s55 offen lds
s_add_u32 m0, s54, 10240
s_nop 0
buffer_load_dwordx4 v18, s[32:35], s55 offen lds
s_add_u32 m0, s54, 11264
s_nop 0
buffer_load_dwordx4 v19, s[32:35], s55 offen lds
s_add_u32 s55, s55, 128
s_cmp_eq_u32 s55, 1280
s_cselect_b32 s55, 0, s55
s_add_u32 m0, s54, 12288
s_nop 0
buffer_load_dwordx4 v16, s[32:35], s55 offen lds
s_add_u32 m0, s54, 13312
s_nop 0
buffer_load_dwordx4 v17, s[32:35], s55 offen lds
s_add_u32 m0, s54, 14336
s_nop 0
buffer_load_dwordx4 v18, s[32:35], s55 offen lds
s_add_u32 m0, s54, 15360
s_nop 0
buffer_load_dwordx4 v19, s[32:35], s55 offen lds
s_add_u32 s55, s55, 128
s_cmp_eq_u32 s55, 1280
s_cselect_b32 s55, 0, s55
s_add_u32 m0, s54, 16384
s_nop 0
buffer_load_dwordx4 v16, s[32:35], s55 offen lds
s_add_u32 m0, s54, 17408
s_nop 0
buffer_load_dwordx4 v17, s[32:35], s55 offen lds
s_add_u32 m0, s54, 18432
s_nop 0
buffer_load_dwordx4 v18, s[32:35], s55 offen lds
s_add_u32 m0, s54, 19456
s_nop 0
buffer_load_dwordx4 v19, s[32:35], s55 offen lds
s_add_u32 s55, s55, 128
s_cmp_eq_u32 s55, 1280
s_cselect_b32 s55, 0, s55
s_add_u32 m0, s54, 20480
s_nop 0
buffer_load_dwordx4 v16, s[32:35], s55 offen lds
s_add_u32 m0, s54, 21504
s_nop 0
buffer_load_dwordx4 v17, s[32:35], s55 offen lds
s_add_u32 m0, s54, 22528
s_nop 0
buffer_load_dwordx4 v18, s[32:35], s55 offen lds
s_add_u32 m0, s54, 23552
s_nop 0
buffer_load_dwordx4 v19, s[32:35], s55 offen lds
s_add_u32 s55, s55, 128
s_cmp_eq_u32 s55, 1280
s_cselect_b32 s55, 0, s55
s_add_u32 m0, s54, 24576
s_nop 0
buffer_load_dwordx4 v16, s[32:35], s55 offen lds
s_add_u32 m0, s54, 25600
s_nop 0
buffer_load_dwordx4 v17, s[32:35], s55 offen lds
s_add_u32 m0, s54, 26624
s_nop 0
buffer_load_dwordx4 v18, s[32:35], s55 offen lds
s_add_u32 m0, s54, 27648
s_nop 0
buffer_load_dwordx4 v19, s[32:35], s55 offen lds
s_add_u32 s55, s55, 128
s_cmp_eq_u32 s55, 1280
s_cselect_b32 s55, 0, s55
s_mov_b32 s64, s10
s_mov_b32 s65, s11
s_mov_b32 s66, 1314820
s_mov_b32 s67, 0x20000
s_mov_b32 s84, s12
s_mov_b32 s85, s13
s_mov_b32 s86, 1314820
s_mov_b32 s87, 0x20000
s_add_u32 s88, s28, 10485760
s_addc_u32 s89, s29, 0
s_mov_b32 s90, 2629632
s_mov_b32 s91, 0x20000
s_and_b32 s48, s30, 3
s_lshr_b32 s49, s30, 2
s_lshl_b32 s48, s48, 3
v_add_u32 v5, s48, v4
s_lshl_b32 s50, s49, 7
v_add_u32 v24, s50, v5
v_mul_u32_u24 v24, 642, v24
v_lshl_add_u32 v24, v3, 3, v24
s_lshl_b32 s50, s7, 6
v_add_u32 v24, s50, v24
s_lshl_b32 s50, s49, 9
s_lshl_b32 s48, s7, 18
s_add_u32 s50, s50, s48
v_lshlrev_b32 v28, 15, v3
v_lshl_add_u32 v28, v5, 4, v28
v_add_u32 v28, s50, v28
v_accvgpr_write_b32 a80, v24
v_accvgpr_write_b32 a81, v28
s_lshl_b32 s48, s7, 6
s_add_u32 s48, s48, s30
v_mul_u32_u24 v24, 960, v0
v_add_u32 v24, s48, v24
v_lshlrev_b32 v24, 7, v24
v_accvgpr_write_b32 a82, v24
s_mov_b32 s44, s18
s_mov_b32 s45, s19
s_mov_b32 s46, 3456
s_mov_b32 s47, 0x20000
v_add_u32 v2, s31, v0
v_lshlrev_b32 v2, 1, v2
v_lshrrev_b32 v3, 5, v0
v_lshl_or_b32 v1, v3, 30, v2
s_mov_b32 s36, s16
s_mov_b32 s37, s17
s_mov_b32 s38, 2211840
s_mov_b32 s39, 0x20000
s_add_u32 s40, s28, 3145728
s_addc_u32 s41, s29, 0
s_mov_b32 s42, 7077888
s_mov_b32 s43, 0x20000
s_mul_i32 s48, s3, 5120
s_lshl_b32 s57, s31, 1
s_mul_i32 s49, s56, 221184
s_add_u32 s49, s49, s57
s_add_u32 s58, s57, 2211840
s_mov_b32 s50, 52429
v_lshlrev_b32 v10, 4, v0
v_add_u32 v10, s48, v10
v_add_u32 v10, 0, v10
v_lshrrev_b32 v11, 6, v10
v_mul_lo_u32 v11, v11, s50
v_lshrrev_b32 v11, 18, v11
v_mul_u32_u24 v11, 3136, v11
v_add_u32 v2, v10, v11
v_lshlrev_b32 v10, 4, v0
v_add_u32 v10, s48, v10
v_add_u32 v10, 1024, v10
v_lshrrev_b32 v11, 6, v10
v_mul_lo_u32 v11, v11, s50
v_lshrrev_b32 v11, 18, v11
v_mul_u32_u24 v11, 3136, v11
v_add_u32 v3, v10, v11
v_lshlrev_b32 v10, 4, v0
v_add_u32 v10, s48, v10
v_add_u32 v10, 2048, v10
v_lshrrev_b32 v11, 6, v10
v_mul_lo_u32 v11, v11, s50
v_lshrrev_b32 v11, 18, v11
v_mul_u32_u24 v11, 3136, v11
v_add_u32 v4, v10, v11
v_lshlrev_b32 v10, 4, v0
v_add_u32 v10, s48, v10
v_add_u32 v10, 3072, v10
v_lshrrev_b32 v11, 6, v10
v_mul_lo_u32 v11, v11, s50
v_lshrrev_b32 v11, 18, v11
v_mul_u32_u24 v11, 3136, v11
v_add_u32 v5, v10, v11
v_lshlrev_b32 v10, 4, v0
v_add_u32 v10, s48, v10
v_add_u32 v10, 4096, v10
v_lshrrev_b32 v11, 6, v10
v_mul_lo_u32 v11, v11, s50
v_lshrrev_b32 v11, 18, v11
v_mul_u32_u24 v11, 3136, v11
v_add_u32 v6, v10, v11
s_add_u32 m0, s48, 0
s_nop 0
buffer_load_dwordx4 v2, s[36:39], s49 offen lds
s_add_u32 m0, s48, 1024
s_nop 0
buffer_load_dwordx4 v3, s[36:39], s49 offen lds
s_add_u32 m0, s48, 2048
s_nop 0
buffer_load_dwordx4 v4, s[36:39], s49 offen lds
s_add_u32 m0, s48, 3072
s_nop 0
buffer_load_dwordx4 v5, s[36:39], s49 offen lds
s_add_u32 m0, s48, 4096
s_nop 0
buffer_load_dwordx4 v6, s[36:39], s49 offen lds
s_add_u32 s49, s49, 221184
s_cmp_eq_u32 s49, s58
s_cselect_b32 s49, s57, s49
buffer_load_ushort a40, v1, s[44:47], 0 offen offset:0
buffer_load_ushort a41, v1, s[44:47], 0 offen offset:0
buffer_load_ushort a44, v1, s[44:47], 0 offen offset:64
buffer_load_ushort a45, v1, s[44:47], 0 offen offset:64
buffer_load_ushort a48, v1, s[44:47], 0 offen offset:128
buffer_load_ushort a49, v1, s[44:47], 0 offen offset:128
buffer_load_ushort a52, v1, s[44:47], 0 offen offset:192
buffer_load_ushort a53, v1, s[44:47], 0 offen offset:192
buffer_load_ushort a56, v1, s[44:47], 0 offen offset:256
buffer_load_ushort a57, v1, s[44:47], 0 offen offset:256
v_and_b32 v10, 31, v0
v_lshlrev_b32 v12, 7, v10
v_add_u32 v12, s54, v12
v_bfe_u32 v10, v10, 1, 3
v_lshrrev_b32 v11, 5, v0
v_xor_b32 v10, v10, v11
v_xor_b32 v11, 0, v10
v_lshl_add_u32 v20, v11, 4, v12
v_xor_b32 v11, 2, v10
v_lshl_add_u32 v21, v11, 4, v12
v_xor_b32 v11, 4, v10
v_lshl_add_u32 v22, v11, 4, v12
v_xor_b32 v11, 6, v10
v_lshl_add_u32 v23, v11, 4, v12
v_lshrrev_b32 v10, 5, v0
v_lshlrev_b32 v10, 3, v10
v_bfe_u32 v11, v0, 2, 2
v_add_u32 v10, v10, v11
v_mul_u32_u24 v10, 320, v10
v_bfe_u32 v11, v0, 4, 1
v_lshl_add_u32 v10, v11, 5, v10
v_and_b32 v11, 3, v0
v_lshl_add_u32 v7, v11, 3, v10
v_add_u32 v8, 61440, v7
v_add_u32 v9, 122880, v7
s_mov_b32 s51, 0x3f803f80
s_mov_b32 s63, 0xffff0000
v_mov_b32 v10, 0
v_mov_b32 v11, 0
v_mov_b32 v12, 0
v_mov_b32 v13, 0
v_accvgpr_write_b32 a42, 0
v_accvgpr_write_b32 a43, 0
v_accvgpr_write_b32 a46, 0
v_accvgpr_write_b32 a47, 0
v_accvgpr_write_b32 a50, 0
v_accvgpr_write_b32 a51, 0
v_accvgpr_write_b32 a54, 0
v_accvgpr_write_b32 a55, 0
v_accvgpr_write_b32 a58, 0
v_accvgpr_write_b32 a59, 0
v_accvgpr_write_b32 a62, 0
v_accvgpr_write_b32 a63, 0
s_waitcnt vmcnt(39)
ds_read_b128 v[96:99], v20 offset:0
ds_read_b128 v[100:103], v21 offset:0
ds_read_b128 v[104:107], v22 offset:0
ds_read_b128 v[108:111], v23 offset:0
s_waitcnt vmcnt(35)
ds_read_b128 v[112:115], v20 offset:4096
ds_read_b128 v[116:119], v21 offset:4096
ds_read_b128 v[120:123], v22 offset:4096
ds_read_b128 v[124:127], v23 offset:4096
s_waitcnt lgkmcnt(4)
s_add_u32 m0, s54, 0
s_nop 0
buffer_load_dwordx4 v16, s[32:35], s55 offen lds
s_add_u32 m0, s54, 1024
s_nop 0
buffer_load_dwordx4 v17, s[32:35], s55 offen lds
s_add_u32 m0, s54, 2048
s_nop 0
buffer_load_dwordx4 v18, s[32:35], s55 offen lds
s_add_u32 m0, s54, 3072
s_nop 0
buffer_load_dwordx4 v19, s[32:35], s55 offen lds
s_add_u32 s55, s55, 128
s_cmp_eq_u32 s55, 1280
s_cselect_b32 s55, 0, s55
v_dot2_f32_bf16 v10, v96, s51, v10
v_dot2_f32_bf16 v12, v96, v96, v12
v_dot2_f32_bf16 v11, v97, s51, v11
v_dot2_f32_bf16 v13, v97, v97, v13
v_dot2_f32_bf16 v10, v98, s51, v10
v_dot2_f32_bf16 v12, v98, v98, v12
v_dot2_f32_bf16 v11, v99, s51, v11
v_dot2_f32_bf16 v13, v99, v99, v13
v_dot2_f32_bf16 v10, v100, s51, v10
v_dot2_f32_bf16 v12, v100, v100, v12
v_dot2_f32_bf16 v11, v101, s51, v11
v_dot2_f32_bf16 v13, v101, v101, v13
v_dot2_f32_bf16 v10, v102, s51, v10
v_dot2_f32_bf16 v12, v102, v102, v12
v_dot2_f32_bf16 v11, v103, s51, v11
v_dot2_f32_bf16 v13, v103, v103, v13
v_dot2_f32_bf16 v10, v104, s51, v10
v_dot2_f32_bf16 v12, v104, v104, v12
v_dot2_f32_bf16 v11, v105, s51, v11
v_dot2_f32_bf16 v13, v105, v105, v13
v_dot2_f32_bf16 v10, v106, s51, v10
v_dot2_f32_bf16 v12, v106, v106, v12
v_dot2_f32_bf16 v11, v107, s51, v11
v_dot2_f32_bf16 v13, v107, v107, v13
v_dot2_f32_bf16 v10, v108, s51, v10
v_dot2_f32_bf16 v12, v108, v108, v12
v_dot2_f32_bf16 v11, v109, s51, v11
v_dot2_f32_bf16 v13, v109, v109, v13
v_dot2_f32_bf16 v10, v110, s51, v10
v_dot2_f32_bf16 v12, v110, v110, v12
v_dot2_f32_bf16 v11, v111, s51, v11
v_dot2_f32_bf16 v13, v111, v111, v13
s_waitcnt vmcnt(35)
ds_read_b128 v[128:131], v20 offset:8192
ds_read_b128 v[132:135], v21 offset:8192
ds_read_b128 v[136:139], v22 offset:8192
ds_read_b128 v[140:143], v23 offset:8192
s_waitcnt lgkmcnt(4)
s_add_u32 m0, s54, 4096
s_nop 0
buffer_load_dwordx4 v16, s[32:35], s55 offen lds
s_add_u32 m0, s54, 5120
s_nop 0
buffer_load_dwordx4 v17, s[32:35], s55 offen lds
s_add_u32 m0, s54, 6144
s_nop 0
buffer_load_dwordx4 v18, s[32:35], s55 offen lds
s_add_u32 m0, s54, 7168
s_nop 0
buffer_load_dwordx4 v19, s[32:35], s55 offen lds
s_add_u32 s55, s55, 128
s_cmp_eq_u32 s55, 1280
s_cselect_b32 s55, 0, s55
v_dot2_f32_bf16 v10, v112, s51, v10
v_dot2_f32_bf16 v12, v112, v112, v12
v_dot2_f32_bf16 v11, v113, s51, v11
v_dot2_f32_bf16 v13, v113, v113, v13
v_dot2_f32_bf16 v10, v114, s51, v10
v_dot2_f32_bf16 v12, v114, v114, v12
v_dot2_f32_bf16 v11, v115, s51, v11
v_dot2_f32_bf16 v13, v115, v115, v13
v_dot2_f32_bf16 v10, v116, s51, v10
v_dot2_f32_bf16 v12, v116, v116, v12
v_dot2_f32_bf16 v11, v117, s51, v11
v_dot2_f32_bf16 v13, v117, v117, v13
v_dot2_f32_bf16 v10, v118, s51, v10
v_dot2_f32_bf16 v12, v118, v118, v12
v_dot2_f32_bf16 v11, v119, s51, v11
v_dot2_f32_bf16 v13, v119, v119, v13
v_dot2_f32_bf16 v10, v120, s51, v10
v_dot2_f32_bf16 v12, v120, v120, v12
v_dot2_f32_bf16 v11, v121, s51, v11
v_dot2_f32_bf16 v13, v121, v121, v13
v_dot2_f32_bf16 v10, v122, s51, v10
v_dot2_f32_bf16 v12, v122, v122, v12
v_dot2_f32_bf16 v11, v123, s51, v11
v_dot2_f32_bf16 v13, v123, v123, v13
v_dot2_f32_bf16 v10, v124, s51, v10
v_dot2_f32_bf16 v12, v124, v124, v12
v_dot2_f32_bf16 v11, v125, s51, v11
v_dot2_f32_bf16 v13, v125, v125, v13
v_dot2_f32_bf16 v10, v126, s51, v10
v_dot2_f32_bf16 v12, v126, v126, v12
v_dot2_f32_bf16 v11, v127, s51, v11
v_dot2_f32_bf16 v13, v127, v127, v13
s_waitcnt vmcnt(35)
ds_read_b128 v[144:147], v20 offset:12288
ds_read_b128 v[148:151], v21 offset:12288
ds_read_b128 v[152:155], v22 offset:12288
ds_read_b128 v[156:159], v23 offset:12288
s_waitcnt lgkmcnt(4)
s_add_u32 m0, s54, 8192
s_nop 0
buffer_load_dwordx4 v16, s[32:35], s55 offen lds
s_add_u32 m0, s54, 9216
s_nop 0
buffer_load_dwordx4 v17, s[32:35], s55 offen lds
s_add_u32 m0, s54, 10240
s_nop 0
buffer_load_dwordx4 v18, s[32:35], s55 offen lds
s_add_u32 m0, s54, 11264
s_nop 0
buffer_load_dwordx4 v19, s[32:35], s55 offen lds
s_add_u32 s55, s55, 128
s_cmp_eq_u32 s55, 1280
s_cselect_b32 s55, 0, s55
s_add_u32 m0, s48, 20480
s_nop 0
buffer_load_dwordx4 v2, s[36:39], s49 offen lds
s_add_u32 m0, s48, 21504
s_nop 0
buffer_load_dwordx4 v3, s[36:39], s49 offen lds
s_add_u32 m0, s48, 22528
s_nop 0
buffer_load_dwordx4 v4, s[36:39], s49 offen lds
s_add_u32 m0, s48, 23552
s_nop 0
buffer_load_dwordx4 v5, s[36:39], s49 offen lds
s_add_u32 m0, s48, 24576
s_nop 0
buffer_load_dwordx4 v6, s[36:39], s49 offen lds
s_add_u32 s49, s49, 221184
s_cmp_eq_u32 s49, s58
s_cselect_b32 s49, s57, s49
v_dot2_f32_bf16 v10, v128, s51, v10
v_dot2_f32_bf16 v12, v128, v128, v12
v_dot2_f32_bf16 v11, v129, s51, v11
v_dot2_f32_bf16 v13, v129, v129, v13
v_dot2_f32_bf16 v10, v130, s51, v10
v_dot2_f32_bf16 v12, v130, v130, v12
v_dot2_f32_bf16 v11, v131, s51, v11
v_dot2_f32_bf16 v13, v131, v131, v13
v_dot2_f32_bf16 v10, v132, s51, v10
v_dot2_f32_bf16 v12, v132, v132, v12
v_dot2_f32_bf16 v11, v133, s51, v11
v_dot2_f32_bf16 v13, v133, v133, v13
v_dot2_f32_bf16 v10, v134, s51, v10
v_dot2_f32_bf16 v12, v134, v134, v12
v_dot2_f32_bf16 v11, v135, s51, v11
v_dot2_f32_bf16 v13, v135, v135, v13
v_dot2_f32_bf16 v10, v136, s51, v10
v_dot2_f32_bf16 v12, v136, v136, v12
v_dot2_f32_bf16 v11, v137, s51, v11
v_dot2_f32_bf16 v13, v137, v137, v13
v_dot2_f32_bf16 v10, v138, s51, v10
v_dot2_f32_bf16 v12, v138, v138, v12
v_dot2_f32_bf16 v11, v139, s51, v11
v_dot2_f32_bf16 v13, v139, v139, v13
v_dot2_f32_bf16 v10, v140, s51, v10
v_dot2_f32_bf16 v12, v140, v140, v12
v_dot2_f32_bf16 v11, v141, s51, v11
v_dot2_f32_bf16 v13, v141, v141, v13
v_dot2_f32_bf16 v10, v142, s51, v10
v_dot2_f32_bf16 v12, v142, v142, v12
v_dot2_f32_bf16 v11, v143, s51, v11
v_dot2_f32_bf16 v13, v143, v143, v13
s_waitcnt vmcnt(40)
ds_read_b128 v[160:163], v20 offset:16384
ds_read_b128 v[164:167], v21 offset:16384
ds_read_b128 v[168:171], v22 offset:16384
ds_read_b128 v[172:175], v23 offset:16384
s_waitcnt lgkmcnt(4)
v_dot2_f32_bf16 v10, v144, s51, v10
v_dot2_f32_bf16 v12, v144, v144, v12
v_dot2_f32_bf16 v11, v145, s51, v11
v_dot2_f32_bf16 v13, v145, v145, v13
v_dot2_f32_bf16 v10, v146, s51, v10
v_dot2_f32_bf16 v12, v146, v146, v12
v_dot2_f32_bf16 v11, v147, s51, v11
v_dot2_f32_bf16 v13, v147, v147, v13
v_dot2_f32_bf16 v10, v148, s51, v10
v_dot2_f32_bf16 v12, v148, v148, v12
v_dot2_f32_bf16 v11, v149, s51, v11
v_dot2_f32_bf16 v13, v149, v149, v13
v_dot2_f32_bf16 v10, v150, s51, v10
v_dot2_f32_bf16 v12, v150, v150, v12
v_dot2_f32_bf16 v11, v151, s51, v11
v_dot2_f32_bf16 v13, v151, v151, v13
v_dot2_f32_bf16 v10, v152, s51, v10
v_dot2_f32_bf16 v12, v152, v152, v12
v_dot2_f32_bf16 v11, v153, s51, v11
v_dot2_f32_bf16 v13, v153, v153, v13
v_dot2_f32_bf16 v10, v154, s51, v10
v_dot2_f32_bf16 v12, v154, v154, v12
v_dot2_f32_bf16 v11, v155, s51, v11
v_dot2_f32_bf16 v13, v155, v155, v13
v_dot2_f32_bf16 v10, v156, s51, v10
v_dot2_f32_bf16 v12, v156, v156, v12
v_dot2_f32_bf16 v11, v157, s51, v11
v_dot2_f32_bf16 v13, v157, v157, v13
v_dot2_f32_bf16 v10, v158, s51, v10
v_dot2_f32_bf16 v12, v158, v158, v12
v_dot2_f32_bf16 v11, v159, s51, v11
v_dot2_f32_bf16 v13, v159, v159, v13
s_waitcnt vmcnt(36)
ds_read_b128 v[176:179], v20 offset:20480
ds_read_b128 v[180:183], v21 offset:20480
ds_read_b128 v[184:187], v22 offset:20480
ds_read_b128 v[188:191], v23 offset:20480
s_waitcnt lgkmcnt(4)
v_dot2_f32_bf16 v10, v160, s51, v10
v_dot2_f32_bf16 v12, v160, v160, v12
v_dot2_f32_bf16 v11, v161, s51, v11
v_dot2_f32_bf16 v13, v161, v161, v13
v_dot2_f32_bf16 v10, v162, s51, v10
v_dot2_f32_bf16 v12, v162, v162, v12
v_dot2_f32_bf16 v11, v163, s51, v11
v_dot2_f32_bf16 v13, v163, v163, v13
v_dot2_f32_bf16 v10, v164, s51, v10
v_dot2_f32_bf16 v12, v164, v164, v12
v_dot2_f32_bf16 v11, v165, s51, v11
v_dot2_f32_bf16 v13, v165, v165, v13
v_dot2_f32_bf16 v10, v166, s51, v10
v_dot2_f32_bf16 v12, v166, v166, v12
v_dot2_f32_bf16 v11, v167, s51, v11
v_dot2_f32_bf16 v13, v167, v167, v13
v_dot2_f32_bf16 v10, v168, s51, v10
v_dot2_f32_bf16 v12, v168, v168, v12
v_dot2_f32_bf16 v11, v169, s51, v11
v_dot2_f32_bf16 v13, v169, v169, v13
v_dot2_f32_bf16 v10, v170, s51, v10
v_dot2_f32_bf16 v12, v170, v170, v12
v_dot2_f32_bf16 v11, v171, s51, v11
v_dot2_f32_bf16 v13, v171, v171, v13
v_dot2_f32_bf16 v10, v172, s51, v10
v_dot2_f32_bf16 v12, v172, v172, v12
v_dot2_f32_bf16 v11, v173, s51, v11
v_dot2_f32_bf16 v13, v173, v173, v13
v_dot2_f32_bf16 v10, v174, s51, v10
v_dot2_f32_bf16 v12, v174, v174, v12
v_dot2_f32_bf16 v11, v175, s51, v11
v_dot2_f32_bf16 v13, v175, v175, v13
s_waitcnt vmcnt(32)
ds_read_b128 v[192:195], v20 offset:24576
ds_read_b128 v[196:199], v21 offset:24576
ds_read_b128 v[200:203], v22 offset:24576
ds_read_b128 v[204:207], v23 offset:24576
s_waitcnt lgkmcnt(4)
v_dot2_f32_bf16 v10, v176, s51, v10
v_dot2_f32_bf16 v12, v176, v176, v12
v_dot2_f32_bf16 v11, v177, s51, v11
v_dot2_f32_bf16 v13, v177, v177, v13
v_dot2_f32_bf16 v10, v178, s51, v10
v_dot2_f32_bf16 v12, v178, v178, v12
v_dot2_f32_bf16 v11, v179, s51, v11
v_dot2_f32_bf16 v13, v179, v179, v13
v_dot2_f32_bf16 v10, v180, s51, v10
v_dot2_f32_bf16 v12, v180, v180, v12
v_dot2_f32_bf16 v11, v181, s51, v11
v_dot2_f32_bf16 v13, v181, v181, v13
v_dot2_f32_bf16 v10, v182, s51, v10
v_dot2_f32_bf16 v12, v182, v182, v12
v_dot2_f32_bf16 v11, v183, s51, v11
v_dot2_f32_bf16 v13, v183, v183, v13
v_dot2_f32_bf16 v10, v184, s51, v10
v_dot2_f32_bf16 v12, v184, v184, v12
v_dot2_f32_bf16 v11, v185, s51, v11
v_dot2_f32_bf16 v13, v185, v185, v13
v_dot2_f32_bf16 v10, v186, s51, v10
v_dot2_f32_bf16 v12, v186, v186, v12
v_dot2_f32_bf16 v11, v187, s51, v11
v_dot2_f32_bf16 v13, v187, v187, v13
v_dot2_f32_bf16 v10, v188, s51, v10
v_dot2_f32_bf16 v12, v188, v188, v12
v_dot2_f32_bf16 v11, v189, s51, v11
v_dot2_f32_bf16 v13, v189, v189, v13
v_dot2_f32_bf16 v10, v190, s51, v10
v_dot2_f32_bf16 v12, v190, v190, v12
v_dot2_f32_bf16 v11, v191, s51, v11
v_dot2_f32_bf16 v13, v191, v191, v13
s_waitcnt vmcnt(13)
ds_read_b128 v[208:211], v20 offset:0
ds_read_b128 v[212:215], v21 offset:0
ds_read_b128 v[216:219], v22 offset:0
ds_read_b128 v[220:223], v23 offset:0
s_waitcnt lgkmcnt(4)
v_dot2_f32_bf16 v10, v192, s51, v10
v_dot2_f32_bf16 v12, v192, v192, v12
v_dot2_f32_bf16 v11, v193, s51, v11
v_dot2_f32_bf16 v13, v193, v193, v13
v_dot2_f32_bf16 v10, v194, s51, v10
v_dot2_f32_bf16 v12, v194, v194, v12
v_dot2_f32_bf16 v11, v195, s51, v11
v_dot2_f32_bf16 v13, v195, v195, v13
v_dot2_f32_bf16 v10, v196, s51, v10
v_dot2_f32_bf16 v12, v196, v196, v12
v_dot2_f32_bf16 v11, v197, s51, v11
v_dot2_f32_bf16 v13, v197, v197, v13
v_dot2_f32_bf16 v10, v198, s51, v10
v_dot2_f32_bf16 v12, v198, v198, v12
v_dot2_f32_bf16 v11, v199, s51, v11
v_dot2_f32_bf16 v13, v199, v199, v13
v_dot2_f32_bf16 v10, v200, s51, v10
v_dot2_f32_bf16 v12, v200, v200, v12
v_dot2_f32_bf16 v11, v201, s51, v11
v_dot2_f32_bf16 v13, v201, v201, v13
v_dot2_f32_bf16 v10, v202, s51, v10
v_dot2_f32_bf16 v12, v202, v202, v12
v_dot2_f32_bf16 v11, v203, s51, v11
v_dot2_f32_bf16 v13, v203, v203, v13
v_dot2_f32_bf16 v10, v204, s51, v10
v_dot2_f32_bf16 v12, v204, v204, v12
v_dot2_f32_bf16 v11, v205, s51, v11
v_dot2_f32_bf16 v13, v205, v205, v13
v_dot2_f32_bf16 v10, v206, s51, v10
v_dot2_f32_bf16 v12, v206, v206, v12
v_dot2_f32_bf16 v11, v207, s51, v11
v_dot2_f32_bf16 v13, v207, v207, v13
s_waitcnt vmcnt(9)
ds_read_b128 v[224:227], v20 offset:4096
ds_read_b128 v[228:231], v21 offset:4096
ds_read_b128 v[232:235], v22 offset:4096
ds_read_b128 v[236:239], v23 offset:4096
s_waitcnt lgkmcnt(4)
v_dot2_f32_bf16 v10, v208, s51, v10
v_dot2_f32_bf16 v12, v208, v208, v12
v_dot2_f32_bf16 v11, v209, s51, v11
v_dot2_f32_bf16 v13, v209, v209, v13
v_dot2_f32_bf16 v10, v210, s51, v10
v_dot2_f32_bf16 v12, v210, v210, v12
v_dot2_f32_bf16 v11, v211, s51, v11
v_dot2_f32_bf16 v13, v211, v211, v13
v_dot2_f32_bf16 v10, v212, s51, v10
v_dot2_f32_bf16 v12, v212, v212, v12
v_dot2_f32_bf16 v11, v213, s51, v11
v_dot2_f32_bf16 v13, v213, v213, v13
v_dot2_f32_bf16 v10, v214, s51, v10
v_dot2_f32_bf16 v12, v214, v214, v12
v_dot2_f32_bf16 v11, v215, s51, v11
v_dot2_f32_bf16 v13, v215, v215, v13
v_dot2_f32_bf16 v10, v216, s51, v10
v_dot2_f32_bf16 v12, v216, v216, v12
v_dot2_f32_bf16 v11, v217, s51, v11
v_dot2_f32_bf16 v13, v217, v217, v13
v_dot2_f32_bf16 v10, v218, s51, v10
v_dot2_f32_bf16 v12, v218, v218, v12
v_dot2_f32_bf16 v11, v219, s51, v11
v_dot2_f32_bf16 v13, v219, v219, v13
v_dot2_f32_bf16 v10, v220, s51, v10
v_dot2_f32_bf16 v12, v220, v220, v12
v_dot2_f32_bf16 v11, v221, s51, v11
v_dot2_f32_bf16 v13, v221, v221, v13
v_dot2_f32_bf16 v10, v222, s51, v10
v_dot2_f32_bf16 v12, v222, v222, v12
v_dot2_f32_bf16 v11, v223, s51, v11
v_dot2_f32_bf16 v13, v223, v223, v13
s_waitcnt vmcnt(5)
ds_read_b128 v[240:243], v20 offset:8192
ds_read_b128 v[244:247], v21 offset:8192
ds_read_b128 v[248:251], v22 offset:8192
ds_read_b128 v[252:255], v23 offset:8192
s_waitcnt lgkmcnt(4)
v_dot2_f32_bf16 v10, v224, s51, v10
v_dot2_f32_bf16 v12, v224, v224, v12
v_dot2_f32_bf16 v11, v225, s51, v11
v_dot2_f32_bf16 v13, v225, v225, v13
v_dot2_f32_bf16 v10, v226, s51, v10
v_dot2_f32_bf16 v12, v226, v226, v12
v_dot2_f32_bf16 v11, v227, s51, v11
v_dot2_f32_bf16 v13, v227, v227, v13
v_dot2_f32_bf16 v10, v228, s51, v10
v_dot2_f32_bf16 v12, v228, v228, v12
v_dot2_f32_bf16 v11, v229, s51, v11
v_dot2_f32_bf16 v13, v229, v229, v13
v_dot2_f32_bf16 v10, v230, s51, v10
v_dot2_f32_bf16 v12, v230, v230, v12
v_dot2_f32_bf16 v11, v231, s51, v11
v_dot2_f32_bf16 v13, v231, v231, v13
v_dot2_f32_bf16 v10, v232, s51, v10
v_dot2_f32_bf16 v12, v232, v232, v12
v_dot2_f32_bf16 v11, v233, s51, v11
v_dot2_f32_bf16 v13, v233, v233, v13
v_dot2_f32_bf16 v10, v234, s51, v10
v_dot2_f32_bf16 v12, v234, v234, v12
v_dot2_f32_bf16 v11, v235, s51, v11
v_dot2_f32_bf16 v13, v235, v235, v13
v_dot2_f32_bf16 v10, v236, s51, v10
v_dot2_f32_bf16 v12, v236, v236, v12
v_dot2_f32_bf16 v11, v237, s51, v11
v_dot2_f32_bf16 v13, v237, v237, v13
v_dot2_f32_bf16 v10, v238, s51, v10
v_dot2_f32_bf16 v12, v238, v238, v12
v_dot2_f32_bf16 v11, v239, s51, v11
v_dot2_f32_bf16 v13, v239, v239, v13
s_waitcnt lgkmcnt(0)
s_waitcnt vmcnt(27)
s_barrier
ds_read_b64_tr_b16 a[0:1], v7 offset:0
ds_read_b64_tr_b16 a[2:3], v7 offset:1280
ds_read_b64_tr_b16 a[4:5], v7 offset:64
ds_read_b64_tr_b16 a[6:7], v7 offset:1344
ds_read_b64_tr_b16 a[8:9], v7 offset:128
ds_read_b64_tr_b16 a[10:11], v7 offset:1408
ds_read_b64_tr_b16 a[12:13], v7 offset:192
ds_read_b64_tr_b16 a[14:15], v7 offset:1472
ds_read_b64_tr_b16 a[16:17], v7 offset:256
ds_read_b64_tr_b16 a[18:19], v7 offset:1536
ds_read_b64_tr_b16 a[20:21], v7 offset:5120
ds_read_b64_tr_b16 a[22:23], v7 offset:6400
ds_read_b64_tr_b16 a[24:25], v7 offset:5184
ds_read_b64_tr_b16 a[26:27], v7 offset:6464
ds_read_b64_tr_b16 a[28:29], v7 offset:5248
ds_read_b64_tr_b16 a[30:31], v7 offset:6528
ds_read_b64_tr_b16 a[32:33], v7 offset:5312
ds_read_b64_tr_b16 a[34:35], v7 offset:6592
s_add_u32 m0, s48, 40960
s_nop 0
buffer_load_dwordx4 v2, s[36:39], s49 offen lds
s_add_u32 m0, s48, 41984
s_nop 0
buffer_load_dwordx4 v3, s[36:39], s49 offen lds
s_add_u32 m0, s48, 43008
s_nop 0
buffer_load_dwordx4 v4, s[36:39], s49 offen lds
s_add_u32 m0, s48, 44032
s_nop 0
buffer_load_dwordx4 v5, s[36:39], s49 offen lds
s_add_u32 m0, s48, 45056
s_nop 0
buffer_load_dwordx4 v6, s[36:39], s49 offen lds
s_add_u32 s49, s49, 221184
s_cmp_eq_u32 s49, s58
s_cselect_b32 s49, s57, s49
v_dot2_f32_bf16 v10, v240, s51, v10
v_dot2_f32_bf16 v12, v240, v240, v12
v_dot2_f32_bf16 v11, v241, s51, v11
v_dot2_f32_bf16 v13, v241, v241, v13
v_dot2_f32_bf16 v10, v242, s51, v10
v_dot2_f32_bf16 v12, v242, v242, v12
v_dot2_f32_bf16 v11, v243, s51, v11
v_dot2_f32_bf16 v13, v243, v243, v13
v_dot2_f32_bf16 v10, v244, s51, v10
v_dot2_f32_bf16 v12, v244, v244, v12
v_dot2_f32_bf16 v11, v245, s51, v11
v_dot2_f32_bf16 v13, v245, v245, v13
v_dot2_f32_bf16 v10, v246, s51, v10
v_dot2_f32_bf16 v12, v246, v246, v12
v_dot2_f32_bf16 v11, v247, s51, v11
v_dot2_f32_bf16 v13, v247, v247, v13
v_dot2_f32_bf16 v10, v248, s51, v10
v_dot2_f32_bf16 v12, v248, v248, v12
v_dot2_f32_bf16 v11, v249, s51, v11
v_dot2_f32_bf16 v13, v249, v249, v13
v_dot2_f32_bf16 v10, v250, s51, v10
v_dot2_f32_bf16 v12, v250, v250, v12
v_dot2_f32_bf16 v11, v251, s51, v11
v_dot2_f32_bf16 v13, v251, v251, v13
v_dot2_f32_bf16 v10, v252, s51, v10
v_dot2_f32_bf16 v12, v252, v252, v12
v_dot2_f32_bf16 v11, v253, s51, v11
v_dot2_f32_bf16 v13, v253, v253, v13
v_dot2_f32_bf16 v10, v254, s51, v10
v_dot2_f32_bf16 v12, v254, v254, v12
v_dot2_f32_bf16 v11, v255, s51, v11
v_dot2_f32_bf16 v13, v255, v255, v13
s_nop 1
v_add_f32 v10, v10, v11
v_add_f32 v12, v12, v13
v_mov_b32 v11, v10
v_mov_b32 v13, v12
s_nop 0
v_permlane32_swap_b32 v10, v11
v_permlane32_swap_b32 v12, v13
v_add_f32 v10, v10, v11
v_add_f32 v12, v12, v13
v_mul_f32 v10, 0x3acccccd, v10
v_mul_f32 v12, 0x3acccccd, v12
v_fma_f32 v12, -v10, v10, v12
v_max_f32 v12, 0, v12
v_mov_b32 v13, v10
v_mov_b32 v14, v12
v_cvt_pk_bf16_f32 v13, v13, v13
v_lshlrev_b32 v13, 16, v13
v_cvt_pk_bf16_f32 v14, v14, v14
v_lshlrev_b32 v14, 16, v14
v_add_f32 v14, 0x3727c5ac, v14
v_cvt_pk_bf16_f32 v14, v14, v14
v_lshlrev_b32 v14, 16, v14
v_sqrt_f32 v14, v14
s_nop 0
v_cvt_pk_bf16_f32 v14, v14, v14
v_lshlrev_b32 v14, 16, v14
v_rcp_f32 v14, v14
v_sub_f32 v10, v10, v13
v_mul_f32 v10, v10, v14
v_mul_f32 v12, v12, v14
v_mul_f32 v12, v12, v14
v_cvt_pk_bf16_f32 v10, v10, v10
v_lshlrev_b32 v10, 16, v10
v_cvt_pk_bf16_f32 v12, v12, v12
v_lshlrev_b32 v12, 16, v12
v_add_f32 v12, 0x3727c5ac, v12
v_cvt_pk_bf16_f32 v12, v12, v12
v_lshlrev_b32 v12, 16, v12
v_sqrt_f32 v12, v12
s_nop 0
v_cvt_pk_bf16_f32 v12, v12, v12
v_lshlrev_b32 v12, 16, v12
v_rcp_f32 v12, v12
v_fma_f32 v11, v13, v14, v10
v_mul_f32 v11, v11, v12
v_sub_f32 v11, 0, v11
v_mul_f32 v10, v14, v12
v_rcp_f32 v12, v10
s_nop 0
v_mul_f32 v11, v11, v12
v_cvt_pk_bf16_f32 v13, v12, v12
v_lshlrev_b32 v14, 16, v13
v_sub_f32 v14, v12, v14
v_cvt_pk_bf16_f32 v14, v14, v14
v_and_b32 v13, 0xffff, v13
v_and_b32 v14, 0xffff, v14
v_accvgpr_write_b32 a60, v13
v_accvgpr_write_b32 a61, v14
v_accvgpr_write_b32 a85, v12
v_lshlrev_b32 v12, 16, v96
v_and_b32 v13, s63, v96
v_lshlrev_b32 v14, 16, v97
v_and_b32 v15, s63, v97
v_add_f32 v12, v11, v12
v_add_f32 v13, v11, v13
v_add_f32 v14, v11, v14
v_add_f32 v15, v11, v15
v_cvt_pk_bf16_f32 v96, v12, v13
v_cvt_pk_bf16_f32 v97, v14, v15
v_lshlrev_b32 v12, 16, v98
v_and_b32 v13, s63, v98
v_lshlrev_b32 v14, 16, v99
v_and_b32 v15, s63, v99
v_add_f32 v12, v11, v12
v_add_f32 v13, v11, v13
v_add_f32 v14, v11, v14
v_add_f32 v15, v11, v15
v_cvt_pk_bf16_f32 v98, v12, v13
v_cvt_pk_bf16_f32 v99, v14, v15
s_waitcnt vmcnt(22)
v_mfma_f32_32x32x16_bf16 v[16:31], a[40:43], a[60:63], 0
v_mfma_f32_32x32x16_bf16 v[32:47], a[44:47], a[60:63], 0
v_mfma_f32_32x32x16_bf16 v[48:63], a[48:51], a[60:63], 0
v_mfma_f32_32x32x16_bf16 v[64:79], a[52:55], a[60:63], 0
v_mfma_f32_32x32x16_bf16 v[80:95], a[56:59], a[60:63], 0
s_waitcnt lgkmcnt(8)
v_mfma_f32_32x32x16_bf16 v[16:31], a[0:3], v[96:99], v[16:31]
ds_read_b64_tr_b16 a[36:37], v7 offset:5376
ds_read_b64_tr_b16 a[38:39], v7 offset:6656
v_lshlrev_b32 v12, 16, v100
v_and_b32 v13, s63, v100
v_lshlrev_b32 v14, 16, v101
v_and_b32 v15, s63, v101
s_add_u32 m0, s48, 61440
s_nop 0
buffer_load_dwordx4 v2, s[36:39], s49 offen lds
v_mfma_f32_32x32x16_bf16 v[32:47], a[4:7], v[96:99], v[32:47]
ds_read_b64_tr_b16 a[0:1], v7 offset:10240
ds_read_b64_tr_b16 a[2:3], v7 offset:11520
v_add_f32 v12, v11, v12
v_add_f32 v13, v11, v13
v_add_f32 v14, v11, v14
v_add_f32 v15, v11, v15
v_mfma_f32_32x32x16_bf16 v[48:63], a[8:11], v[96:99], v[48:63]
ds_read_b64_tr_b16 a[4:5], v7 offset:10304
ds_read_b64_tr_b16 a[6:7], v7 offset:11584
v_cvt_pk_bf16_f32 v100, v12, v13
v_cvt_pk_bf16_f32 v101, v14, v15
v_lshlrev_b32 v12, 16, v102
v_and_b32 v13, s63, v102
s_add_u32 m0, s48, 62464
s_nop 0
buffer_load_dwordx4 v3, s[36:39], s49 offen lds
v_mfma_f32_32x32x16_bf16 v[64:79], a[12:15], v[96:99], v[64:79]
ds_read_b64_tr_b16 a[8:9], v7 offset:10368
ds_read_b64_tr_b16 a[10:11], v7 offset:11648
v_lshlrev_b32 v14, 16, v103
v_and_b32 v15, s63, v103
v_add_f32 v12, v11, v12
v_add_f32 v13, v11, v13
v_mfma_f32_32x32x16_bf16 v[80:95], a[16:19], v[96:99], v[80:95]
ds_read_b64_tr_b16 a[12:13], v7 offset:10432
ds_read_b64_tr_b16 a[14:15], v7 offset:11712
v_add_f32 v14, v11, v14
v_add_f32 v15, v11, v15
v_cvt_pk_bf16_f32 v102, v12, v13
v_cvt_pk_bf16_f32 v103, v14, v15
s_add_u32 m0, s48, 63488
s_nop 0
buffer_load_dwordx4 v4, s[36:39], s49 offen lds
s_waitcnt lgkmcnt(8)
v_mfma_f32_32x32x16_bf16 v[16:31], a[20:23], v[100:103], v[16:31]
ds_read_b64_tr_b16 a[16:17], v7 offset:10496
ds_read_b64_tr_b16 a[18:19], v7 offset:11776
v_lshlrev_b32 v12, 16, v104
v_and_b32 v13, s63, v104
v_lshlrev_b32 v14, 16, v105
v_and_b32 v15, s63, v105
v_mfma_f32_32x32x16_bf16 v[32:47], a[24:27], v[100:103], v[32:47]
ds_read_b64_tr_b16 a[20:21], v7 offset:15360
ds_read_b64_tr_b16 a[22:23], v7 offset:16640
v_add_f32 v12, v11, v12
v_add_f32 v13, v11, v13
v_add_f32 v14, v11, v14
v_add_f32 v15, v11, v15
s_add_u32 m0, s48, 64512
s_nop 0
buffer_load_dwordx4 v5, s[36:39], s49 offen lds
v_mfma_f32_32x32x16_bf16 v[48:63], a[28:31], v[100:103], v[48:63]
ds_read_b64_tr_b16 a[24:25], v7 offset:15424
ds_read_b64_tr_b16 a[26:27], v7 offset:16704
v_cvt_pk_bf16_f32 v104, v12, v13
v_cvt_pk_bf16_f32 v105, v14, v15
v_lshlrev_b32 v12, 16, v106
v_and_b32 v13, s63, v106
v_mfma_f32_32x32x16_bf16 v[64:79], a[32:35], v[100:103], v[64:79]
ds_read_b64_tr_b16 a[28:29], v7 offset:15488
ds_read_b64_tr_b16 a[30:31], v7 offset:16768
v_lshlrev_b32 v14, 16, v107
v_and_b32 v15, s63, v107
v_add_f32 v12, v11, v12
v_add_f32 v13, v11, v13
s_add_u32 m0, s48, 65536
s_nop 0
buffer_load_dwordx4 v6, s[36:39], s49 offen lds
s_add_u32 s49, s49, 221184
s_cmp_eq_u32 s49, s58
s_cselect_b32 s49, s57, s49
v_mfma_f32_32x32x16_bf16 v[80:95], a[36:39], v[100:103], v[80:95]
ds_read_b64_tr_b16 a[32:33], v7 offset:15552
ds_read_b64_tr_b16 a[34:35], v7 offset:16832
v_add_f32 v14, v11, v14
v_add_f32 v15, v11, v15
v_cvt_pk_bf16_f32 v106, v12, v13
v_cvt_pk_bf16_f32 v107, v14, v15
s_waitcnt lgkmcnt(8)
s_nop 0
v_mfma_f32_32x32x16_bf16 v[16:31], a[0:3], v[104:107], v[16:31]
ds_read_b64_tr_b16 a[36:37], v7 offset:15616
ds_read_b64_tr_b16 a[38:39], v7 offset:16896
v_lshlrev_b32 v12, 16, v108
v_and_b32 v13, s63, v108
v_lshlrev_b32 v14, 16, v109
v_and_b32 v15, s63, v109
s_add_u32 m0, s48, 81920
s_nop 0
buffer_load_dwordx4 v2, s[36:39], s49 offen lds
v_mfma_f32_32x32x16_bf16 v[32:47], a[4:7], v[104:107], v[32:47]
s_waitcnt vmcnt(11)
s_barrier
ds_read_b64_tr_b16 a[0:1], v7 offset:20480
ds_read_b64_tr_b16 a[2:3], v7 offset:21760
v_add_f32 v12, v11, v12
v_add_f32 v13, v11, v13
v_add_f32 v14, v11, v14
v_add_f32 v15, v11, v15
v_mfma_f32_32x32x16_bf16 v[48:63], a[8:11], v[104:107], v[48:63]
ds_read_b64_tr_b16 a[4:5], v7 offset:20544
ds_read_b64_tr_b16 a[6:7], v7 offset:21824
v_cvt_pk_bf16_f32 v108, v12, v13
v_cvt_pk_bf16_f32 v109, v14, v15
v_lshlrev_b32 v12, 16, v110
v_and_b32 v13, s63, v110
s_add_u32 m0, s48, 82944
s_nop 0
buffer_load_dwordx4 v3, s[36:39], s49 offen lds
v_mfma_f32_32x32x16_bf16 v[64:79], a[12:15], v[104:107], v[64:79]
ds_read_b64_tr_b16 a[8:9], v7 offset:20608
ds_read_b64_tr_b16 a[10:11], v7 offset:21888
v_lshlrev_b32 v14, 16, v111
v_and_b32 v15, s63, v111
v_add_f32 v12, v11, v12
v_add_f32 v13, v11, v13
v_mfma_f32_32x32x16_bf16 v[80:95], a[16:19], v[104:107], v[80:95]
ds_read_b64_tr_b16 a[12:13], v7 offset:20672
ds_read_b64_tr_b16 a[14:15], v7 offset:21952
v_add_f32 v14, v11, v14
v_add_f32 v15, v11, v15
v_cvt_pk_bf16_f32 v110, v12, v13
v_cvt_pk_bf16_f32 v111, v14, v15
s_add_u32 m0, s48, 83968
s_nop 0
buffer_load_dwordx4 v4, s[36:39], s49 offen lds
s_waitcnt lgkmcnt(8)
v_mfma_f32_32x32x16_bf16 v[16:31], a[20:23], v[108:111], v[16:31]
ds_read_b64_tr_b16 a[16:17], v7 offset:20736
ds_read_b64_tr_b16 a[18:19], v7 offset:22016
v_lshlrev_b32 v12, 16, v112
v_and_b32 v13, s63, v112
v_lshlrev_b32 v14, 16, v113
v_and_b32 v15, s63, v113
v_mfma_f32_32x32x16_bf16 v[32:47], a[24:27], v[108:111], v[32:47]
ds_read_b64_tr_b16 a[20:21], v7 offset:25600
ds_read_b64_tr_b16 a[22:23], v7 offset:26880
v_add_f32 v12, v11, v12
v_add_f32 v13, v11, v13
v_add_f32 v14, v11, v14
v_add_f32 v15, v11, v15
s_add_u32 m0, s48, 84992
s_nop 0
buffer_load_dwordx4 v5, s[36:39], s49 offen lds
v_mfma_f32_32x32x16_bf16 v[48:63], a[28:31], v[108:111], v[48:63]
ds_read_b64_tr_b16 a[24:25], v7 offset:25664
ds_read_b64_tr_b16 a[26:27], v7 offset:26944
v_cvt_pk_bf16_f32 v112, v12, v13
v_cvt_pk_bf16_f32 v113, v14, v15
v_lshlrev_b32 v12, 16, v114
v_and_b32 v13, s63, v114
v_mfma_f32_32x32x16_bf16 v[64:79], a[32:35], v[108:111], v[64:79]
ds_read_b64_tr_b16 a[28:29], v7 offset:25728
ds_read_b64_tr_b16 a[30:31], v7 offset:27008
v_lshlrev_b32 v14, 16, v115
v_and_b32 v15, s63, v115
v_add_f32 v12, v11, v12
v_add_f32 v13, v11, v13
s_add_u32 m0, s48, 86016
s_nop 0
buffer_load_dwordx4 v6, s[36:39], s49 offen lds
s_add_u32 s49, s49, 221184
s_cmp_eq_u32 s49, s58
s_cselect_b32 s49, s57, s49
v_mfma_f32_32x32x16_bf16 v[80:95], a[36:39], v[108:111], v[80:95]
ds_read_b64_tr_b16 a[32:33], v7 offset:25792
ds_read_b64_tr_b16 a[34:35], v7 offset:27072
v_add_f32 v14, v11, v14
v_add_f32 v15, v11, v15
v_cvt_pk_bf16_f32 v114, v12, v13
v_cvt_pk_bf16_f32 v115, v14, v15
s_waitcnt lgkmcnt(8)
s_nop 0
v_mfma_f32_32x32x16_bf16 v[16:31], a[0:3], v[112:115], v[16:31]
ds_read_b64_tr_b16 a[36:37], v7 offset:25856
ds_read_b64_tr_b16 a[38:39], v7 offset:27136
v_lshlrev_b32 v12, 16, v116
v_and_b32 v13, s63, v116
v_lshlrev_b32 v14, 16, v117
v_and_b32 v15, s63, v117
s_add_u32 m0, s48, 102400
s_nop 0
buffer_load_dwordx4 v2, s[36:39], s49 offen lds
v_mfma_f32_32x32x16_bf16 v[32:47], a[4:7], v[112:115], v[32:47]
ds_read_b64_tr_b16 a[0:1], v7 offset:30720
ds_read_b64_tr_b16 a[2:3], v7 offset:32000
v_add_f32 v12, v11, v12
v_add_f32 v13, v11, v13
v_add_f32 v14, v11, v14
v_add_f32 v15, v11, v15
v_mfma_f32_32x32x16_bf16 v[48:63], a[8:11], v[112:115], v[48:63]
ds_read_b64_tr_b16 a[4:5], v7 offset:30784
ds_read_b64_tr_b16 a[6:7], v7 offset:32064
v_cvt_pk_bf16_f32 v116, v12, v13
v_cvt_pk_bf16_f32 v117, v14, v15
v_lshlrev_b32 v12, 16, v118
v_and_b32 v13, s63, v118
s_add_u32 m0, s48, 103424
s_nop 0
buffer_load_dwordx4 v3, s[36:39], s49 offen lds
v_mfma_f32_32x32x16_bf16 v[64:79], a[12:15], v[112:115], v[64:79]
ds_read_b64_tr_b16 a[8:9], v7 offset:30848
ds_read_b64_tr_b16 a[10:11], v7 offset:32128
v_lshlrev_b32 v14, 16, v119
v_and_b32 v15, s63, v119
v_add_f32 v12, v11, v12
v_add_f32 v13, v11, v13
v_mfma_f32_32x32x16_bf16 v[80:95], a[16:19], v[112:115], v[80:95]
ds_read_b64_tr_b16 a[12:13], v7 offset:30912
ds_read_b64_tr_b16 a[14:15], v7 offset:32192
v_add_f32 v14, v11, v14
v_add_f32 v15, v11, v15
v_cvt_pk_bf16_f32 v118, v12, v13
v_cvt_pk_bf16_f32 v119, v14, v15
s_add_u32 m0, s48, 104448
s_nop 0
buffer_load_dwordx4 v4, s[36:39], s49 offen lds
s_waitcnt lgkmcnt(8)
v_mfma_f32_32x32x16_bf16 v[16:31], a[20:23], v[116:119], v[16:31]
ds_read_b64_tr_b16 a[16:17], v7 offset:30976
ds_read_b64_tr_b16 a[18:19], v7 offset:32256
v_lshlrev_b32 v12, 16, v120
v_and_b32 v13, s63, v120
v_lshlrev_b32 v14, 16, v121
v_and_b32 v15, s63, v121
v_mfma_f32_32x32x16_bf16 v[32:47], a[24:27], v[116:119], v[32:47]
ds_read_b64_tr_b16 a[20:21], v7 offset:35840
ds_read_b64_tr_b16 a[22:23], v7 offset:37120
v_add_f32 v12, v11, v12
v_add_f32 v13, v11, v13
v_add_f32 v14, v11, v14
v_add_f32 v15, v11, v15
s_add_u32 m0, s48, 105472
s_nop 0
buffer_load_dwordx4 v5, s[36:39], s49 offen lds
v_mfma_f32_32x32x16_bf16 v[48:63], a[28:31], v[116:119], v[48:63]
ds_read_b64_tr_b16 a[24:25], v7 offset:35904
ds_read_b64_tr_b16 a[26:27], v7 offset:37184
v_cvt_pk_bf16_f32 v120, v12, v13
v_cvt_pk_bf16_f32 v121, v14, v15
v_lshlrev_b32 v12, 16, v122
v_and_b32 v13, s63, v122
v_mfma_f32_32x32x16_bf16 v[64:79], a[32:35], v[116:119], v[64:79]
ds_read_b64_tr_b16 a[28:29], v7 offset:35968
ds_read_b64_tr_b16 a[30:31], v7 offset:37248
v_lshlrev_b32 v14, 16, v123
v_and_b32 v15, s63, v123
v_add_f32 v12, v11, v12
v_add_f32 v13, v11, v13
s_add_u32 m0, s48, 106496
s_nop 0
buffer_load_dwordx4 v6, s[36:39], s49 offen lds
s_add_u32 s49, s49, 221184
s_cmp_eq_u32 s49, s58
s_cselect_b32 s49, s57, s49
v_mfma_f32_32x32x16_bf16 v[80:95], a[36:39], v[116:119], v[80:95]
ds_read_b64_tr_b16 a[32:33], v7 offset:36032
ds_read_b64_tr_b16 a[34:35], v7 offset:37312
v_add_f32 v14, v11, v14
v_add_f32 v15, v11, v15
v_cvt_pk_bf16_f32 v122, v12, v13
v_cvt_pk_bf16_f32 v123, v14, v15
s_waitcnt lgkmcnt(8)
s_nop 0
v_mfma_f32_32x32x16_bf16 v[16:31], a[0:3], v[120:123], v[16:31]
ds_read_b64_tr_b16 a[36:37], v7 offset:36096
ds_read_b64_tr_b16 a[38:39], v7 offset:37376
v_lshlrev_b32 v12, 16, v124
v_and_b32 v13, s63, v124
v_lshlrev_b32 v14, 16, v125
v_and_b32 v15, s63, v125
s_add_u32 m0, s48, 122880
s_nop 0
buffer_load_dwordx4 v2, s[36:39], s49 offen lds
v_mfma_f32_32x32x16_bf16 v[32:47], a[4:7], v[120:123], v[32:47]
s_waitcnt vmcnt(16)
s_barrier
ds_read_b64_tr_b16 a[0:1], v7 offset:40960
ds_read_b64_tr_b16 a[2:3], v7 offset:42240
v_add_f32 v12, v11, v12
v_add_f32 v13, v11, v13
v_add_f32 v14, v11, v14
v_add_f32 v15, v11, v15
v_mfma_f32_32x32x16_bf16 v[48:63], a[8:11], v[120:123], v[48:63]
ds_read_b64_tr_b16 a[4:5], v7 offset:41024
ds_read_b64_tr_b16 a[6:7], v7 offset:42304
v_cvt_pk_bf16_f32 v124, v12, v13
v_cvt_pk_bf16_f32 v125, v14, v15
v_lshlrev_b32 v12, 16, v126
v_and_b32 v13, s63, v126
s_add_u32 m0, s48, 123904
s_nop 0
buffer_load_dwordx4 v3, s[36:39], s49 offen lds
v_mfma_f32_32x32x16_bf16 v[64:79], a[12:15], v[120:123], v[64:79]
ds_read_b64_tr_b16 a[8:9], v7 offset:41088
ds_read_b64_tr_b16 a[10:11], v7 offset:42368
v_lshlrev_b32 v14, 16, v127
v_and_b32 v15, s63, v127
v_add_f32 v12, v11, v12
v_add_f32 v13, v11, v13
v_mfma_f32_32x32x16_bf16 v[80:95], a[16:19], v[120:123], v[80:95]
ds_read_b64_tr_b16 a[12:13], v7 offset:41152
ds_read_b64_tr_b16 a[14:15], v7 offset:42432
v_add_f32 v14, v11, v14
v_add_f32 v15, v11, v15
v_cvt_pk_bf16_f32 v126, v12, v13
v_cvt_pk_bf16_f32 v127, v14, v15
s_add_u32 m0, s48, 124928
s_nop 0
buffer_load_dwordx4 v4, s[36:39], s49 offen lds
s_waitcnt lgkmcnt(8)
v_mfma_f32_32x32x16_bf16 v[16:31], a[20:23], v[124:127], v[16:31]
ds_read_b64_tr_b16 a[16:17], v7 offset:41216
ds_read_b64_tr_b16 a[18:19], v7 offset:42496
v_lshlrev_b32 v12, 16, v128
v_and_b32 v13, s63, v128
v_lshlrev_b32 v14, 16, v129
v_and_b32 v15, s63, v129
v_mfma_f32_32x32x16_bf16 v[32:47], a[24:27], v[124:127], v[32:47]
ds_read_b64_tr_b16 a[20:21], v7 offset:46080
ds_read_b64_tr_b16 a[22:23], v7 offset:47360
v_add_f32 v12, v11, v12
v_add_f32 v13, v11, v13
v_add_f32 v14, v11, v14
v_add_f32 v15, v11, v15
s_add_u32 m0, s48, 125952
s_nop 0
buffer_load_dwordx4 v5, s[36:39], s49 offen lds
v_mfma_f32_32x32x16_bf16 v[48:63], a[28:31], v[124:127], v[48:63]
ds_read_b64_tr_b16 a[24:25], v7 offset:46144
ds_read_b64_tr_b16 a[26:27], v7 offset:47424
v_cvt_pk_bf16_f32 v128, v12, v13
v_cvt_pk_bf16_f32 v129, v14, v15
v_lshlrev_b32 v12, 16, v130
v_and_b32 v13, s63, v130
v_mfma_f32_32x32x16_bf16 v[64:79], a[32:35], v[124:127], v[64:79]
ds_read_b64_tr_b16 a[28:29], v7 offset:46208
ds_read_b64_tr_b16 a[30:31], v7 offset:47488
v_lshlrev_b32 v14, 16, v131
v_and_b32 v15, s63, v131
v_add_f32 v12, v11, v12
v_add_f32 v13, v11, v13
s_add_u32 m0, s48, 126976
s_nop 0
buffer_load_dwordx4 v6, s[36:39], s49 offen lds
s_add_u32 s49, s49, 221184
s_cmp_eq_u32 s49, s58
s_cselect_b32 s49, s57, s49
v_mfma_f32_32x32x16_bf16 v[80:95], a[36:39], v[124:127], v[80:95]
ds_read_b64_tr_b16 a[32:33], v7 offset:46272
ds_read_b64_tr_b16 a[34:35], v7 offset:47552
v_add_f32 v14, v11, v14
v_add_f32 v15, v11, v15
v_cvt_pk_bf16_f32 v130, v12, v13
v_cvt_pk_bf16_f32 v131, v14, v15
s_waitcnt lgkmcnt(8)
s_nop 0
v_mfma_f32_32x32x16_bf16 v[16:31], a[0:3], v[128:131], v[16:31]
ds_read_b64_tr_b16 a[36:37], v7 offset:46336
ds_read_b64_tr_b16 a[38:39], v7 offset:47616
v_lshlrev_b32 v12, 16, v132
v_and_b32 v13, s63, v132
v_lshlrev_b32 v14, 16, v133
v_and_b32 v15, s63, v133
s_add_u32 m0, s48, 143360
s_nop 0
buffer_load_dwordx4 v2, s[36:39], s49 offen lds
v_mfma_f32_32x32x16_bf16 v[32:47], a[4:7], v[128:131], v[32:47]
ds_read_b64_tr_b16 a[0:1], v7 offset:51200
ds_read_b64_tr_b16 a[2:3], v7 offset:52480
v_add_f32 v12, v11, v12
v_add_f32 v13, v11, v13
v_add_f32 v14, v11, v14
v_add_f32 v15, v11, v15
s_add_u32 m0, s48, 144384
s_nop 0
buffer_load_dwordx4 v3, s[36:39], s49 offen lds
v_mfma_f32_32x32x16_bf16 v[48:63], a[8:11], v[128:131], v[48:63]
ds_read_b64_tr_b16 a[4:5], v7 offset:51264
ds_read_b64_tr_b16 a[6:7], v7 offset:52544
v_cvt_pk_bf16_f32 v132, v12, v13
v_cvt_pk_bf16_f32 v133, v14, v15
v_lshlrev_b32 v12, 16, v134
v_and_b32 v13, s63, v134
s_add_u32 m0, s48, 145408
s_nop 0
buffer_load_dwordx4 v4, s[36:39], s49 offen lds
v_mfma_f32_32x32x16_bf16 v[64:79], a[12:15], v[128:131], v[64:79]
ds_read_b64_tr_b16 a[8:9], v7 offset:51328
ds_read_b64_tr_b16 a[10:11], v7 offset:52608
v_lshlrev_b32 v14, 16, v135
v_and_b32 v15, s63, v135
v_add_f32 v12, v11, v12
v_add_f32 v13, v11, v13
s_add_u32 m0, s48, 146432
s_nop 0
buffer_load_dwordx4 v5, s[36:39], s49 offen lds
v_mfma_f32_32x32x16_bf16 v[80:95], a[16:19], v[128:131], v[80:95]
ds_read_b64_tr_b16 a[12:13], v7 offset:51392
ds_read_b64_tr_b16 a[14:15], v7 offset:52672
v_add_f32 v14, v11, v14
v_add_f32 v15, v11, v15
v_cvt_pk_bf16_f32 v134, v12, v13
v_cvt_pk_bf16_f32 v135, v14, v15
s_add_u32 m0, s48, 147456
s_nop 0
buffer_load_dwordx4 v6, s[36:39], s49 offen lds
s_add_u32 s49, s49, 221184
s_cmp_eq_u32 s49, s58
s_cselect_b32 s49, s57, s49
s_waitcnt lgkmcnt(8)
v_mfma_f32_32x32x16_bf16 v[16:31], a[20:23], v[132:135], v[16:31]
ds_read_b64_tr_b16 a[16:17], v7 offset:51456
ds_read_b64_tr_b16 a[18:19], v7 offset:52736
v_lshlrev_b32 v12, 16, v136
v_and_b32 v13, s63, v136
v_lshlrev_b32 v14, 16, v137
v_and_b32 v15, s63, v137
s_add_u32 m0, s48, 0
s_nop 0
buffer_load_dwordx4 v2, s[36:39], s49 offen lds
v_mfma_f32_32x32x16_bf16 v[32:47], a[24:27], v[132:135], v[32:47]
ds_read_b64_tr_b16 a[20:21], v7 offset:56320
ds_read_b64_tr_b16 a[22:23], v7 offset:57600
v_add_f32 v12, v11, v12
v_add_f32 v13, v11, v13
v_add_f32 v14, v11, v14
v_add_f32 v15, v11, v15
s_add_u32 m0, s48, 1024
s_nop 0
buffer_load_dwordx4 v3, s[36:39], s49 offen lds
v_mfma_f32_32x32x16_bf16 v[48:63], a[28:31], v[132:135], v[48:63]
ds_read_b64_tr_b16 a[24:25], v7 offset:56384
ds_read_b64_tr_b16 a[26:27], v7 offset:57664
v_cvt_pk_bf16_f32 v136, v12, v13
v_cvt_pk_bf16_f32 v137, v14, v15
v_lshlrev_b32 v12, 16, v138
v_and_b32 v13, s63, v138
s_add_u32 m0, s48, 2048
s_nop 0
buffer_load_dwordx4 v4, s[36:39], s49 offen lds
v_mfma_f32_32x32x16_bf16 v[64:79], a[32:35], v[132:135], v[64:79]
ds_read_b64_tr_b16 a[28:29], v7 offset:56448
ds_read_b64_tr_b16 a[30:31], v7 offset:57728
v_lshlrev_b32 v14, 16, v139
v_and_b32 v15, s63, v139
v_add_f32 v12, v11, v12
v_add_f32 v13, v11, v13
s_add_u32 m0, s48, 3072
s_nop 0
buffer_load_dwordx4 v5, s[36:39], s49 offen lds
v_mfma_f32_32x32x16_bf16 v[80:95], a[36:39], v[132:135], v[80:95]
ds_read_b64_tr_b16 a[32:33], v7 offset:56512
ds_read_b64_tr_b16 a[34:35], v7 offset:57792
v_add_f32 v14, v11, v14
v_add_f32 v15, v11, v15
v_cvt_pk_bf16_f32 v138, v12, v13
v_cvt_pk_bf16_f32 v139, v14, v15
s_add_u32 m0, s48, 4096
s_nop 0
buffer_load_dwordx4 v6, s[36:39], s49 offen lds
s_add_u32 s49, s49, 221184
s_cmp_eq_u32 s49, s58
s_cselect_b32 s49, s57, s49
s_waitcnt lgkmcnt(8)
v_mfma_f32_32x32x16_bf16 v[16:31], a[0:3], v[136:139], v[16:31]
ds_read_b64_tr_b16 a[36:37], v7 offset:56576
ds_read_b64_tr_b16 a[38:39], v7 offset:57856
v_lshlrev_b32 v12, 16, v140
v_and_b32 v13, s63, v140
v_lshlrev_b32 v14, 16, v141
v_and_b32 v15, s63, v141
v_mfma_f32_32x32x16_bf16 v[32:47], a[4:7], v[136:139], v[32:47]
s_waitcnt vmcnt(25)
s_barrier
ds_read_b64_tr_b16 a[0:1], v8 offset:0
ds_read_b64_tr_b16 a[2:3], v8 offset:1280
v_add_f32 v12, v11, v12
v_add_f32 v13, v11, v13
v_add_f32 v14, v11, v14
v_add_f32 v15, v11, v15
s_add_u32 m0, s48, 20480
s_nop 0
buffer_load_dwordx4 v2, s[36:39], s49 offen lds
v_mfma_f32_32x32x16_bf16 v[48:63], a[8:11], v[136:139], v[48:63]
ds_read_b64_tr_b16 a[4:5], v8 offset:64
ds_read_b64_tr_b16 a[6:7], v8 offset:1344
v_cvt_pk_bf16_f32 v140, v12, v13
v_cvt_pk_bf16_f32 v141, v14, v15
v_lshlrev_b32 v12, 16, v142
v_and_b32 v13, s63, v142
s_add_u32 m0, s48, 21504
s_nop 0
buffer_load_dwordx4 v3, s[36:39], s49 offen lds
v_mfma_f32_32x32x16_bf16 v[64:79], a[12:15], v[136:139], v[64:79]
ds_read_b64_tr_b16 a[8:9], v8 offset:128
ds_read_b64_tr_b16 a[10:11], v8 offset:1408
v_lshlrev_b32 v14, 16, v143
v_and_b32 v15, s63, v143
v_add_f32 v12, v11, v12
v_add_f32 v13, v11, v13
s_add_u32 m0, s48, 22528
s_nop 0
buffer_load_dwordx4 v4, s[36:39], s49 offen lds
v_mfma_f32_32x32x16_bf16 v[80:95], a[16:19], v[136:139], v[80:95]
ds_read_b64_tr_b16 a[12:13], v8 offset:192
ds_read_b64_tr_b16 a[14:15], v8 offset:1472
v_add_f32 v14, v11, v14
v_add_f32 v15, v11, v15
v_cvt_pk_bf16_f32 v142, v12, v13
v_cvt_pk_bf16_f32 v143, v14, v15
s_add_u32 m0, s48, 23552
s_nop 0
buffer_load_dwordx4 v5, s[36:39], s49 offen lds
s_waitcnt lgkmcnt(8)
v_mfma_f32_32x32x16_bf16 v[16:31], a[20:23], v[140:143], v[16:31]
ds_read_b64_tr_b16 a[16:17], v8 offset:256
ds_read_b64_tr_b16 a[18:19], v8 offset:1536
v_lshlrev_b32 v12, 16, v144
v_and_b32 v13, s63, v144
v_lshlrev_b32 v14, 16, v145
v_and_b32 v15, s63, v145
s_add_u32 m0, s48, 24576
s_nop 0
buffer_load_dwordx4 v6, s[36:39], s49 offen lds
s_add_u32 s49, s49, 221184
s_cmp_eq_u32 s49, s58
s_cselect_b32 s49, s57, s49
v_accvgpr_read_b32 v2, a80
v_accvgpr_read_b32 v3, a82
v_lshlrev_b32 v6, 4, v0
s_mul_i32 s59, s30, 108
s_lshr_b32 s49, s31, 4
s_add_u32 s59, s59, s49
s_lshl_b32 s59, s59, 10
s_mov_b32 s32, s20
s_mov_b32 s33, s21
s_mov_b32 s34, 2211840
s_mov_b32 s35, 0x20000
s_getpc_b64 s[36:37]
s_add_u32 s36, s36, TABG@rel32@lo+4
s_addc_u32 s37, s37, TABG@rel32@hi+12
s_mov_b32 s38, 884736
s_mov_b32 s39, 0x20000
s_getpc_b64 s[44:45]
s_add_u32 s44, s44, p2_kernel@rel32@lo+4
s_addc_u32 s45, s45, p2_kernel@rel32@hi+12
s_mov_b32 s46, END_p2_kernel-p2_kernel
s_mov_b32 s47, 0x20000
v_mfma_f32_32x32x16_bf16 v[32:47], a[24:27], v[140:143], v[32:47]
ds_read_b64_tr_b16 a[20:21], v8 offset:5120
ds_read_b64_tr_b16 a[22:23], v8 offset:6400
v_add_f32 v12, v11, v12
v_add_f32 v13, v11, v13
v_add_f32 v14, v11, v14
v_add_f32 v15, v11, v15
s_mov_b32 s48, 0
buffer_load_dwordx2 a[64:65], v2, s[64:67], s48 offen
v_mfma_f32_32x32x16_bf16 v[48:63], a[28:31], v[140:143], v[48:63]
ds_read_b64_tr_b16 a[24:25], v8 offset:5184
ds_read_b64_tr_b16 a[26:27], v8 offset:6464
v_cvt_pk_bf16_f32 v144, v12, v13
v_cvt_pk_bf16_f32 v145, v14, v15
v_lshlrev_b32 v12, 16, v146
v_and_b32 v13, s63, v146
v_mfma_f32_32x32x16_bf16 v[64:79], a[32:35], v[140:143], v[64:79]
ds_read_b64_tr_b16 a[28:29], v8 offset:5248
ds_read_b64_tr_b16 a[30:31], v8 offset:6528
v_lshlrev_b32 v14, 16, v147
v_and_b32 v15, s63, v147
v_add_f32 v12, v11, v12
v_add_f32 v13, v11, v13
v_mfma_f32_32x32x16_bf16 v[80:95], a[36:39], v[140:143], v[80:95]
ds_read_b64_tr_b16 a[32:33], v8 offset:5312
ds_read_b64_tr_b16 a[34:35], v8 offset:6592
v_add_f32 v14, v11, v14
v_add_f32 v15, v11, v15
v_cvt_pk_bf16_f32 v146, v12, v13
v_cvt_pk_bf16_f32 v147, v14, v15
s_waitcnt lgkmcnt(8)
s_nop 0
v_mfma_f32_32x32x16_bf16 v[16:31], a[0:3], v[144:147], v[16:31]
ds_read_b64_tr_b16 a[36:37], v8 offset:5376
ds_read_b64_tr_b16 a[38:39], v8 offset:6656
v_lshlrev_b32 v12, 16, v148
v_and_b32 v13, s63, v148
v_lshlrev_b32 v14, 16, v149
v_and_b32 v15, s63, v149
v_mfma_f32_32x32x16_bf16 v[32:47], a[4:7], v[144:147], v[32:47]
ds_read_b64_tr_b16 a[0:1], v8 offset:10240
ds_read_b64_tr_b16 a[2:3], v8 offset:11520
v_add_f32 v12, v11, v12
v_add_f32 v13, v11, v13
v_add_f32 v14, v11, v14
v_add_f32 v15, v11, v15
v_mfma_f32_32x32x16_bf16 v[48:63], a[8:11], v[144:147], v[48:63]
ds_read_b64_tr_b16 a[4:5], v8 offset:10304
ds_read_b64_tr_b16 a[6:7], v8 offset:11584
v_cvt_pk_bf16_f32 v148, v12, v13
v_cvt_pk_bf16_f32 v149, v14, v15
v_lshlrev_b32 v12, 16, v150
v_and_b32 v13, s63, v150
v_mfma_f32_32x32x16_bf16 v[64:79], a[12:15], v[144:147], v[64:79]
ds_read_b64_tr_b16 a[8:9], v8 offset:10368
ds_read_b64_tr_b16 a[10:11], v8 offset:11648
v_lshlrev_b32 v14, 16, v151
v_and_b32 v15, s63, v151
v_add_f32 v12, v11, v12
v_add_f32 v13, v11, v13
v_mfma_f32_32x32x16_bf16 v[80:95], a[16:19], v[144:147], v[80:95]
ds_read_b64_tr_b16 a[12:13], v8 offset:10432
ds_read_b64_tr_b16 a[14:15], v8 offset:11712
v_add_f32 v14, v11, v14
v_add_f32 v15, v11, v15
v_cvt_pk_bf16_f32 v150, v12, v13
v_cvt_pk_bf16_f32 v151, v14, v15
buffer_load_dwordx2 a[66:67], v2, s[84:87], s48 offen
s_waitcnt lgkmcnt(8)
v_mfma_f32_32x32x16_bf16 v[16:31], a[20:23], v[148:151], v[16:31]
ds_read_b64_tr_b16 a[16:17], v8 offset:10496
ds_read_b64_tr_b16 a[18:19], v8 offset:11776
v_lshlrev_b32 v12, 16, v152
v_and_b32 v13, s63, v152
v_lshlrev_b32 v14, 16, v153
v_and_b32 v15, s63, v153
v_mfma_f32_32x32x16_bf16 v[32:47], a[24:27], v[148:151], v[32:47]
ds_read_b64_tr_b16 a[20:21], v8 offset:15360
ds_read_b64_tr_b16 a[22:23], v8 offset:16640
v_add_f32 v12, v11, v12
v_add_f32 v13, v11, v13
v_add_f32 v14, v11, v14
v_add_f32 v15, v11, v15
v_mfma_f32_32x32x16_bf16 v[48:63], a[28:31], v[148:151], v[48:63]
ds_read_b64_tr_b16 a[24:25], v8 offset:15424
ds_read_b64_tr_b16 a[26:27], v8 offset:16704
v_cvt_pk_bf16_f32 v152, v12, v13
v_cvt_pk_bf16_f32 v153, v14, v15
v_lshlrev_b32 v12, 16, v154
v_and_b32 v13, s63, v154
v_mfma_f32_32x32x16_bf16 v[64:79], a[32:35], v[148:151], v[64:79]
ds_read_b64_tr_b16 a[28:29], v8 offset:15488
ds_read_b64_tr_b16 a[30:31], v8 offset:16768
v_lshlrev_b32 v14, 16, v155
v_and_b32 v15, s63, v155
v_add_f32 v12, v11, v12
v_add_f32 v13, v11, v13
v_mfma_f32_32x32x16_bf16 v[80:95], a[36:39], v[148:151], v[80:95]
ds_read_b64_tr_b16 a[32:33], v8 offset:15552
ds_read_b64_tr_b16 a[34:35], v8 offset:16832
v_add_f32 v14, v11, v14
v_add_f32 v15, v11, v15
v_cvt_pk_bf16_f32 v154, v12, v13
v_cvt_pk_bf16_f32 v155, v14, v15
s_waitcnt lgkmcnt(8)
s_nop 0
v_mfma_f32_32x32x16_bf16 v[16:31], a[0:3], v[152:155], v[16:31]
ds_read_b64_tr_b16 a[36:37], v8 offset:15616
ds_read_b64_tr_b16 a[38:39], v8 offset:16896
v_lshlrev_b32 v12, 16, v156
v_and_b32 v13, s63, v156
v_lshlrev_b32 v14, 16, v157
v_and_b32 v15, s63, v157
v_mfma_f32_32x32x16_bf16 v[32:47], a[4:7], v[152:155], v[32:47]
s_waitcnt vmcnt(27)
s_barrier
ds_read_b64_tr_b16 a[0:1], v8 offset:20480
ds_read_b64_tr_b16 a[2:3], v8 offset:21760
v_add_f32 v12, v11, v12
v_add_f32 v13, v11, v13
v_add_f32 v14, v11, v14
v_add_f32 v15, v11, v15
v_mfma_f32_32x32x16_bf16 v[48:63], a[8:11], v[152:155], v[48:63]
ds_read_b64_tr_b16 a[4:5], v8 offset:20544
ds_read_b64_tr_b16 a[6:7], v8 offset:21824
v_cvt_pk_bf16_f32 v156, v12, v13
v_cvt_pk_bf16_f32 v157, v14, v15
v_lshlrev_b32 v12, 16, v158
v_and_b32 v13, s63, v158
s_mov_b32 s48, 20544
buffer_load_dwordx2 a[68:69], v2, s[64:67], s48 offen
v_mfma_f32_32x32x16_bf16 v[64:79], a[12:15], v[152:155], v[64:79]
ds_read_b64_tr_b16 a[8:9], v8 offset:20608
ds_read_b64_tr_b16 a[10:11], v8 offset:21888
v_lshlrev_b32 v14, 16, v159
v_and_b32 v15, s63, v159
v_add_f32 v12, v11, v12
v_add_f32 v13, v11, v13
v_mfma_f32_32x32x16_bf16 v[80:95], a[16:19], v[152:155], v[80:95]
ds_read_b64_tr_b16 a[12:13], v8 offset:20672
ds_read_b64_tr_b16 a[14:15], v8 offset:21952
v_add_f32 v14, v11, v14
v_add_f32 v15, v11, v15
v_cvt_pk_bf16_f32 v158, v12, v13
v_cvt_pk_bf16_f32 v159, v14, v15
s_waitcnt lgkmcnt(8)
s_nop 0
v_mfma_f32_32x32x16_bf16 v[16:31], a[20:23], v[156:159], v[16:31]
ds_read_b64_tr_b16 a[16:17], v8 offset:20736
ds_read_b64_tr_b16 a[18:19], v8 offset:22016
v_lshlrev_b32 v12, 16, v160
v_and_b32 v13, s63, v160
v_lshlrev_b32 v14, 16, v161
v_and_b32 v15, s63, v161
v_mfma_f32_32x32x16_bf16 v[32:47], a[24:27], v[156:159], v[32:47]
ds_read_b64_tr_b16 a[20:21], v8 offset:25600
ds_read_b64_tr_b16 a[22:23], v8 offset:26880
v_add_f32 v12, v11, v12
v_add_f32 v13, v11, v13
v_add_f32 v14, v11, v14
v_add_f32 v15, v11, v15
v_mfma_f32_32x32x16_bf16 v[48:63], a[28:31], v[156:159], v[48:63]
ds_read_b64_tr_b16 a[24:25], v8 offset:25664
ds_read_b64_tr_b16 a[26:27], v8 offset:26944
v_cvt_pk_bf16_f32 v160, v12, v13
v_cvt_pk_bf16_f32 v161, v14, v15
v_lshlrev_b32 v12, 16, v162
v_and_b32 v13, s63, v162
v_mfma_f32_32x32x16_bf16 v[64:79], a[32:35], v[156:159], v[64:79]
ds_read_b64_tr_b16 a[28:29], v8 offset:25728
ds_read_b64_tr_b16 a[30:31], v8 offset:27008
v_lshlrev_b32 v14, 16, v163
v_and_b32 v15, s63, v163
v_add_f32 v12, v11, v12
v_add_f32 v13, v11, v13
v_mfma_f32_32x32x16_bf16 v[80:95], a[36:39], v[156:159], v[80:95]
ds_read_b64_tr_b16 a[32:33], v8 offset:25792
ds_read_b64_tr_b16 a[34:35], v8 offset:27072
v_add_f32 v14, v11, v14
v_add_f32 v15, v11, v15
v_cvt_pk_bf16_f32 v162, v12, v13
v_cvt_pk_bf16_f32 v163, v14, v15
s_waitcnt lgkmcnt(8)
s_nop 0
v_mfma_f32_32x32x16_bf16 v[16:31], a[0:3], v[160:163], v[16:31]
ds_read_b64_tr_b16 a[36:37], v8 offset:25856
ds_read_b64_tr_b16 a[38:39], v8 offset:27136
v_lshlrev_b32 v12, 16, v164
v_and_b32 v13, s63, v164
v_lshlrev_b32 v14, 16, v165
v_and_b32 v15, s63, v165
buffer_load_dwordx2 a[70:71], v2, s[84:87], s48 offen
v_mfma_f32_32x32x16_bf16 v[32:47], a[4:7], v[160:163], v[32:47]
ds_read_b64_tr_b16 a[0:1], v8 offset:30720
ds_read_b64_tr_b16 a[2:3], v8 offset:32000
v_add_f32 v12, v11, v12
v_add_f32 v13, v11, v13
v_add_f32 v14, v11, v14
v_add_f32 v15, v11, v15
v_mfma_f32_32x32x16_bf16 v[48:63], a[8:11], v[160:163], v[48:63]
ds_read_b64_tr_b16 a[4:5], v8 offset:30784
ds_read_b64_tr_b16 a[6:7], v8 offset:32064
v_cvt_pk_bf16_f32 v164, v12, v13
v_cvt_pk_bf16_f32 v165, v14, v15
v_lshlrev_b32 v12, 16, v166
v_and_b32 v13, s63, v166
v_mfma_f32_32x32x16_bf16 v[64:79], a[12:15], v[160:163], v[64:79]
ds_read_b64_tr_b16 a[8:9], v8 offset:30848
ds_read_b64_tr_b16 a[10:11], v8 offset:32128
v_lshlrev_b32 v14, 16, v167
v_and_b32 v15, s63, v167
v_add_f32 v12, v11, v12
v_add_f32 v13, v11, v13
v_mfma_f32_32x32x16_bf16 v[80:95], a[16:19], v[160:163], v[80:95]
ds_read_b64_tr_b16 a[12:13], v8 offset:30912
ds_read_b64_tr_b16 a[14:15], v8 offset:32192
v_add_f32 v14, v11, v14
v_add_f32 v15, v11, v15
v_cvt_pk_bf16_f32 v166, v12, v13
v_cvt_pk_bf16_f32 v167, v14, v15
s_waitcnt lgkmcnt(8)
s_nop 0
v_mfma_f32_32x32x16_bf16 v[16:31], a[20:23], v[164:167], v[16:31]
ds_read_b64_tr_b16 a[16:17], v8 offset:30976
ds_read_b64_tr_b16 a[18:19], v8 offset:32256
v_lshlrev_b32 v12, 16, v168
v_and_b32 v13, s63, v168
v_lshlrev_b32 v14, 16, v169
v_and_b32 v15, s63, v169
v_mfma_f32_32x32x16_bf16 v[32:47], a[24:27], v[164:167], v[32:47]
ds_read_b64_tr_b16 a[20:21], v8 offset:35840
ds_read_b64_tr_b16 a[22:23], v8 offset:37120
v_add_f32 v12, v11, v12
v_add_f32 v13, v11, v13
v_add_f32 v14, v11, v14
v_add_f32 v15, v11, v15
v_mfma_f32_32x32x16_bf16 v[48:63], a[28:31], v[164:167], v[48:63]
ds_read_b64_tr_b16 a[24:25], v8 offset:35904
ds_read_b64_tr_b16 a[26:27], v8 offset:37184
v_cvt_pk_bf16_f32 v168, v12, v13
v_cvt_pk_bf16_f32 v169, v14, v15
v_lshlrev_b32 v12, 16, v170
v_and_b32 v13, s63, v170
v_mfma_f32_32x32x16_bf16 v[64:79], a[32:35], v[164:167], v[64:79]
ds_read_b64_tr_b16 a[28:29], v8 offset:35968
ds_read_b64_tr_b16 a[30:31], v8 offset:37248
v_lshlrev_b32 v14, 16, v171
v_and_b32 v15, s63, v171
v_add_f32 v12, v11, v12
v_add_f32 v13, v11, v13
s_mov_b32 s48, 41088
buffer_load_dwordx2 a[72:73], v2, s[64:67], s48 offen
v_mfma_f32_32x32x16_bf16 v[80:95], a[36:39], v[164:167], v[80:95]
ds_read_b64_tr_b16 a[32:33], v8 offset:36032
ds_read_b64_tr_b16 a[34:35], v8 offset:37312
v_add_f32 v14, v11, v14
v_add_f32 v15, v11, v15
v_cvt_pk_bf16_f32 v170, v12, v13
v_cvt_pk_bf16_f32 v171, v14, v15
s_waitcnt lgkmcnt(8)
s_nop 0
v_mfma_f32_32x32x16_bf16 v[16:31], a[0:3], v[168:171], v[16:31]
ds_read_b64_tr_b16 a[36:37], v8 offset:36096
ds_read_b64_tr_b16 a[38:39], v8 offset:37376
v_lshlrev_b32 v12, 16, v172
v_and_b32 v13, s63, v172
v_lshlrev_b32 v14, 16, v173
v_and_b32 v15, s63, v173
v_mfma_f32_32x32x16_bf16 v[32:47], a[4:7], v[168:171], v[32:47]
s_waitcnt vmcnt(25)
s_barrier
ds_read_b64_tr_b16 a[0:1], v8 offset:40960
ds_read_b64_tr_b16 a[2:3], v8 offset:42240
v_add_f32 v12, v11, v12
v_add_f32 v13, v11, v13
v_add_f32 v14, v11, v14
v_add_f32 v15, v11, v15
v_mfma_f32_32x32x16_bf16 v[48:63], a[8:11], v[168:171], v[48:63]
ds_read_b64_tr_b16 a[4:5], v8 offset:41024
ds_read_b64_tr_b16 a[6:7], v8 offset:42304
v_cvt_pk_bf16_f32 v172, v12, v13
v_cvt_pk_bf16_f32 v173, v14, v15
v_lshlrev_b32 v12, 16, v174
v_and_b32 v13, s63, v174
v_mfma_f32_32x32x16_bf16 v[64:79], a[12:15], v[168:171], v[64:79]
ds_read_b64_tr_b16 a[8:9], v8 offset:41088
ds_read_b64_tr_b16 a[10:11], v8 offset:42368
v_lshlrev_b32 v14, 16, v175
v_and_b32 v15, s63, v175
v_add_f32 v12, v11, v12
v_add_f32 v13, v11, v13
v_mfma_f32_32x32x16_bf16 v[80:95], a[16:19], v[168:171], v[80:95]
ds_read_b64_tr_b16 a[12:13], v8 offset:41152
ds_read_b64_tr_b16 a[14:15], v8 offset:42432
v_add_f32 v14, v11, v14
v_add_f32 v15, v11, v15
v_cvt_pk_bf16_f32 v174, v12, v13
v_cvt_pk_bf16_f32 v175, v14, v15
s_waitcnt lgkmcnt(8)
s_nop 0
v_mfma_f32_32x32x16_bf16 v[16:31], a[20:23], v[172:175], v[16:31]
ds_read_b64_tr_b16 a[16:17], v8 offset:41216
ds_read_b64_tr_b16 a[18:19], v8 offset:42496
v_lshlrev_b32 v12, 16, v176
v_and_b32 v13, s63, v176
v_lshlrev_b32 v14, 16, v177
v_and_b32 v15, s63, v177
v_mfma_f32_32x32x16_bf16 v[32:47], a[24:27], v[172:175], v[32:47]
ds_read_b64_tr_b16 a[20:21], v8 offset:46080
ds_read_b64_tr_b16 a[22:23], v8 offset:47360
v_add_f32 v12, v11, v12
v_add_f32 v13, v11, v13
v_add_f32 v14, v11, v14
v_add_f32 v15, v11, v15
buffer_load_dwordx2 a[74:75], v2, s[84:87], s48 offen
v_mfma_f32_32x32x16_bf16 v[48:63], a[28:31], v[172:175], v[48:63]
ds_read_b64_tr_b16 a[24:25], v8 offset:46144
ds_read_b64_tr_b16 a[26:27], v8 offset:47424
v_cvt_pk_bf16_f32 v176, v12, v13
v_cvt_pk_bf16_f32 v177, v14, v15
v_lshlrev_b32 v12, 16, v178
v_and_b32 v13, s63, v178
v_mfma_f32_32x32x16_bf16 v[64:79], a[32:35], v[172:175], v[64:79]
ds_read_b64_tr_b16 a[28:29], v8 offset:46208
ds_read_b64_tr_b16 a[30:31], v8 offset:47488
v_lshlrev_b32 v14, 16, v179
v_and_b32 v15, s63, v179
v_add_f32 v12, v11, v12
v_add_f32 v13, v11, v13
v_mfma_f32_32x32x16_bf16 v[80:95], a[36:39], v[172:175], v[80:95]
ds_read_b64_tr_b16 a[32:33], v8 offset:46272
ds_read_b64_tr_b16 a[34:35], v8 offset:47552
v_add_f32 v14, v11, v14
v_add_f32 v15, v11, v15
v_cvt_pk_bf16_f32 v178, v12, v13
v_cvt_pk_bf16_f32 v179, v14, v15
s_waitcnt lgkmcnt(8)
s_nop 0
v_mfma_f32_32x32x16_bf16 v[16:31], a[0:3], v[176:179], v[16:31]
ds_read_b64_tr_b16 a[36:37], v8 offset:46336
ds_read_b64_tr_b16 a[38:39], v8 offset:47616
v_lshlrev_b32 v12, 16, v180
v_and_b32 v13, s63, v180
v_lshlrev_b32 v14, 16, v181
v_and_b32 v15, s63, v181
v_mfma_f32_32x32x16_bf16 v[32:47], a[4:7], v[176:179], v[32:47]
ds_read_b64_tr_b16 a[0:1], v8 offset:51200
ds_read_b64_tr_b16 a[2:3], v8 offset:52480
v_add_f32 v12, v11, v12
v_add_f32 v13, v11, v13
v_add_f32 v14, v11, v14
v_add_f32 v15, v11, v15
v_mfma_f32_32x32x16_bf16 v[48:63], a[8:11], v[176:179], v[48:63]
ds_read_b64_tr_b16 a[4:5], v8 offset:51264
ds_read_b64_tr_b16 a[6:7], v8 offset:52544
v_cvt_pk_bf16_f32 v180, v12, v13
v_cvt_pk_bf16_f32 v181, v14, v15
v_lshlrev_b32 v12, 16, v182
v_and_b32 v13, s63, v182
v_mfma_f32_32x32x16_bf16 v[64:79], a[12:15], v[176:179], v[64:79]
ds_read_b64_tr_b16 a[8:9], v8 offset:51328
ds_read_b64_tr_b16 a[10:11], v8 offset:52608
v_lshlrev_b32 v14, 16, v183
v_and_b32 v15, s63, v183
v_add_f32 v12, v11, v12
v_add_f32 v13, v11, v13
v_mfma_f32_32x32x16_bf16 v[80:95], a[16:19], v[176:179], v[80:95]
ds_read_b64_tr_b16 a[12:13], v8 offset:51392
ds_read_b64_tr_b16 a[14:15], v8 offset:52672
v_add_f32 v14, v11, v14
v_add_f32 v15, v11, v15
v_cvt_pk_bf16_f32 v182, v12, v13
v_cvt_pk_bf16_f32 v183, v14, v15
s_mov_b32 s48, 61632
buffer_load_dwordx2 a[76:77], v2, s[64:67], s48 offen
s_waitcnt lgkmcnt(8)
v_mfma_f32_32x32x16_bf16 v[16:31], a[20:23], v[180:183], v[16:31]
ds_read_b64_tr_b16 a[16:17], v8 offset:51456
ds_read_b64_tr_b16 a[18:19], v8 offset:52736
v_lshlrev_b32 v12, 16, v184
v_and_b32 v13, s63, v184
v_lshlrev_b32 v14, 16, v185
v_and_b32 v15, s63, v185
v_mfma_f32_32x32x16_bf16 v[32:47], a[24:27], v[180:183], v[32:47]
ds_read_b64_tr_b16 a[20:21], v8 offset:56320
ds_read_b64_tr_b16 a[22:23], v8 offset:57600
v_add_f32 v12, v11, v12
v_add_f32 v13, v11, v13
v_add_f32 v14, v11, v14
v_add_f32 v15, v11, v15
v_mfma_f32_32x32x16_bf16 v[48:63], a[28:31], v[180:183], v[48:63]
ds_read_b64_tr_b16 a[24:25], v8 offset:56384
ds_read_b64_tr_b16 a[26:27], v8 offset:57664
v_cvt_pk_bf16_f32 v184, v12, v13
v_cvt_pk_bf16_f32 v185, v14, v15
v_lshlrev_b32 v12, 16, v186
v_and_b32 v13, s63, v186
v_mfma_f32_32x32x16_bf16 v[64:79], a[32:35], v[180:183], v[64:79]
ds_read_b64_tr_b16 a[28:29], v8 offset:56448
ds_read_b64_tr_b16 a[30:31], v8 offset:57728
v_lshlrev_b32 v14, 16, v187
v_and_b32 v15, s63, v187
v_add_f32 v12, v11, v12
v_add_f32 v13, v11, v13
v_mfma_f32_32x32x16_bf16 v[80:95], a[36:39], v[180:183], v[80:95]
ds_read_b64_tr_b16 a[32:33], v8 offset:56512
ds_read_b64_tr_b16 a[34:35], v8 offset:57792
v_add_f32 v14, v11, v14
v_add_f32 v15, v11, v15
v_cvt_pk_bf16_f32 v186, v12, v13
v_cvt_pk_bf16_f32 v187, v14, v15
s_waitcnt lgkmcnt(8)
s_nop 0
v_mfma_f32_32x32x16_bf16 v[16:31], a[0:3], v[184:187], v[16:31]
ds_read_b64_tr_b16 a[36:37], v8 offset:56576
ds_read_b64_tr_b16 a[38:39], v8 offset:57856
v_lshlrev_b32 v12, 16, v188
v_and_b32 v13, s63, v188
v_lshlrev_b32 v14, 16, v189
v_and_b32 v15, s63, v189
v_mfma_f32_32x32x16_bf16 v[32:47], a[4:7], v[184:187], v[32:47]
s_waitcnt vmcnt(22)
s_barrier
ds_read_b64_tr_b16 a[0:1], v9 offset:0
ds_read_b64_tr_b16 a[2:3], v9 offset:1280
v_add_f32 v12, v11, v12
v_add_f32 v13, v11, v13
v_add_f32 v14, v11, v14
v_add_f32 v15, v11, v15
v_mfma_f32_32x32x16_bf16 v[48:63], a[8:11], v[184:187], v[48:63]
ds_read_b64_tr_b16 a[4:5], v9 offset:64
ds_read_b64_tr_b16 a[6:7], v9 offset:1344
v_cvt_pk_bf16_f32 v188, v12, v13
v_cvt_pk_bf16_f32 v189, v14, v15
v_lshlrev_b32 v12, 16, v190
v_and_b32 v13, s63, v190
buffer_load_dwordx2 a[78:79], v2, s[84:87], s48 offen
v_mfma_f32_32x32x16_bf16 v[64:79], a[12:15], v[184:187], v[64:79]
ds_read_b64_tr_b16 a[8:9], v9 offset:128
ds_read_b64_tr_b16 a[10:11], v9 offset:1408
v_lshlrev_b32 v14, 16, v191
v_and_b32 v15, s63, v191
v_add_f32 v12, v11, v12
v_add_f32 v13, v11, v13
v_mfma_f32_32x32x16_bf16 v[80:95], a[16:19], v[184:187], v[80:95]
ds_read_b64_tr_b16 a[12:13], v9 offset:192
ds_read_b64_tr_b16 a[14:15], v9 offset:1472
v_add_f32 v14, v11, v14
v_add_f32 v15, v11, v15
v_cvt_pk_bf16_f32 v190, v12, v13
v_cvt_pk_bf16_f32 v191, v14, v15
s_waitcnt lgkmcnt(8)
s_nop 0
v_mfma_f32_32x32x16_bf16 v[16:31], a[20:23], v[188:191], v[16:31]
ds_read_b64_tr_b16 a[16:17], v9 offset:256
ds_read_b64_tr_b16 a[18:19], v9 offset:1536
v_lshlrev_b32 v12, 16, v192
v_and_b32 v13, s63, v192
v_lshlrev_b32 v14, 16, v193
v_and_b32 v15, s63, v193
v_mfma_f32_32x32x16_bf16 v[32:47], a[24:27], v[188:191], v[32:47]
ds_read_b64_tr_b16 a[20:21], v9 offset:5120
ds_read_b64_tr_b16 a[22:23], v9 offset:6400
v_add_f32 v12, v11, v12
v_add_f32 v13, v11, v13
v_add_f32 v14, v11, v14
v_add_f32 v15, v11, v15
v_mfma_f32_32x32x16_bf16 v[48:63], a[28:31], v[188:191], v[48:63]
ds_read_b64_tr_b16 a[24:25], v9 offset:5184
ds_read_b64_tr_b16 a[26:27], v9 offset:6464
v_cvt_pk_bf16_f32 v192, v12, v13
v_cvt_pk_bf16_f32 v193, v14, v15
v_lshlrev_b32 v12, 16, v194
v_and_b32 v13, s63, v194
v_mfma_f32_32x32x16_bf16 v[64:79], a[32:35], v[188:191], v[64:79]
ds_read_b64_tr_b16 a[28:29], v9 offset:5248
ds_read_b64_tr_b16 a[30:31], v9 offset:6528
v_lshlrev_b32 v14, 16, v195
v_and_b32 v15, s63, v195
v_add_f32 v12, v11, v12
v_add_f32 v13, v11, v13
v_mfma_f32_32x32x16_bf16 v[80:95], a[36:39], v[188:191], v[80:95]
ds_read_b64_tr_b16 a[32:33], v9 offset:5312
ds_read_b64_tr_b16 a[34:35], v9 offset:6592
v_add_f32 v14, v11, v14
v_add_f32 v15, v11, v15
v_cvt_pk_bf16_f32 v194, v12, v13
v_cvt_pk_bf16_f32 v195, v14, v15
s_waitcnt lgkmcnt(8)
s_nop 0
v_mfma_f32_32x32x16_bf16 v[16:31], a[0:3], v[192:195], v[16:31]
ds_read_b64_tr_b16 a[36:37], v9 offset:5376
ds_read_b64_tr_b16 a[38:39], v9 offset:6656
v_lshlrev_b32 v12, 16, v196
v_and_b32 v13, s63, v196
v_lshlrev_b32 v14, 16, v197
v_and_b32 v15, s63, v197
buffer_load_dword a83, v3, s[32:35], 0 offen
v_mfma_f32_32x32x16_bf16 v[32:47], a[4:7], v[192:195], v[32:47]
ds_read_b64_tr_b16 a[0:1], v9 offset:10240
ds_read_b64_tr_b16 a[2:3], v9 offset:11520
v_add_f32 v12, v11, v12
v_add_f32 v13, v11, v13
v_add_f32 v14, v11, v14
v_add_f32 v15, v11, v15
v_mfma_f32_32x32x16_bf16 v[48:63], a[8:11], v[192:195], v[48:63]
ds_read_b64_tr_b16 a[4:5], v9 offset:10304
ds_read_b64_tr_b16 a[6:7], v9 offset:11584
v_cvt_pk_bf16_f32 v196, v12, v13
v_cvt_pk_bf16_f32 v197, v14, v15
v_lshlrev_b32 v12, 16, v198
v_and_b32 v13, s63, v198
v_mfma_f32_32x32x16_bf16 v[64:79], a[12:15], v[192:195], v[64:79]
ds_read_b64_tr_b16 a[8:9], v9 offset:10368
ds_read_b64_tr_b16 a[10:11], v9 offset:11648
v_lshlrev_b32 v14, 16, v199
v_and_b32 v15, s63, v199
v_add_f32 v12, v11, v12
v_add_f32 v13, v11, v13
v_mfma_f32_32x32x16_bf16 v[80:95], a[16:19], v[192:195], v[80:95]
ds_read_b64_tr_b16 a[12:13], v9 offset:10432
ds_read_b64_tr_b16 a[14:15], v9 offset:11712
v_add_f32 v14, v11, v14
v_add_f32 v15, v11, v15
v_cvt_pk_bf16_f32 v198, v12, v13
v_cvt_pk_bf16_f32 v199, v14, v15
s_waitcnt lgkmcnt(8)
s_nop 0
v_mfma_f32_32x32x16_bf16 v[16:31], a[20:23], v[196:199], v[16:31]
ds_read_b64_tr_b16 a[16:17], v9 offset:10496
ds_read_b64_tr_b16 a[18:19], v9 offset:11776
v_lshlrev_b32 v12, 16, v200
v_and_b32 v13, s63, v200
v_lshlrev_b32 v14, 16, v201
v_and_b32 v15, s63, v201
v_mfma_f32_32x32x16_bf16 v[32:47], a[24:27], v[196:199], v[32:47]
ds_read_b64_tr_b16 a[20:21], v9 offset:15360
ds_read_b64_tr_b16 a[22:23], v9 offset:16640
v_add_f32 v12, v11, v12
v_add_f32 v13, v11, v13
v_add_f32 v14, v11, v14
v_add_f32 v15, v11, v15
v_mfma_f32_32x32x16_bf16 v[48:63], a[28:31], v[196:199], v[48:63]
ds_read_b64_tr_b16 a[24:25], v9 offset:15424
ds_read_b64_tr_b16 a[26:27], v9 offset:16704
v_cvt_pk_bf16_f32 v200, v12, v13
v_cvt_pk_bf16_f32 v201, v14, v15
v_lshlrev_b32 v12, 16, v202
v_and_b32 v13, s63, v202
v_mfma_f32_32x32x16_bf16 v[64:79], a[32:35], v[196:199], v[64:79]
ds_read_b64_tr_b16 a[28:29], v9 offset:15488
ds_read_b64_tr_b16 a[30:31], v9 offset:16768
v_lshlrev_b32 v14, 16, v203
v_and_b32 v15, s63, v203
v_add_f32 v12, v11, v12
v_add_f32 v13, v11, v13
buffer_load_dword a84, v3, s[36:39], 0 offen
buffer_load_dword a86, v3, s[44:47], 0 offen
v_mfma_f32_32x32x16_bf16 v[80:95], a[36:39], v[196:199], v[80:95]
ds_read_b64_tr_b16 a[32:33], v9 offset:15552
ds_read_b64_tr_b16 a[34:35], v9 offset:16832
v_add_f32 v14, v11, v14
v_add_f32 v15, v11, v15
v_cvt_pk_bf16_f32 v202, v12, v13
v_cvt_pk_bf16_f32 v203, v14, v15
s_waitcnt lgkmcnt(8)
s_nop 0
v_mfma_f32_32x32x16_bf16 v[16:31], a[0:3], v[200:203], v[16:31]
ds_read_b64_tr_b16 a[36:37], v9 offset:15616
ds_read_b64_tr_b16 a[38:39], v9 offset:16896
v_lshlrev_b32 v12, 16, v204
v_and_b32 v13, s63, v204
v_lshlrev_b32 v14, 16, v205
v_and_b32 v15, s63, v205
v_mfma_f32_32x32x16_bf16 v[32:47], a[4:7], v[200:203], v[32:47]
s_waitcnt vmcnt(21)
s_barrier
ds_read_b64_tr_b16 a[0:1], v9 offset:20480
ds_read_b64_tr_b16 a[2:3], v9 offset:21760
v_add_f32 v12, v11, v12
v_add_f32 v13, v11, v13
v_add_f32 v14, v11, v14
v_add_f32 v15, v11, v15
v_mfma_f32_32x32x16_bf16 v[48:63], a[8:11], v[200:203], v[48:63]
ds_read_b64_tr_b16 a[4:5], v9 offset:20544
ds_read_b64_tr_b16 a[6:7], v9 offset:21824
v_cvt_pk_bf16_f32 v204, v12, v13
v_cvt_pk_bf16_f32 v205, v14, v15
v_lshlrev_b32 v12, 16, v206
v_and_b32 v13, s63, v206
v_mfma_f32_32x32x16_bf16 v[64:79], a[12:15], v[200:203], v[64:79]
ds_read_b64_tr_b16 a[8:9], v9 offset:20608
ds_read_b64_tr_b16 a[10:11], v9 offset:21888
v_lshlrev_b32 v14, 16, v207
v_and_b32 v15, s63, v207
v_add_f32 v12, v11, v12
v_add_f32 v13, v11, v13
v_mfma_f32_32x32x16_bf16 v[80:95], a[16:19], v[200:203], v[80:95]
ds_read_b64_tr_b16 a[12:13], v9 offset:20672
ds_read_b64_tr_b16 a[14:15], v9 offset:21952
v_add_f32 v14, v11, v14
v_add_f32 v15, v11, v15
v_cvt_pk_bf16_f32 v206, v12, v13
v_cvt_pk_bf16_f32 v207, v14, v15
s_waitcnt lgkmcnt(8)
s_nop 0
v_mfma_f32_32x32x16_bf16 v[16:31], a[20:23], v[204:207], v[16:31]
ds_read_b64_tr_b16 a[16:17], v9 offset:20736
ds_read_b64_tr_b16 a[18:19], v9 offset:22016
v_lshlrev_b32 v12, 16, v208
v_and_b32 v13, s63, v208
v_lshlrev_b32 v14, 16, v209
v_and_b32 v15, s63, v209
v_mfma_f32_32x32x16_bf16 v[32:47], a[24:27], v[204:207], v[32:47]
ds_read_b64_tr_b16 a[20:21], v9 offset:25600
ds_read_b64_tr_b16 a[22:23], v9 offset:26880
v_add_f32 v12, v11, v12
v_add_f32 v13, v11, v13
v_add_f32 v14, v11, v14
v_add_f32 v15, v11, v15
v_mfma_f32_32x32x16_bf16 v[48:63], a[28:31], v[204:207], v[48:63]
ds_read_b64_tr_b16 a[24:25], v9 offset:25664
ds_read_b64_tr_b16 a[26:27], v9 offset:26944
v_cvt_pk_bf16_f32 v208, v12, v13
v_cvt_pk_bf16_f32 v209, v14, v15
v_lshlrev_b32 v12, 16, v210
v_and_b32 v13, s63, v210
v_mfma_f32_32x32x16_bf16 v[64:79], a[32:35], v[204:207], v[64:79]
ds_read_b64_tr_b16 a[28:29], v9 offset:25728
ds_read_b64_tr_b16 a[30:31], v9 offset:27008
v_lshlrev_b32 v14, 16, v211
v_and_b32 v15, s63, v211
v_add_f32 v12, v11, v12
v_add_f32 v13, v11, v13
v_mfma_f32_32x32x16_bf16 v[80:95], a[36:39], v[204:207], v[80:95]
ds_read_b64_tr_b16 a[32:33], v9 offset:25792
ds_read_b64_tr_b16 a[34:35], v9 offset:27072
v_add_f32 v14, v11, v14
v_add_f32 v15, v11, v15
v_cvt_pk_bf16_f32 v210, v12, v13
v_cvt_pk_bf16_f32 v211, v14, v15
s_waitcnt lgkmcnt(8)
s_nop 0
v_mfma_f32_32x32x16_bf16 v[16:31], a[0:3], v[208:211], v[16:31]
ds_read_b64_tr_b16 a[36:37], v9 offset:25856
ds_read_b64_tr_b16 a[38:39], v9 offset:27136
v_lshlrev_b32 v12, 16, v212
v_and_b32 v13, s63, v212
v_lshlrev_b32 v14, 16, v213
v_and_b32 v15, s63, v213
v_mfma_f32_32x32x16_bf16 v[32:47], a[4:7], v[208:211], v[32:47]
ds_read_b64_tr_b16 a[0:1], v9 offset:30720
ds_read_b64_tr_b16 a[2:3], v9 offset:32000
v_add_f32 v12, v11, v12
v_add_f32 v13, v11, v13
v_add_f32 v14, v11, v14
v_add_f32 v15, v11, v15
v_mfma_f32_32x32x16_bf16 v[48:63], a[8:11], v[208:211], v[48:63]
ds_read_b64_tr_b16 a[4:5], v9 offset:30784
ds_read_b64_tr_b16 a[6:7], v9 offset:32064
v_cvt_pk_bf16_f32 v212, v12, v13
v_cvt_pk_bf16_f32 v213, v14, v15
v_lshlrev_b32 v12, 16, v214
v_and_b32 v13, s63, v214
v_mfma_f32_32x32x16_bf16 v[64:79], a[12:15], v[208:211], v[64:79]
ds_read_b64_tr_b16 a[8:9], v9 offset:30848
ds_read_b64_tr_b16 a[10:11], v9 offset:32128
v_lshlrev_b32 v14, 16, v215
v_and_b32 v15, s63, v215
v_add_f32 v12, v11, v12
v_add_f32 v13, v11, v13
v_mfma_f32_32x32x16_bf16 v[80:95], a[16:19], v[208:211], v[80:95]
ds_read_b64_tr_b16 a[12:13], v9 offset:30912
ds_read_b64_tr_b16 a[14:15], v9 offset:32192
v_add_f32 v14, v11, v14
v_add_f32 v15, v11, v15
v_cvt_pk_bf16_f32 v214, v12, v13
v_cvt_pk_bf16_f32 v215, v14, v15
s_waitcnt lgkmcnt(8)
s_nop 0
v_mfma_f32_32x32x16_bf16 v[16:31], a[20:23], v[212:215], v[16:31]
ds_read_b64_tr_b16 a[16:17], v9 offset:30976
ds_read_b64_tr_b16 a[18:19], v9 offset:32256
v_lshlrev_b32 v12, 16, v216
v_and_b32 v13, s63, v216
v_lshlrev_b32 v14, 16, v217
v_and_b32 v15, s63, v217
v_mfma_f32_32x32x16_bf16 v[32:47], a[24:27], v[212:215], v[32:47]
ds_read_b64_tr_b16 a[20:21], v9 offset:35840
ds_read_b64_tr_b16 a[22:23], v9 offset:37120
v_add_f32 v12, v11, v12
v_add_f32 v13, v11, v13
v_add_f32 v14, v11, v14
v_add_f32 v15, v11, v15
v_mfma_f32_32x32x16_bf16 v[48:63], a[28:31], v[212:215], v[48:63]
ds_read_b64_tr_b16 a[24:25], v9 offset:35904
ds_read_b64_tr_b16 a[26:27], v9 offset:37184
v_cvt_pk_bf16_f32 v216, v12, v13
v_cvt_pk_bf16_f32 v217, v14, v15
v_lshlrev_b32 v12, 16, v218
v_and_b32 v13, s63, v218
v_mfma_f32_32x32x16_bf16 v[64:79], a[32:35], v[212:215], v[64:79]
ds_read_b64_tr_b16 a[28:29], v9 offset:35968
ds_read_b64_tr_b16 a[30:31], v9 offset:37248
v_lshlrev_b32 v14, 16, v219
v_and_b32 v15, s63, v219
v_add_f32 v12, v11, v12
v_add_f32 v13, v11, v13
v_mfma_f32_32x32x16_bf16 v[80:95], a[36:39], v[212:215], v[80:95]
ds_read_b64_tr_b16 a[32:33], v9 offset:36032
ds_read_b64_tr_b16 a[34:35], v9 offset:37312
v_add_f32 v14, v11, v14
v_add_f32 v15, v11, v15
v_cvt_pk_bf16_f32 v218, v12, v13
v_cvt_pk_bf16_f32 v219, v14, v15
s_waitcnt lgkmcnt(8)
s_nop 0
v_mfma_f32_32x32x16_bf16 v[16:31], a[0:3], v[216:219], v[16:31]
ds_read_b64_tr_b16 a[36:37], v9 offset:36096
ds_read_b64_tr_b16 a[38:39], v9 offset:37376
v_lshlrev_b32 v12, 16, v220
v_and_b32 v13, s63, v220
v_lshlrev_b32 v14, 16, v221
v_and_b32 v15, s63, v221
v_mfma_f32_32x32x16_bf16 v[32:47], a[4:7], v[216:219], v[32:47]
s_waitcnt vmcnt(16)
s_barrier
ds_read_b64_tr_b16 a[0:1], v7 offset:0
ds_read_b64_tr_b16 a[2:3], v7 offset:1280
v_add_f32 v12, v11, v12
v_add_f32 v13, v11, v13
v_add_f32 v14, v11, v14
v_add_f32 v15, v11, v15
v_mfma_f32_32x32x16_bf16 v[48:63], a[8:11], v[216:219], v[48:63]
ds_read_b64_tr_b16 a[4:5], v7 offset:64
ds_read_b64_tr_b16 a[6:7], v7 offset:1344
v_cvt_pk_bf16_f32 v220, v12, v13
v_cvt_pk_bf16_f32 v221, v14, v15
v_lshlrev_b32 v12, 16, v222
v_and_b32 v13, s63, v222
v_mfma_f32_32x32x16_bf16 v[64:79], a[12:15], v[216:219], v[64:79]
ds_read_b64_tr_b16 a[8:9], v7 offset:128
ds_read_b64_tr_b16 a[10:11], v7 offset:1408
v_lshlrev_b32 v14, 16, v223
v_and_b32 v15, s63, v223
v_add_f32 v12, v11, v12
v_add_f32 v13, v11, v13
v_mfma_f32_32x32x16_bf16 v[80:95], a[16:19], v[216:219], v[80:95]
ds_read_b64_tr_b16 a[12:13], v7 offset:192
ds_read_b64_tr_b16 a[14:15], v7 offset:1472
v_add_f32 v14, v11, v14
v_add_f32 v15, v11, v15
v_cvt_pk_bf16_f32 v222, v12, v13
v_cvt_pk_bf16_f32 v223, v14, v15
s_waitcnt lgkmcnt(8)
s_nop 0
v_mfma_f32_32x32x16_bf16 v[16:31], a[20:23], v[220:223], v[16:31]
ds_read_b64_tr_b16 a[16:17], v7 offset:256
ds_read_b64_tr_b16 a[18:19], v7 offset:1536
v_lshlrev_b32 v12, 16, v224
v_and_b32 v13, s63, v224
v_lshlrev_b32 v14, 16, v225
v_and_b32 v15, s63, v225
v_mfma_f32_32x32x16_bf16 v[32:47], a[24:27], v[220:223], v[32:47]
ds_read_b64_tr_b16 a[20:21], v7 offset:5120
ds_read_b64_tr_b16 a[22:23], v7 offset:6400
v_add_f32 v12, v11, v12
v_add_f32 v13, v11, v13
v_add_f32 v14, v11, v14
v_add_f32 v15, v11, v15
v_mfma_f32_32x32x16_bf16 v[48:63], a[28:31], v[220:223], v[48:63]
ds_read_b64_tr_b16 a[24:25], v7 offset:5184
ds_read_b64_tr_b16 a[26:27], v7 offset:6464
v_cvt_pk_bf16_f32 v224, v12, v13
v_cvt_pk_bf16_f32 v225, v14, v15
v_lshlrev_b32 v12, 16, v226
v_and_b32 v13, s63, v226
v_mfma_f32_32x32x16_bf16 v[64:79], a[32:35], v[220:223], v[64:79]
ds_read_b64_tr_b16 a[28:29], v7 offset:5248
ds_read_b64_tr_b16 a[30:31], v7 offset:6528
v_lshlrev_b32 v14, 16, v227
v_and_b32 v15, s63, v227
v_add_f32 v12, v11, v12
v_add_f32 v13, v11, v13
v_mfma_f32_32x32x16_bf16 v[80:95], a[36:39], v[220:223], v[80:95]
ds_read_b64_tr_b16 a[32:33], v7 offset:5312
ds_read_b64_tr_b16 a[34:35], v7 offset:6592
v_add_f32 v14, v11, v14
v_add_f32 v15, v11, v15
v_cvt_pk_bf16_f32 v226, v12, v13
v_cvt_pk_bf16_f32 v227, v14, v15
s_waitcnt lgkmcnt(8)
s_nop 0
v_mfma_f32_32x32x16_bf16 v[16:31], a[0:3], v[224:227], v[16:31]
ds_read_b64_tr_b16 a[36:37], v7 offset:5376
ds_read_b64_tr_b16 a[38:39], v7 offset:6656
v_lshlrev_b32 v12, 16, v228
v_and_b32 v13, s63, v228
v_lshlrev_b32 v14, 16, v229
v_and_b32 v15, s63, v229
v_mfma_f32_32x32x16_bf16 v[32:47], a[4:7], v[224:227], v[32:47]
ds_read_b64_tr_b16 a[0:1], v7 offset:10240
ds_read_b64_tr_b16 a[2:3], v7 offset:11520
v_add_f32 v12, v11, v12
v_add_f32 v13, v11, v13
v_add_f32 v14, v11, v14
v_add_f32 v15, v11, v15
v_mfma_f32_32x32x16_bf16 v[48:63], a[8:11], v[224:227], v[48:63]
ds_read_b64_tr_b16 a[4:5], v7 offset:10304
ds_read_b64_tr_b16 a[6:7], v7 offset:11584
v_cvt_pk_bf16_f32 v228, v12, v13
v_cvt_pk_bf16_f32 v229, v14, v15
v_lshlrev_b32 v12, 16, v230
v_and_b32 v13, s63, v230
v_mfma_f32_32x32x16_bf16 v[64:79], a[12:15], v[224:227], v[64:79]
ds_read_b64_tr_b16 a[8:9], v7 offset:10368
ds_read_b64_tr_b16 a[10:11], v7 offset:11648
v_lshlrev_b32 v14, 16, v231
v_and_b32 v15, s63, v231
v_add_f32 v12, v11, v12
v_add_f32 v13, v11, v13
v_mfma_f32_32x32x16_bf16 v[80:95], a[16:19], v[224:227], v[80:95]
ds_read_b64_tr_b16 a[12:13], v7 offset:10432
ds_read_b64_tr_b16 a[14:15], v7 offset:11712
v_add_f32 v14, v11, v14
v_add_f32 v15, v11, v15
v_cvt_pk_bf16_f32 v230, v12, v13
v_cvt_pk_bf16_f32 v231, v14, v15
s_waitcnt lgkmcnt(8)
s_nop 0
v_mfma_f32_32x32x16_bf16 v[16:31], a[20:23], v[228:231], v[16:31]
ds_read_b64_tr_b16 a[16:17], v7 offset:10496
ds_read_b64_tr_b16 a[18:19], v7 offset:11776
v_lshlrev_b32 v12, 16, v232
v_and_b32 v13, s63, v232
v_lshlrev_b32 v14, 16, v233
v_and_b32 v15, s63, v233
v_mfma_f32_32x32x16_bf16 v[32:47], a[24:27], v[228:231], v[32:47]
ds_read_b64_tr_b16 a[20:21], v7 offset:15360
ds_read_b64_tr_b16 a[22:23], v7 offset:16640
v_add_f32 v12, v11, v12
v_add_f32 v13, v11, v13
v_add_f32 v14, v11, v14
v_add_f32 v15, v11, v15
v_mfma_f32_32x32x16_bf16 v[48:63], a[28:31], v[228:231], v[48:63]
ds_read_b64_tr_b16 a[24:25], v7 offset:15424
ds_read_b64_tr_b16 a[26:27], v7 offset:16704
v_cvt_pk_bf16_f32 v232, v12, v13
v_cvt_pk_bf16_f32 v233, v14, v15
v_lshlrev_b32 v12, 16, v234
v_and_b32 v13, s63, v234
v_mfma_f32_32x32x16_bf16 v[64:79], a[32:35], v[228:231], v[64:79]
ds_read_b64_tr_b16 a[28:29], v7 offset:15488
ds_read_b64_tr_b16 a[30:31], v7 offset:16768
v_lshlrev_b32 v14, 16, v235
v_and_b32 v15, s63, v235
v_add_f32 v12, v11, v12
v_add_f32 v13, v11, v13
v_mfma_f32_32x32x16_bf16 v[80:95], a[36:39], v[228:231], v[80:95]
ds_read_b64_tr_b16 a[32:33], v7 offset:15552
ds_read_b64_tr_b16 a[34:35], v7 offset:16832
v_add_f32 v14, v11, v14
v_add_f32 v15, v11, v15
v_cvt_pk_bf16_f32 v234, v12, v13
v_cvt_pk_bf16_f32 v235, v14, v15
s_waitcnt lgkmcnt(8)
s_nop 0
v_mfma_f32_32x32x16_bf16 v[16:31], a[0:3], v[232:235], v[16:31]
ds_read_b64_tr_b16 a[36:37], v7 offset:15616
ds_read_b64_tr_b16 a[38:39], v7 offset:16896
v_lshlrev_b32 v12, 16, v236
v_and_b32 v13, s63, v236
v_lshlrev_b32 v14, 16, v237
v_and_b32 v15, s63, v237
v_mfma_f32_32x32x16_bf16 v[32:47], a[4:7], v[232:235], v[32:47]
s_waitcnt vmcnt(11)
s_barrier
ds_read_b64_tr_b16 a[0:1], v7 offset:20480
ds_read_b64_tr_b16 a[2:3], v7 offset:21760
v_add_f32 v12, v11, v12
v_add_f32 v13, v11, v13
v_add_f32 v14, v11, v14
v_add_f32 v15, v11, v15
v_mfma_f32_32x32x16_bf16 v[48:63], a[8:11], v[232:235], v[48:63]
ds_read_b64_tr_b16 a[4:5], v7 offset:20544
ds_read_b64_tr_b16 a[6:7], v7 offset:21824
v_cvt_pk_bf16_f32 v236, v12, v13
v_cvt_pk_bf16_f32 v237, v14, v15
v_lshlrev_b32 v12, 16, v238
v_and_b32 v13, s63, v238
v_mfma_f32_32x32x16_bf16 v[64:79], a[12:15], v[232:235], v[64:79]
ds_read_b64_tr_b16 a[8:9], v7 offset:20608
ds_read_b64_tr_b16 a[10:11], v7 offset:21888
v_lshlrev_b32 v14, 16, v239
v_and_b32 v15, s63, v239
v_add_f32 v12, v11, v12
v_add_f32 v13, v11, v13
v_mfma_f32_32x32x16_bf16 v[80:95], a[16:19], v[232:235], v[80:95]
ds_read_b64_tr_b16 a[12:13], v7 offset:20672
ds_read_b64_tr_b16 a[14:15], v7 offset:21952
v_add_f32 v14, v11, v14
v_add_f32 v15, v11, v15
v_cvt_pk_bf16_f32 v238, v12, v13
v_cvt_pk_bf16_f32 v239, v14, v15
s_waitcnt lgkmcnt(8)
s_nop 0
v_mfma_f32_32x32x16_bf16 v[16:31], a[20:23], v[236:239], v[16:31]
ds_read_b64_tr_b16 a[16:17], v7 offset:20736
ds_read_b64_tr_b16 a[18:19], v7 offset:22016
v_lshlrev_b32 v12, 16, v240
v_and_b32 v13, s63, v240
v_lshlrev_b32 v14, 16, v241
v_and_b32 v15, s63, v241
v_mfma_f32_32x32x16_bf16 v[32:47], a[24:27], v[236:239], v[32:47]
ds_read_b64_tr_b16 a[20:21], v7 offset:25600
ds_read_b64_tr_b16 a[22:23], v7 offset:26880
v_add_f32 v12, v11, v12
v_add_f32 v13, v11, v13
v_add_f32 v14, v11, v14
v_add_f32 v15, v11, v15
v_mfma_f32_32x32x16_bf16 v[48:63], a[28:31], v[236:239], v[48:63]
ds_read_b64_tr_b16 a[24:25], v7 offset:25664
ds_read_b64_tr_b16 a[26:27], v7 offset:26944
v_cvt_pk_bf16_f32 v240, v12, v13
v_cvt_pk_bf16_f32 v241, v14, v15
v_lshlrev_b32 v12, 16, v242
v_and_b32 v13, s63, v242
v_mfma_f32_32x32x16_bf16 v[64:79], a[32:35], v[236:239], v[64:79]
ds_read_b64_tr_b16 a[28:29], v7 offset:25728
ds_read_b64_tr_b16 a[30:31], v7 offset:27008
v_lshlrev_b32 v14, 16, v243
v_and_b32 v15, s63, v243
v_add_f32 v12, v11, v12
v_add_f32 v13, v11, v13
v_mfma_f32_32x32x16_bf16 v[80:95], a[36:39], v[236:239], v[80:95]
ds_read_b64_tr_b16 a[32:33], v7 offset:25792
ds_read_b64_tr_b16 a[34:35], v7 offset:27072
v_add_f32 v14, v11, v14
v_add_f32 v15, v11, v15
v_cvt_pk_bf16_f32 v242, v12, v13
v_cvt_pk_bf16_f32 v243, v14, v15
s_waitcnt lgkmcnt(8)
s_nop 0
v_mfma_f32_32x32x16_bf16 v[16:31], a[0:3], v[240:243], v[16:31]
ds_read_b64_tr_b16 a[36:37], v7 offset:25856
ds_read_b64_tr_b16 a[38:39], v7 offset:27136
v_lshlrev_b32 v12, 16, v244
v_and_b32 v13, s63, v244
v_lshlrev_b32 v14, 16, v245
v_and_b32 v15, s63, v245
v_mfma_f32_32x32x16_bf16 v[32:47], a[4:7], v[240:243], v[32:47]
ds_read_b64_tr_b16 a[0:1], v7 offset:30720
ds_read_b64_tr_b16 a[2:3], v7 offset:32000
v_add_f32 v12, v11, v12
v_add_f32 v13, v11, v13
v_add_f32 v14, v11, v14
v_add_f32 v15, v11, v15
v_mfma_f32_32x32x16_bf16 v[48:63], a[8:11], v[240:243], v[48:63]
ds_read_b64_tr_b16 a[4:5], v7 offset:30784
ds_read_b64_tr_b16 a[6:7], v7 offset:32064
v_cvt_pk_bf16_f32 v244, v12, v13
v_cvt_pk_bf16_f32 v245, v14, v15
v_lshlrev_b32 v12, 16, v246
v_and_b32 v13, s63, v246
v_mfma_f32_32x32x16_bf16 v[64:79], a[12:15], v[240:243], v[64:79]
ds_read_b64_tr_b16 a[8:9], v7 offset:30848
ds_read_b64_tr_b16 a[10:11], v7 offset:32128
v_lshlrev_b32 v14, 16, v247
v_and_b32 v15, s63, v247
v_add_f32 v12, v11, v12
v_add_f32 v13, v11, v13
v_mfma_f32_32x32x16_bf16 v[80:95], a[16:19], v[240:243], v[80:95]
ds_read_b64_tr_b16 a[12:13], v7 offset:30912
ds_read_b64_tr_b16 a[14:15], v7 offset:32192
v_add_f32 v14, v11, v14
v_add_f32 v15, v11, v15
v_cvt_pk_bf16_f32 v246, v12, v13
v_cvt_pk_bf16_f32 v247, v14, v15
s_waitcnt lgkmcnt(8)
s_nop 0
v_mfma_f32_32x32x16_bf16 v[16:31], a[20:23], v[244:247], v[16:31]
ds_read_b64_tr_b16 a[16:17], v7 offset:30976
ds_read_b64_tr_b16 a[18:19], v7 offset:32256
v_lshlrev_b32 v12, 16, v248
v_and_b32 v13, s63, v248
v_lshlrev_b32 v14, 16, v249
v_and_b32 v15, s63, v249
v_mfma_f32_32x32x16_bf16 v[32:47], a[24:27], v[244:247], v[32:47]
ds_read_b64_tr_b16 a[20:21], v7 offset:35840
ds_read_b64_tr_b16 a[22:23], v7 offset:37120
v_add_f32 v12, v11, v12
v_add_f32 v13, v11, v13
v_add_f32 v14, v11, v14
v_add_f32 v15, v11, v15
v_mfma_f32_32x32x16_bf16 v[48:63], a[28:31], v[244:247], v[48:63]
ds_read_b64_tr_b16 a[24:25], v7 offset:35904
ds_read_b64_tr_b16 a[26:27], v7 offset:37184
v_cvt_pk_bf16_f32 v248, v12, v13
v_cvt_pk_bf16_f32 v249, v14, v15
v_lshlrev_b32 v12, 16, v250
v_and_b32 v13, s63, v250
v_mfma_f32_32x32x16_bf16 v[64:79], a[32:35], v[244:247], v[64:79]
ds_read_b64_tr_b16 a[28:29], v7 offset:35968
ds_read_b64_tr_b16 a[30:31], v7 offset:37248
v_lshlrev_b32 v14, 16, v251
v_and_b32 v15, s63, v251
v_add_f32 v12, v11, v12
v_add_f32 v13, v11, v13
v_mfma_f32_32x32x16_bf16 v[80:95], a[36:39], v[244:247], v[80:95]
ds_read_b64_tr_b16 a[32:33], v7 offset:36032
ds_read_b64_tr_b16 a[34:35], v7 offset:37312
v_add_f32 v14, v11, v14
v_add_f32 v15, v11, v15
v_cvt_pk_bf16_f32 v250, v12, v13
v_cvt_pk_bf16_f32 v251, v14, v15
s_waitcnt lgkmcnt(8)
s_nop 0
v_mfma_f32_32x32x16_bf16 v[16:31], a[0:3], v[248:251], v[16:31]
ds_read_b64_tr_b16 a[36:37], v7 offset:36096
ds_read_b64_tr_b16 a[38:39], v7 offset:37376
v_lshlrev_b32 v12, 16, v252
v_and_b32 v13, s63, v252
v_lshlrev_b32 v14, 16, v253
v_and_b32 v15, s63, v253
v_mfma_f32_32x32x16_bf16 v[32:47], a[4:7], v[248:251], v[32:47]
v_add_f32 v12, v11, v12
v_add_f32 v13, v11, v13
v_add_f32 v14, v11, v14
v_add_f32 v15, v11, v15
v_mfma_f32_32x32x16_bf16 v[48:63], a[8:11], v[248:251], v[48:63]
v_cvt_pk_bf16_f32 v252, v12, v13
v_cvt_pk_bf16_f32 v253, v14, v15
v_lshlrev_b32 v12, 16, v254
v_and_b32 v13, s63, v254
v_mfma_f32_32x32x16_bf16 v[64:79], a[12:15], v[248:251], v[64:79]
v_lshlrev_b32 v14, 16, v255
v_and_b32 v15, s63, v255
v_add_f32 v12, v11, v12
v_add_f32 v13, v11, v13
v_mfma_f32_32x32x16_bf16 v[80:95], a[16:19], v[248:251], v[80:95]
v_add_f32 v14, v11, v14
v_add_f32 v15, v11, v15
v_cvt_pk_bf16_f32 v254, v12, v13
v_cvt_pk_bf16_f32 v255, v14, v15
s_waitcnt lgkmcnt(0)
s_nop 0
v_mfma_f32_32x32x16_bf16 v[16:31], a[20:23], v[252:255], v[16:31]
v_mfma_f32_32x32x16_bf16 v[32:47], a[24:27], v[252:255], v[32:47]
v_mfma_f32_32x32x16_bf16 v[48:63], a[28:31], v[252:255], v[48:63]
v_mfma_f32_32x32x16_bf16 v[64:79], a[32:35], v[252:255], v[64:79]
v_mfma_f32_32x32x16_bf16 v[80:95], a[36:39], v[252:255], v[80:95]
s_waitcnt vmcnt(3)
s_mov_b32 s56, 0x05040100
s_mov_b32 s57, 0x07060302
v_accvgpr_read_b32 v3, a81
v_accvgpr_read_b32 v176, a64
v_accvgpr_read_b32 v177, a65
v_accvgpr_read_b32 v178, a66
v_accvgpr_read_b32 v179, a67
v_accvgpr_read_b32 v180, a68
v_accvgpr_read_b32 v181, a69
v_accvgpr_read_b32 v182, a70
v_accvgpr_read_b32 v183, a71
v_accvgpr_read_b32 v184, a72
v_accvgpr_read_b32 v185, a73
v_accvgpr_read_b32 v186, a74
v_accvgpr_read_b32 v187, a75
v_accvgpr_read_b32 v188, a76
v_accvgpr_read_b32 v189, a77
v_accvgpr_read_b32 v190, a78
v_accvgpr_read_b32 v191, a79
v_perm_b32 v192, v178, v176, s56
v_perm_b32 v193, v182, v180, s56
v_perm_b32 v194, v186, v184, s56
v_perm_b32 v195, v190, v188, s56
s_mov_b32 s55, 0
buffer_store_dwordx4 v[192:195], v3, s[88:91], s55 offen sc1
v_perm_b32 v196, v178, v176, s57
v_perm_b32 v197, v182, v180, s57
v_perm_b32 v198, v186, v184, s57
v_perm_b32 v199, v190, v188, s57
s_mov_b32 s55, 8192
buffer_store_dwordx4 v[196:199], v3, s[88:91], s55 offen sc1
v_perm_b32 v200, v179, v177, s56
v_perm_b32 v201, v183, v181, s56
v_perm_b32 v202, v187, v185, s56
v_perm_b32 v203, v191, v189, s56
s_mov_b32 s55, 16384
buffer_store_dwordx4 v[200:203], v3, s[88:91], s55 offen sc1
v_perm_b32 v204, v179, v177, s57
v_perm_b32 v205, v183, v181, s57
v_perm_b32 v206, v187, v185, s57
v_perm_b32 v207, v191, v189, s57
s_mov_b32 s55, 24576
buffer_store_dwordx4 v[204:207], v3, s[88:91], s55 offen sc1
v_mul_f32 v12, 0xc0135761, v10
v_mul_f32 v11, v10, v10
v_mul_f32 v10, v11, v10
v_mul_f32 v10, 0xbdd2d3e8, v10
v_accvgpr_read_b32 v14, a85
v_mov_b32 v11, v10
v_mov_b32 v13, v12
v_mov_b32 v15, v14
v_pk_mul_f32 v[96:97], v[16:17], v[16:17]
v_pk_mul_f32 v[98:99], v[18:19], v[18:19]
v_pk_mul_f32 v[100:101], v[20:21], v[20:21]
v_pk_mul_f32 v[102:103], v[22:23], v[22:23]
v_pk_fma_f32 v[96:97], v[96:97], v[10:11], v[12:13]
v_pk_fma_f32 v[98:99], v[98:99], v[10:11], v[12:13]
v_pk_fma_f32 v[100:101], v[100:101], v[10:11], v[12:13]
v_pk_fma_f32 v[102:103], v[102:103], v[10:11], v[12:13]
v_pk_mul_f32 v[96:97], v[96:97], v[16:17]
v_pk_mul_f32 v[98:99], v[98:99], v[18:19]
v_pk_mul_f32 v[100:101], v[100:101], v[20:21]
v_pk_mul_f32 v[102:103], v[102:103], v[22:23]
v_exp_f32 v96, v96
v_exp_f32 v97, v97
v_exp_f32 v98, v98
v_exp_f32 v99, v99
v_exp_f32 v100, v100
v_exp_f32 v101, v101
v_exp_f32 v102, v102
v_exp_f32 v103, v103
v_pk_fma_f32 v[96:97], v[96:97], v[14:15], v[14:15]
v_pk_fma_f32 v[98:99], v[98:99], v[14:15], v[14:15]
v_pk_fma_f32 v[100:101], v[100:101], v[14:15], v[14:15]
v_pk_fma_f32 v[102:103], v[102:103], v[14:15], v[14:15]
v_rcp_f32 v96, v96
v_rcp_f32 v97, v97
v_rcp_f32 v98, v98
v_rcp_f32 v99, v99
v_rcp_f32 v100, v100
v_rcp_f32 v101, v101
v_rcp_f32 v102, v102
v_rcp_f32 v103, v103
v_pk_mul_f32 v[96:97], v[96:97], v[16:17]
v_pk_mul_f32 v[98:99], v[98:99], v[18:19]
v_pk_mul_f32 v[100:101], v[100:101], v[20:21]
v_pk_mul_f32 v[102:103], v[102:103], v[22:23]
v_cvt_pk_bf16_f32 v16, v96, v97
v_cvt_pk_bf16_f32 v17, v98, v99
v_cvt_pk_bf16_f32 v18, v100, v101
v_cvt_pk_bf16_f32 v19, v102, v103
buffer_store_dwordx4 v[16:19], v6, s[40:43], s59 offen offset:0 sc1
v_pk_mul_f32 v[112:113], v[24:25], v[24:25]
v_pk_mul_f32 v[114:115], v[26:27], v[26:27]
v_pk_mul_f32 v[116:117], v[28:29], v[28:29]
v_pk_mul_f32 v[118:119], v[30:31], v[30:31]
v_pk_fma_f32 v[112:113], v[112:113], v[10:11], v[12:13]
v_pk_fma_f32 v[114:115], v[114:115], v[10:11], v[12:13]
v_pk_fma_f32 v[116:117], v[116:117], v[10:11], v[12:13]
v_pk_fma_f32 v[118:119], v[118:119], v[10:11], v[12:13]
v_pk_mul_f32 v[112:113], v[112:113], v[24:25]
v_pk_mul_f32 v[114:115], v[114:115], v[26:27]
v_pk_mul_f32 v[116:117], v[116:117], v[28:29]
v_pk_mul_f32 v[118:119], v[118:119], v[30:31]
v_exp_f32 v112, v112
v_exp_f32 v113, v113
v_exp_f32 v114, v114
v_exp_f32 v115, v115
v_exp_f32 v116, v116
v_exp_f32 v117, v117
v_exp_f32 v118, v118
v_exp_f32 v119, v119
v_pk_fma_f32 v[112:113], v[112:113], v[14:15], v[14:15]
v_pk_fma_f32 v[114:115], v[114:115], v[14:15], v[14:15]
v_pk_fma_f32 v[116:117], v[116:117], v[14:15], v[14:15]
v_pk_fma_f32 v[118:119], v[118:119], v[14:15], v[14:15]
v_rcp_f32 v112, v112
v_rcp_f32 v113, v113
v_rcp_f32 v114, v114
v_rcp_f32 v115, v115
v_rcp_f32 v116, v116
v_rcp_f32 v117, v117
v_rcp_f32 v118, v118
v_rcp_f32 v119, v119
v_pk_mul_f32 v[112:113], v[112:113], v[24:25]
v_pk_mul_f32 v[114:115], v[114:115], v[26:27]
v_pk_mul_f32 v[116:117], v[116:117], v[28:29]
v_pk_mul_f32 v[118:119], v[118:119], v[30:31]
v_cvt_pk_bf16_f32 v24, v112, v113
v_cvt_pk_bf16_f32 v25, v114, v115
v_cvt_pk_bf16_f32 v26, v116, v117
v_cvt_pk_bf16_f32 v27, v118, v119
buffer_store_dwordx4 v[24:27], v6, s[40:43], s59 offen offset:1024 sc1
s_add_u32 s59, s59, 2048
v_pk_mul_f32 v[96:97], v[32:33], v[32:33]
v_pk_mul_f32 v[98:99], v[34:35], v[34:35]
v_pk_mul_f32 v[100:101], v[36:37], v[36:37]
v_pk_mul_f32 v[102:103], v[38:39], v[38:39]
v_pk_fma_f32 v[96:97], v[96:97], v[10:11], v[12:13]
v_pk_fma_f32 v[98:99], v[98:99], v[10:11], v[12:13]
v_pk_fma_f32 v[100:101], v[100:101], v[10:11], v[12:13]
v_pk_fma_f32 v[102:103], v[102:103], v[10:11], v[12:13]
v_pk_mul_f32 v[96:97], v[96:97], v[32:33]
v_pk_mul_f32 v[98:99], v[98:99], v[34:35]
v_pk_mul_f32 v[100:101], v[100:101], v[36:37]
v_pk_mul_f32 v[102:103], v[102:103], v[38:39]
v_exp_f32 v96, v96
v_exp_f32 v97, v97
v_exp_f32 v98, v98
v_exp_f32 v99, v99
v_exp_f32 v100, v100
v_exp_f32 v101, v101
v_exp_f32 v102, v102
v_exp_f32 v103, v103
v_pk_fma_f32 v[96:97], v[96:97], v[14:15], v[14:15]
v_pk_fma_f32 v[98:99], v[98:99], v[14:15], v[14:15]
v_pk_fma_f32 v[100:101], v[100:101], v[14:15], v[14:15]
v_pk_fma_f32 v[102:103], v[102:103], v[14:15], v[14:15]
v_rcp_f32 v96, v96
v_rcp_f32 v97, v97
v_rcp_f32 v98, v98
v_rcp_f32 v99, v99
v_rcp_f32 v100, v100
v_rcp_f32 v101, v101
v_rcp_f32 v102, v102
v_rcp_f32 v103, v103
v_pk_mul_f32 v[96:97], v[96:97], v[32:33]
v_pk_mul_f32 v[98:99], v[98:99], v[34:35]
v_pk_mul_f32 v[100:101], v[100:101], v[36:37]
v_pk_mul_f32 v[102:103], v[102:103], v[38:39]
v_cvt_pk_bf16_f32 v32, v96, v97
v_cvt_pk_bf16_f32 v33, v98, v99
v_cvt_pk_bf16_f32 v34, v100, v101
v_cvt_pk_bf16_f32 v35, v102, v103
buffer_store_dwordx4 v[32:35], v6, s[40:43], s59 offen offset:0 sc1
v_pk_mul_f32 v[112:113], v[40:41], v[40:41]
v_pk_mul_f32 v[114:115], v[42:43], v[42:43]
v_pk_mul_f32 v[116:117], v[44:45], v[44:45]
v_pk_mul_f32 v[118:119], v[46:47], v[46:47]
v_pk_fma_f32 v[112:113], v[112:113], v[10:11], v[12:13]
v_pk_fma_f32 v[114:115], v[114:115], v[10:11], v[12:13]
v_pk_fma_f32 v[116:117], v[116:117], v[10:11], v[12:13]
v_pk_fma_f32 v[118:119], v[118:119], v[10:11], v[12:13]
v_pk_mul_f32 v[112:113], v[112:113], v[40:41]
v_pk_mul_f32 v[114:115], v[114:115], v[42:43]
v_pk_mul_f32 v[116:117], v[116:117], v[44:45]
v_pk_mul_f32 v[118:119], v[118:119], v[46:47]
v_exp_f32 v112, v112
v_exp_f32 v113, v113
v_exp_f32 v114, v114
v_exp_f32 v115, v115
v_exp_f32 v116, v116
v_exp_f32 v117, v117
v_exp_f32 v118, v118
v_exp_f32 v119, v119
v_pk_fma_f32 v[112:113], v[112:113], v[14:15], v[14:15]
v_pk_fma_f32 v[114:115], v[114:115], v[14:15], v[14:15]
v_pk_fma_f32 v[116:117], v[116:117], v[14:15], v[14:15]
v_pk_fma_f32 v[118:119], v[118:119], v[14:15], v[14:15]
v_rcp_f32 v112, v112
v_rcp_f32 v113, v113
v_rcp_f32 v114, v114
v_rcp_f32 v115, v115
v_rcp_f32 v116, v116
v_rcp_f32 v117, v117
v_rcp_f32 v118, v118
v_rcp_f32 v119, v119
v_pk_mul_f32 v[112:113], v[112:113], v[40:41]
v_pk_mul_f32 v[114:115], v[114:115], v[42:43]
v_pk_mul_f32 v[116:117], v[116:117], v[44:45]
v_pk_mul_f32 v[118:119], v[118:119], v[46:47]
v_cvt_pk_bf16_f32 v40, v112, v113
v_cvt_pk_bf16_f32 v41, v114, v115
v_cvt_pk_bf16_f32 v42, v116, v117
v_cvt_pk_bf16_f32 v43, v118, v119
buffer_store_dwordx4 v[40:43], v6, s[40:43], s59 offen offset:1024 sc1
s_add_u32 s59, s59, 2048
v_pk_mul_f32 v[96:97], v[48:49], v[48:49]
v_pk_mul_f32 v[98:99], v[50:51], v[50:51]
v_pk_mul_f32 v[100:101], v[52:53], v[52:53]
v_pk_mul_f32 v[102:103], v[54:55], v[54:55]
v_pk_fma_f32 v[96:97], v[96:97], v[10:11], v[12:13]
v_pk_fma_f32 v[98:99], v[98:99], v[10:11], v[12:13]
v_pk_fma_f32 v[100:101], v[100:101], v[10:11], v[12:13]
v_pk_fma_f32 v[102:103], v[102:103], v[10:11], v[12:13]
v_pk_mul_f32 v[96:97], v[96:97], v[48:49]
v_pk_mul_f32 v[98:99], v[98:99], v[50:51]
v_pk_mul_f32 v[100:101], v[100:101], v[52:53]
v_pk_mul_f32 v[102:103], v[102:103], v[54:55]
v_exp_f32 v96, v96
v_exp_f32 v97, v97
v_exp_f32 v98, v98
v_exp_f32 v99, v99
v_exp_f32 v100, v100
v_exp_f32 v101, v101
v_exp_f32 v102, v102
v_exp_f32 v103, v103
v_pk_fma_f32 v[96:97], v[96:97], v[14:15], v[14:15]
v_pk_fma_f32 v[98:99], v[98:99], v[14:15], v[14:15]
v_pk_fma_f32 v[100:101], v[100:101], v[14:15], v[14:15]
v_pk_fma_f32 v[102:103], v[102:103], v[14:15], v[14:15]
v_rcp_f32 v96, v96
v_rcp_f32 v97, v97
v_rcp_f32 v98, v98
v_rcp_f32 v99, v99
v_rcp_f32 v100, v100
v_rcp_f32 v101, v101
v_rcp_f32 v102, v102
v_rcp_f32 v103, v103
v_pk_mul_f32 v[96:97], v[96:97], v[48:49]
v_pk_mul_f32 v[98:99], v[98:99], v[50:51]
v_pk_mul_f32 v[100:101], v[100:101], v[52:53]
v_pk_mul_f32 v[102:103], v[102:103], v[54:55]
v_cvt_pk_bf16_f32 v48, v96, v97
v_cvt_pk_bf16_f32 v49, v98, v99
v_cvt_pk_bf16_f32 v50, v100, v101
v_cvt_pk_bf16_f32 v51, v102, v103
buffer_store_dwordx4 v[48:51], v6, s[40:43], s59 offen offset:0 sc1
v_pk_mul_f32 v[112:113], v[56:57], v[56:57]
v_pk_mul_f32 v[114:115], v[58:59], v[58:59]
v_pk_mul_f32 v[116:117], v[60:61], v[60:61]
v_pk_mul_f32 v[118:119], v[62:63], v[62:63]
v_pk_fma_f32 v[112:113], v[112:113], v[10:11], v[12:13]
v_pk_fma_f32 v[114:115], v[114:115], v[10:11], v[12:13]
v_pk_fma_f32 v[116:117], v[116:117], v[10:11], v[12:13]
v_pk_fma_f32 v[118:119], v[118:119], v[10:11], v[12:13]
v_pk_mul_f32 v[112:113], v[112:113], v[56:57]
v_pk_mul_f32 v[114:115], v[114:115], v[58:59]
v_pk_mul_f32 v[116:117], v[116:117], v[60:61]
v_pk_mul_f32 v[118:119], v[118:119], v[62:63]
v_exp_f32 v112, v112
v_exp_f32 v113, v113
v_exp_f32 v114, v114
v_exp_f32 v115, v115
v_exp_f32 v116, v116
v_exp_f32 v117, v117
v_exp_f32 v118, v118
v_exp_f32 v119, v119
v_pk_fma_f32 v[112:113], v[112:113], v[14:15], v[14:15]
v_pk_fma_f32 v[114:115], v[114:115], v[14:15], v[14:15]
v_pk_fma_f32 v[116:117], v[116:117], v[14:15], v[14:15]
v_pk_fma_f32 v[118:119], v[118:119], v[14:15], v[14:15]
v_rcp_f32 v112, v112
v_rcp_f32 v113, v113
v_rcp_f32 v114, v114
v_rcp_f32 v115, v115
v_rcp_f32 v116, v116
v_rcp_f32 v117, v117
v_rcp_f32 v118, v118
v_rcp_f32 v119, v119
v_pk_mul_f32 v[112:113], v[112:113], v[56:57]
v_pk_mul_f32 v[114:115], v[114:115], v[58:59]
v_pk_mul_f32 v[116:117], v[116:117], v[60:61]
v_pk_mul_f32 v[118:119], v[118:119], v[62:63]
v_cvt_pk_bf16_f32 v56, v112, v113
v_cvt_pk_bf16_f32 v57, v114, v115
v_cvt_pk_bf16_f32 v58, v116, v117
v_cvt_pk_bf16_f32 v59, v118, v119
buffer_store_dwordx4 v[56:59], v6, s[40:43], s59 offen offset:1024 sc1
s_add_u32 s59, s59, 2048
v_pk_mul_f32 v[96:97], v[64:65], v[64:65]
v_pk_mul_f32 v[98:99], v[66:67], v[66:67]
v_pk_mul_f32 v[100:101], v[68:69], v[68:69]
v_pk_mul_f32 v[102:103], v[70:71], v[70:71]
v_pk_fma_f32 v[96:97], v[96:97], v[10:11], v[12:13]
v_pk_fma_f32 v[98:99], v[98:99], v[10:11], v[12:13]
v_pk_fma_f32 v[100:101], v[100:101], v[10:11], v[12:13]
v_pk_fma_f32 v[102:103], v[102:103], v[10:11], v[12:13]
v_pk_mul_f32 v[96:97], v[96:97], v[64:65]
v_pk_mul_f32 v[98:99], v[98:99], v[66:67]
v_pk_mul_f32 v[100:101], v[100:101], v[68:69]
v_pk_mul_f32 v[102:103], v[102:103], v[70:71]
v_exp_f32 v96, v96
v_exp_f32 v97, v97
v_exp_f32 v98, v98
v_exp_f32 v99, v99
v_exp_f32 v100, v100
v_exp_f32 v101, v101
v_exp_f32 v102, v102
v_exp_f32 v103, v103
v_pk_fma_f32 v[96:97], v[96:97], v[14:15], v[14:15]
v_pk_fma_f32 v[98:99], v[98:99], v[14:15], v[14:15]
v_pk_fma_f32 v[100:101], v[100:101], v[14:15], v[14:15]
v_pk_fma_f32 v[102:103], v[102:103], v[14:15], v[14:15]
v_rcp_f32 v96, v96
v_rcp_f32 v97, v97
v_rcp_f32 v98, v98
v_rcp_f32 v99, v99
v_rcp_f32 v100, v100
v_rcp_f32 v101, v101
v_rcp_f32 v102, v102
v_rcp_f32 v103, v103
v_pk_mul_f32 v[96:97], v[96:97], v[64:65]
v_pk_mul_f32 v[98:99], v[98:99], v[66:67]
v_pk_mul_f32 v[100:101], v[100:101], v[68:69]
v_pk_mul_f32 v[102:103], v[102:103], v[70:71]
v_cvt_pk_bf16_f32 v64, v96, v97
v_cvt_pk_bf16_f32 v65, v98, v99
v_cvt_pk_bf16_f32 v66, v100, v101
v_cvt_pk_bf16_f32 v67, v102, v103
buffer_store_dwordx4 v[64:67], v6, s[40:43], s59 offen offset:0 sc1
v_pk_mul_f32 v[112:113], v[72:73], v[72:73]
v_pk_mul_f32 v[114:115], v[74:75], v[74:75]
v_pk_mul_f32 v[116:117], v[76:77], v[76:77]
v_pk_mul_f32 v[118:119], v[78:79], v[78:79]
v_pk_fma_f32 v[112:113], v[112:113], v[10:11], v[12:13]
v_pk_fma_f32 v[114:115], v[114:115], v[10:11], v[12:13]
v_pk_fma_f32 v[116:117], v[116:117], v[10:11], v[12:13]
v_pk_fma_f32 v[118:119], v[118:119], v[10:11], v[12:13]
v_pk_mul_f32 v[112:113], v[112:113], v[72:73]
v_pk_mul_f32 v[114:115], v[114:115], v[74:75]
v_pk_mul_f32 v[116:117], v[116:117], v[76:77]
v_pk_mul_f32 v[118:119], v[118:119], v[78:79]
v_exp_f32 v112, v112
v_exp_f32 v113, v113
v_exp_f32 v114, v114
v_exp_f32 v115, v115
v_exp_f32 v116, v116
v_exp_f32 v117, v117
v_exp_f32 v118, v118
v_exp_f32 v119, v119
v_pk_fma_f32 v[112:113], v[112:113], v[14:15], v[14:15]
v_pk_fma_f32 v[114:115], v[114:115], v[14:15], v[14:15]
v_pk_fma_f32 v[116:117], v[116:117], v[14:15], v[14:15]
v_pk_fma_f32 v[118:119], v[118:119], v[14:15], v[14:15]
v_rcp_f32 v112, v112
v_rcp_f32 v113, v113
v_rcp_f32 v114, v114
v_rcp_f32 v115, v115
v_rcp_f32 v116, v116
v_rcp_f32 v117, v117
v_rcp_f32 v118, v118
v_rcp_f32 v119, v119
v_pk_mul_f32 v[112:113], v[112:113], v[72:73]
v_pk_mul_f32 v[114:115], v[114:115], v[74:75]
v_pk_mul_f32 v[116:117], v[116:117], v[76:77]
v_pk_mul_f32 v[118:119], v[118:119], v[78:79]
v_cvt_pk_bf16_f32 v72, v112, v113
v_cvt_pk_bf16_f32 v73, v114, v115
v_cvt_pk_bf16_f32 v74, v116, v117
v_cvt_pk_bf16_f32 v75, v118, v119
buffer_store_dwordx4 v[72:75], v6, s[40:43], s59 offen offset:1024 sc1
s_add_u32 s59, s59, 2048
s_cmp_eq_u32 s31, 1600
s_cbranch_scc1 P1E
v_pk_mul_f32 v[96:97], v[80:81], v[80:81]
v_pk_mul_f32 v[98:99], v[82:83], v[82:83]
v_pk_mul_f32 v[100:101], v[84:85], v[84:85]
v_pk_mul_f32 v[102:103], v[86:87], v[86:87]
v_pk_fma_f32 v[96:97], v[96:97], v[10:11], v[12:13]
v_pk_fma_f32 v[98:99], v[98:99], v[10:11], v[12:13]
v_pk_fma_f32 v[100:101], v[100:101], v[10:11], v[12:13]
v_pk_fma_f32 v[102:103], v[102:103], v[10:11], v[12:13]
v_pk_mul_f32 v[96:97], v[96:97], v[80:81]
v_pk_mul_f32 v[98:99], v[98:99], v[82:83]
v_pk_mul_f32 v[100:101], v[100:101], v[84:85]
v_pk_mul_f32 v[102:103], v[102:103], v[86:87]
v_exp_f32 v96, v96
v_exp_f32 v97, v97
v_exp_f32 v98, v98
v_exp_f32 v99, v99
v_exp_f32 v100, v100
v_exp_f32 v101, v101
v_exp_f32 v102, v102
v_exp_f32 v103, v103
v_pk_fma_f32 v[96:97], v[96:97], v[14:15], v[14:15]
v_pk_fma_f32 v[98:99], v[98:99], v[14:15], v[14:15]
v_pk_fma_f32 v[100:101], v[100:101], v[14:15], v[14:15]
v_pk_fma_f32 v[102:103], v[102:103], v[14:15], v[14:15]
v_rcp_f32 v96, v96
v_rcp_f32 v97, v97
v_rcp_f32 v98, v98
v_rcp_f32 v99, v99
v_rcp_f32 v100, v100
v_rcp_f32 v101, v101
v_rcp_f32 v102, v102
v_rcp_f32 v103, v103
v_pk_mul_f32 v[96:97], v[96:97], v[80:81]
v_pk_mul_f32 v[98:99], v[98:99], v[82:83]
v_pk_mul_f32 v[100:101], v[100:101], v[84:85]
v_pk_mul_f32 v[102:103], v[102:103], v[86:87]
v_cvt_pk_bf16_f32 v80, v96, v97
v_cvt_pk_bf16_f32 v81, v98, v99
v_cvt_pk_bf16_f32 v82, v100, v101
v_cvt_pk_bf16_f32 v83, v102, v103
buffer_store_dwordx4 v[80:83], v6, s[40:43], s59 offen offset:0 sc1
v_pk_mul_f32 v[112:113], v[88:89], v[88:89]
v_pk_mul_f32 v[114:115], v[90:91], v[90:91]
v_pk_mul_f32 v[116:117], v[92:93], v[92:93]
v_pk_mul_f32 v[118:119], v[94:95], v[94:95]
v_pk_fma_f32 v[112:113], v[112:113], v[10:11], v[12:13]
v_pk_fma_f32 v[114:115], v[114:115], v[10:11], v[12:13]
v_pk_fma_f32 v[116:117], v[116:117], v[10:11], v[12:13]
v_pk_fma_f32 v[118:119], v[118:119], v[10:11], v[12:13]
v_pk_mul_f32 v[112:113], v[112:113], v[88:89]
v_pk_mul_f32 v[114:115], v[114:115], v[90:91]
v_pk_mul_f32 v[116:117], v[116:117], v[92:93]
v_pk_mul_f32 v[118:119], v[118:119], v[94:95]
v_exp_f32 v112, v112
v_exp_f32 v113, v113
v_exp_f32 v114, v114
v_exp_f32 v115, v115
v_exp_f32 v116, v116
v_exp_f32 v117, v117
v_exp_f32 v118, v118
v_exp_f32 v119, v119
v_pk_fma_f32 v[112:113], v[112:113], v[14:15], v[14:15]
v_pk_fma_f32 v[114:115], v[114:115], v[14:15], v[14:15]
v_pk_fma_f32 v[116:117], v[116:117], v[14:15], v[14:15]
v_pk_fma_f32 v[118:119], v[118:119], v[14:15], v[14:15]
v_rcp_f32 v112, v112
v_rcp_f32 v113, v113
v_rcp_f32 v114, v114
v_rcp_f32 v115, v115
v_rcp_f32 v116, v116
v_rcp_f32 v117, v117
v_rcp_f32 v118, v118
v_rcp_f32 v119, v119
v_pk_mul_f32 v[112:113], v[112:113], v[88:89]
v_pk_mul_f32 v[114:115], v[114:115], v[90:91]
v_pk_mul_f32 v[116:117], v[116:117], v[92:93]
v_pk_mul_f32 v[118:119], v[118:119], v[94:95]
v_cvt_pk_bf16_f32 v88, v112, v113
v_cvt_pk_bf16_f32 v89, v114, v115
v_cvt_pk_bf16_f32 v90, v116, v117
v_cvt_pk_bf16_f32 v91, v118, v119
buffer_store_dwordx4 v[88:91], v6, s[40:43], s59 offen offset:1024 sc1
s_add_u32 s59, s59, 2048
P1E:
s_waitcnt vmcnt(6)
s_endpgm
P1D:
s_mul_i32 s31, s7, 160
s_cmp_eq_u32 s2, 0
s_cselect_b32 s60, 0, s60
s_mul_i32 s54, s3, 30720
s_add_u32 s54, s54, 40960
v_lshrrev_b32 v3, 3, v0
v_and_b32 v4, 7, v0
v_add_u32 v5, 0, v3
v_mov_b32 v2, v5
v_lshlrev_b32 v2, 6, v2
v_add_u32 v2, s30, v2
v_mul_u32_u24 v2, 1280, v2
v_bfe_u32 v5, v5, 1, 3
v_xor_b32 v5, v5, v4
v_lshl_add_u32 v16, v5, 4, v2
v_add_u32 v5, 8, v3
v_mov_b32 v2, v5
v_lshlrev_b32 v2, 6, v2
v_add_u32 v2, s30, v2
v_mul_u32_u24 v2, 1280, v2
v_bfe_u32 v5, v5, 1, 3
v_xor_b32 v5, v5, v4
v_lshl_add_u32 v17, v5, 4, v2
v_add_u32 v5, 16, v3
v_mov_b32 v2, v5
v_lshlrev_b32 v2, 6, v2
v_add_u32 v2, s30, v2
v_mul_u32_u24 v2, 1280, v2
v_bfe_u32 v5, v5, 1, 3
v_xor_b32 v5, v5, v4
v_lshl_add_u32 v18, v5, 4, v2
v_add_u32 v5, 24, v3
v_mov_b32 v2, v5
v_lshlrev_b32 v2, 6, v2
v_add_u32 v2, s30, v2
v_mul_u32_u24 v2, 1280, v2
v_bfe_u32 v5, v5, 1, 3
v_xor_b32 v5, v5, v4
v_lshl_add_u32 v19, v5, 4, v2
s_and_b32 s55, s5, 3
s_mul_i32 s55, s55, 3
s_lshr_b32 s56, s5, 2
s_mul_i32 s56, s56, 1
s_add_u32 s56, s56, s55
s_lshr_b32 s55, s4, 0
s_mul_i32 s55, s55, 3
s_add_u32 s56, s56, s55
s_mul_i32 s55, s56, 205
s_lshr_b32 s55, s55, 11
s_mul_i32 s55, s55, 10
s_sub_u32 s56, s56, s55
s_lshl_b32 s55, s56, 7
s_waitcnt lgkmcnt(0)
s_mov_b32 s32, s8
s_mov_b32 s33, s9
s_mov_b32 s34, 2621440
s_mov_b32 s35, 0x20000
s_add_u32 m0, s54, 0
s_nop 0
buffer_load_dwordx4 v16, s[32:35], s55 offen lds
s_add_u32 m0, s54, 1024
s_nop 0
buffer_load_dwordx4 v17, s[32:35], s55 offen lds
s_add_u32 m0, s54, 2048
s_nop 0
buffer_load_dwordx4 v18, s[32:35], s55 offen lds
s_add_u32 m0, s54, 3072
s_nop 0
buffer_load_dwordx4 v19, s[32:35], s55 offen lds
s_add_u32 s55, s55, 128
s_cmp_eq_u32 s55, 1280
s_cselect_b32 s55, 0, s55
s_add_u32 m0, s54, 4096
s_nop 0
buffer_load_dwordx4 v16, s[32:35], s55 offen lds
s_add_u32 m0, s54, 5120
s_nop 0
buffer_load_dwordx4 v17, s[32:35], s55 offen lds
s_add_u32 m0, s54, 6144
s_nop 0
buffer_load_dwordx4 v18, s[32:35], s55 offen lds
s_add_u32 m0, s54, 7168
s_nop 0
buffer_load_dwordx4 v19, s[32:35], s55 offen lds
s_add_u32 s55, s55, 128
s_cmp_eq_u32 s55, 1280
s_cselect_b32 s55, 0, s55
s_add_u32 m0, s54, 8192
s_nop 0
buffer_load_dwordx4 v16, s[32:35], s55 offen lds
s_add_u32 m0, s54, 9216
s_nop 0
buffer_load_dwordx4 v17, s[32:35], s55 offen lds
s_add_u32 m0, s54, 10240
s_nop 0
buffer_load_dwordx4 v18, s[32:35], s55 offen lds
s_add_u32 m0, s54, 11264
s_nop 0
buffer_load_dwordx4 v19, s[32:35], s55 offen lds
s_add_u32 s55, s55, 128
s_cmp_eq_u32 s55, 1280
s_cselect_b32 s55, 0, s55
s_add_u32 m0, s54, 12288
s_nop 0
buffer_load_dwordx4 v16, s[32:35], s55 offen lds
s_add_u32 m0, s54, 13312
s_nop 0
buffer_load_dwordx4 v17, s[32:35], s55 offen lds
s_add_u32 m0, s54, 14336
s_nop 0
buffer_load_dwordx4 v18, s[32:35], s55 offen lds
s_add_u32 m0, s54, 15360
s_nop 0
buffer_load_dwordx4 v19, s[32:35], s55 offen lds
s_add_u32 s55, s55, 128
s_cmp_eq_u32 s55, 1280
s_cselect_b32 s55, 0, s55
s_add_u32 m0, s54, 16384
s_nop 0
buffer_load_dwordx4 v16, s[32:35], s55 offen lds
s_add_u32 m0, s54, 17408
s_nop 0
buffer_load_dwordx4 v17, s[32:35], s55 offen lds
s_add_u32 m0, s54, 18432
s_nop 0
buffer_load_dwordx4 v18, s[32:35], s55 offen lds
s_add_u32 m0, s54, 19456
s_nop 0
buffer_load_dwordx4 v19, s[32:35], s55 offen lds
s_add_u32 s55, s55, 128
s_cmp_eq_u32 s55, 1280
s_cselect_b32 s55, 0, s55
s_add_u32 m0, s54, 20480
s_nop 0
buffer_load_dwordx4 v16, s[32:35], s55 offen lds
s_add_u32 m0, s54, 21504
s_nop 0
buffer_load_dwordx4 v17, s[32:35], s55 offen lds
s_add_u32 m0, s54, 22528
s_nop 0
buffer_load_dwordx4 v18, s[32:35], s55 offen lds
s_add_u32 m0, s54, 23552
s_nop 0
buffer_load_dwordx4 v19, s[32:35], s55 offen lds
s_add_u32 s55, s55, 128
s_cmp_eq_u32 s55, 1280
s_cselect_b32 s55, 0, s55
s_add_u32 m0, s54, 24576
s_nop 0
buffer_load_dwordx4 v16, s[32:35], s55 offen lds
s_add_u32 m0, s54, 25600
s_nop 0
buffer_load_dwordx4 v17, s[32:35], s55 offen lds
s_add_u32 m0, s54, 26624
s_nop 0
buffer_load_dwordx4 v18, s[32:35], s55 offen lds
s_add_u32 m0, s54, 27648
s_nop 0
buffer_load_dwordx4 v19, s[32:35], s55 offen lds
s_add_u32 s55, s55, 128
s_cmp_eq_u32 s55, 1280
s_cselect_b32 s55, 0, s55
s_mov_b32 s64, s10
s_mov_b32 s65, s11
s_mov_b32 s66, 1314820
s_mov_b32 s67, 0x20000
s_mov_b32 s84, s12
s_mov_b32 s85, s13
s_mov_b32 s86, 1314820
s_mov_b32 s87, 0x20000
s_add_u32 s88, s28, 10485760
s_addc_u32 s89, s29, 0
s_mov_b32 s90, 2629632
s_mov_b32 s91, 0x20000
s_and_b32 s48, s30, 3
s_lshr_b32 s49, s30, 2
s_lshl_b32 s48, s48, 3
v_add_u32 v5, s48, v4
s_lshl_b32 s50, s49, 7
v_add_u32 v24, s50, v5
v_mul_u32_u24 v24, 642, v24
v_lshl_add_u32 v24, v3, 3, v24
s_lshl_b32 s50, s7, 6
v_add_u32 v24, s50, v24
s_lshl_b32 s50, s49, 9
s_lshl_b32 s48, s7, 18
s_add_u32 s50, s50, s48
v_lshlrev_b32 v28, 15, v3
v_lshl_add_u32 v28, v5, 4, v28
v_add_u32 v28, s50, v28
v_accvgpr_write_b32 a80, v24
v_accvgpr_write_b32 a81, v28
s_lshl_b32 s48, s7, 6
s_add_u32 s48, s48, s30
v_mul_u32_u24 v24, 960, v0
v_add_u32 v24, s48, v24
v_lshlrev_b32 v24, 7, v24
v_accvgpr_write_b32 a82, v24
s_getpc_b64 s[36:37]
s_add_u32 s36, s36, TABF@rel32@lo+4
s_addc_u32 s37, s37, TABF@rel32@hi+12
s_mov_b32 s38, 819200
s_mov_b32 s39, 0x20000
s_mov_b32 s40, s28
s_mov_b32 s41, s29
s_mov_b32 s42, 2621440
s_mov_b32 s43, 0x20000
s_mul_i32 s48, s3, 5120
s_lshl_b32 s57, s31, 1
s_mul_i32 s49, s56, 81920
s_add_u32 s49, s49, s57
s_add_u32 s58, s57, 819200
s_mov_b32 s50, 52429
v_lshlrev_b32 v10, 4, v0
v_add_u32 v10, s48, v10
v_add_u32 v10, 0, v10
v_lshrrev_b32 v11, 6, v10
v_mul_lo_u32 v11, v11, s50
v_lshrrev_b32 v11, 18, v11
v_mul_u32_u24 v11, 960, v11
v_add_u32 v2, v10, v11
v_lshlrev_b32 v10, 4, v0
v_add_u32 v10, s48, v10
v_add_u32 v10, 1024, v10
v_lshrrev_b32 v11, 6, v10
v_mul_lo_u32 v11, v11, s50
v_lshrrev_b32 v11, 18, v11
v_mul_u32_u24 v11, 960, v11
v_add_u32 v3, v10, v11
v_lshlrev_b32 v10, 4, v0
v_add_u32 v10, s48, v10
v_add_u32 v10, 2048, v10
v_lshrrev_b32 v11, 6, v10
v_mul_lo_u32 v11, v11, s50
v_lshrrev_b32 v11, 18, v11
v_mul_u32_u24 v11, 960, v11
v_add_u32 v4, v10, v11
v_lshlrev_b32 v10, 4, v0
v_add_u32 v10, s48, v10
v_add_u32 v10, 3072, v10
v_lshrrev_b32 v11, 6, v10
v_mul_lo_u32 v11, v11, s50
v_lshrrev_b32 v11, 18, v11
v_mul_u32_u24 v11, 960, v11
v_add_u32 v5, v10, v11
v_lshlrev_b32 v10, 4, v0
v_add_u32 v10, s48, v10
v_add_u32 v10, 4096, v10
v_lshrrev_b32 v11, 6, v10
v_mul_lo_u32 v11, v11, s50
v_lshrrev_b32 v11, 18, v11
v_mul_u32_u24 v11, 960, v11
v_add_u32 v6, v10, v11
s_add_u32 m0, s48, 0
s_nop 0
buffer_load_dwordx4 v2, s[36:39], s49 offen lds
s_add_u32 m0, s48, 1024
s_nop 0
buffer_load_dwordx4 v3, s[36:39], s49 offen lds
s_add_u32 m0, s48, 2048
s_nop 0
buffer_load_dwordx4 v4, s[36:39], s49 offen lds
s_add_u32 m0, s48, 3072
s_nop 0
buffer_load_dwordx4 v5, s[36:39], s49 offen lds
s_add_u32 m0, s48, 4096
s_nop 0
buffer_load_dwordx4 v6, s[36:39], s49 offen lds
s_add_u32 s49, s49, 81920
s_cmp_eq_u32 s49, s58
s_cselect_b32 s49, s57, s49
v_and_b32 v10, 31, v0
v_lshlrev_b32 v12, 7, v10
v_add_u32 v12, s54, v12
v_bfe_u32 v10, v10, 1, 3
v_lshrrev_b32 v11, 5, v0
v_xor_b32 v10, v10, v11
v_xor_b32 v11, 0, v10
v_lshl_add_u32 v20, v11, 4, v12
v_xor_b32 v11, 2, v10
v_lshl_add_u32 v21, v11, 4, v12
v_xor_b32 v11, 4, v10
v_lshl_add_u32 v22, v11, 4, v12
v_xor_b32 v11, 6, v10
v_lshl_add_u32 v23, v11, 4, v12
v_lshrrev_b32 v10, 5, v0
v_lshlrev_b32 v10, 3, v10
v_bfe_u32 v11, v0, 2, 2
v_add_u32 v10, v10, v11
v_mul_u32_u24 v10, 320, v10
v_bfe_u32 v11, v0, 4, 1
v_lshl_add_u32 v10, v11, 5, v10
v_and_b32 v11, 3, v0
v_lshl_add_u32 v7, v11, 3, v10
v_add_u32 v8, 61440, v7
v_add_u32 v9, 122880, v7
s_mov_b32 s51, 0x3f803f80
s_mov_b32 s63, 0xffff0000
v_mov_b32 v10, 0
v_mov_b32 v11, 0
v_mov_b32 v12, 0
v_mov_b32 v13, 0
s_waitcnt vmcnt(29)
ds_read_b128 v[96:99], v20 offset:0
ds_read_b128 v[100:103], v21 offset:0
ds_read_b128 v[104:107], v22 offset:0
ds_read_b128 v[108:111], v23 offset:0
s_waitcnt vmcnt(25)
ds_read_b128 v[112:115], v20 offset:4096
ds_read_b128 v[116:119], v21 offset:4096
ds_read_b128 v[120:123], v22 offset:4096
ds_read_b128 v[124:127], v23 offset:4096
s_waitcnt lgkmcnt(4)
s_add_u32 m0, s54, 0
s_nop 0
buffer_load_dwordx4 v16, s[32:35], s55 offen lds
s_add_u32 m0, s54, 1024
s_nop 0
buffer_load_dwordx4 v17, s[32:35], s55 offen lds
s_add_u32 m0, s54, 2048
s_nop 0
buffer_load_dwordx4 v18, s[32:35], s55 offen lds
s_add_u32 m0, s54, 3072
s_nop 0
buffer_load_dwordx4 v19, s[32:35], s55 offen lds
s_add_u32 s55, s55, 128
s_cmp_eq_u32 s55, 1280
s_cselect_b32 s55, 0, s55
v_dot2_f32_bf16 v10, v96, s51, v10
v_dot2_f32_bf16 v12, v96, v96, v12
v_dot2_f32_bf16 v11, v97, s51, v11
v_dot2_f32_bf16 v13, v97, v97, v13
v_dot2_f32_bf16 v10, v98, s51, v10
v_dot2_f32_bf16 v12, v98, v98, v12
v_dot2_f32_bf16 v11, v99, s51, v11
v_dot2_f32_bf16 v13, v99, v99, v13
v_dot2_f32_bf16 v10, v100, s51, v10
v_dot2_f32_bf16 v12, v100, v100, v12
v_dot2_f32_bf16 v11, v101, s51, v11
v_dot2_f32_bf16 v13, v101, v101, v13
v_dot2_f32_bf16 v10, v102, s51, v10
v_dot2_f32_bf16 v12, v102, v102, v12
v_dot2_f32_bf16 v11, v103, s51, v11
v_dot2_f32_bf16 v13, v103, v103, v13
v_dot2_f32_bf16 v10, v104, s51, v10
v_dot2_f32_bf16 v12, v104, v104, v12
v_dot2_f32_bf16 v11, v105, s51, v11
v_dot2_f32_bf16 v13, v105, v105, v13
v_dot2_f32_bf16 v10, v106, s51, v10
v_dot2_f32_bf16 v12, v106, v106, v12
v_dot2_f32_bf16 v11, v107, s51, v11
v_dot2_f32_bf16 v13, v107, v107, v13
v_dot2_f32_bf16 v10, v108, s51, v10
v_dot2_f32_bf16 v12, v108, v108, v12
v_dot2_f32_bf16 v11, v109, s51, v11
v_dot2_f32_bf16 v13, v109, v109, v13
v_dot2_f32_bf16 v10, v110, s51, v10
v_dot2_f32_bf16 v12, v110, v110, v12
v_dot2_f32_bf16 v11, v111, s51, v11
v_dot2_f32_bf16 v13, v111, v111, v13
s_waitcnt vmcnt(25)
ds_read_b128 v[128:131], v20 offset:8192
ds_read_b128 v[132:135], v21 offset:8192
ds_read_b128 v[136:139], v22 offset:8192
ds_read_b128 v[140:143], v23 offset:8192
s_waitcnt lgkmcnt(4)
s_add_u32 m0, s54, 4096
s_nop 0
buffer_load_dwordx4 v16, s[32:35], s55 offen lds
s_add_u32 m0, s54, 5120
s_nop 0
buffer_load_dwordx4 v17, s[32:35], s55 offen lds
s_add_u32 m0, s54, 6144
s_nop 0
buffer_load_dwordx4 v18, s[32:35], s55 offen lds
s_add_u32 m0, s54, 7168
s_nop 0
buffer_load_dwordx4 v19, s[32:35], s55 offen lds
s_add_u32 s55, s55, 128
s_cmp_eq_u32 s55, 1280
s_cselect_b32 s55, 0, s55
v_dot2_f32_bf16 v10, v112, s51, v10
v_dot2_f32_bf16 v12, v112, v112, v12
v_dot2_f32_bf16 v11, v113, s51, v11
v_dot2_f32_bf16 v13, v113, v113, v13
v_dot2_f32_bf16 v10, v114, s51, v10
v_dot2_f32_bf16 v12, v114, v114, v12
v_dot2_f32_bf16 v11, v115, s51, v11
v_dot2_f32_bf16 v13, v115, v115, v13
v_dot2_f32_bf16 v10, v116, s51, v10
v_dot2_f32_bf16 v12, v116, v116, v12
v_dot2_f32_bf16 v11, v117, s51, v11
v_dot2_f32_bf16 v13, v117, v117, v13
v_dot2_f32_bf16 v10, v118, s51, v10
v_dot2_f32_bf16 v12, v118, v118, v12
v_dot2_f32_bf16 v11, v119, s51, v11
v_dot2_f32_bf16 v13, v119, v119, v13
v_dot2_f32_bf16 v10, v120, s51, v10
v_dot2_f32_bf16 v12, v120, v120, v12
v_dot2_f32_bf16 v11, v121, s51, v11
v_dot2_f32_bf16 v13, v121, v121, v13
v_dot2_f32_bf16 v10, v122, s51, v10
v_dot2_f32_bf16 v12, v122, v122, v12
v_dot2_f32_bf16 v11, v123, s51, v11
v_dot2_f32_bf16 v13, v123, v123, v13
v_dot2_f32_bf16 v10, v124, s51, v10
v_dot2_f32_bf16 v12, v124, v124, v12
v_dot2_f32_bf16 v11, v125, s51, v11
v_dot2_f32_bf16 v13, v125, v125, v13
v_dot2_f32_bf16 v10, v126, s51, v10
v_dot2_f32_bf16 v12, v126, v126, v12
v_dot2_f32_bf16 v11, v127, s51, v11
v_dot2_f32_bf16 v13, v127, v127, v13
s_waitcnt vmcnt(25)
ds_read_b128 v[144:147], v20 offset:12288
ds_read_b128 v[148:151], v21 offset:12288
ds_read_b128 v[152:155], v22 offset:12288
ds_read_b128 v[156:159], v23 offset:12288
s_waitcnt lgkmcnt(4)
s_add_u32 m0, s54, 8192
s_nop 0
buffer_load_dwordx4 v16, s[32:35], s55 offen lds
s_add_u32 m0, s54, 9216
s_nop 0
buffer_load_dwordx4 v17, s[32:35], s55 offen lds
s_add_u32 m0, s54, 10240
s_nop 0
buffer_load_dwordx4 v18, s[32:35], s55 offen lds
s_add_u32 m0, s54, 11264
s_nop 0
buffer_load_dwordx4 v19, s[32:35], s55 offen lds
s_add_u32 s55, s55, 128
s_cmp_eq_u32 s55, 1280
s_cselect_b32 s55, 0, s55
s_add_u32 m0, s48, 20480
s_nop 0
buffer_load_dwordx4 v2, s[36:39], s49 offen lds
s_add_u32 m0, s48, 21504
s_nop 0
buffer_load_dwordx4 v3, s[36:39], s49 offen lds
s_add_u32 m0, s48, 22528
s_nop 0
buffer_load_dwordx4 v4, s[36:39], s49 offen lds
s_add_u32 m0, s48, 23552
s_nop 0
buffer_load_dwordx4 v5, s[36:39], s49 offen lds
s_add_u32 m0, s48, 24576
s_nop 0
buffer_load_dwordx4 v6, s[36:39], s49 offen lds
s_add_u32 s49, s49, 81920
s_cmp_eq_u32 s49, s58
s_cselect_b32 s49, s57, s49
v_dot2_f32_bf16 v10, v128, s51, v10
v_dot2_f32_bf16 v12, v128, v128, v12
v_dot2_f32_bf16 v11, v129, s51, v11
v_dot2_f32_bf16 v13, v129, v129, v13
v_dot2_f32_bf16 v10, v130, s51, v10
v_dot2_f32_bf16 v12, v130, v130, v12
v_dot2_f32_bf16 v11, v131, s51, v11
v_dot2_f32_bf16 v13, v131, v131, v13
v_dot2_f32_bf16 v10, v132, s51, v10
v_dot2_f32_bf16 v12, v132, v132, v12
v_dot2_f32_bf16 v11, v133, s51, v11
v_dot2_f32_bf16 v13, v133, v133, v13
v_dot2_f32_bf16 v10, v134, s51, v10
v_dot2_f32_bf16 v12, v134, v134, v12
v_dot2_f32_bf16 v11, v135, s51, v11
v_dot2_f32_bf16 v13, v135, v135, v13
v_dot2_f32_bf16 v10, v136, s51, v10
v_dot2_f32_bf16 v12, v136, v136, v12
v_dot2_f32_bf16 v11, v137, s51, v11
v_dot2_f32_bf16 v13, v137, v137, v13
v_dot2_f32_bf16 v10, v138, s51, v10
v_dot2_f32_bf16 v12, v138, v138, v12
v_dot2_f32_bf16 v11, v139, s51, v11
v_dot2_f32_bf16 v13, v139, v139, v13
v_dot2_f32_bf16 v10, v140, s51, v10
v_dot2_f32_bf16 v12, v140, v140, v12
v_dot2_f32_bf16 v11, v141, s51, v11
v_dot2_f32_bf16 v13, v141, v141, v13
v_dot2_f32_bf16 v10, v142, s51, v10
v_dot2_f32_bf16 v12, v142, v142, v12
v_dot2_f32_bf16 v11, v143, s51, v11
v_dot2_f32_bf16 v13, v143, v143, v13
s_waitcnt vmcnt(30)
ds_read_b128 v[160:163], v20 offset:16384
ds_read_b128 v[164:167], v21 offset:16384
ds_read_b128 v[168:171], v22 offset:16384
ds_read_b128 v[172:175], v23 offset:16384
s_waitcnt lgkmcnt(4)
v_dot2_f32_bf16 v10, v144, s51, v10
v_dot2_f32_bf16 v12, v144, v144, v12
v_dot2_f32_bf16 v11, v145, s51, v11
v_dot2_f32_bf16 v13, v145, v145, v13
v_dot2_f32_bf16 v10, v146, s51, v10
v_dot2_f32_bf16 v12, v146, v146, v12
v_dot2_f32_bf16 v11, v147, s51, v11
v_dot2_f32_bf16 v13, v147, v147, v13
v_dot2_f32_bf16 v10, v148, s51, v10
v_dot2_f32_bf16 v12, v148, v148, v12
v_dot2_f32_bf16 v11, v149, s51, v11
v_dot2_f32_bf16 v13, v149, v149, v13
v_dot2_f32_bf16 v10, v150, s51, v10
v_dot2_f32_bf16 v12, v150, v150, v12
v_dot2_f32_bf16 v11, v151, s51, v11
v_dot2_f32_bf16 v13, v151, v151, v13
v_dot2_f32_bf16 v10, v152, s51, v10
v_dot2_f32_bf16 v12, v152, v152, v12
v_dot2_f32_bf16 v11, v153, s51, v11
v_dot2_f32_bf16 v13, v153, v153, v13
v_dot2_f32_bf16 v10, v154, s51, v10
v_dot2_f32_bf16 v12, v154, v154, v12
v_dot2_f32_bf16 v11, v155, s51, v11
v_dot2_f32_bf16 v13, v155, v155, v13
v_dot2_f32_bf16 v10, v156, s51, v10
v_dot2_f32_bf16 v12, v156, v156, v12
v_dot2_f32_bf16 v11, v157, s51, v11
v_dot2_f32_bf16 v13, v157, v157, v13
v_dot2_f32_bf16 v10, v158, s51, v10
v_dot2_f32_bf16 v12, v158, v158, v12
v_dot2_f32_bf16 v11, v159, s51, v11
v_dot2_f32_bf16 v13, v159, v159, v13
s_waitcnt vmcnt(26)
ds_read_b128 v[176:179], v20 offset:20480
ds_read_b128 v[180:183], v21 offset:20480
ds_read_b128 v[184:187], v22 offset:20480
ds_read_b128 v[188:191], v23 offset:20480
s_waitcnt lgkmcnt(4)
v_dot2_f32_bf16 v10, v160, s51, v10
v_dot2_f32_bf16 v12, v160, v160, v12
v_dot2_f32_bf16 v11, v161, s51, v11
v_dot2_f32_bf16 v13, v161, v161, v13
v_dot2_f32_bf16 v10, v162, s51, v10
v_dot2_f32_bf16 v12, v162, v162, v12
v_dot2_f32_bf16 v11, v163, s51, v11
v_dot2_f32_bf16 v13, v163, v163, v13
v_dot2_f32_bf16 v10, v164, s51, v10
v_dot2_f32_bf16 v12, v164, v164, v12
v_dot2_f32_bf16 v11, v165, s51, v11
v_dot2_f32_bf16 v13, v165, v165, v13
v_dot2_f32_bf16 v10, v166, s51, v10
v_dot2_f32_bf16 v12, v166, v166, v12
v_dot2_f32_bf16 v11, v167, s51, v11
v_dot2_f32_bf16 v13, v167, v167, v13
v_dot2_f32_bf16 v10, v168, s51, v10
v_dot2_f32_bf16 v12, v168, v168, v12
v_dot2_f32_bf16 v11, v169, s51, v11
v_dot2_f32_bf16 v13, v169, v169, v13
v_dot2_f32_bf16 v10, v170, s51, v10
v_dot2_f32_bf16 v12, v170, v170, v12
v_dot2_f32_bf16 v11, v171, s51, v11
v_dot2_f32_bf16 v13, v171, v171, v13
v_dot2_f32_bf16 v10, v172, s51, v10
v_dot2_f32_bf16 v12, v172, v172, v12
v_dot2_f32_bf16 v11, v173, s51, v11
v_dot2_f32_bf16 v13, v173, v173, v13
v_dot2_f32_bf16 v10, v174, s51, v10
v_dot2_f32_bf16 v12, v174, v174, v12
v_dot2_f32_bf16 v11, v175, s51, v11
v_dot2_f32_bf16 v13, v175, v175, v13
s_waitcnt vmcnt(22)
ds_read_b128 v[192:195], v20 offset:24576
ds_read_b128 v[196:199], v21 offset:24576
ds_read_b128 v[200:203], v22 offset:24576
ds_read_b128 v[204:207], v23 offset:24576
s_waitcnt lgkmcnt(4)
v_dot2_f32_bf16 v10, v176, s51, v10
v_dot2_f32_bf16 v12, v176, v176, v12
v_dot2_f32_bf16 v11, v177, s51, v11
v_dot2_f32_bf16 v13, v177, v177, v13
v_dot2_f32_bf16 v10, v178, s51, v10
v_dot2_f32_bf16 v12, v178, v178, v12
v_dot2_f32_bf16 v11, v179, s51, v11
v_dot2_f32_bf16 v13, v179, v179, v13
v_dot2_f32_bf16 v10, v180, s51, v10
v_dot2_f32_bf16 v12, v180, v180, v12
v_dot2_f32_bf16 v11, v181, s51, v11
v_dot2_f32_bf16 v13, v181, v181, v13
v_dot2_f32_bf16 v10, v182, s51, v10
v_dot2_f32_bf16 v12, v182, v182, v12
v_dot2_f32_bf16 v11, v183, s51, v11
v_dot2_f32_bf16 v13, v183, v183, v13
v_dot2_f32_bf16 v10, v184, s51, v10
v_dot2_f32_bf16 v12, v184, v184, v12
v_dot2_f32_bf16 v11, v185, s51, v11
v_dot2_f32_bf16 v13, v185, v185, v13
v_dot2_f32_bf16 v10, v186, s51, v10
v_dot2_f32_bf16 v12, v186, v186, v12
v_dot2_f32_bf16 v11, v187, s51, v11
v_dot2_f32_bf16 v13, v187, v187, v13
v_dot2_f32_bf16 v10, v188, s51, v10
v_dot2_f32_bf16 v12, v188, v188, v12
v_dot2_f32_bf16 v11, v189, s51, v11
v_dot2_f32_bf16 v13, v189, v189, v13
v_dot2_f32_bf16 v10, v190, s51, v10
v_dot2_f32_bf16 v12, v190, v190, v12
v_dot2_f32_bf16 v11, v191, s51, v11
v_dot2_f32_bf16 v13, v191, v191, v13
s_waitcnt vmcnt(13)
ds_read_b128 v[208:211], v20 offset:0
ds_read_b128 v[212:215], v21 offset:0
ds_read_b128 v[216:219], v22 offset:0
ds_read_b128 v[220:223], v23 offset:0
s_waitcnt lgkmcnt(4)
v_dot2_f32_bf16 v10, v192, s51, v10
v_dot2_f32_bf16 v12, v192, v192, v12
v_dot2_f32_bf16 v11, v193, s51, v11
v_dot2_f32_bf16 v13, v193, v193, v13
v_dot2_f32_bf16 v10, v194, s51, v10
v_dot2_f32_bf16 v12, v194, v194, v12
v_dot2_f32_bf16 v11, v195, s51, v11
v_dot2_f32_bf16 v13, v195, v195, v13
v_dot2_f32_bf16 v10, v196, s51, v10
v_dot2_f32_bf16 v12, v196, v196, v12
v_dot2_f32_bf16 v11, v197, s51, v11
v_dot2_f32_bf16 v13, v197, v197, v13
v_dot2_f32_bf16 v10, v198, s51, v10
v_dot2_f32_bf16 v12, v198, v198, v12
v_dot2_f32_bf16 v11, v199, s51, v11
v_dot2_f32_bf16 v13, v199, v199, v13
v_dot2_f32_bf16 v10, v200, s51, v10
v_dot2_f32_bf16 v12, v200, v200, v12
v_dot2_f32_bf16 v11, v201, s51, v11
v_dot2_f32_bf16 v13, v201, v201, v13
v_dot2_f32_bf16 v10, v202, s51, v10
v_dot2_f32_bf16 v12, v202, v202, v12
v_dot2_f32_bf16 v11, v203, s51, v11
v_dot2_f32_bf16 v13, v203, v203, v13
v_dot2_f32_bf16 v10, v204, s51, v10
v_dot2_f32_bf16 v12, v204, v204, v12
v_dot2_f32_bf16 v11, v205, s51, v11
v_dot2_f32_bf16 v13, v205, v205, v13
v_dot2_f32_bf16 v10, v206, s51, v10
v_dot2_f32_bf16 v12, v206, v206, v12
v_dot2_f32_bf16 v11, v207, s51, v11
v_dot2_f32_bf16 v13, v207, v207, v13
s_waitcnt vmcnt(9)
ds_read_b128 v[224:227], v20 offset:4096
ds_read_b128 v[228:231], v21 offset:4096
ds_read_b128 v[232:235], v22 offset:4096
ds_read_b128 v[236:239], v23 offset:4096
s_waitcnt lgkmcnt(4)
v_dot2_f32_bf16 v10, v208, s51, v10
v_dot2_f32_bf16 v12, v208, v208, v12
v_dot2_f32_bf16 v11, v209, s51, v11
v_dot2_f32_bf16 v13, v209, v209, v13
v_dot2_f32_bf16 v10, v210, s51, v10
v_dot2_f32_bf16 v12, v210, v210, v12
v_dot2_f32_bf16 v11, v211, s51, v11
v_dot2_f32_bf16 v13, v211, v211, v13
v_dot2_f32_bf16 v10, v212, s51, v10
v_dot2_f32_bf16 v12, v212, v212, v12
v_dot2_f32_bf16 v11, v213, s51, v11
v_dot2_f32_bf16 v13, v213, v213, v13
v_dot2_f32_bf16 v10, v214, s51, v10
v_dot2_f32_bf16 v12, v214, v214, v12
v_dot2_f32_bf16 v11, v215, s51, v11
v_dot2_f32_bf16 v13, v215, v215, v13
v_dot2_f32_bf16 v10, v216, s51, v10
v_dot2_f32_bf16 v12, v216, v216, v12
v_dot2_f32_bf16 v11, v217, s51, v11
v_dot2_f32_bf16 v13, v217, v217, v13
v_dot2_f32_bf16 v10, v218, s51, v10
v_dot2_f32_bf16 v12, v218, v218, v12
v_dot2_f32_bf16 v11, v219, s51, v11
v_dot2_f32_bf16 v13, v219, v219, v13
v_dot2_f32_bf16 v10, v220, s51, v10
v_dot2_f32_bf16 v12, v220, v220, v12
v_dot2_f32_bf16 v11, v221, s51, v11
v_dot2_f32_bf16 v13, v221, v221, v13
v_dot2_f32_bf16 v10, v222, s51, v10
v_dot2_f32_bf16 v12, v222, v222, v12
v_dot2_f32_bf16 v11, v223, s51, v11
v_dot2_f32_bf16 v13, v223, v223, v13
s_waitcnt vmcnt(5)
ds_read_b128 v[240:243], v20 offset:8192
ds_read_b128 v[244:247], v21 offset:8192
ds_read_b128 v[248:251], v22 offset:8192
ds_read_b128 v[252:255], v23 offset:8192
s_waitcnt lgkmcnt(4)
v_dot2_f32_bf16 v10, v224, s51, v10
v_dot2_f32_bf16 v12, v224, v224, v12
v_dot2_f32_bf16 v11, v225, s51, v11
v_dot2_f32_bf16 v13, v225, v225, v13
v_dot2_f32_bf16 v10, v226, s51, v10
v_dot2_f32_bf16 v12, v226, v226, v12
v_dot2_f32_bf16 v11, v227, s51, v11
v_dot2_f32_bf16 v13, v227, v227, v13
v_dot2_f32_bf16 v10, v228, s51, v10
v_dot2_f32_bf16 v12, v228, v228, v12
v_dot2_f32_bf16 v11, v229, s51, v11
v_dot2_f32_bf16 v13, v229, v229, v13
v_dot2_f32_bf16 v10, v230, s51, v10
v_dot2_f32_bf16 v12, v230, v230, v12
v_dot2_f32_bf16 v11, v231, s51, v11
v_dot2_f32_bf16 v13, v231, v231, v13
v_dot2_f32_bf16 v10, v232, s51, v10
v_dot2_f32_bf16 v12, v232, v232, v12
v_dot2_f32_bf16 v11, v233, s51, v11
v_dot2_f32_bf16 v13, v233, v233, v13
v_dot2_f32_bf16 v10, v234, s51, v10
v_dot2_f32_bf16 v12, v234, v234, v12
v_dot2_f32_bf16 v11, v235, s51, v11
v_dot2_f32_bf16 v13, v235, v235, v13
v_dot2_f32_bf16 v10, v236, s51, v10
v_dot2_f32_bf16 v12, v236, v236, v12
v_dot2_f32_bf16 v11, v237, s51, v11
v_dot2_f32_bf16 v13, v237, v237, v13
v_dot2_f32_bf16 v10, v238, s51, v10
v_dot2_f32_bf16 v12, v238, v238, v12
v_dot2_f32_bf16 v11, v239, s51, v11
v_dot2_f32_bf16 v13, v239, v239, v13
s_waitcnt lgkmcnt(0)
s_waitcnt vmcnt(17)
s_barrier
ds_read_b64_tr_b16 a[0:1], v7 offset:0
ds_read_b64_tr_b16 a[2:3], v7 offset:1280
ds_read_b64_tr_b16 a[4:5], v7 offset:64
ds_read_b64_tr_b16 a[6:7], v7 offset:1344
ds_read_b64_tr_b16 a[8:9], v7 offset:128
ds_read_b64_tr_b16 a[10:11], v7 offset:1408
ds_read_b64_tr_b16 a[12:13], v7 offset:192
ds_read_b64_tr_b16 a[14:15], v7 offset:1472
ds_read_b64_tr_b16 a[16:17], v7 offset:256
ds_read_b64_tr_b16 a[18:19], v7 offset:1536
ds_read_b64_tr_b16 a[20:21], v7 offset:5120
ds_read_b64_tr_b16 a[22:23], v7 offset:6400
ds_read_b64_tr_b16 a[24:25], v7 offset:5184
ds_read_b64_tr_b16 a[26:27], v7 offset:6464
ds_read_b64_tr_b16 a[28:29], v7 offset:5248
ds_read_b64_tr_b16 a[30:31], v7 offset:6528
ds_read_b64_tr_b16 a[32:33], v7 offset:5312
ds_read_b64_tr_b16 a[34:35], v7 offset:6592
s_add_u32 m0, s48, 40960
s_nop 0
buffer_load_dwordx4 v2, s[36:39], s49 offen lds
s_add_u32 m0, s48, 41984
s_nop 0
buffer_load_dwordx4 v3, s[36:39], s49 offen lds
s_add_u32 m0, s48, 43008
s_nop 0
buffer_load_dwordx4 v4, s[36:39], s49 offen lds
s_add_u32 m0, s48, 44032
s_nop 0
buffer_load_dwordx4 v5, s[36:39], s49 offen lds
s_add_u32 m0, s48, 45056
s_nop 0
buffer_load_dwordx4 v6, s[36:39], s49 offen lds
s_add_u32 s49, s49, 81920
s_cmp_eq_u32 s49, s58
s_cselect_b32 s49, s57, s49
v_dot2_f32_bf16 v10, v240, s51, v10
v_dot2_f32_bf16 v12, v240, v240, v12
v_dot2_f32_bf16 v11, v241, s51, v11
v_dot2_f32_bf16 v13, v241, v241, v13
v_dot2_f32_bf16 v10, v242, s51, v10
v_dot2_f32_bf16 v12, v242, v242, v12
v_dot2_f32_bf16 v11, v243, s51, v11
v_dot2_f32_bf16 v13, v243, v243, v13
v_dot2_f32_bf16 v10, v244, s51, v10
v_dot2_f32_bf16 v12, v244, v244, v12
v_dot2_f32_bf16 v11, v245, s51, v11
v_dot2_f32_bf16 v13, v245, v245, v13
v_dot2_f32_bf16 v10, v246, s51, v10
v_dot2_f32_bf16 v12, v246, v246, v12
v_dot2_f32_bf16 v11, v247, s51, v11
v_dot2_f32_bf16 v13, v247, v247, v13
v_dot2_f32_bf16 v10, v248, s51, v10
v_dot2_f32_bf16 v12, v248, v248, v12
v_dot2_f32_bf16 v11, v249, s51, v11
v_dot2_f32_bf16 v13, v249, v249, v13
v_dot2_f32_bf16 v10, v250, s51, v10
v_dot2_f32_bf16 v12, v250, v250, v12
v_dot2_f32_bf16 v11, v251, s51, v11
v_dot2_f32_bf16 v13, v251, v251, v13
v_dot2_f32_bf16 v10, v252, s51, v10
v_dot2_f32_bf16 v12, v252, v252, v12
v_dot2_f32_bf16 v11, v253, s51, v11
v_dot2_f32_bf16 v13, v253, v253, v13
v_dot2_f32_bf16 v10, v254, s51, v10
v_dot2_f32_bf16 v12, v254, v254, v12
v_dot2_f32_bf16 v11, v255, s51, v11
v_dot2_f32_bf16 v13, v255, v255, v13
s_nop 1
v_add_f32 v10, v10, v11
v_add_f32 v12, v12, v13
v_mov_b32 v11, v10
v_mov_b32 v13, v12
s_nop 0
v_permlane32_swap_b32 v10, v11
v_permlane32_swap_b32 v12, v13
v_add_f32 v10, v10, v11
v_add_f32 v12, v12, v13
v_mul_f32 v10, 0x3acccccd, v10
v_mul_f32 v12, 0x3acccccd, v12
v_fma_f32 v12, -v10, v10, v12
v_max_f32 v12, 0, v12
v_mov_b32 v13, v10
v_mov_b32 v14, v12
v_cvt_pk_bf16_f32 v13, v13, v13
v_lshlrev_b32 v13, 16, v13
v_cvt_pk_bf16_f32 v14, v14, v14
v_lshlrev_b32 v14, 16, v14
v_add_f32 v14, 0x3727c5ac, v14
v_cvt_pk_bf16_f32 v14, v14, v14
v_lshlrev_b32 v14, 16, v14
v_sqrt_f32 v14, v14
s_nop 0
v_cvt_pk_bf16_f32 v14, v14, v14
v_lshlrev_b32 v14, 16, v14
v_rcp_f32 v14, v14
s_nop 0
v_mul_f32 v11, v13, v14
v_sub_f32 v11, 0, v11
v_mov_b32 v10, v14
v_lshlrev_b32 v12, 16, v96
v_and_b32 v13, s63, v96
v_lshlrev_b32 v14, 16, v97
v_and_b32 v15, s63, v97
v_fma_f32 v12, v12, v10, v11
v_fma_f32 v13, v13, v10, v11
v_fma_f32 v14, v14, v10, v11
v_fma_f32 v15, v15, v10, v11
v_cvt_pk_bf16_f32 v96, v12, v13
v_cvt_pk_bf16_f32 v97, v14, v15
v_lshlrev_b32 v12, 16, v98
v_and_b32 v13, s63, v98
v_lshlrev_b32 v14, 16, v99
v_and_b32 v15, s63, v99
v_fma_f32 v12, v12, v10, v11
v_fma_f32 v13, v13, v10, v11
v_fma_f32 v14, v14, v10, v11
v_fma_f32 v15, v15, v10, v11
v_cvt_pk_bf16_f32 v98, v12, v13
v_cvt_pk_bf16_f32 v99, v14, v15
s_waitcnt lgkmcnt(8)
s_nop 0
v_mfma_f32_32x32x16_bf16 v[16:31], v[96:99], a[0:3], 0
ds_read_b64_tr_b16 a[36:37], v7 offset:5376
ds_read_b64_tr_b16 a[38:39], v7 offset:6656
v_lshlrev_b32 v12, 16, v100
v_and_b32 v13, s63, v100
v_lshlrev_b32 v14, 16, v101
v_and_b32 v15, s63, v101
s_add_u32 m0, s48, 61440
s_nop 0
buffer_load_dwordx4 v2, s[36:39], s49 offen lds
v_mfma_f32_32x32x16_bf16 v[32:47], v[96:99], a[4:7], 0
ds_read_b64_tr_b16 a[0:1], v7 offset:10240
ds_read_b64_tr_b16 a[2:3], v7 offset:11520
v_fma_f32 v12, v12, v10, v11
v_fma_f32 v13, v13, v10, v11
v_fma_f32 v14, v14, v10, v11
v_fma_f32 v15, v15, v10, v11
v_mfma_f32_32x32x16_bf16 v[48:63], v[96:99], a[8:11], 0
ds_read_b64_tr_b16 a[4:5], v7 offset:10304
ds_read_b64_tr_b16 a[6:7], v7 offset:11584
v_cvt_pk_bf16_f32 v100, v12, v13
v_cvt_pk_bf16_f32 v101, v14, v15
v_lshlrev_b32 v12, 16, v102
v_and_b32 v13, s63, v102
s_add_u32 m0, s48, 62464
s_nop 0
buffer_load_dwordx4 v3, s[36:39], s49 offen lds
v_mfma_f32_32x32x16_bf16 v[64:79], v[96:99], a[12:15], 0
ds_read_b64_tr_b16 a[8:9], v7 offset:10368
ds_read_b64_tr_b16 a[10:11], v7 offset:11648
v_lshlrev_b32 v14, 16, v103
v_and_b32 v15, s63, v103
v_fma_f32 v12, v12, v10, v11
v_fma_f32 v13, v13, v10, v11
v_mfma_f32_32x32x16_bf16 v[80:95], v[96:99], a[16:19], 0
ds_read_b64_tr_b16 a[12:13], v7 offset:10432
ds_read_b64_tr_b16 a[14:15], v7 offset:11712
v_fma_f32 v14, v14, v10, v11
v_fma_f32 v15, v15, v10, v11
v_cvt_pk_bf16_f32 v102, v12, v13
v_cvt_pk_bf16_f32 v103, v14, v15
s_add_u32 m0, s48, 63488
s_nop 0
buffer_load_dwordx4 v4, s[36:39], s49 offen lds
s_waitcnt lgkmcnt(8)
v_mfma_f32_32x32x16_bf16 v[16:31], v[100:103], a[20:23], v[16:31]
ds_read_b64_tr_b16 a[16:17], v7 offset:10496
ds_read_b64_tr_b16 a[18:19], v7 offset:11776
v_lshlrev_b32 v12, 16, v104
v_and_b32 v13, s63, v104
v_lshlrev_b32 v14, 16, v105
v_and_b32 v15, s63, v105
v_mfma_f32_32x32x16_bf16 v[32:47], v[100:103], a[24:27], v[32:47]
ds_read_b64_tr_b16 a[20:21], v7 offset:15360
ds_read_b64_tr_b16 a[22:23], v7 offset:16640
v_fma_f32 v12, v12, v10, v11
v_fma_f32 v13, v13, v10, v11
v_fma_f32 v14, v14, v10, v11
v_fma_f32 v15, v15, v10, v11
s_add_u32 m0, s48, 64512
s_nop 0
buffer_load_dwordx4 v5, s[36:39], s49 offen lds
v_mfma_f32_32x32x16_bf16 v[48:63], v[100:103], a[28:31], v[48:63]
ds_read_b64_tr_b16 a[24:25], v7 offset:15424
ds_read_b64_tr_b16 a[26:27], v7 offset:16704
v_cvt_pk_bf16_f32 v104, v12, v13
v_cvt_pk_bf16_f32 v105, v14, v15
v_lshlrev_b32 v12, 16, v106
v_and_b32 v13, s63, v106
v_mfma_f32_32x32x16_bf16 v[64:79], v[100:103], a[32:35], v[64:79]
ds_read_b64_tr_b16 a[28:29], v7 offset:15488
ds_read_b64_tr_b16 a[30:31], v7 offset:16768
v_lshlrev_b32 v14, 16, v107
v_and_b32 v15, s63, v107
v_fma_f32 v12, v12, v10, v11
v_fma_f32 v13, v13, v10, v11
s_add_u32 m0, s48, 65536
s_nop 0
buffer_load_dwordx4 v6, s[36:39], s49 offen lds
s_add_u32 s49, s49, 81920
s_cmp_eq_u32 s49, s58
s_cselect_b32 s49, s57, s49
v_mfma_f32_32x32x16_bf16 v[80:95], v[100:103], a[36:39], v[80:95]
ds_read_b64_tr_b16 a[32:33], v7 offset:15552
ds_read_b64_tr_b16 a[34:35], v7 offset:16832
v_fma_f32 v14, v14, v10, v11
v_fma_f32 v15, v15, v10, v11
v_cvt_pk_bf16_f32 v106, v12, v13
v_cvt_pk_bf16_f32 v107, v14, v15
s_waitcnt lgkmcnt(8)
s_nop 0
v_mfma_f32_32x32x16_bf16 v[16:31], v[104:107], a[0:3], v[16:31]
ds_read_b64_tr_b16 a[36:37], v7 offset:15616
ds_read_b64_tr_b16 a[38:39], v7 offset:16896
v_lshlrev_b32 v12, 16, v108
v_and_b32 v13, s63, v108
v_lshlrev_b32 v14, 16, v109
v_and_b32 v15, s63, v109
s_add_u32 m0, s48, 81920
s_nop 0
buffer_load_dwordx4 v2, s[36:39], s49 offen lds
v_mfma_f32_32x32x16_bf16 v[32:47], v[104:107], a[4:7], v[32:47]
s_waitcnt vmcnt(11)
s_barrier
ds_read_b64_tr_b16 a[0:1], v7 offset:20480
ds_read_b64_tr_b16 a[2:3], v7 offset:21760
v_fma_f32 v12, v12, v10, v11
v_fma_f32 v13, v13, v10, v11
v_fma_f32 v14, v14, v10, v11
v_fma_f32 v15, v15, v10, v11
v_mfma_f32_32x32x16_bf16 v[48:63], v[104:107], a[8:11], v[48:63]
ds_read_b64_tr_b16 a[4:5], v7 offset:20544
ds_read_b64_tr_b16 a[6:7], v7 offset:21824
v_cvt_pk_bf16_f32 v108, v12, v13
v_cvt_pk_bf16_f32 v109, v14, v15
v_lshlrev_b32 v12, 16, v110
v_and_b32 v13, s63, v110
s_add_u32 m0, s48, 82944
s_nop 0
buffer_load_dwordx4 v3, s[36:39], s49 offen lds
v_mfma_f32_32x32x16_bf16 v[64:79], v[104:107], a[12:15], v[64:79]
ds_read_b64_tr_b16 a[8:9], v7 offset:20608
ds_read_b64_tr_b16 a[10:11], v7 offset:21888
v_lshlrev_b32 v14, 16, v111
v_and_b32 v15, s63, v111
v_fma_f32 v12, v12, v10, v11
v_fma_f32 v13, v13, v10, v11
v_mfma_f32_32x32x16_bf16 v[80:95], v[104:107], a[16:19], v[80:95]
ds_read_b64_tr_b16 a[12:13], v7 offset:20672
ds_read_b64_tr_b16 a[14:15], v7 offset:21952
v_fma_f32 v14, v14, v10, v11
v_fma_f32 v15, v15, v10, v11
v_cvt_pk_bf16_f32 v110, v12, v13
v_cvt_pk_bf16_f32 v111, v14, v15
s_add_u32 m0, s48, 83968
s_nop 0
buffer_load_dwordx4 v4, s[36:39], s49 offen lds
s_waitcnt lgkmcnt(8)
v_mfma_f32_32x32x16_bf16 v[16:31], v[108:111], a[20:23], v[16:31]
ds_read_b64_tr_b16 a[16:17], v7 offset:20736
ds_read_b64_tr_b16 a[18:19], v7 offset:22016
v_lshlrev_b32 v12, 16, v112
v_and_b32 v13, s63, v112
v_lshlrev_b32 v14, 16, v113
v_and_b32 v15, s63, v113
v_mfma_f32_32x32x16_bf16 v[32:47], v[108:111], a[24:27], v[32:47]
ds_read_b64_tr_b16 a[20:21], v7 offset:25600
ds_read_b64_tr_b16 a[22:23], v7 offset:26880
v_fma_f32 v12, v12, v10, v11
v_fma_f32 v13, v13, v10, v11
v_fma_f32 v14, v14, v10, v11
v_fma_f32 v15, v15, v10, v11
s_add_u32 m0, s48, 84992
s_nop 0
buffer_load_dwordx4 v5, s[36:39], s49 offen lds
v_mfma_f32_32x32x16_bf16 v[48:63], v[108:111], a[28:31], v[48:63]
ds_read_b64_tr_b16 a[24:25], v7 offset:25664
ds_read_b64_tr_b16 a[26:27], v7 offset:26944
v_cvt_pk_bf16_f32 v112, v12, v13
v_cvt_pk_bf16_f32 v113, v14, v15
v_lshlrev_b32 v12, 16, v114
v_and_b32 v13, s63, v114
v_mfma_f32_32x32x16_bf16 v[64:79], v[108:111], a[32:35], v[64:79]
ds_read_b64_tr_b16 a[28:29], v7 offset:25728
ds_read_b64_tr_b16 a[30:31], v7 offset:27008
v_lshlrev_b32 v14, 16, v115
v_and_b32 v15, s63, v115
v_fma_f32 v12, v12, v10, v11
v_fma_f32 v13, v13, v10, v11
s_add_u32 m0, s48, 86016
s_nop 0
buffer_load_dwordx4 v6, s[36:39], s49 offen lds
s_add_u32 s49, s49, 81920
s_cmp_eq_u32 s49, s58
s_cselect_b32 s49, s57, s49
v_mfma_f32_32x32x16_bf16 v[80:95], v[108:111], a[36:39], v[80:95]
ds_read_b64_tr_b16 a[32:33], v7 offset:25792
ds_read_b64_tr_b16 a[34:35], v7 offset:27072
v_fma_f32 v14, v14, v10, v11
v_fma_f32 v15, v15, v10, v11
v_cvt_pk_bf16_f32 v114, v12, v13
v_cvt_pk_bf16_f32 v115, v14, v15
s_waitcnt lgkmcnt(8)
s_nop 0
v_mfma_f32_32x32x16_bf16 v[16:31], v[112:115], a[0:3], v[16:31]
ds_read_b64_tr_b16 a[36:37], v7 offset:25856
ds_read_b64_tr_b16 a[38:39], v7 offset:27136
v_lshlrev_b32 v12, 16, v116
v_and_b32 v13, s63, v116
v_lshlrev_b32 v14, 16, v117
v_and_b32 v15, s63, v117
s_add_u32 m0, s48, 102400
s_nop 0
buffer_load_dwordx4 v2, s[36:39], s49 offen lds
v_mfma_f32_32x32x16_bf16 v[32:47], v[112:115], a[4:7], v[32:47]
ds_read_b64_tr_b16 a[0:1], v7 offset:30720
ds_read_b64_tr_b16 a[2:3], v7 offset:32000
v_fma_f32 v12, v12, v10, v11
v_fma_f32 v13, v13, v10, v11
v_fma_f32 v14, v14, v10, v11
v_fma_f32 v15, v15, v10, v11
v_mfma_f32_32x32x16_bf16 v[48:63], v[112:115], a[8:11], v[48:63]
ds_read_b64_tr_b16 a[4:5], v7 offset:30784
ds_read_b64_tr_b16 a[6:7], v7 offset:32064
v_cvt_pk_bf16_f32 v116, v12, v13
v_cvt_pk_bf16_f32 v117, v14, v15
v_lshlrev_b32 v12, 16, v118
v_and_b32 v13, s63, v118
s_add_u32 m0, s48, 103424
s_nop 0
buffer_load_dwordx4 v3, s[36:39], s49 offen lds
v_mfma_f32_32x32x16_bf16 v[64:79], v[112:115], a[12:15], v[64:79]
ds_read_b64_tr_b16 a[8:9], v7 offset:30848
ds_read_b64_tr_b16 a[10:11], v7 offset:32128
v_lshlrev_b32 v14, 16, v119
v_and_b32 v15, s63, v119
v_fma_f32 v12, v12, v10, v11
v_fma_f32 v13, v13, v10, v11
v_mfma_f32_32x32x16_bf16 v[80:95], v[112:115], a[16:19], v[80:95]
ds_read_b64_tr_b16 a[12:13], v7 offset:30912
ds_read_b64_tr_b16 a[14:15], v7 offset:32192
v_fma_f32 v14, v14, v10, v11
v_fma_f32 v15, v15, v10, v11
v_cvt_pk_bf16_f32 v118, v12, v13
v_cvt_pk_bf16_f32 v119, v14, v15
s_add_u32 m0, s48, 104448
s_nop 0
buffer_load_dwordx4 v4, s[36:39], s49 offen lds
s_waitcnt lgkmcnt(8)
v_mfma_f32_32x32x16_bf16 v[16:31], v[116:119], a[20:23], v[16:31]
ds_read_b64_tr_b16 a[16:17], v7 offset:30976
ds_read_b64_tr_b16 a[18:19], v7 offset:32256
v_lshlrev_b32 v12, 16, v120
v_and_b32 v13, s63, v120
v_lshlrev_b32 v14, 16, v121
v_and_b32 v15, s63, v121
v_mfma_f32_32x32x16_bf16 v[32:47], v[116:119], a[24:27], v[32:47]
ds_read_b64_tr_b16 a[20:21], v7 offset:35840
ds_read_b64_tr_b16 a[22:23], v7 offset:37120
v_fma_f32 v12, v12, v10, v11
v_fma_f32 v13, v13, v10, v11
v_fma_f32 v14, v14, v10, v11
v_fma_f32 v15, v15, v10, v11
s_add_u32 m0, s48, 105472
s_nop 0
buffer_load_dwordx4 v5, s[36:39], s49 offen lds
v_mfma_f32_32x32x16_bf16 v[48:63], v[116:119], a[28:31], v[48:63]
ds_read_b64_tr_b16 a[24:25], v7 offset:35904
ds_read_b64_tr_b16 a[26:27], v7 offset:37184
v_cvt_pk_bf16_f32 v120, v12, v13
v_cvt_pk_bf16_f32 v121, v14, v15
v_lshlrev_b32 v12, 16, v122
v_and_b32 v13, s63, v122
v_mfma_f32_32x32x16_bf16 v[64:79], v[116:119], a[32:35], v[64:79]
ds_read_b64_tr_b16 a[28:29], v7 offset:35968
ds_read_b64_tr_b16 a[30:31], v7 offset:37248
v_lshlrev_b32 v14, 16, v123
v_and_b32 v15, s63, v123
v_fma_f32 v12, v12, v10, v11
v_fma_f32 v13, v13, v10, v11
s_add_u32 m0, s48, 106496
s_nop 0
buffer_load_dwordx4 v6, s[36:39], s49 offen lds
s_add_u32 s49, s49, 81920
s_cmp_eq_u32 s49, s58
s_cselect_b32 s49, s57, s49
v_mfma_f32_32x32x16_bf16 v[80:95], v[116:119], a[36:39], v[80:95]
ds_read_b64_tr_b16 a[32:33], v7 offset:36032
ds_read_b64_tr_b16 a[34:35], v7 offset:37312
v_fma_f32 v14, v14, v10, v11
v_fma_f32 v15, v15, v10, v11
v_cvt_pk_bf16_f32 v122, v12, v13
v_cvt_pk_bf16_f32 v123, v14, v15
s_waitcnt lgkmcnt(8)
s_nop 0
v_mfma_f32_32x32x16_bf16 v[16:31], v[120:123], a[0:3], v[16:31]
ds_read_b64_tr_b16 a[36:37], v7 offset:36096
ds_read_b64_tr_b16 a[38:39], v7 offset:37376
v_lshlrev_b32 v12, 16, v124
v_and_b32 v13, s63, v124
v_lshlrev_b32 v14, 16, v125
v_and_b32 v15, s63, v125
s_add_u32 m0, s48, 122880
s_nop 0
buffer_load_dwordx4 v2, s[36:39], s49 offen lds
v_mfma_f32_32x32x16_bf16 v[32:47], v[120:123], a[4:7], v[32:47]
s_waitcnt vmcnt(16)
s_barrier
ds_read_b64_tr_b16 a[0:1], v7 offset:40960
ds_read_b64_tr_b16 a[2:3], v7 offset:42240
v_fma_f32 v12, v12, v10, v11
v_fma_f32 v13, v13, v10, v11
v_fma_f32 v14, v14, v10, v11
v_fma_f32 v15, v15, v10, v11
v_mfma_f32_32x32x16_bf16 v[48:63], v[120:123], a[8:11], v[48:63]
ds_read_b64_tr_b16 a[4:5], v7 offset:41024
ds_read_b64_tr_b16 a[6:7], v7 offset:42304
v_cvt_pk_bf16_f32 v124, v12, v13
v_cvt_pk_bf16_f32 v125, v14, v15
v_lshlrev_b32 v12, 16, v126
v_and_b32 v13, s63, v126
s_add_u32 m0, s48, 123904
s_nop 0
buffer_load_dwordx4 v3, s[36:39], s49 offen lds
v_mfma_f32_32x32x16_bf16 v[64:79], v[120:123], a[12:15], v[64:79]
ds_read_b64_tr_b16 a[8:9], v7 offset:41088
ds_read_b64_tr_b16 a[10:11], v7 offset:42368
v_lshlrev_b32 v14, 16, v127
v_and_b32 v15, s63, v127
v_fma_f32 v12, v12, v10, v11
v_fma_f32 v13, v13, v10, v11
v_mfma_f32_32x32x16_bf16 v[80:95], v[120:123], a[16:19], v[80:95]
ds_read_b64_tr_b16 a[12:13], v7 offset:41152
ds_read_b64_tr_b16 a[14:15], v7 offset:42432
v_fma_f32 v14, v14, v10, v11
v_fma_f32 v15, v15, v10, v11
v_cvt_pk_bf16_f32 v126, v12, v13
v_cvt_pk_bf16_f32 v127, v14, v15
s_add_u32 m0, s48, 124928
s_nop 0
buffer_load_dwordx4 v4, s[36:39], s49 offen lds
s_waitcnt lgkmcnt(8)
v_mfma_f32_32x32x16_bf16 v[16:31], v[124:127], a[20:23], v[16:31]
ds_read_b64_tr_b16 a[16:17], v7 offset:41216
ds_read_b64_tr_b16 a[18:19], v7 offset:42496
v_lshlrev_b32 v12, 16, v128
v_and_b32 v13, s63, v128
v_lshlrev_b32 v14, 16, v129
v_and_b32 v15, s63, v129
v_mfma_f32_32x32x16_bf16 v[32:47], v[124:127], a[24:27], v[32:47]
ds_read_b64_tr_b16 a[20:21], v7 offset:46080
ds_read_b64_tr_b16 a[22:23], v7 offset:47360
v_fma_f32 v12, v12, v10, v11
v_fma_f32 v13, v13, v10, v11
v_fma_f32 v14, v14, v10, v11
v_fma_f32 v15, v15, v10, v11
s_add_u32 m0, s48, 125952
s_nop 0
buffer_load_dwordx4 v5, s[36:39], s49 offen lds
v_mfma_f32_32x32x16_bf16 v[48:63], v[124:127], a[28:31], v[48:63]
ds_read_b64_tr_b16 a[24:25], v7 offset:46144
ds_read_b64_tr_b16 a[26:27], v7 offset:47424
v_cvt_pk_bf16_f32 v128, v12, v13
v_cvt_pk_bf16_f32 v129, v14, v15
v_lshlrev_b32 v12, 16, v130
v_and_b32 v13, s63, v130
v_mfma_f32_32x32x16_bf16 v[64:79], v[124:127], a[32:35], v[64:79]
ds_read_b64_tr_b16 a[28:29], v7 offset:46208
ds_read_b64_tr_b16 a[30:31], v7 offset:47488
v_lshlrev_b32 v14, 16, v131
v_and_b32 v15, s63, v131
v_fma_f32 v12, v12, v10, v11
v_fma_f32 v13, v13, v10, v11
s_add_u32 m0, s48, 126976
s_nop 0
buffer_load_dwordx4 v6, s[36:39], s49 offen lds
s_add_u32 s49, s49, 81920
s_cmp_eq_u32 s49, s58
s_cselect_b32 s49, s57, s49
v_mfma_f32_32x32x16_bf16 v[80:95], v[124:127], a[36:39], v[80:95]
ds_read_b64_tr_b16 a[32:33], v7 offset:46272
ds_read_b64_tr_b16 a[34:35], v7 offset:47552
v_fma_f32 v14, v14, v10, v11
v_fma_f32 v15, v15, v10, v11
v_cvt_pk_bf16_f32 v130, v12, v13
v_cvt_pk_bf16_f32 v131, v14, v15
s_waitcnt lgkmcnt(8)
s_nop 0
v_mfma_f32_32x32x16_bf16 v[16:31], v[128:131], a[0:3], v[16:31]
ds_read_b64_tr_b16 a[36:37], v7 offset:46336
ds_read_b64_tr_b16 a[38:39], v7 offset:47616
v_lshlrev_b32 v12, 16, v132
v_and_b32 v13, s63, v132
v_lshlrev_b32 v14, 16, v133
v_and_b32 v15, s63, v133
s_add_u32 m0, s48, 143360
s_nop 0
buffer_load_dwordx4 v2, s[36:39], s49 offen lds
v_mfma_f32_32x32x16_bf16 v[32:47], v[128:131], a[4:7], v[32:47]
ds_read_b64_tr_b16 a[0:1], v7 offset:51200
ds_read_b64_tr_b16 a[2:3], v7 offset:52480
v_fma_f32 v12, v12, v10, v11
v_fma_f32 v13, v13, v10, v11
v_fma_f32 v14, v14, v10, v11
v_fma_f32 v15, v15, v10, v11
s_add_u32 m0, s48, 144384
s_nop 0
buffer_load_dwordx4 v3, s[36:39], s49 offen lds
v_mfma_f32_32x32x16_bf16 v[48:63], v[128:131], a[8:11], v[48:63]
ds_read_b64_tr_b16 a[4:5], v7 offset:51264
ds_read_b64_tr_b16 a[6:7], v7 offset:52544
v_cvt_pk_bf16_f32 v132, v12, v13
v_cvt_pk_bf16_f32 v133, v14, v15
v_lshlrev_b32 v12, 16, v134
v_and_b32 v13, s63, v134
s_add_u32 m0, s48, 145408
s_nop 0
buffer_load_dwordx4 v4, s[36:39], s49 offen lds
v_mfma_f32_32x32x16_bf16 v[64:79], v[128:131], a[12:15], v[64:79]
ds_read_b64_tr_b16 a[8:9], v7 offset:51328
ds_read_b64_tr_b16 a[10:11], v7 offset:52608
v_lshlrev_b32 v14, 16, v135
v_and_b32 v15, s63, v135
v_fma_f32 v12, v12, v10, v11
v_fma_f32 v13, v13, v10, v11
s_add_u32 m0, s48, 146432
s_nop 0
buffer_load_dwordx4 v5, s[36:39], s49 offen lds
v_mfma_f32_32x32x16_bf16 v[80:95], v[128:131], a[16:19], v[80:95]
ds_read_b64_tr_b16 a[12:13], v7 offset:51392
ds_read_b64_tr_b16 a[14:15], v7 offset:52672
v_fma_f32 v14, v14, v10, v11
v_fma_f32 v15, v15, v10, v11
v_cvt_pk_bf16_f32 v134, v12, v13
v_cvt_pk_bf16_f32 v135, v14, v15
s_add_u32 m0, s48, 147456
s_nop 0
buffer_load_dwordx4 v6, s[36:39], s49 offen lds
s_add_u32 s49, s49, 81920
s_cmp_eq_u32 s49, s58
s_cselect_b32 s49, s57, s49
s_waitcnt lgkmcnt(8)
v_mfma_f32_32x32x16_bf16 v[16:31], v[132:135], a[20:23], v[16:31]
ds_read_b64_tr_b16 a[16:17], v7 offset:51456
ds_read_b64_tr_b16 a[18:19], v7 offset:52736
v_lshlrev_b32 v12, 16, v136
v_and_b32 v13, s63, v136
v_lshlrev_b32 v14, 16, v137
v_and_b32 v15, s63, v137
s_add_u32 m0, s48, 0
s_nop 0
buffer_load_dwordx4 v2, s[36:39], s49 offen lds
v_mfma_f32_32x32x16_bf16 v[32:47], v[132:135], a[24:27], v[32:47]
ds_read_b64_tr_b16 a[20:21], v7 offset:56320
ds_read_b64_tr_b16 a[22:23], v7 offset:57600
v_fma_f32 v12, v12, v10, v11
v_fma_f32 v13, v13, v10, v11
v_fma_f32 v14, v14, v10, v11
v_fma_f32 v15, v15, v10, v11
s_add_u32 m0, s48, 1024
s_nop 0
buffer_load_dwordx4 v3, s[36:39], s49 offen lds
v_mfma_f32_32x32x16_bf16 v[48:63], v[132:135], a[28:31], v[48:63]
ds_read_b64_tr_b16 a[24:25], v7 offset:56384
ds_read_b64_tr_b16 a[26:27], v7 offset:57664
v_cvt_pk_bf16_f32 v136, v12, v13
v_cvt_pk_bf16_f32 v137, v14, v15
v_lshlrev_b32 v12, 16, v138
v_and_b32 v13, s63, v138
s_add_u32 m0, s48, 2048
s_nop 0
buffer_load_dwordx4 v4, s[36:39], s49 offen lds
v_mfma_f32_32x32x16_bf16 v[64:79], v[132:135], a[32:35], v[64:79]
ds_read_b64_tr_b16 a[28:29], v7 offset:56448
ds_read_b64_tr_b16 a[30:31], v7 offset:57728
v_lshlrev_b32 v14, 16, v139
v_and_b32 v15, s63, v139
v_fma_f32 v12, v12, v10, v11
v_fma_f32 v13, v13, v10, v11
s_add_u32 m0, s48, 3072
s_nop 0
buffer_load_dwordx4 v5, s[36:39], s49 offen lds
v_mfma_f32_32x32x16_bf16 v[80:95], v[132:135], a[36:39], v[80:95]
ds_read_b64_tr_b16 a[32:33], v7 offset:56512
ds_read_b64_tr_b16 a[34:35], v7 offset:57792
v_fma_f32 v14, v14, v10, v11
v_fma_f32 v15, v15, v10, v11
v_cvt_pk_bf16_f32 v138, v12, v13
v_cvt_pk_bf16_f32 v139, v14, v15
s_add_u32 m0, s48, 4096
s_nop 0
buffer_load_dwordx4 v6, s[36:39], s49 offen lds
s_add_u32 s49, s49, 81920
s_cmp_eq_u32 s49, s58
s_cselect_b32 s49, s57, s49
s_waitcnt lgkmcnt(8)
v_mfma_f32_32x32x16_bf16 v[16:31], v[136:139], a[0:3], v[16:31]
ds_read_b64_tr_b16 a[36:37], v7 offset:56576
ds_read_b64_tr_b16 a[38:39], v7 offset:57856
v_lshlrev_b32 v12, 16, v140
v_and_b32 v13, s63, v140
v_lshlrev_b32 v14, 16, v141
v_and_b32 v15, s63, v141
v_mfma_f32_32x32x16_bf16 v[32:47], v[136:139], a[4:7], v[32:47]
s_waitcnt vmcnt(25)
s_barrier
ds_read_b64_tr_b16 a[0:1], v8 offset:0
ds_read_b64_tr_b16 a[2:3], v8 offset:1280
v_fma_f32 v12, v12, v10, v11
v_fma_f32 v13, v13, v10, v11
v_fma_f32 v14, v14, v10, v11
v_fma_f32 v15, v15, v10, v11
s_add_u32 m0, s48, 20480
s_nop 0
buffer_load_dwordx4 v2, s[36:39], s49 offen lds
v_mfma_f32_32x32x16_bf16 v[48:63], v[136:139], a[8:11], v[48:63]
ds_read_b64_tr_b16 a[4:5], v8 offset:64
ds_read_b64_tr_b16 a[6:7], v8 offset:1344
v_cvt_pk_bf16_f32 v140, v12, v13
v_cvt_pk_bf16_f32 v141, v14, v15
v_lshlrev_b32 v12, 16, v142
v_and_b32 v13, s63, v142
s_add_u32 m0, s48, 21504
s_nop 0
buffer_load_dwordx4 v3, s[36:39], s49 offen lds
v_mfma_f32_32x32x16_bf16 v[64:79], v[136:139], a[12:15], v[64:79]
ds_read_b64_tr_b16 a[8:9], v8 offset:128
ds_read_b64_tr_b16 a[10:11], v8 offset:1408
v_lshlrev_b32 v14, 16, v143
v_and_b32 v15, s63, v143
v_fma_f32 v12, v12, v10, v11
v_fma_f32 v13, v13, v10, v11
s_add_u32 m0, s48, 22528
s_nop 0
buffer_load_dwordx4 v4, s[36:39], s49 offen lds
v_mfma_f32_32x32x16_bf16 v[80:95], v[136:139], a[16:19], v[80:95]
ds_read_b64_tr_b16 a[12:13], v8 offset:192
ds_read_b64_tr_b16 a[14:15], v8 offset:1472
v_fma_f32 v14, v14, v10, v11
v_fma_f32 v15, v15, v10, v11
v_cvt_pk_bf16_f32 v142, v12, v13
v_cvt_pk_bf16_f32 v143, v14, v15
s_add_u32 m0, s48, 23552
s_nop 0
buffer_load_dwordx4 v5, s[36:39], s49 offen lds
s_waitcnt lgkmcnt(8)
v_mfma_f32_32x32x16_bf16 v[16:31], v[140:143], a[20:23], v[16:31]
ds_read_b64_tr_b16 a[16:17], v8 offset:256
ds_read_b64_tr_b16 a[18:19], v8 offset:1536
v_lshlrev_b32 v12, 16, v144
v_and_b32 v13, s63, v144
v_lshlrev_b32 v14, 16, v145
v_and_b32 v15, s63, v145
s_add_u32 m0, s48, 24576
s_nop 0
buffer_load_dwordx4 v6, s[36:39], s49 offen lds
s_add_u32 s49, s49, 81920
s_cmp_eq_u32 s49, s58
s_cselect_b32 s49, s57, s49
v_accvgpr_read_b32 v2, a80
v_accvgpr_read_b32 v3, a82
s_mov_b32 s32, s20
s_mov_b32 s33, s21
s_mov_b32 s34, 2211840
s_mov_b32 s35, 0x20000
s_getpc_b64 s[36:37]
s_add_u32 s36, s36, TABG@rel32@lo+4
s_addc_u32 s37, s37, TABG@rel32@hi+12
s_mov_b32 s38, 884736
s_mov_b32 s39, 0x20000
s_getpc_b64 s[44:45]
s_add_u32 s44, s44, p2_kernel@rel32@lo+4
s_addc_u32 s45, s45, p2_kernel@rel32@hi+12
s_mov_b32 s46, END_p2_kernel-p2_kernel
s_mov_b32 s47, 0x20000
v_mfma_f32_32x32x16_bf16 v[32:47], v[140:143], a[24:27], v[32:47]
ds_read_b64_tr_b16 a[20:21], v8 offset:5120
ds_read_b64_tr_b16 a[22:23], v8 offset:6400
v_fma_f32 v12, v12, v10, v11
v_fma_f32 v13, v13, v10, v11
v_fma_f32 v14, v14, v10, v11
v_fma_f32 v15, v15, v10, v11
s_mov_b32 s48, 0
buffer_load_dwordx2 a[64:65], v2, s[64:67], s48 offen
v_mfma_f32_32x32x16_bf16 v[48:63], v[140:143], a[28:31], v[48:63]
ds_read_b64_tr_b16 a[24:25], v8 offset:5184
ds_read_b64_tr_b16 a[26:27], v8 offset:6464
v_cvt_pk_bf16_f32 v144, v12, v13
v_cvt_pk_bf16_f32 v145, v14, v15
v_lshlrev_b32 v12, 16, v146
v_and_b32 v13, s63, v146
v_mfma_f32_32x32x16_bf16 v[64:79], v[140:143], a[32:35], v[64:79]
ds_read_b64_tr_b16 a[28:29], v8 offset:5248
ds_read_b64_tr_b16 a[30:31], v8 offset:6528
v_lshlrev_b32 v14, 16, v147
v_and_b32 v15, s63, v147
v_fma_f32 v12, v12, v10, v11
v_fma_f32 v13, v13, v10, v11
v_mfma_f32_32x32x16_bf16 v[80:95], v[140:143], a[36:39], v[80:95]
ds_read_b64_tr_b16 a[32:33], v8 offset:5312
ds_read_b64_tr_b16 a[34:35], v8 offset:6592
v_fma_f32 v14, v14, v10, v11
v_fma_f32 v15, v15, v10, v11
v_cvt_pk_bf16_f32 v146, v12, v13
v_cvt_pk_bf16_f32 v147, v14, v15
s_waitcnt lgkmcnt(8)
s_nop 0
v_mfma_f32_32x32x16_bf16 v[16:31], v[144:147], a[0:3], v[16:31]
ds_read_b64_tr_b16 a[36:37], v8 offset:5376
ds_read_b64_tr_b16 a[38:39], v8 offset:6656
v_lshlrev_b32 v12, 16, v148
v_and_b32 v13, s63, v148
v_lshlrev_b32 v14, 16, v149
v_and_b32 v15, s63, v149
v_mfma_f32_32x32x16_bf16 v[32:47], v[144:147], a[4:7], v[32:47]
ds_read_b64_tr_b16 a[0:1], v8 offset:10240
ds_read_b64_tr_b16 a[2:3], v8 offset:11520
v_fma_f32 v12, v12, v10, v11
v_fma_f32 v13, v13, v10, v11
v_fma_f32 v14, v14, v10, v11
v_fma_f32 v15, v15, v10, v11
v_mfma_f32_32x32x16_bf16 v[48:63], v[144:147], a[8:11], v[48:63]
ds_read_b64_tr_b16 a[4:5], v8 offset:10304
ds_read_b64_tr_b16 a[6:7], v8 offset:11584
v_cvt_pk_bf16_f32 v148, v12, v13
v_cvt_pk_bf16_f32 v149, v14, v15
v_lshlrev_b32 v12, 16, v150
v_and_b32 v13, s63, v150
v_mfma_f32_32x32x16_bf16 v[64:79], v[144:147], a[12:15], v[64:79]
ds_read_b64_tr_b16 a[8:9], v8 offset:10368
ds_read_b64_tr_b16 a[10:11], v8 offset:11648
v_lshlrev_b32 v14, 16, v151
v_and_b32 v15, s63, v151
v_fma_f32 v12, v12, v10, v11
v_fma_f32 v13, v13, v10, v11
v_mfma_f32_32x32x16_bf16 v[80:95], v[144:147], a[16:19], v[80:95]
ds_read_b64_tr_b16 a[12:13], v8 offset:10432
ds_read_b64_tr_b16 a[14:15], v8 offset:11712
v_fma_f32 v14, v14, v10, v11
v_fma_f32 v15, v15, v10, v11
v_cvt_pk_bf16_f32 v150, v12, v13
v_cvt_pk_bf16_f32 v151, v14, v15
buffer_load_dwordx2 a[66:67], v2, s[84:87], s48 offen
s_waitcnt lgkmcnt(8)
v_mfma_f32_32x32x16_bf16 v[16:31], v[148:151], a[20:23], v[16:31]
ds_read_b64_tr_b16 a[16:17], v8 offset:10496
ds_read_b64_tr_b16 a[18:19], v8 offset:11776
v_lshlrev_b32 v12, 16, v152
v_and_b32 v13, s63, v152
v_lshlrev_b32 v14, 16, v153
v_and_b32 v15, s63, v153
v_mfma_f32_32x32x16_bf16 v[32:47], v[148:151], a[24:27], v[32:47]
ds_read_b64_tr_b16 a[20:21], v8 offset:15360
ds_read_b64_tr_b16 a[22:23], v8 offset:16640
v_fma_f32 v12, v12, v10, v11
v_fma_f32 v13, v13, v10, v11
v_fma_f32 v14, v14, v10, v11
v_fma_f32 v15, v15, v10, v11
v_mfma_f32_32x32x16_bf16 v[48:63], v[148:151], a[28:31], v[48:63]
ds_read_b64_tr_b16 a[24:25], v8 offset:15424
ds_read_b64_tr_b16 a[26:27], v8 offset:16704
v_cvt_pk_bf16_f32 v152, v12, v13
v_cvt_pk_bf16_f32 v153, v14, v15
v_lshlrev_b32 v12, 16, v154
v_and_b32 v13, s63, v154
v_mfma_f32_32x32x16_bf16 v[64:79], v[148:151], a[32:35], v[64:79]
ds_read_b64_tr_b16 a[28:29], v8 offset:15488
ds_read_b64_tr_b16 a[30:31], v8 offset:16768
v_lshlrev_b32 v14, 16, v155
v_and_b32 v15, s63, v155
v_fma_f32 v12, v12, v10, v11
v_fma_f32 v13, v13, v10, v11
v_mfma_f32_32x32x16_bf16 v[80:95], v[148:151], a[36:39], v[80:95]
ds_read_b64_tr_b16 a[32:33], v8 offset:15552
ds_read_b64_tr_b16 a[34:35], v8 offset:16832
v_fma_f32 v14, v14, v10, v11
v_fma_f32 v15, v15, v10, v11
v_cvt_pk_bf16_f32 v154, v12, v13
v_cvt_pk_bf16_f32 v155, v14, v15
s_waitcnt lgkmcnt(8)
s_nop 0
v_mfma_f32_32x32x16_bf16 v[16:31], v[152:155], a[0:3], v[16:31]
ds_read_b64_tr_b16 a[36:37], v8 offset:15616
ds_read_b64_tr_b16 a[38:39], v8 offset:16896
v_lshlrev_b32 v12, 16, v156
v_and_b32 v13, s63, v156
v_lshlrev_b32 v14, 16, v157
v_and_b32 v15, s63, v157
v_mfma_f32_32x32x16_bf16 v[32:47], v[152:155], a[4:7], v[32:47]
s_waitcnt vmcnt(27)
s_barrier
ds_read_b64_tr_b16 a[0:1], v8 offset:20480
ds_read_b64_tr_b16 a[2:3], v8 offset:21760
v_fma_f32 v12, v12, v10, v11
v_fma_f32 v13, v13, v10, v11
v_fma_f32 v14, v14, v10, v11
v_fma_f32 v15, v15, v10, v11
v_mfma_f32_32x32x16_bf16 v[48:63], v[152:155], a[8:11], v[48:63]
ds_read_b64_tr_b16 a[4:5], v8 offset:20544
ds_read_b64_tr_b16 a[6:7], v8 offset:21824
v_cvt_pk_bf16_f32 v156, v12, v13
v_cvt_pk_bf16_f32 v157, v14, v15
v_lshlrev_b32 v12, 16, v158
v_and_b32 v13, s63, v158
s_mov_b32 s48, 20544
buffer_load_dwordx2 a[68:69], v2, s[64:67], s48 offen
v_mfma_f32_32x32x16_bf16 v[64:79], v[152:155], a[12:15], v[64:79]
ds_read_b64_tr_b16 a[8:9], v8 offset:20608
ds_read_b64_tr_b16 a[10:11], v8 offset:21888
v_lshlrev_b32 v14, 16, v159
v_and_b32 v15, s63, v159
v_fma_f32 v12, v12, v10, v11
v_fma_f32 v13, v13, v10, v11
v_mfma_f32_32x32x16_bf16 v[80:95], v[152:155], a[16:19], v[80:95]
ds_read_b64_tr_b16 a[12:13], v8 offset:20672
ds_read_b64_tr_b16 a[14:15], v8 offset:21952
v_fma_f32 v14, v14, v10, v11
v_fma_f32 v15, v15, v10, v11
v_cvt_pk_bf16_f32 v158, v12, v13
v_cvt_pk_bf16_f32 v159, v14, v15
s_waitcnt lgkmcnt(8)
s_nop 0
v_mfma_f32_32x32x16_bf16 v[16:31], v[156:159], a[20:23], v[16:31]
ds_read_b64_tr_b16 a[16:17], v8 offset:20736
ds_read_b64_tr_b16 a[18:19], v8 offset:22016
v_lshlrev_b32 v12, 16, v160
v_and_b32 v13, s63, v160
v_lshlrev_b32 v14, 16, v161
v_and_b32 v15, s63, v161
v_mfma_f32_32x32x16_bf16 v[32:47], v[156:159], a[24:27], v[32:47]
ds_read_b64_tr_b16 a[20:21], v8 offset:25600
ds_read_b64_tr_b16 a[22:23], v8 offset:26880
v_fma_f32 v12, v12, v10, v11
v_fma_f32 v13, v13, v10, v11
v_fma_f32 v14, v14, v10, v11
v_fma_f32 v15, v15, v10, v11
v_mfma_f32_32x32x16_bf16 v[48:63], v[156:159], a[28:31], v[48:63]
ds_read_b64_tr_b16 a[24:25], v8 offset:25664
ds_read_b64_tr_b16 a[26:27], v8 offset:26944
v_cvt_pk_bf16_f32 v160, v12, v13
v_cvt_pk_bf16_f32 v161, v14, v15
v_lshlrev_b32 v12, 16, v162
v_and_b32 v13, s63, v162
v_mfma_f32_32x32x16_bf16 v[64:79], v[156:159], a[32:35], v[64:79]
ds_read_b64_tr_b16 a[28:29], v8 offset:25728
ds_read_b64_tr_b16 a[30:31], v8 offset:27008
v_lshlrev_b32 v14, 16, v163
v_and_b32 v15, s63, v163
v_fma_f32 v12, v12, v10, v11
v_fma_f32 v13, v13, v10, v11
v_mfma_f32_32x32x16_bf16 v[80:95], v[156:159], a[36:39], v[80:95]
ds_read_b64_tr_b16 a[32:33], v8 offset:25792
ds_read_b64_tr_b16 a[34:35], v8 offset:27072
v_fma_f32 v14, v14, v10, v11
v_fma_f32 v15, v15, v10, v11
v_cvt_pk_bf16_f32 v162, v12, v13
v_cvt_pk_bf16_f32 v163, v14, v15
s_waitcnt lgkmcnt(8)
s_nop 0
v_mfma_f32_32x32x16_bf16 v[16:31], v[160:163], a[0:3], v[16:31]
ds_read_b64_tr_b16 a[36:37], v8 offset:25856
ds_read_b64_tr_b16 a[38:39], v8 offset:27136
v_lshlrev_b32 v12, 16, v164
v_and_b32 v13, s63, v164
v_lshlrev_b32 v14, 16, v165
v_and_b32 v15, s63, v165
buffer_load_dwordx2 a[70:71], v2, s[84:87], s48 offen
v_mfma_f32_32x32x16_bf16 v[32:47], v[160:163], a[4:7], v[32:47]
ds_read_b64_tr_b16 a[0:1], v8 offset:30720
ds_read_b64_tr_b16 a[2:3], v8 offset:32000
v_fma_f32 v12, v12, v10, v11
v_fma_f32 v13, v13, v10, v11
v_fma_f32 v14, v14, v10, v11
v_fma_f32 v15, v15, v10, v11
v_mfma_f32_32x32x16_bf16 v[48:63], v[160:163], a[8:11], v[48:63]
ds_read_b64_tr_b16 a[4:5], v8 offset:30784
ds_read_b64_tr_b16 a[6:7], v8 offset:32064
v_cvt_pk_bf16_f32 v164, v12, v13
v_cvt_pk_bf16_f32 v165, v14, v15
v_lshlrev_b32 v12, 16, v166
v_and_b32 v13, s63, v166
v_mfma_f32_32x32x16_bf16 v[64:79], v[160:163], a[12:15], v[64:79]
ds_read_b64_tr_b16 a[8:9], v8 offset:30848
ds_read_b64_tr_b16 a[10:11], v8 offset:32128
v_lshlrev_b32 v14, 16, v167
v_and_b32 v15, s63, v167
v_fma_f32 v12, v12, v10, v11
v_fma_f32 v13, v13, v10, v11
v_mfma_f32_32x32x16_bf16 v[80:95], v[160:163], a[16:19], v[80:95]
ds_read_b64_tr_b16 a[12:13], v8 offset:30912
ds_read_b64_tr_b16 a[14:15], v8 offset:32192
v_fma_f32 v14, v14, v10, v11
v_fma_f32 v15, v15, v10, v11
v_cvt_pk_bf16_f32 v166, v12, v13
v_cvt_pk_bf16_f32 v167, v14, v15
s_waitcnt lgkmcnt(8)
s_nop 0
v_mfma_f32_32x32x16_bf16 v[16:31], v[164:167], a[20:23], v[16:31]
ds_read_b64_tr_b16 a[16:17], v8 offset:30976
ds_read_b64_tr_b16 a[18:19], v8 offset:32256
v_lshlrev_b32 v12, 16, v168
v_and_b32 v13, s63, v168
v_lshlrev_b32 v14, 16, v169
v_and_b32 v15, s63, v169
v_mfma_f32_32x32x16_bf16 v[32:47], v[164:167], a[24:27], v[32:47]
ds_read_b64_tr_b16 a[20:21], v8 offset:35840
ds_read_b64_tr_b16 a[22:23], v8 offset:37120
v_fma_f32 v12, v12, v10, v11
v_fma_f32 v13, v13, v10, v11
v_fma_f32 v14, v14, v10, v11
v_fma_f32 v15, v15, v10, v11
v_mfma_f32_32x32x16_bf16 v[48:63], v[164:167], a[28:31], v[48:63]
ds_read_b64_tr_b16 a[24:25], v8 offset:35904
ds_read_b64_tr_b16 a[26:27], v8 offset:37184
v_cvt_pk_bf16_f32 v168, v12, v13
v_cvt_pk_bf16_f32 v169, v14, v15
v_lshlrev_b32 v12, 16, v170
v_and_b32 v13, s63, v170
v_mfma_f32_32x32x16_bf16 v[64:79], v[164:167], a[32:35], v[64:79]
ds_read_b64_tr_b16 a[28:29], v8 offset:35968
ds_read_b64_tr_b16 a[30:31], v8 offset:37248
v_lshlrev_b32 v14, 16, v171
v_and_b32 v15, s63, v171
v_fma_f32 v12, v12, v10, v11
v_fma_f32 v13, v13, v10, v11
s_mov_b32 s48, 41088
buffer_load_dwordx2 a[72:73], v2, s[64:67], s48 offen
v_mfma_f32_32x32x16_bf16 v[80:95], v[164:167], a[36:39], v[80:95]
ds_read_b64_tr_b16 a[32:33], v8 offset:36032
ds_read_b64_tr_b16 a[34:35], v8 offset:37312
v_fma_f32 v14, v14, v10, v11
v_fma_f32 v15, v15, v10, v11
v_cvt_pk_bf16_f32 v170, v12, v13
v_cvt_pk_bf16_f32 v171, v14, v15
s_waitcnt lgkmcnt(8)
s_nop 0
v_mfma_f32_32x32x16_bf16 v[16:31], v[168:171], a[0:3], v[16:31]
ds_read_b64_tr_b16 a[36:37], v8 offset:36096
ds_read_b64_tr_b16 a[38:39], v8 offset:37376
v_lshlrev_b32 v12, 16, v172
v_and_b32 v13, s63, v172
v_lshlrev_b32 v14, 16, v173
v_and_b32 v15, s63, v173
v_mfma_f32_32x32x16_bf16 v[32:47], v[168:171], a[4:7], v[32:47]
s_waitcnt vmcnt(25)
s_barrier
ds_read_b64_tr_b16 a[0:1], v8 offset:40960
ds_read_b64_tr_b16 a[2:3], v8 offset:42240
v_fma_f32 v12, v12, v10, v11
v_fma_f32 v13, v13, v10, v11
v_fma_f32 v14, v14, v10, v11
v_fma_f32 v15, v15, v10, v11
v_mfma_f32_32x32x16_bf16 v[48:63], v[168:171], a[8:11], v[48:63]
ds_read_b64_tr_b16 a[4:5], v8 offset:41024
ds_read_b64_tr_b16 a[6:7], v8 offset:42304
v_cvt_pk_bf16_f32 v172, v12, v13
v_cvt_pk_bf16_f32 v173, v14, v15
v_lshlrev_b32 v12, 16, v174
v_and_b32 v13, s63, v174
v_mfma_f32_32x32x16_bf16 v[64:79], v[168:171], a[12:15], v[64:79]
ds_read_b64_tr_b16 a[8:9], v8 offset:41088
ds_read_b64_tr_b16 a[10:11], v8 offset:42368
v_lshlrev_b32 v14, 16, v175
v_and_b32 v15, s63, v175
v_fma_f32 v12, v12, v10, v11
v_fma_f32 v13, v13, v10, v11
v_mfma_f32_32x32x16_bf16 v[80:95], v[168:171], a[16:19], v[80:95]
ds_read_b64_tr_b16 a[12:13], v8 offset:41152
ds_read_b64_tr_b16 a[14:15], v8 offset:42432
v_fma_f32 v14, v14, v10, v11
v_fma_f32 v15, v15, v10, v11
v_cvt_pk_bf16_f32 v174, v12, v13
v_cvt_pk_bf16_f32 v175, v14, v15
s_waitcnt lgkmcnt(8)
s_nop 0
v_mfma_f32_32x32x16_bf16 v[16:31], v[172:175], a[20:23], v[16:31]
ds_read_b64_tr_b16 a[16:17], v8 offset:41216
ds_read_b64_tr_b16 a[18:19], v8 offset:42496
v_lshlrev_b32 v12, 16, v176
v_and_b32 v13, s63, v176
v_lshlrev_b32 v14, 16, v177
v_and_b32 v15, s63, v177
v_mfma_f32_32x32x16_bf16 v[32:47], v[172:175], a[24:27], v[32:47]
ds_read_b64_tr_b16 a[20:21], v8 offset:46080
ds_read_b64_tr_b16 a[22:23], v8 offset:47360
v_fma_f32 v12, v12, v10, v11
v_fma_f32 v13, v13, v10, v11
v_fma_f32 v14, v14, v10, v11
v_fma_f32 v15, v15, v10, v11
buffer_load_dwordx2 a[74:75], v2, s[84:87], s48 offen
v_mfma_f32_32x32x16_bf16 v[48:63], v[172:175], a[28:31], v[48:63]
ds_read_b64_tr_b16 a[24:25], v8 offset:46144
ds_read_b64_tr_b16 a[26:27], v8 offset:47424
v_cvt_pk_bf16_f32 v176, v12, v13
v_cvt_pk_bf16_f32 v177, v14, v15
v_lshlrev_b32 v12, 16, v178
v_and_b32 v13, s63, v178
v_mfma_f32_32x32x16_bf16 v[64:79], v[172:175], a[32:35], v[64:79]
ds_read_b64_tr_b16 a[28:29], v8 offset:46208
ds_read_b64_tr_b16 a[30:31], v8 offset:47488
v_lshlrev_b32 v14, 16, v179
v_and_b32 v15, s63, v179
v_fma_f32 v12, v12, v10, v11
v_fma_f32 v13, v13, v10, v11
v_mfma_f32_32x32x16_bf16 v[80:95], v[172:175], a[36:39], v[80:95]
ds_read_b64_tr_b16 a[32:33], v8 offset:46272
ds_read_b64_tr_b16 a[34:35], v8 offset:47552
v_fma_f32 v14, v14, v10, v11
v_fma_f32 v15, v15, v10, v11
v_cvt_pk_bf16_f32 v178, v12, v13
v_cvt_pk_bf16_f32 v179, v14, v15
s_waitcnt lgkmcnt(8)
s_nop 0
v_mfma_f32_32x32x16_bf16 v[16:31], v[176:179], a[0:3], v[16:31]
ds_read_b64_tr_b16 a[36:37], v8 offset:46336
ds_read_b64_tr_b16 a[38:39], v8 offset:47616
v_lshlrev_b32 v12, 16, v180
v_and_b32 v13, s63, v180
v_lshlrev_b32 v14, 16, v181
v_and_b32 v15, s63, v181
v_mfma_f32_32x32x16_bf16 v[32:47], v[176:179], a[4:7], v[32:47]
ds_read_b64_tr_b16 a[0:1], v8 offset:51200
ds_read_b64_tr_b16 a[2:3], v8 offset:52480
v_fma_f32 v12, v12, v10, v11
v_fma_f32 v13, v13, v10, v11
v_fma_f32 v14, v14, v10, v11
v_fma_f32 v15, v15, v10, v11
v_mfma_f32_32x32x16_bf16 v[48:63], v[176:179], a[8:11], v[48:63]
ds_read_b64_tr_b16 a[4:5], v8 offset:51264
ds_read_b64_tr_b16 a[6:7], v8 offset:52544
v_cvt_pk_bf16_f32 v180, v12, v13
v_cvt_pk_bf16_f32 v181, v14, v15
v_lshlrev_b32 v12, 16, v182
v_and_b32 v13, s63, v182
v_mfma_f32_32x32x16_bf16 v[64:79], v[176:179], a[12:15], v[64:79]
ds_read_b64_tr_b16 a[8:9], v8 offset:51328
ds_read_b64_tr_b16 a[10:11], v8 offset:52608
v_lshlrev_b32 v14, 16, v183
v_and_b32 v15, s63, v183
v_fma_f32 v12, v12, v10, v11
v_fma_f32 v13, v13, v10, v11
v_mfma_f32_32x32x16_bf16 v[80:95], v[176:179], a[16:19], v[80:95]
ds_read_b64_tr_b16 a[12:13], v8 offset:51392
ds_read_b64_tr_b16 a[14:15], v8 offset:52672
v_fma_f32 v14, v14, v10, v11
v_fma_f32 v15, v15, v10, v11
v_cvt_pk_bf16_f32 v182, v12, v13
v_cvt_pk_bf16_f32 v183, v14, v15
s_mov_b32 s48, 61632
buffer_load_dwordx2 a[76:77], v2, s[64:67], s48 offen
s_waitcnt lgkmcnt(8)
v_mfma_f32_32x32x16_bf16 v[16:31], v[180:183], a[20:23], v[16:31]
ds_read_b64_tr_b16 a[16:17], v8 offset:51456
ds_read_b64_tr_b16 a[18:19], v8 offset:52736
v_lshlrev_b32 v12, 16, v184
v_and_b32 v13, s63, v184
v_lshlrev_b32 v14, 16, v185
v_and_b32 v15, s63, v185
v_mfma_f32_32x32x16_bf16 v[32:47], v[180:183], a[24:27], v[32:47]
ds_read_b64_tr_b16 a[20:21], v8 offset:56320
ds_read_b64_tr_b16 a[22:23], v8 offset:57600
v_fma_f32 v12, v12, v10, v11
v_fma_f32 v13, v13, v10, v11
v_fma_f32 v14, v14, v10, v11
v_fma_f32 v15, v15, v10, v11
v_mfma_f32_32x32x16_bf16 v[48:63], v[180:183], a[28:31], v[48:63]
ds_read_b64_tr_b16 a[24:25], v8 offset:56384
ds_read_b64_tr_b16 a[26:27], v8 offset:57664
v_cvt_pk_bf16_f32 v184, v12, v13
v_cvt_pk_bf16_f32 v185, v14, v15
v_lshlrev_b32 v12, 16, v186
v_and_b32 v13, s63, v186
v_mfma_f32_32x32x16_bf16 v[64:79], v[180:183], a[32:35], v[64:79]
ds_read_b64_tr_b16 a[28:29], v8 offset:56448
ds_read_b64_tr_b16 a[30:31], v8 offset:57728
v_lshlrev_b32 v14, 16, v187
v_and_b32 v15, s63, v187
v_fma_f32 v12, v12, v10, v11
v_fma_f32 v13, v13, v10, v11
v_mfma_f32_32x32x16_bf16 v[80:95], v[180:183], a[36:39], v[80:95]
ds_read_b64_tr_b16 a[32:33], v8 offset:56512
ds_read_b64_tr_b16 a[34:35], v8 offset:57792
v_fma_f32 v14, v14, v10, v11
v_fma_f32 v15, v15, v10, v11
v_cvt_pk_bf16_f32 v186, v12, v13
v_cvt_pk_bf16_f32 v187, v14, v15
s_waitcnt lgkmcnt(8)
s_nop 0
v_mfma_f32_32x32x16_bf16 v[16:31], v[184:187], a[0:3], v[16:31]
ds_read_b64_tr_b16 a[36:37], v8 offset:56576
ds_read_b64_tr_b16 a[38:39], v8 offset:57856
v_lshlrev_b32 v12, 16, v188
v_and_b32 v13, s63, v188
v_lshlrev_b32 v14, 16, v189
v_and_b32 v15, s63, v189
v_mfma_f32_32x32x16_bf16 v[32:47], v[184:187], a[4:7], v[32:47]
s_waitcnt vmcnt(22)
s_barrier
ds_read_b64_tr_b16 a[0:1], v9 offset:0
ds_read_b64_tr_b16 a[2:3], v9 offset:1280
v_fma_f32 v12, v12, v10, v11
v_fma_f32 v13, v13, v10, v11
v_fma_f32 v14, v14, v10, v11
v_fma_f32 v15, v15, v10, v11
v_mfma_f32_32x32x16_bf16 v[48:63], v[184:187], a[8:11], v[48:63]
ds_read_b64_tr_b16 a[4:5], v9 offset:64
ds_read_b64_tr_b16 a[6:7], v9 offset:1344
v_cvt_pk_bf16_f32 v188, v12, v13
v_cvt_pk_bf16_f32 v189, v14, v15
v_lshlrev_b32 v12, 16, v190
v_and_b32 v13, s63, v190
buffer_load_dwordx2 a[78:79], v2, s[84:87], s48 offen
v_mfma_f32_32x32x16_bf16 v[64:79], v[184:187], a[12:15], v[64:79]
ds_read_b64_tr_b16 a[8:9], v9 offset:128
ds_read_b64_tr_b16 a[10:11], v9 offset:1408
v_lshlrev_b32 v14, 16, v191
v_and_b32 v15, s63, v191
v_fma_f32 v12, v12, v10, v11
v_fma_f32 v13, v13, v10, v11
v_mfma_f32_32x32x16_bf16 v[80:95], v[184:187], a[16:19], v[80:95]
ds_read_b64_tr_b16 a[12:13], v9 offset:192
ds_read_b64_tr_b16 a[14:15], v9 offset:1472
v_fma_f32 v14, v14, v10, v11
v_fma_f32 v15, v15, v10, v11
v_cvt_pk_bf16_f32 v190, v12, v13
v_cvt_pk_bf16_f32 v191, v14, v15
s_waitcnt lgkmcnt(8)
s_nop 0
v_mfma_f32_32x32x16_bf16 v[16:31], v[188:191], a[20:23], v[16:31]
ds_read_b64_tr_b16 a[16:17], v9 offset:256
ds_read_b64_tr_b16 a[18:19], v9 offset:1536
v_lshlrev_b32 v12, 16, v192
v_and_b32 v13, s63, v192
v_lshlrev_b32 v14, 16, v193
v_and_b32 v15, s63, v193
v_mfma_f32_32x32x16_bf16 v[32:47], v[188:191], a[24:27], v[32:47]
ds_read_b64_tr_b16 a[20:21], v9 offset:5120
ds_read_b64_tr_b16 a[22:23], v9 offset:6400
v_fma_f32 v12, v12, v10, v11
v_fma_f32 v13, v13, v10, v11
v_fma_f32 v14, v14, v10, v11
v_fma_f32 v15, v15, v10, v11
v_mfma_f32_32x32x16_bf16 v[48:63], v[188:191], a[28:31], v[48:63]
ds_read_b64_tr_b16 a[24:25], v9 offset:5184
ds_read_b64_tr_b16 a[26:27], v9 offset:6464
v_cvt_pk_bf16_f32 v192, v12, v13
v_cvt_pk_bf16_f32 v193, v14, v15
v_lshlrev_b32 v12, 16, v194
v_and_b32 v13, s63, v194
v_mfma_f32_32x32x16_bf16 v[64:79], v[188:191], a[32:35], v[64:79]
ds_read_b64_tr_b16 a[28:29], v9 offset:5248
ds_read_b64_tr_b16 a[30:31], v9 offset:6528
v_lshlrev_b32 v14, 16, v195
v_and_b32 v15, s63, v195
v_fma_f32 v12, v12, v10, v11
v_fma_f32 v13, v13, v10, v11
v_mfma_f32_32x32x16_bf16 v[80:95], v[188:191], a[36:39], v[80:95]
ds_read_b64_tr_b16 a[32:33], v9 offset:5312
ds_read_b64_tr_b16 a[34:35], v9 offset:6592
v_fma_f32 v14, v14, v10, v11
v_fma_f32 v15, v15, v10, v11
v_cvt_pk_bf16_f32 v194, v12, v13
v_cvt_pk_bf16_f32 v195, v14, v15
s_waitcnt lgkmcnt(8)
s_nop 0
v_mfma_f32_32x32x16_bf16 v[16:31], v[192:195], a[0:3], v[16:31]
ds_read_b64_tr_b16 a[36:37], v9 offset:5376
ds_read_b64_tr_b16 a[38:39], v9 offset:6656
v_lshlrev_b32 v12, 16, v196
v_and_b32 v13, s63, v196
v_lshlrev_b32 v14, 16, v197
v_and_b32 v15, s63, v197
buffer_load_dword a83, v3, s[32:35], 0 offen
v_mfma_f32_32x32x16_bf16 v[32:47], v[192:195], a[4:7], v[32:47]
ds_read_b64_tr_b16 a[0:1], v9 offset:10240
ds_read_b64_tr_b16 a[2:3], v9 offset:11520
v_fma_f32 v12, v12, v10, v11
v_fma_f32 v13, v13, v10, v11
v_fma_f32 v14, v14, v10, v11
v_fma_f32 v15, v15, v10, v11
v_mfma_f32_32x32x16_bf16 v[48:63], v[192:195], a[8:11], v[48:63]
ds_read_b64_tr_b16 a[4:5], v9 offset:10304
ds_read_b64_tr_b16 a[6:7], v9 offset:11584
v_cvt_pk_bf16_f32 v196, v12, v13
v_cvt_pk_bf16_f32 v197, v14, v15
v_lshlrev_b32 v12, 16, v198
v_and_b32 v13, s63, v198
v_mfma_f32_32x32x16_bf16 v[64:79], v[192:195], a[12:15], v[64:79]
ds_read_b64_tr_b16 a[8:9], v9 offset:10368
ds_read_b64_tr_b16 a[10:11], v9 offset:11648
v_lshlrev_b32 v14, 16, v199
v_and_b32 v15, s63, v199
v_fma_f32 v12, v12, v10, v11
v_fma_f32 v13, v13, v10, v11
v_mfma_f32_32x32x16_bf16 v[80:95], v[192:195], a[16:19], v[80:95]
ds_read_b64_tr_b16 a[12:13], v9 offset:10432
ds_read_b64_tr_b16 a[14:15], v9 offset:11712
v_fma_f32 v14, v14, v10, v11
v_fma_f32 v15, v15, v10, v11
v_cvt_pk_bf16_f32 v198, v12, v13
v_cvt_pk_bf16_f32 v199, v14, v15
s_waitcnt lgkmcnt(8)
s_nop 0
v_mfma_f32_32x32x16_bf16 v[16:31], v[196:199], a[20:23], v[16:31]
ds_read_b64_tr_b16 a[16:17], v9 offset:10496
ds_read_b64_tr_b16 a[18:19], v9 offset:11776
v_lshlrev_b32 v12, 16, v200
v_and_b32 v13, s63, v200
v_lshlrev_b32 v14, 16, v201
v_and_b32 v15, s63, v201
v_mfma_f32_32x32x16_bf16 v[32:47], v[196:199], a[24:27], v[32:47]
ds_read_b64_tr_b16 a[20:21], v9 offset:15360
ds_read_b64_tr_b16 a[22:23], v9 offset:16640
v_fma_f32 v12, v12, v10, v11
v_fma_f32 v13, v13, v10, v11
v_fma_f32 v14, v14, v10, v11
v_fma_f32 v15, v15, v10, v11
v_mfma_f32_32x32x16_bf16 v[48:63], v[196:199], a[28:31], v[48:63]
ds_read_b64_tr_b16 a[24:25], v9 offset:15424
ds_read_b64_tr_b16 a[26:27], v9 offset:16704
v_cvt_pk_bf16_f32 v200, v12, v13
v_cvt_pk_bf16_f32 v201, v14, v15
v_lshlrev_b32 v12, 16, v202
v_and_b32 v13, s63, v202
v_mfma_f32_32x32x16_bf16 v[64:79], v[196:199], a[32:35], v[64:79]
ds_read_b64_tr_b16 a[28:29], v9 offset:15488
ds_read_b64_tr_b16 a[30:31], v9 offset:16768
v_lshlrev_b32 v14, 16, v203
v_and_b32 v15, s63, v203
v_fma_f32 v12, v12, v10, v11
v_fma_f32 v13, v13, v10, v11
buffer_load_dword a84, v3, s[36:39], 0 offen
buffer_load_dword a86, v3, s[44:47], 0 offen
v_mfma_f32_32x32x16_bf16 v[80:95], v[196:199], a[36:39], v[80:95]
ds_read_b64_tr_b16 a[32:33], v9 offset:15552
ds_read_b64_tr_b16 a[34:35], v9 offset:16832
v_fma_f32 v14, v14, v10, v11
v_fma_f32 v15, v15, v10, v11
v_cvt_pk_bf16_f32 v202, v12, v13
v_cvt_pk_bf16_f32 v203, v14, v15
s_waitcnt lgkmcnt(8)
s_nop 0
v_mfma_f32_32x32x16_bf16 v[16:31], v[200:203], a[0:3], v[16:31]
ds_read_b64_tr_b16 a[36:37], v9 offset:15616
ds_read_b64_tr_b16 a[38:39], v9 offset:16896
v_lshlrev_b32 v12, 16, v204
v_and_b32 v13, s63, v204
v_lshlrev_b32 v14, 16, v205
v_and_b32 v15, s63, v205
v_mfma_f32_32x32x16_bf16 v[32:47], v[200:203], a[4:7], v[32:47]
s_waitcnt vmcnt(21)
s_barrier
ds_read_b64_tr_b16 a[0:1], v9 offset:20480
ds_read_b64_tr_b16 a[2:3], v9 offset:21760
v_fma_f32 v12, v12, v10, v11
v_fma_f32 v13, v13, v10, v11
v_fma_f32 v14, v14, v10, v11
v_fma_f32 v15, v15, v10, v11
v_mfma_f32_32x32x16_bf16 v[48:63], v[200:203], a[8:11], v[48:63]
ds_read_b64_tr_b16 a[4:5], v9 offset:20544
ds_read_b64_tr_b16 a[6:7], v9 offset:21824
v_cvt_pk_bf16_f32 v204, v12, v13
v_cvt_pk_bf16_f32 v205, v14, v15
v_lshlrev_b32 v12, 16, v206
v_and_b32 v13, s63, v206
v_mfma_f32_32x32x16_bf16 v[64:79], v[200:203], a[12:15], v[64:79]
ds_read_b64_tr_b16 a[8:9], v9 offset:20608
ds_read_b64_tr_b16 a[10:11], v9 offset:21888
v_lshlrev_b32 v14, 16, v207
v_and_b32 v15, s63, v207
v_fma_f32 v12, v12, v10, v11
v_fma_f32 v13, v13, v10, v11
v_mfma_f32_32x32x16_bf16 v[80:95], v[200:203], a[16:19], v[80:95]
ds_read_b64_tr_b16 a[12:13], v9 offset:20672
ds_read_b64_tr_b16 a[14:15], v9 offset:21952
v_fma_f32 v14, v14, v10, v11
v_fma_f32 v15, v15, v10, v11
v_cvt_pk_bf16_f32 v206, v12, v13
v_cvt_pk_bf16_f32 v207, v14, v15
s_waitcnt lgkmcnt(8)
s_nop 0
v_mfma_f32_32x32x16_bf16 v[16:31], v[204:207], a[20:23], v[16:31]
ds_read_b64_tr_b16 a[16:17], v9 offset:20736
ds_read_b64_tr_b16 a[18:19], v9 offset:22016
v_lshlrev_b32 v12, 16, v208
v_and_b32 v13, s63, v208
v_lshlrev_b32 v14, 16, v209
v_and_b32 v15, s63, v209
v_mfma_f32_32x32x16_bf16 v[32:47], v[204:207], a[24:27], v[32:47]
ds_read_b64_tr_b16 a[20:21], v9 offset:25600
ds_read_b64_tr_b16 a[22:23], v9 offset:26880
v_fma_f32 v12, v12, v10, v11
v_fma_f32 v13, v13, v10, v11
v_fma_f32 v14, v14, v10, v11
v_fma_f32 v15, v15, v10, v11
v_mfma_f32_32x32x16_bf16 v[48:63], v[204:207], a[28:31], v[48:63]
ds_read_b64_tr_b16 a[24:25], v9 offset:25664
ds_read_b64_tr_b16 a[26:27], v9 offset:26944
v_cvt_pk_bf16_f32 v208, v12, v13
v_cvt_pk_bf16_f32 v209, v14, v15
v_lshlrev_b32 v12, 16, v210
v_and_b32 v13, s63, v210
v_mfma_f32_32x32x16_bf16 v[64:79], v[204:207], a[32:35], v[64:79]
ds_read_b64_tr_b16 a[28:29], v9 offset:25728
ds_read_b64_tr_b16 a[30:31], v9 offset:27008
v_lshlrev_b32 v14, 16, v211
v_and_b32 v15, s63, v211
v_fma_f32 v12, v12, v10, v11
v_fma_f32 v13, v13, v10, v11
v_mfma_f32_32x32x16_bf16 v[80:95], v[204:207], a[36:39], v[80:95]
ds_read_b64_tr_b16 a[32:33], v9 offset:25792
ds_read_b64_tr_b16 a[34:35], v9 offset:27072
v_fma_f32 v14, v14, v10, v11
v_fma_f32 v15, v15, v10, v11
v_cvt_pk_bf16_f32 v210, v12, v13
v_cvt_pk_bf16_f32 v211, v14, v15
s_waitcnt lgkmcnt(8)
s_nop 0
v_mfma_f32_32x32x16_bf16 v[16:31], v[208:211], a[0:3], v[16:31]
ds_read_b64_tr_b16 a[36:37], v9 offset:25856
ds_read_b64_tr_b16 a[38:39], v9 offset:27136
v_lshlrev_b32 v12, 16, v212
v_and_b32 v13, s63, v212
v_lshlrev_b32 v14, 16, v213
v_and_b32 v15, s63, v213
v_mfma_f32_32x32x16_bf16 v[32:47], v[208:211], a[4:7], v[32:47]
ds_read_b64_tr_b16 a[0:1], v9 offset:30720
ds_read_b64_tr_b16 a[2:3], v9 offset:32000
v_fma_f32 v12, v12, v10, v11
v_fma_f32 v13, v13, v10, v11
v_fma_f32 v14, v14, v10, v11
v_fma_f32 v15, v15, v10, v11
v_mfma_f32_32x32x16_bf16 v[48:63], v[208:211], a[8:11], v[48:63]
ds_read_b64_tr_b16 a[4:5], v9 offset:30784
ds_read_b64_tr_b16 a[6:7], v9 offset:32064
v_cvt_pk_bf16_f32 v212, v12, v13
v_cvt_pk_bf16_f32 v213, v14, v15
v_lshlrev_b32 v12, 16, v214
v_and_b32 v13, s63, v214
v_mfma_f32_32x32x16_bf16 v[64:79], v[208:211], a[12:15], v[64:79]
ds_read_b64_tr_b16 a[8:9], v9 offset:30848
ds_read_b64_tr_b16 a[10:11], v9 offset:32128
v_lshlrev_b32 v14, 16, v215
v_and_b32 v15, s63, v215
v_fma_f32 v12, v12, v10, v11
v_fma_f32 v13, v13, v10, v11
v_mfma_f32_32x32x16_bf16 v[80:95], v[208:211], a[16:19], v[80:95]
ds_read_b64_tr_b16 a[12:13], v9 offset:30912
ds_read_b64_tr_b16 a[14:15], v9 offset:32192
v_fma_f32 v14, v14, v10, v11
v_fma_f32 v15, v15, v10, v11
v_cvt_pk_bf16_f32 v214, v12, v13
v_cvt_pk_bf16_f32 v215, v14, v15
s_waitcnt lgkmcnt(8)
s_nop 0
v_mfma_f32_32x32x16_bf16 v[16:31], v[212:215], a[20:23], v[16:31]
ds_read_b64_tr_b16 a[16:17], v9 offset:30976
ds_read_b64_tr_b16 a[18:19], v9 offset:32256
v_lshlrev_b32 v12, 16, v216
v_and_b32 v13, s63, v216
v_lshlrev_b32 v14, 16, v217
v_and_b32 v15, s63, v217
v_mfma_f32_32x32x16_bf16 v[32:47], v[212:215], a[24:27], v[32:47]
ds_read_b64_tr_b16 a[20:21], v9 offset:35840
ds_read_b64_tr_b16 a[22:23], v9 offset:37120
v_fma_f32 v12, v12, v10, v11
v_fma_f32 v13, v13, v10, v11
v_fma_f32 v14, v14, v10, v11
v_fma_f32 v15, v15, v10, v11
v_mfma_f32_32x32x16_bf16 v[48:63], v[212:215], a[28:31], v[48:63]
ds_read_b64_tr_b16 a[24:25], v9 offset:35904
ds_read_b64_tr_b16 a[26:27], v9 offset:37184
v_cvt_pk_bf16_f32 v216, v12, v13
v_cvt_pk_bf16_f32 v217, v14, v15
v_lshlrev_b32 v12, 16, v218
v_and_b32 v13, s63, v218
v_mfma_f32_32x32x16_bf16 v[64:79], v[212:215], a[32:35], v[64:79]
ds_read_b64_tr_b16 a[28:29], v9 offset:35968
ds_read_b64_tr_b16 a[30:31], v9 offset:37248
v_lshlrev_b32 v14, 16, v219
v_and_b32 v15, s63, v219
v_fma_f32 v12, v12, v10, v11
v_fma_f32 v13, v13, v10, v11
v_mfma_f32_32x32x16_bf16 v[80:95], v[212:215], a[36:39], v[80:95]
ds_read_b64_tr_b16 a[32:33], v9 offset:36032
ds_read_b64_tr_b16 a[34:35], v9 offset:37312
v_fma_f32 v14, v14, v10, v11
v_fma_f32 v15, v15, v10, v11
v_cvt_pk_bf16_f32 v218, v12, v13
v_cvt_pk_bf16_f32 v219, v14, v15
s_waitcnt lgkmcnt(8)
s_nop 0
v_mfma_f32_32x32x16_bf16 v[16:31], v[216:219], a[0:3], v[16:31]
ds_read_b64_tr_b16 a[36:37], v9 offset:36096
ds_read_b64_tr_b16 a[38:39], v9 offset:37376
v_lshlrev_b32 v12, 16, v220
v_and_b32 v13, s63, v220
v_lshlrev_b32 v14, 16, v221
v_and_b32 v15, s63, v221
v_mfma_f32_32x32x16_bf16 v[32:47], v[216:219], a[4:7], v[32:47]
s_waitcnt vmcnt(16)
s_barrier
ds_read_b64_tr_b16 a[0:1], v7 offset:0
ds_read_b64_tr_b16 a[2:3], v7 offset:1280
v_fma_f32 v12, v12, v10, v11
v_fma_f32 v13, v13, v10, v11
v_fma_f32 v14, v14, v10, v11
v_fma_f32 v15, v15, v10, v11
v_mfma_f32_32x32x16_bf16 v[48:63], v[216:219], a[8:11], v[48:63]
ds_read_b64_tr_b16 a[4:5], v7 offset:64
ds_read_b64_tr_b16 a[6:7], v7 offset:1344
v_cvt_pk_bf16_f32 v220, v12, v13
v_cvt_pk_bf16_f32 v221, v14, v15
v_lshlrev_b32 v12, 16, v222
v_and_b32 v13, s63, v222
v_mfma_f32_32x32x16_bf16 v[64:79], v[216:219], a[12:15], v[64:79]
ds_read_b64_tr_b16 a[8:9], v7 offset:128
ds_read_b64_tr_b16 a[10:11], v7 offset:1408
v_lshlrev_b32 v14, 16, v223
v_and_b32 v15, s63, v223
v_fma_f32 v12, v12, v10, v11
v_fma_f32 v13, v13, v10, v11
v_mfma_f32_32x32x16_bf16 v[80:95], v[216:219], a[16:19], v[80:95]
ds_read_b64_tr_b16 a[12:13], v7 offset:192
ds_read_b64_tr_b16 a[14:15], v7 offset:1472
v_fma_f32 v14, v14, v10, v11
v_fma_f32 v15, v15, v10, v11
v_cvt_pk_bf16_f32 v222, v12, v13
v_cvt_pk_bf16_f32 v223, v14, v15
s_waitcnt lgkmcnt(8)
s_nop 0
v_mfma_f32_32x32x16_bf16 v[16:31], v[220:223], a[20:23], v[16:31]
ds_read_b64_tr_b16 a[16:17], v7 offset:256
ds_read_b64_tr_b16 a[18:19], v7 offset:1536
v_lshlrev_b32 v12, 16, v224
v_and_b32 v13, s63, v224
v_lshlrev_b32 v14, 16, v225
v_and_b32 v15, s63, v225
v_mfma_f32_32x32x16_bf16 v[32:47], v[220:223], a[24:27], v[32:47]
ds_read_b64_tr_b16 a[20:21], v7 offset:5120
ds_read_b64_tr_b16 a[22:23], v7 offset:6400
v_fma_f32 v12, v12, v10, v11
v_fma_f32 v13, v13, v10, v11
v_fma_f32 v14, v14, v10, v11
v_fma_f32 v15, v15, v10, v11
v_mfma_f32_32x32x16_bf16 v[48:63], v[220:223], a[28:31], v[48:63]
ds_read_b64_tr_b16 a[24:25], v7 offset:5184
ds_read_b64_tr_b16 a[26:27], v7 offset:6464
v_cvt_pk_bf16_f32 v224, v12, v13
v_cvt_pk_bf16_f32 v225, v14, v15
v_lshlrev_b32 v12, 16, v226
v_and_b32 v13, s63, v226
v_mfma_f32_32x32x16_bf16 v[64:79], v[220:223], a[32:35], v[64:79]
ds_read_b64_tr_b16 a[28:29], v7 offset:5248
ds_read_b64_tr_b16 a[30:31], v7 offset:6528
v_lshlrev_b32 v14, 16, v227
v_and_b32 v15, s63, v227
v_fma_f32 v12, v12, v10, v11
v_fma_f32 v13, v13, v10, v11
v_mfma_f32_32x32x16_bf16 v[80:95], v[220:223], a[36:39], v[80:95]
ds_read_b64_tr_b16 a[32:33], v7 offset:5312
ds_read_b64_tr_b16 a[34:35], v7 offset:6592
v_fma_f32 v14, v14, v10, v11
v_fma_f32 v15, v15, v10, v11
v_cvt_pk_bf16_f32 v226, v12, v13
v_cvt_pk_bf16_f32 v227, v14, v15
s_waitcnt lgkmcnt(8)
s_nop 0
v_mfma_f32_32x32x16_bf16 v[16:31], v[224:227], a[0:3], v[16:31]
ds_read_b64_tr_b16 a[36:37], v7 offset:5376
ds_read_b64_tr_b16 a[38:39], v7 offset:6656
v_lshlrev_b32 v12, 16, v228
v_and_b32 v13, s63, v228
v_lshlrev_b32 v14, 16, v229
v_and_b32 v15, s63, v229
v_mfma_f32_32x32x16_bf16 v[32:47], v[224:227], a[4:7], v[32:47]
ds_read_b64_tr_b16 a[0:1], v7 offset:10240
ds_read_b64_tr_b16 a[2:3], v7 offset:11520
v_fma_f32 v12, v12, v10, v11
v_fma_f32 v13, v13, v10, v11
v_fma_f32 v14, v14, v10, v11
v_fma_f32 v15, v15, v10, v11
v_mfma_f32_32x32x16_bf16 v[48:63], v[224:227], a[8:11], v[48:63]
ds_read_b64_tr_b16 a[4:5], v7 offset:10304
ds_read_b64_tr_b16 a[6:7], v7 offset:11584
v_cvt_pk_bf16_f32 v228, v12, v13
v_cvt_pk_bf16_f32 v229, v14, v15
v_lshlrev_b32 v12, 16, v230
v_and_b32 v13, s63, v230
v_mfma_f32_32x32x16_bf16 v[64:79], v[224:227], a[12:15], v[64:79]
ds_read_b64_tr_b16 a[8:9], v7 offset:10368
ds_read_b64_tr_b16 a[10:11], v7 offset:11648
v_lshlrev_b32 v14, 16, v231
v_and_b32 v15, s63, v231
v_fma_f32 v12, v12, v10, v11
v_fma_f32 v13, v13, v10, v11
v_mfma_f32_32x32x16_bf16 v[80:95], v[224:227], a[16:19], v[80:95]
ds_read_b64_tr_b16 a[12:13], v7 offset:10432
ds_read_b64_tr_b16 a[14:15], v7 offset:11712
v_fma_f32 v14, v14, v10, v11
v_fma_f32 v15, v15, v10, v11
v_cvt_pk_bf16_f32 v230, v12, v13
v_cvt_pk_bf16_f32 v231, v14, v15
s_waitcnt lgkmcnt(8)
s_nop 0
v_mfma_f32_32x32x16_bf16 v[16:31], v[228:231], a[20:23], v[16:31]
ds_read_b64_tr_b16 a[16:17], v7 offset:10496
ds_read_b64_tr_b16 a[18:19], v7 offset:11776
v_lshlrev_b32 v12, 16, v232
v_and_b32 v13, s63, v232
v_lshlrev_b32 v14, 16, v233
v_and_b32 v15, s63, v233
v_mfma_f32_32x32x16_bf16 v[32:47], v[228:231], a[24:27], v[32:47]
ds_read_b64_tr_b16 a[20:21], v7 offset:15360
ds_read_b64_tr_b16 a[22:23], v7 offset:16640
v_fma_f32 v12, v12, v10, v11
v_fma_f32 v13, v13, v10, v11
v_fma_f32 v14, v14, v10, v11
v_fma_f32 v15, v15, v10, v11
v_mfma_f32_32x32x16_bf16 v[48:63], v[228:231], a[28:31], v[48:63]
ds_read_b64_tr_b16 a[24:25], v7 offset:15424
ds_read_b64_tr_b16 a[26:27], v7 offset:16704
v_cvt_pk_bf16_f32 v232, v12, v13
v_cvt_pk_bf16_f32 v233, v14, v15
v_lshlrev_b32 v12, 16, v234
v_and_b32 v13, s63, v234
v_mfma_f32_32x32x16_bf16 v[64:79], v[228:231], a[32:35], v[64:79]
ds_read_b64_tr_b16 a[28:29], v7 offset:15488
ds_read_b64_tr_b16 a[30:31], v7 offset:16768
v_lshlrev_b32 v14, 16, v235
v_and_b32 v15, s63, v235
v_fma_f32 v12, v12, v10, v11
v_fma_f32 v13, v13, v10, v11
v_mfma_f32_32x32x16_bf16 v[80:95], v[228:231], a[36:39], v[80:95]
ds_read_b64_tr_b16 a[32:33], v7 offset:15552
ds_read_b64_tr_b16 a[34:35], v7 offset:16832
v_fma_f32 v14, v14, v10, v11
v_fma_f32 v15, v15, v10, v11
v_cvt_pk_bf16_f32 v234, v12, v13
v_cvt_pk_bf16_f32 v235, v14, v15
s_waitcnt lgkmcnt(8)
s_nop 0
v_mfma_f32_32x32x16_bf16 v[16:31], v[232:235], a[0:3], v[16:31]
ds_read_b64_tr_b16 a[36:37], v7 offset:15616
ds_read_b64_tr_b16 a[38:39], v7 offset:16896
v_lshlrev_b32 v12, 16, v236
v_and_b32 v13, s63, v236
v_lshlrev_b32 v14, 16, v237
v_and_b32 v15, s63, v237
v_mfma_f32_32x32x16_bf16 v[32:47], v[232:235], a[4:7], v[32:47]
s_waitcnt vmcnt(11)
s_barrier
ds_read_b64_tr_b16 a[0:1], v7 offset:20480
ds_read_b64_tr_b16 a[2:3], v7 offset:21760
v_fma_f32 v12, v12, v10, v11
v_fma_f32 v13, v13, v10, v11
v_fma_f32 v14, v14, v10, v11
v_fma_f32 v15, v15, v10, v11
v_mfma_f32_32x32x16_bf16 v[48:63], v[232:235], a[8:11], v[48:63]
ds_read_b64_tr_b16 a[4:5], v7 offset:20544
ds_read_b64_tr_b16 a[6:7], v7 offset:21824
v_cvt_pk_bf16_f32 v236, v12, v13
v_cvt_pk_bf16_f32 v237, v14, v15
v_lshlrev_b32 v12, 16, v238
v_and_b32 v13, s63, v238
v_mfma_f32_32x32x16_bf16 v[64:79], v[232:235], a[12:15], v[64:79]
ds_read_b64_tr_b16 a[8:9], v7 offset:20608
ds_read_b64_tr_b16 a[10:11], v7 offset:21888
v_lshlrev_b32 v14, 16, v239
v_and_b32 v15, s63, v239
v_fma_f32 v12, v12, v10, v11
v_fma_f32 v13, v13, v10, v11
v_mfma_f32_32x32x16_bf16 v[80:95], v[232:235], a[16:19], v[80:95]
ds_read_b64_tr_b16 a[12:13], v7 offset:20672
ds_read_b64_tr_b16 a[14:15], v7 offset:21952
v_fma_f32 v14, v14, v10, v11
v_fma_f32 v15, v15, v10, v11
v_cvt_pk_bf16_f32 v238, v12, v13
v_cvt_pk_bf16_f32 v239, v14, v15
s_waitcnt lgkmcnt(8)
s_nop 0
v_mfma_f32_32x32x16_bf16 v[16:31], v[236:239], a[20:23], v[16:31]
ds_read_b64_tr_b16 a[16:17], v7 offset:20736
ds_read_b64_tr_b16 a[18:19], v7 offset:22016
v_lshlrev_b32 v12, 16, v240
v_and_b32 v13, s63, v240
v_lshlrev_b32 v14, 16, v241
v_and_b32 v15, s63, v241
v_mfma_f32_32x32x16_bf16 v[32:47], v[236:239], a[24:27], v[32:47]
ds_read_b64_tr_b16 a[20:21], v7 offset:25600
ds_read_b64_tr_b16 a[22:23], v7 offset:26880
v_fma_f32 v12, v12, v10, v11
v_fma_f32 v13, v13, v10, v11
v_fma_f32 v14, v14, v10, v11
v_fma_f32 v15, v15, v10, v11
v_mfma_f32_32x32x16_bf16 v[48:63], v[236:239], a[28:31], v[48:63]
ds_read_b64_tr_b16 a[24:25], v7 offset:25664
ds_read_b64_tr_b16 a[26:27], v7 offset:26944
v_cvt_pk_bf16_f32 v240, v12, v13
v_cvt_pk_bf16_f32 v241, v14, v15
v_lshlrev_b32 v12, 16, v242
v_and_b32 v13, s63, v242
v_mfma_f32_32x32x16_bf16 v[64:79], v[236:239], a[32:35], v[64:79]
ds_read_b64_tr_b16 a[28:29], v7 offset:25728
ds_read_b64_tr_b16 a[30:31], v7 offset:27008
v_lshlrev_b32 v14, 16, v243
v_and_b32 v15, s63, v243
v_fma_f32 v12, v12, v10, v11
v_fma_f32 v13, v13, v10, v11
v_mfma_f32_32x32x16_bf16 v[80:95], v[236:239], a[36:39], v[80:95]
ds_read_b64_tr_b16 a[32:33], v7 offset:25792
ds_read_b64_tr_b16 a[34:35], v7 offset:27072
v_fma_f32 v14, v14, v10, v11
v_fma_f32 v15, v15, v10, v11
v_cvt_pk_bf16_f32 v242, v12, v13
v_cvt_pk_bf16_f32 v243, v14, v15
s_waitcnt lgkmcnt(8)
s_nop 0
v_mfma_f32_32x32x16_bf16 v[16:31], v[240:243], a[0:3], v[16:31]
ds_read_b64_tr_b16 a[36:37], v7 offset:25856
ds_read_b64_tr_b16 a[38:39], v7 offset:27136
v_lshlrev_b32 v12, 16, v244
v_and_b32 v13, s63, v244
v_lshlrev_b32 v14, 16, v245
v_and_b32 v15, s63, v245
v_mfma_f32_32x32x16_bf16 v[32:47], v[240:243], a[4:7], v[32:47]
ds_read_b64_tr_b16 a[0:1], v7 offset:30720
ds_read_b64_tr_b16 a[2:3], v7 offset:32000
v_fma_f32 v12, v12, v10, v11
v_fma_f32 v13, v13, v10, v11
v_fma_f32 v14, v14, v10, v11
v_fma_f32 v15, v15, v10, v11
v_mfma_f32_32x32x16_bf16 v[48:63], v[240:243], a[8:11], v[48:63]
ds_read_b64_tr_b16 a[4:5], v7 offset:30784
ds_read_b64_tr_b16 a[6:7], v7 offset:32064
v_cvt_pk_bf16_f32 v244, v12, v13
v_cvt_pk_bf16_f32 v245, v14, v15
v_lshlrev_b32 v12, 16, v246
v_and_b32 v13, s63, v246
v_mfma_f32_32x32x16_bf16 v[64:79], v[240:243], a[12:15], v[64:79]
ds_read_b64_tr_b16 a[8:9], v7 offset:30848
ds_read_b64_tr_b16 a[10:11], v7 offset:32128
v_lshlrev_b32 v14, 16, v247
v_and_b32 v15, s63, v247
v_fma_f32 v12, v12, v10, v11
v_fma_f32 v13, v13, v10, v11
v_mfma_f32_32x32x16_bf16 v[80:95], v[240:243], a[16:19], v[80:95]
ds_read_b64_tr_b16 a[12:13], v7 offset:30912
ds_read_b64_tr_b16 a[14:15], v7 offset:32192
v_fma_f32 v14, v14, v10, v11
v_fma_f32 v15, v15, v10, v11
v_cvt_pk_bf16_f32 v246, v12, v13
v_cvt_pk_bf16_f32 v247, v14, v15
s_waitcnt lgkmcnt(8)
s_nop 0
v_mfma_f32_32x32x16_bf16 v[16:31], v[244:247], a[20:23], v[16:31]
ds_read_b64_tr_b16 a[16:17], v7 offset:30976
ds_read_b64_tr_b16 a[18:19], v7 offset:32256
v_lshlrev_b32 v12, 16, v248
v_and_b32 v13, s63, v248
v_lshlrev_b32 v14, 16, v249
v_and_b32 v15, s63, v249
v_mfma_f32_32x32x16_bf16 v[32:47], v[244:247], a[24:27], v[32:47]
ds_read_b64_tr_b16 a[20:21], v7 offset:35840
ds_read_b64_tr_b16 a[22:23], v7 offset:37120
v_fma_f32 v12, v12, v10, v11
v_fma_f32 v13, v13, v10, v11
v_fma_f32 v14, v14, v10, v11
v_fma_f32 v15, v15, v10, v11
v_mfma_f32_32x32x16_bf16 v[48:63], v[244:247], a[28:31], v[48:63]
ds_read_b64_tr_b16 a[24:25], v7 offset:35904
ds_read_b64_tr_b16 a[26:27], v7 offset:37184
v_cvt_pk_bf16_f32 v248, v12, v13
v_cvt_pk_bf16_f32 v249, v14, v15
v_lshlrev_b32 v12, 16, v250
v_and_b32 v13, s63, v250
v_mfma_f32_32x32x16_bf16 v[64:79], v[244:247], a[32:35], v[64:79]
ds_read_b64_tr_b16 a[28:29], v7 offset:35968
ds_read_b64_tr_b16 a[30:31], v7 offset:37248
v_lshlrev_b32 v14, 16, v251
v_and_b32 v15, s63, v251
v_fma_f32 v12, v12, v10, v11
v_fma_f32 v13, v13, v10, v11
v_mfma_f32_32x32x16_bf16 v[80:95], v[244:247], a[36:39], v[80:95]
ds_read_b64_tr_b16 a[32:33], v7 offset:36032
ds_read_b64_tr_b16 a[34:35], v7 offset:37312
v_fma_f32 v14, v14, v10, v11
v_fma_f32 v15, v15, v10, v11
v_cvt_pk_bf16_f32 v250, v12, v13
v_cvt_pk_bf16_f32 v251, v14, v15
s_waitcnt lgkmcnt(8)
s_nop 0
v_mfma_f32_32x32x16_bf16 v[16:31], v[248:251], a[0:3], v[16:31]
ds_read_b64_tr_b16 a[36:37], v7 offset:36096
ds_read_b64_tr_b16 a[38:39], v7 offset:37376
v_lshlrev_b32 v12, 16, v252
v_and_b32 v13, s63, v252
v_lshlrev_b32 v14, 16, v253
v_and_b32 v15, s63, v253
v_mfma_f32_32x32x16_bf16 v[32:47], v[248:251], a[4:7], v[32:47]
v_fma_f32 v12, v12, v10, v11
v_fma_f32 v13, v13, v10, v11
v_fma_f32 v14, v14, v10, v11
v_fma_f32 v15, v15, v10, v11
v_mfma_f32_32x32x16_bf16 v[48:63], v[248:251], a[8:11], v[48:63]
v_cvt_pk_bf16_f32 v252, v12, v13
v_cvt_pk_bf16_f32 v253, v14, v15
v_lshlrev_b32 v12, 16, v254
v_and_b32 v13, s63, v254
v_mfma_f32_32x32x16_bf16 v[64:79], v[248:251], a[12:15], v[64:79]
v_lshlrev_b32 v14, 16, v255
v_and_b32 v15, s63, v255
v_fma_f32 v12, v12, v10, v11
v_fma_f32 v13, v13, v10, v11
v_mfma_f32_32x32x16_bf16 v[80:95], v[248:251], a[16:19], v[80:95]
v_fma_f32 v14, v14, v10, v11
v_fma_f32 v15, v15, v10, v11
v_cvt_pk_bf16_f32 v254, v12, v13
v_cvt_pk_bf16_f32 v255, v14, v15
s_waitcnt lgkmcnt(0)
s_nop 0
v_mfma_f32_32x32x16_bf16 v[16:31], v[252:255], a[20:23], v[16:31]
v_mfma_f32_32x32x16_bf16 v[32:47], v[252:255], a[24:27], v[32:47]
v_mfma_f32_32x32x16_bf16 v[48:63], v[252:255], a[28:31], v[48:63]
v_mfma_f32_32x32x16_bf16 v[64:79], v[252:255], a[32:35], v[64:79]
v_mfma_f32_32x32x16_bf16 v[80:95], v[252:255], a[36:39], v[80:95]
s_waitcnt vmcnt(3)
s_mov_b32 s56, 0x05040100
s_mov_b32 s57, 0x07060302
v_accvgpr_read_b32 v3, a81
v_accvgpr_read_b32 v176, a64
v_accvgpr_read_b32 v177, a65
v_accvgpr_read_b32 v178, a66
v_accvgpr_read_b32 v179, a67
v_accvgpr_read_b32 v180, a68
v_accvgpr_read_b32 v181, a69
v_accvgpr_read_b32 v182, a70
v_accvgpr_read_b32 v183, a71
v_accvgpr_read_b32 v184, a72
v_accvgpr_read_b32 v185, a73
v_accvgpr_read_b32 v186, a74
v_accvgpr_read_b32 v187, a75
v_accvgpr_read_b32 v188, a76
v_accvgpr_read_b32 v189, a77
v_accvgpr_read_b32 v190, a78
v_accvgpr_read_b32 v191, a79
v_perm_b32 v192, v178, v176, s56
v_perm_b32 v193, v182, v180, s56
v_perm_b32 v194, v186, v184, s56
v_perm_b32 v195, v190, v188, s56
s_mov_b32 s55, 0
buffer_store_dwordx4 v[192:195], v3, s[88:91], s55 offen sc1
v_perm_b32 v196, v178, v176, s57
v_perm_b32 v197, v182, v180, s57
v_perm_b32 v198, v186, v184, s57
v_perm_b32 v199, v190, v188, s57
s_mov_b32 s55, 8192
buffer_store_dwordx4 v[196:199], v3, s[88:91], s55 offen sc1
v_perm_b32 v200, v179, v177, s56
v_perm_b32 v201, v183, v181, s56
v_perm_b32 v202, v187, v185, s56
v_perm_b32 v203, v191, v189, s56
s_mov_b32 s55, 16384
buffer_store_dwordx4 v[200:203], v3, s[88:91], s55 offen sc1
v_perm_b32 v204, v179, v177, s57
v_perm_b32 v205, v183, v181, s57
v_perm_b32 v206, v187, v185, s57
v_perm_b32 v207, v191, v189, s57
s_mov_b32 s55, 24576
buffer_store_dwordx4 v[204:207], v3, s[88:91], s55 offen sc1
v_and_b32 v2, 31, v0
v_mul_u32_u24 v2, 272, v2
v_lshrrev_b32 v3, 5, v0
v_lshl_add_u32 v2, v3, 6, v2
s_lshl_b32 s48, s3, 4
s_add_u32 s48, s48, 49152
v_add_u32 v2, s48, v2
v_lshrrev_b32 v4, 4, v0
s_mul_i32 s48, s3, 40
v_add_u32 v4, s48, v4
v_and_b32 v5, 15, v0
v_mul_u32_u24 v6, 272, v4
v_lshl_add_u32 v6, v5, 4, v6
v_add_u32 v6, 49152, v6
v_add_u32 v4, s31, v4
v_lshlrev_b32 v4, 12, v4
v_bfe_u32 v7, v0, 3, 1
v_lshl_add_u32 v4, v7, 11, v4
v_bfe_u32 v7, v0, 2, 1
v_lshl_add_u32 v4, v7, 9, v4
v_and_b32 v7, 3, v0
v_lshl_add_u32 v4, v7, 4, v4
s_lshr_b32 s48, s6, 3
s_lshl_b32 s48, s48, 10
s_and_b32 s49, s6, 7
s_lshl_b32 s49, s49, 6
s_add_u32 s48, s48, s49
v_cvt_pk_bf16_f32 v96, v16, v17
v_cvt_pk_bf16_f32 v97, v18, v19
v_cvt_pk_bf16_f32 v98, v20, v21
v_cvt_pk_bf16_f32 v99, v22, v23
ds_write_b128 v2, v[96:99] offset:0
v_cvt_pk_bf16_f32 v100, v24, v25
v_cvt_pk_bf16_f32 v101, v26, v27
v_cvt_pk_bf16_f32 v102, v28, v29
v_cvt_pk_bf16_f32 v103, v30, v31
ds_write_b128 v2, v[100:103] offset:128
v_cvt_pk_bf16_f32 v104, v32, v33
v_cvt_pk_bf16_f32 v105, v34, v35
v_cvt_pk_bf16_f32 v106, v36, v37
v_cvt_pk_bf16_f32 v107, v38, v39
ds_write_b128 v2, v[104:107] offset:8704
v_cvt_pk_bf16_f32 v108, v40, v41
v_cvt_pk_bf16_f32 v109, v42, v43
v_cvt_pk_bf16_f32 v110, v44, v45
v_cvt_pk_bf16_f32 v111, v46, v47
ds_write_b128 v2, v[108:111] offset:8832
v_cvt_pk_bf16_f32 v112, v48, v49
v_cvt_pk_bf16_f32 v113, v50, v51
v_cvt_pk_bf16_f32 v114, v52, v53
v_cvt_pk_bf16_f32 v115, v54, v55
ds_write_b128 v2, v[112:115] offset:17408
v_cvt_pk_bf16_f32 v116, v56, v57
v_cvt_pk_bf16_f32 v117, v58, v59
v_cvt_pk_bf16_f32 v118, v60, v61
v_cvt_pk_bf16_f32 v119, v62, v63
ds_write_b128 v2, v[116:119] offset:17536
v_cvt_pk_bf16_f32 v120, v64, v65
v_cvt_pk_bf16_f32 v121, v66, v67
v_cvt_pk_bf16_f32 v122, v68, v69
v_cvt_pk_bf16_f32 v123, v70, v71
ds_write_b128 v2, v[120:123] offset:26112
v_cvt_pk_bf16_f32 v124, v72, v73
v_cvt_pk_bf16_f32 v125, v74, v75
v_cvt_pk_bf16_f32 v126, v76, v77
v_cvt_pk_bf16_f32 v127, v78, v79
ds_write_b128 v2, v[124:127] offset:26240
v_cvt_pk_bf16_f32 v128, v80, v81
v_cvt_pk_bf16_f32 v129, v82, v83
v_cvt_pk_bf16_f32 v130, v84, v85
v_cvt_pk_bf16_f32 v131, v86, v87
ds_write_b128 v2, v[128:131] offset:34816
v_cvt_pk_bf16_f32 v132, v88, v89
v_cvt_pk_bf16_f32 v133, v90, v91
v_cvt_pk_bf16_f32 v134, v92, v93
v_cvt_pk_bf16_f32 v135, v94, v95
ds_write_b128 v2, v[132:135] offset:34944
s_waitcnt lgkmcnt(0)
s_barrier
ds_read_b128 v[16:19], v6 offset:0
ds_read_b128 v[20:23], v6 offset:1088
ds_read_b128 v[24:27], v6 offset:2176
ds_read_b128 v[28:31], v6 offset:3264
ds_read_b128 v[32:35], v6 offset:4352
ds_read_b128 v[36:39], v6 offset:5440
ds_read_b128 v[40:43], v6 offset:6528
ds_read_b128 v[44:47], v6 offset:7616
ds_read_b128 v[48:51], v6 offset:8704
ds_read_b128 v[52:55], v6 offset:9792
s_waitcnt lgkmcnt(9)
buffer_store_dwordx4 v[16:19], v4, s[40:43], s48 offen sc1
s_add_u32 s48, s48, 16384
s_waitcnt lgkmcnt(8)
buffer_store_dwordx4 v[20:23], v4, s[40:43], s48 offen sc1
s_add_u32 s48, s48, 16384
s_waitcnt lgkmcnt(7)
buffer_store_dwordx4 v[24:27], v4, s[40:43], s48 offen sc1
s_add_u32 s48, s48, 16384
s_waitcnt lgkmcnt(6)
buffer_store_dwordx4 v[28:31], v4, s[40:43], s48 offen sc1
s_add_u32 s48, s48, 16384
s_waitcnt lgkmcnt(5)
buffer_store_dwordx4 v[32:35], v4, s[40:43], s48 offen sc1
s_add_u32 s48, s48, 16384
s_waitcnt lgkmcnt(4)
buffer_store_dwordx4 v[36:39], v4, s[40:43], s48 offen sc1
s_add_u32 s48, s48, 16384
s_waitcnt lgkmcnt(3)
buffer_store_dwordx4 v[40:43], v4, s[40:43], s48 offen sc1
s_add_u32 s48, s48, 16384
s_waitcnt lgkmcnt(2)
buffer_store_dwordx4 v[44:47], v4, s[40:43], s48 offen sc1
s_add_u32 s48, s48, 16384
s_waitcnt lgkmcnt(1)
buffer_store_dwordx4 v[48:51], v4, s[40:43], s48 offen sc1
s_add_u32 s48, s48, 16384
s_waitcnt lgkmcnt(0)
buffer_store_dwordx4 v[52:55], v4, s[40:43], s48 offen sc1
s_add_u32 s48, s48, 16384
s_waitcnt vmcnt(6)
s_endpgm
P1X:
s_waitcnt lgkmcnt(0)
s_cmp_eq_u32 s30, 0
s_cbranch_scc0 P1Y
s_add_u32 s50, s28, 0x1800000
s_addc_u32 s51, s29, 0
v_lshlrev_b32 v1, 7, v0
v_mov_b32 v2, 0
global_store_dword v1, v2, s[50:51] sc1
P1Y:
s_mov_b32 s36, s16
s_mov_b32 s37, s17
s_mov_b32 s38, 2211840
s_mov_b32 s39, 0x20000
s_getpc_b64 s[40:41]
s_add_u32 s40, s40, TABF@rel32@lo+4
s_addc_u32 s41, s41, TABF@rel32@hi+12
s_mov_b32 s42, 819200
s_mov_b32 s43, 0x20000
s_lshl_b32 s48, s30, 13
v_lshlrev_b32 v1, 7, v0
v_add_u32 v1, s48, v1
buffer_load_dword v8, v1, s[36:39], 0 offen
buffer_load_dword v16, v1, s[40:43], 0 offen
v_add_u32 v1, 0x80000, v1
buffer_load_dword v9, v1, s[36:39], 0 offen
buffer_load_dword v17, v1, s[40:43], 0 offen
v_add_u32 v1, 0x80000, v1
buffer_load_dword v10, v1, s[36:39], 0 offen
v_add_u32 v1, 0x80000, v1
buffer_load_dword v11, v1, s[36:39], 0 offen
v_add_u32 v1, 0x80000, v1
buffer_load_dword v12, v1, s[36:39], 0 offen
v_add_u32 v1, 0x80000, v1
s_waitcnt vmcnt(0)
EXIT_p1_kernel:
s_endpgm
END_p1_kernel:
.globl p2_kernel
.p2align 8
.type p2_kernel,@function
p2_kernel:
s_cmp_ge_u32 s2, 256
s_cbranch_scc1 EXIT_p2_kernel
s_load_dwordx16 s[8:23], s[0:1], 0
s_load_dwordx4 s[24:27], s[0:1], 64
s_load_dwordx2 s[28:29], s[0:1], 80
v_lshrrev_b32 v1, 6, v0
v_and_b32 v0, 63, v0
v_readfirstlane_b32 s3, v1
s_and_b32 s4, s2, 7
s_lshr_b32 s5, s2, 3
s_mov_b32 s60, 99
s_getpc_b64 s[32:33]
s_add_u32 s32, s32, p2_kernel@rel32@lo+4
s_addc_u32 s33, s33, p2_kernel@rel32@hi+12
s_mov_b32 s34, END_p2_kernel-p2_kernel
s_mov_b32 s35, 0x20000
s_lshl_b32 s48, s5, 2
s_add_u32 s48, s48, s3
s_mul_i32 s48, s48, 256
v_lshlrev_b32 v2, 7, v0
v_add_u32 v2, s48, v2
v_cmp_gt_u32 vcc, 2, v0
s_nop 1
v_cndmask_b32 v2, -1, v2, vcc
buffer_load_dword v250, v2, s[32:35], 0 offen
s_getpc_b64 s[64:65]
s_add_u32 s64, s64, TABG@rel32@lo+4
s_addc_u32 s65, s65, TABG@rel32@hi+12
s_mov_b32 s66, 819200
s_mov_b32 s67, 0x20000
s_and_b32 s62, s5, 7
s_mul_i32 s62, s62, 4
s_lshr_b32 s63, s5, 3
s_mul_i32 s68, s63, 12
s_add_u32 s62, s62, s68
s_cmp_ge_u32 s62, 40
s_cselect_b32 s68, 40, 0
s_sub_u32 s62, s62, s68
s_mul_i32 s63, s63, 5
s_add_u32 s68, s63, s3
s_mul_i32 s68, s68, 40960
s_add_u32 s84, s68, 40960
s_lshl_b32 s69, s62, 10
s_add_u32 s69, s69, s68
v_lshlrev_b32 v1, 4, v0
s_cmp_ge_u32 s2, 241
s_cbranch_scc1 P2I
s_cmp_ge_u32 s2, 160
s_cbranch_scc1 P2F
s_and_b32 s6, s4, 1
s_lshr_b32 s7, s4, 1
s_lshl_b32 s7, s7, 2
s_and_b32 s30, s5, 3
s_add_u32 s7, s7, s30
s_lshl_b32 s7, s7, 2
s_add_u32 s7, s7, s3
s_lshr_b32 s30, s5, 2
s_cmp_eq_u32 s2, 0
s_cselect_b32 s60, 0, s60
s_mul_i32 s48, s7, 108
s_mul_i32 s49, s6, 54
s_add_u32 s48, s48, s49
s_lshl_b32 s48, s48, 10
s_mul_i32 s49, s6, 864*1280
s_lshl_b32 s50, s30, 8
s_add_u32 s49, s49, s50
s_mul_i32 s50, s3, 24*1280
s_add_u32 s49, s49, s50
s_mul_i32 s50, s3, 6144
v_lshlrev_b32 v1, 4, v0
v_lshrrev_b32 v3, 4, v0
v_bfe_u32 v4, v0, 2, 2
v_xor_b32 v5, v3, v4
v_mul_u32_u24 v2, 1280, v3
v_lshl_add_u32 v2, v5, 6, v2
v_and_b32 v5, 3, v0
v_lshl_add_u32 v2, v5, 4, v2
s_waitcnt lgkmcnt(0)
s_add_u32 s32, s28, 3145728
s_addc_u32 s33, s29, 0
s_mov_b32 s34, 7077888
s_mov_b32 s35, 0x20000
s_mov_b32 s36, s20
s_mov_b32 s37, s21
s_mov_b32 s38, 2211840
s_mov_b32 s39, 0x20000
s_add_u32 s40, s28, 16777216
s_addc_u32 s41, s29, 0
s_mov_b32 s42, 5242880
s_mov_b32 s43, 0x20000
s_and_b32 s55, s5, 3
s_add_u32 s55, s55, s30
s_mul_i32 s55, s55, 1
s_cmp_ge_u32 s55, 9
s_cselect_b32 s56, 9, 0
s_sub_u32 s55, s55, s56
s_mov_b32 s56, s48
s_mov_b32 s57, s49
s_add_u32 s58, s48, 54*1024
s_mul_i32 s59, s55, 6144
s_add_u32 s48, s48, s59
s_mul_i32 s59, s55, 96*1280
s_add_u32 s49, s49, s59
s_add_u32 m0, s50, 0
s_nop 0
buffer_load_dwordx4 v2, s[36:39], s49 offen lds
s_add_u32 s49, s49, 5120
s_add_u32 m0, s50, 1024
s_nop 0
buffer_load_dwordx4 v2, s[36:39], s49 offen lds
s_add_u32 s49, s49, 5120
s_add_u32 m0, s50, 2048
s_nop 0
buffer_load_dwordx4 v2, s[36:39], s49 offen lds
s_add_u32 s49, s49, 5120
s_add_u32 m0, s50, 3072
s_nop 0
buffer_load_dwordx4 v2, s[36:39], s49 offen lds
s_add_u32 s49, s49, 5120
s_add_u32 m0, s50, 4096
s_nop 0
buffer_load_dwordx4 v2, s[36:39], s49 offen lds
s_add_u32 s49, s49, 5120
s_add_u32 m0, s50, 5120
s_nop 0
buffer_load_dwordx4 v2, s[36:39], s49 offen lds
s_add_u32 s49, s49, 97280
buffer_load_dwordx4 a[0:3], v1, s[32:35], s48 offen offset:0
buffer_load_dwordx4 a[4:7], v1, s[32:35], s48 offen offset:1024
buffer_load_dwordx4 a[8:11], v1, s[32:35], s48 offen offset:2048
s_add_u32 s48, s48, 3072
buffer_load_dwordx4 a[12:15], v1, s[32:35], s48 offen offset:0
buffer_load_dwordx4 a[16:19], v1, s[32:35], s48 offen offset:1024
buffer_load_dwordx4 a[20:23], v1, s[32:35], s48 offen offset:2048
s_add_u32 s48, s48, 3072
s_cmp_eq_u32 s48, s58
s_cselect_b32 s48, s56, s48
s_cselect_b32 s49, s57, s49
s_add_u32 m0, s50, 24576
s_nop 0
buffer_load_dwordx4 v2, s[36:39], s49 offen lds
s_add_u32 s49, s49, 5120
s_add_u32 m0, s50, 25600
s_nop 0
buffer_load_dwordx4 v2, s[36:39], s49 offen lds
s_add_u32 s49, s49, 5120
s_add_u32 m0, s50, 26624
s_nop 0
buffer_load_dwordx4 v2, s[36:39], s49 offen lds
s_add_u32 s49, s49, 5120
s_add_u32 m0, s50, 27648
s_nop 0
buffer_load_dwordx4 v2, s[36:39], s49 offen lds
s_add_u32 s49, s49, 5120
s_add_u32 m0, s50, 28672
s_nop 0
buffer_load_dwordx4 v2, s[36:39], s49 offen lds
s_add_u32 s49, s49, 5120
s_add_u32 m0, s50, 29696
s_nop 0
buffer_load_dwordx4 v2, s[36:39], s49 offen lds
s_add_u32 s49, s49, 97280
buffer_load_dwordx4 a[24:27], v1, s[32:35], s48 offen offset:0
buffer_load_dwordx4 a[28:31], v1, s[32:35], s48 offen offset:1024
buffer_load_dwordx4 a[32:35], v1, s[32:35], s48 offen offset:2048
s_add_u32 s48, s48, 3072
buffer_load_dwordx4 a[36:39], v1, s[32:35], s48 offen offset:0
buffer_load_dwordx4 a[40:43], v1, s[32:35], s48 offen offset:1024
buffer_load_dwordx4 a[44:47], v1, s[32:35], s48 offen offset:2048
s_add_u32 s48, s48, 3072
s_cmp_eq_u32 s48, s58
s_cselect_b32 s48, s56, s48
s_cselect_b32 s49, s57, s49
v_lshrrev_b32 v6, 5, v0
v_lshl_add_u32 v6, v6, 2, v4
v_lshlrev_b32 v6, 8, v6
v_and_b32 v7, 1, v3
v_lshl_add_u32 v6, v7, 5, v6
v_and_b32 v7, 1, v0
v_lshl_add_u32 v6, v7, 4, v6
v_bfe_u32 v7, v0, 1, 1
v_lshl_add_u32 v6, v7, 3, v6
v_xor_b32 v7, 0, v4
v_lshl_add_u32 v100, v7, 6, v6
v_add_u32 v104, 49152, v100
v_add_u32 v108, 98304, v100
v_xor_b32 v7, 1, v4
v_lshl_add_u32 v101, v7, 6, v6
v_add_u32 v105, 49152, v101
v_add_u32 v109, 98304, v101
v_xor_b32 v7, 2, v4
v_lshl_add_u32 v102, v7, 6, v6
v_add_u32 v106, 49152, v102
v_add_u32 v110, 98304, v102
v_xor_b32 v7, 3, v4
v_lshl_add_u32 v103, v7, 6, v6
v_add_u32 v107, 49152, v103
v_add_u32 v111, 98304, v103
s_waitcnt vmcnt(12)
s_barrier
ds_read_b64_tr_b16 a[216:217], v100 offset:0
ds_read_b64_tr_b16 a[218:219], v100 offset:2048
ds_read_b64_tr_b16 a[220:221], v101 offset:0
ds_read_b64_tr_b16 a[222:223], v101 offset:2048
ds_read_b64_tr_b16 a[224:225], v102 offset:0
ds_read_b64_tr_b16 a[226:227], v102 offset:2048
ds_read_b64_tr_b16 a[228:229], v103 offset:0
ds_read_b64_tr_b16 a[230:231], v103 offset:2048
s_waitcnt lgkmcnt(6)
v_mfma_f32_32x32x16_bf16 v[16:31], a[216:219], a[0:3], 0
ds_read_b64_tr_b16 a[232:233], v100 offset:4096
ds_read_b64_tr_b16 a[234:235], v100 offset:6144
s_add_u32 m0, s50, 49152
s_nop 0
buffer_load_dwordx4 v2, s[36:39], s49 offen lds
s_add_u32 s49, s49, 5120
s_add_u32 m0, s50, 50176
s_nop 0
buffer_load_dwordx4 v2, s[36:39], s49 offen lds
s_waitcnt lgkmcnt(6)
v_mfma_f32_32x32x16_bf16 v[32:47], a[220:223], a[0:3], 0
ds_read_b64_tr_b16 a[236:237], v101 offset:4096
ds_read_b64_tr_b16 a[238:239], v101 offset:6144
s_add_u32 s49, s49, 5120
s_add_u32 m0, s50, 51200
s_nop 0
buffer_load_dwordx4 v2, s[36:39], s49 offen lds
s_add_u32 s49, s49, 5120
s_add_u32 m0, s50, 52224
s_waitcnt lgkmcnt(6)
v_mfma_f32_32x32x16_bf16 v[48:63], a[224:227], a[0:3], 0
ds_read_b64_tr_b16 a[240:241], v102 offset:4096
ds_read_b64_tr_b16 a[242:243], v102 offset:6144
buffer_load_dwordx4 v2, s[36:39], s49 offen lds
s_add_u32 s49, s49, 5120
s_add_u32 m0, s50, 53248
s_nop 0
buffer_load_dwordx4 v2, s[36:39], s49 offen lds
s_add_u32 s49, s49, 5120
s_waitcnt lgkmcnt(6)
v_mfma_f32_32x32x16_bf16 v[64:79], a[228:231], a[0:3], 0
ds_read_b64_tr_b16 a[244:245], v103 offset:4096
ds_read_b64_tr_b16 a[246:247], v103 offset:6144
s_add_u32 m0, s50, 54272
s_nop 0
buffer_load_dwordx4 v2, s[36:39], s49 offen lds
s_add_u32 s49, s49, 97280
buffer_load_dwordx4 a[48:51], v1, s[32:35], s48 offen offset:0
buffer_load_dwordx4 a[52:55], v1, s[32:35], s48 offen offset:1024
s_waitcnt lgkmcnt(6)
v_mfma_f32_32x32x16_bf16 v[16:31], a[232:235], a[4:7], v[16:31]
ds_read_b64_tr_b16 a[216:217], v100 offset:8192
ds_read_b64_tr_b16 a[218:219], v100 offset:10240
buffer_load_dwordx4 a[56:59], v1, s[32:35], s48 offen offset:2048
s_add_u32 s48, s48, 3072
buffer_load_dwordx4 a[60:63], v1, s[32:35], s48 offen offset:0
buffer_load_dwordx4 a[64:67], v1, s[32:35], s48 offen offset:1024
buffer_load_dwordx4 a[68:71], v1, s[32:35], s48 offen offset:2048
s_waitcnt lgkmcnt(6)
v_mfma_f32_32x32x16_bf16 v[32:47], a[236:239], a[4:7], v[32:47]
ds_read_b64_tr_b16 a[220:221], v101 offset:8192
ds_read_b64_tr_b16 a[222:223], v101 offset:10240
s_add_u32 s48, s48, 3072
s_cmp_eq_u32 s48, s58
s_cselect_b32 s48, s56, s48
s_cselect_b32 s49, s57, s49
s_add_u32 m0, s50, 73728
s_nop 0
buffer_load_dwordx4 v2, s[36:39], s49 offen lds
s_add_u32 s49, s49, 5120
s_waitcnt lgkmcnt(6)
v_mfma_f32_32x32x16_bf16 v[48:63], a[240:243], a[4:7], v[48:63]
ds_read_b64_tr_b16 a[224:225], v102 offset:8192
ds_read_b64_tr_b16 a[226:227], v102 offset:10240
s_add_u32 m0, s50, 74752
s_nop 0
buffer_load_dwordx4 v2, s[36:39], s49 offen lds
s_add_u32 s49, s49, 5120
s_add_u32 m0, s50, 75776
s_nop 0
buffer_load_dwordx4 v2, s[36:39], s49 offen lds
s_waitcnt lgkmcnt(6)
v_mfma_f32_32x32x16_bf16 v[64:79], a[244:247], a[4:7], v[64:79]
ds_read_b64_tr_b16 a[228:229], v103 offset:8192
ds_read_b64_tr_b16 a[230:231], v103 offset:10240
s_add_u32 s49, s49, 5120
s_add_u32 m0, s50, 76800
s_nop 0
buffer_load_dwordx4 v2, s[36:39], s49 offen lds
s_add_u32 s49, s49, 5120
s_add_u32 m0, s50, 77824
s_waitcnt lgkmcnt(6)
v_mfma_f32_32x32x16_bf16 v[16:31], a[216:219], a[8:11], v[16:31]
ds_read_b64_tr_b16 a[232:233], v100 offset:12288
ds_read_b64_tr_b16 a[234:235], v100 offset:14336
buffer_load_dwordx4 v2, s[36:39], s49 offen lds
s_add_u32 s49, s49, 5120
s_add_u32 m0, s50, 78848
s_nop 0
buffer_load_dwordx4 v2, s[36:39], s49 offen lds
s_add_u32 s49, s49, 97280
s_waitcnt lgkmcnt(6)
v_mfma_f32_32x32x16_bf16 v[32:47], a[220:223], a[8:11], v[32:47]
ds_read_b64_tr_b16 a[236:237], v101 offset:12288
ds_read_b64_tr_b16 a[238:239], v101 offset:14336
buffer_load_dwordx4 a[72:75], v1, s[32:35], s48 offen offset:0
buffer_load_dwordx4 a[76:79], v1, s[32:35], s48 offen offset:1024
buffer_load_dwordx4 a[80:83], v1, s[32:35], s48 offen offset:2048
s_add_u32 s48, s48, 3072
buffer_load_dwordx4 a[84:87], v1, s[32:35], s48 offen offset:0
s_waitcnt lgkmcnt(6)
v_mfma_f32_32x32x16_bf16 v[48:63], a[224:227], a[8:11], v[48:63]
ds_read_b64_tr_b16 a[240:241], v102 offset:12288
ds_read_b64_tr_b16 a[242:243], v102 offset:14336
buffer_load_dwordx4 a[88:91], v1, s[32:35], s48 offen offset:1024
buffer_load_dwordx4 a[92:95], v1, s[32:35], s48 offen offset:2048
s_add_u32 s48, s48, 3072
s_cmp_eq_u32 s48, s58
s_cselect_b32 s48, s56, s48
s_cselect_b32 s49, s57, s49
s_add_u32 m0, s50, 98304
s_waitcnt lgkmcnt(6)
v_mfma_f32_32x32x16_bf16 v[64:79], a[228:231], a[8:11], v[64:79]
ds_read_b64_tr_b16 a[244:245], v103 offset:12288
ds_read_b64_tr_b16 a[246:247], v103 offset:14336
buffer_load_dwordx4 v2, s[36:39], s49 offen lds
s_add_u32 s49, s49, 5120
s_add_u32 m0, s50, 99328
s_nop 0
buffer_load_dwordx4 v2, s[36:39], s49 offen lds
s_add_u32 s49, s49, 5120
s_waitcnt lgkmcnt(6)
v_mfma_f32_32x32x16_bf16 v[16:31], a[232:235], a[12:15], v[16:31]
ds_read_b64_tr_b16 a[216:217], v100 offset:16384
ds_read_b64_tr_b16 a[218:219], v100 offset:18432
s_add_u32 m0, s50, 100352
s_nop 0
buffer_load_dwordx4 v2, s[36:39], s49 offen lds
s_add_u32 s49, s49, 5120
s_add_u32 m0, s50, 101376
s_nop 0
buffer_load_dwordx4 v2, s[36:39], s49 offen lds
s_waitcnt lgkmcnt(6)
v_mfma_f32_32x32x16_bf16 v[32:47], a[236:239], a[12:15], v[32:47]
ds_read_b64_tr_b16 a[220:221], v101 offset:16384
ds_read_b64_tr_b16 a[222:223], v101 offset:18432
s_add_u32 s49, s49, 5120
s_add_u32 m0, s50, 102400
s_nop 0
buffer_load_dwordx4 v2, s[36:39], s49 offen lds
s_add_u32 s49, s49, 5120
s_add_u32 m0, s50, 103424
s_waitcnt lgkmcnt(6)
v_mfma_f32_32x32x16_bf16 v[48:63], a[240:243], a[12:15], v[48:63]
ds_read_b64_tr_b16 a[224:225], v102 offset:16384
ds_read_b64_tr_b16 a[226:227], v102 offset:18432
buffer_load_dwordx4 v2, s[36:39], s49 offen lds
s_add_u32 s49, s49, 97280
buffer_load_dwordx4 a[96:99], v1, s[32:35], s48 offen offset:0
buffer_load_dwordx4 a[100:103], v1, s[32:35], s48 offen offset:1024
buffer_load_dwordx4 a[104:107], v1, s[32:35], s48 offen offset:2048
s_waitcnt lgkmcnt(6)
v_mfma_f32_32x32x16_bf16 v[64:79], a[244:247], a[12:15], v[64:79]
ds_read_b64_tr_b16 a[228:229], v103 offset:16384
ds_read_b64_tr_b16 a[230:231], v103 offset:18432
s_add_u32 s48, s48, 3072
buffer_load_dwordx4 a[108:111], v1, s[32:35], s48 offen offset:0
buffer_load_dwordx4 a[112:115], v1, s[32:35], s48 offen offset:1024
buffer_load_dwordx4 a[116:119], v1, s[32:35], s48 offen offset:2048
s_add_u32 s48, s48, 3072
s_waitcnt lgkmcnt(6)
v_mfma_f32_32x32x16_bf16 v[16:31], a[216:219], a[16:19], v[16:31]
ds_read_b64_tr_b16 a[232:233], v100 offset:20480
ds_read_b64_tr_b16 a[234:235], v100 offset:22528
s_cmp_eq_u32 s48, s58
s_cselect_b32 s48, s56, s48
s_cselect_b32 s49, s57, s49
s_waitcnt lgkmcnt(6)
v_mfma_f32_32x32x16_bf16 v[32:47], a[220:223], a[16:19], v[32:47]
ds_read_b64_tr_b16 a[236:237], v101 offset:20480
ds_read_b64_tr_b16 a[238:239], v101 offset:22528
s_waitcnt lgkmcnt(6)
v_mfma_f32_32x32x16_bf16 v[48:63], a[224:227], a[16:19], v[48:63]
ds_read_b64_tr_b16 a[240:241], v102 offset:20480
ds_read_b64_tr_b16 a[242:243], v102 offset:22528
s_waitcnt lgkmcnt(6)
v_mfma_f32_32x32x16_bf16 v[64:79], a[228:231], a[16:19], v[64:79]
ds_read_b64_tr_b16 a[244:245], v103 offset:20480
ds_read_b64_tr_b16 a[246:247], v103 offset:22528
s_waitcnt lgkmcnt(6)
v_mfma_f32_32x32x16_bf16 v[16:31], a[232:235], a[20:23], v[16:31]
s_waitcnt vmcnt(36)
s_barrier
ds_read_b64_tr_b16 a[216:217], v100 offset:24576
ds_read_b64_tr_b16 a[218:219], v100 offset:26624
s_add_u32 m0, s50, 122880
s_nop 0
buffer_load_dwordx4 v2, s[36:39], s49 offen lds
s_waitcnt lgkmcnt(6)
v_mfma_f32_32x32x16_bf16 v[32:47], a[236:239], a[20:23], v[32:47]
ds_read_b64_tr_b16 a[220:221], v101 offset:24576
ds_read_b64_tr_b16 a[222:223], v101 offset:26624
s_add_u32 s49, s49, 5120
s_add_u32 m0, s50, 123904
s_waitcnt lgkmcnt(6)
v_mfma_f32_32x32x16_bf16 v[48:63], a[240:243], a[20:23], v[48:63]
ds_read_b64_tr_b16 a[224:225], v102 offset:24576
ds_read_b64_tr_b16 a[226:227], v102 offset:26624
buffer_load_dwordx4 v2, s[36:39], s49 offen lds
s_add_u32 s49, s49, 5120
s_waitcnt lgkmcnt(6)
v_mfma_f32_32x32x16_bf16 v[64:79], a[244:247], a[20:23], v[64:79]
ds_read_b64_tr_b16 a[228:229], v103 offset:24576
ds_read_b64_tr_b16 a[230:231], v103 offset:26624
s_add_u32 m0, s50, 124928
s_nop 0
buffer_load_dwordx4 v2, s[36:39], s49 offen lds
s_waitcnt lgkmcnt(6)
v_mfma_f32_32x32x16_bf16 v[16:31], a[216:219], a[24:27], v[16:31]
ds_read_b64_tr_b16 a[232:233], v100 offset:28672
ds_read_b64_tr_b16 a[234:235], v100 offset:30720
s_add_u32 s49, s49, 5120
s_add_u32 m0, s50, 125952
s_waitcnt lgkmcnt(6)
v_mfma_f32_32x32x16_bf16 v[32:47], a[220:223], a[24:27], v[32:47]
ds_read_b64_tr_b16 a[236:237], v101 offset:28672
ds_read_b64_tr_b16 a[238:239], v101 offset:30720
buffer_load_dwordx4 v2, s[36:39], s49 offen lds
s_add_u32 s49, s49, 5120
s_waitcnt lgkmcnt(6)
v_mfma_f32_32x32x16_bf16 v[48:63], a[224:227], a[24:27], v[48:63]
ds_read_b64_tr_b16 a[240:241], v102 offset:28672
ds_read_b64_tr_b16 a[242:243], v102 offset:30720
s_add_u32 m0, s50, 126976
s_nop 0
buffer_load_dwordx4 v2, s[36:39], s49 offen lds
s_waitcnt lgkmcnt(6)
v_mfma_f32_32x32x16_bf16 v[64:79], a[228:231], a[24:27], v[64:79]
ds_read_b64_tr_b16 a[244:245], v103 offset:28672
ds_read_b64_tr_b16 a[246:247], v103 offset:30720
s_add_u32 s49, s49, 5120
s_add_u32 m0, s50, 128000
s_waitcnt lgkmcnt(6)
v_mfma_f32_32x32x16_bf16 v[16:31], a[232:235], a[28:31], v[16:31]
ds_read_b64_tr_b16 a[216:217], v100 offset:32768
ds_read_b64_tr_b16 a[218:219], v100 offset:34816
buffer_load_dwordx4 v2, s[36:39], s49 offen lds
s_add_u32 s49, s49, 97280
s_waitcnt lgkmcnt(6)
v_mfma_f32_32x32x16_bf16 v[32:47], a[236:239], a[28:31], v[32:47]
ds_read_b64_tr_b16 a[220:221], v101 offset:32768
ds_read_b64_tr_b16 a[222:223], v101 offset:34816
buffer_load_dwordx4 a[120:123], v1, s[32:35], s48 offen offset:0
buffer_load_dwordx4 a[124:127], v1, s[32:35], s48 offen offset:1024
s_waitcnt lgkmcnt(6)
v_mfma_f32_32x32x16_bf16 v[48:63], a[240:243], a[28:31], v[48:63]
ds_read_b64_tr_b16 a[224:225], v102 offset:32768
ds_read_b64_tr_b16 a[226:227], v102 offset:34816
buffer_load_dwordx4 a[128:131], v1, s[32:35], s48 offen offset:2048
s_add_u32 s48, s48, 3072
s_waitcnt lgkmcnt(6)
v_mfma_f32_32x32x16_bf16 v[64:79], a[244:247], a[28:31], v[64:79]
ds_read_b64_tr_b16 a[228:229], v103 offset:32768
ds_read_b64_tr_b16 a[230:231], v103 offset:34816
buffer_load_dwordx4 a[132:135], v1, s[32:35], s48 offen offset:0
buffer_load_dwordx4 a[136:139], v1, s[32:35], s48 offen offset:1024
s_waitcnt lgkmcnt(6)
v_mfma_f32_32x32x16_bf16 v[16:31], a[216:219], a[32:35], v[16:31]
ds_read_b64_tr_b16 a[232:233], v100 offset:36864
ds_read_b64_tr_b16 a[234:235], v100 offset:38912
buffer_load_dwordx4 a[140:143], v1, s[32:35], s48 offen offset:2048
s_add_u32 s48, s48, 3072
s_waitcnt lgkmcnt(6)
v_mfma_f32_32x32x16_bf16 v[32:47], a[220:223], a[32:35], v[32:47]
ds_read_b64_tr_b16 a[236:237], v101 offset:36864
ds_read_b64_tr_b16 a[238:239], v101 offset:38912
s_cmp_eq_u32 s48, s58
s_cselect_b32 s48, s56, s48
s_cselect_b32 s49, s57, s49
s_waitcnt lgkmcnt(6)
v_mfma_f32_32x32x16_bf16 v[48:63], a[224:227], a[32:35], v[48:63]
ds_read_b64_tr_b16 a[240:241], v102 offset:36864
ds_read_b64_tr_b16 a[242:243], v102 offset:38912
s_waitcnt lgkmcnt(6)
v_mfma_f32_32x32x16_bf16 v[64:79], a[228:231], a[32:35], v[64:79]
ds_read_b64_tr_b16 a[244:245], v103 offset:36864
ds_read_b64_tr_b16 a[246:247], v103 offset:38912
s_waitcnt lgkmcnt(6)
v_mfma_f32_32x32x16_bf16 v[16:31], a[232:235], a[36:39], v[16:31]
ds_read_b64_tr_b16 a[216:217], v100 offset:40960
ds_read_b64_tr_b16 a[218:219], v100 offset:43008
s_waitcnt lgkmcnt(6)
v_mfma_f32_32x32x16_bf16 v[32:47], a[236:239], a[36:39], v[32:47]
ds_read_b64_tr_b16 a[220:221], v101 offset:40960
ds_read_b64_tr_b16 a[222:223], v101 offset:43008
s_waitcnt lgkmcnt(6)
v_mfma_f32_32x32x16_bf16 v[48:63], a[240:243], a[36:39], v[48:63]
ds_read_b64_tr_b16 a[224:225], v102 offset:40960
ds_read_b64_tr_b16 a[226:227], v102 offset:43008
s_waitcnt lgkmcnt(6)
v_mfma_f32_32x32x16_bf16 v[64:79], a[244:247], a[36:39], v[64:79]
ds_read_b64_tr_b16 a[228:229], v103 offset:40960
ds_read_b64_tr_b16 a[230:231], v103 offset:43008
s_waitcnt lgkmcnt(6)
v_mfma_f32_32x32x16_bf16 v[16:31], a[216:219], a[40:43], v[16:31]
ds_read_b64_tr_b16 a[232:233], v100 offset:45056
ds_read_b64_tr_b16 a[234:235], v100 offset:47104
s_waitcnt lgkmcnt(6)
v_mfma_f32_32x32x16_bf16 v[32:47], a[220:223], a[40:43], v[32:47]
ds_read_b64_tr_b16 a[236:237], v101 offset:45056
ds_read_b64_tr_b16 a[238:239], v101 offset:47104
s_waitcnt lgkmcnt(6)
v_mfma_f32_32x32x16_bf16 v[48:63], a[224:227], a[40:43], v[48:63]
ds_read_b64_tr_b16 a[240:241], v102 offset:45056
ds_read_b64_tr_b16 a[242:243], v102 offset:47104
s_waitcnt lgkmcnt(6)
v_mfma_f32_32x32x16_bf16 v[64:79], a[228:231], a[40:43], v[64:79]
ds_read_b64_tr_b16 a[244:245], v103 offset:45056
ds_read_b64_tr_b16 a[246:247], v103 offset:47104
s_waitcnt lgkmcnt(6)
v_mfma_f32_32x32x16_bf16 v[16:31], a[232:235], a[44:47], v[16:31]
s_waitcnt vmcnt(36)
s_barrier
ds_read_b64_tr_b16 a[216:217], v104 offset:0
ds_read_b64_tr_b16 a[218:219], v104 offset:2048
s_add_u32 m0, s50, 0
s_nop 0
buffer_load_dwordx4 v2, s[36:39], s49 offen lds
s_waitcnt lgkmcnt(6)
v_mfma_f32_32x32x16_bf16 v[32:47], a[236:239], a[44:47], v[32:47]
ds_read_b64_tr_b16 a[220:221], v105 offset:0
ds_read_b64_tr_b16 a[222:223], v105 offset:2048
s_add_u32 s49, s49, 5120
s_add_u32 m0, s50, 1024
s_waitcnt lgkmcnt(6)
v_mfma_f32_32x32x16_bf16 v[48:63], a[240:243], a[44:47], v[48:63]
ds_read_b64_tr_b16 a[224:225], v106 offset:0
ds_read_b64_tr_b16 a[226:227], v106 offset:2048
buffer_load_dwordx4 v2, s[36:39], s49 offen lds
s_add_u32 s49, s49, 5120
s_waitcnt lgkmcnt(6)
v_mfma_f32_32x32x16_bf16 v[64:79], a[244:247], a[44:47], v[64:79]
ds_read_b64_tr_b16 a[228:229], v107 offset:0
ds_read_b64_tr_b16 a[230:231], v107 offset:2048
s_add_u32 m0, s50, 2048
s_nop 0
buffer_load_dwordx4 v2, s[36:39], s49 offen lds
s_waitcnt lgkmcnt(6)
v_mfma_f32_32x32x16_bf16 v[16:31], a[216:219], a[48:51], v[16:31]
ds_read_b64_tr_b16 a[232:233], v104 offset:4096
ds_read_b64_tr_b16 a[234:235], v104 offset:6144
s_add_u32 s49, s49, 5120
s_add_u32 m0, s50, 3072
s_waitcnt lgkmcnt(6)
v_mfma_f32_32x32x16_bf16 v[32:47], a[220:223], a[48:51], v[32:47]
ds_read_b64_tr_b16 a[236:237], v105 offset:4096
ds_read_b64_tr_b16 a[238:239], v105 offset:6144
buffer_load_dwordx4 v2, s[36:39], s49 offen lds
s_add_u32 s49, s49, 5120
s_waitcnt lgkmcnt(6)
v_mfma_f32_32x32x16_bf16 v[48:63], a[224:227], a[48:51], v[48:63]
ds_read_b64_tr_b16 a[240:241], v106 offset:4096
ds_read_b64_tr_b16 a[242:243], v106 offset:6144
s_add_u32 m0, s50, 4096
s_nop 0
buffer_load_dwordx4 v2, s[36:39], s49 offen lds
s_waitcnt lgkmcnt(6)
v_mfma_f32_32x32x16_bf16 v[64:79], a[228:231], a[48:51], v[64:79]
ds_read_b64_tr_b16 a[244:245], v107 offset:4096
ds_read_b64_tr_b16 a[246:247], v107 offset:6144
s_add_u32 s49, s49, 5120
s_add_u32 m0, s50, 5120
s_waitcnt lgkmcnt(6)
v_mfma_f32_32x32x16_bf16 v[16:31], a[232:235], a[52:55], v[16:31]
ds_read_b64_tr_b16 a[216:217], v104 offset:8192
ds_read_b64_tr_b16 a[218:219], v104 offset:10240
buffer_load_dwordx4 v2, s[36:39], s49 offen lds
s_add_u32 s49, s49, 97280
s_waitcnt lgkmcnt(6)
v_mfma_f32_32x32x16_bf16 v[32:47], a[236:239], a[52:55], v[32:47]
ds_read_b64_tr_b16 a[220:221], v105 offset:8192
ds_read_b64_tr_b16 a[222:223], v105 offset:10240
buffer_load_dwordx4 a[144:147], v1, s[32:35], s48 offen offset:0
buffer_load_dwordx4 a[148:151], v1, s[32:35], s48 offen offset:1024
s_waitcnt lgkmcnt(6)
v_mfma_f32_32x32x16_bf16 v[48:63], a[240:243], a[52:55], v[48:63]
ds_read_b64_tr_b16 a[224:225], v106 offset:8192
ds_read_b64_tr_b16 a[226:227], v106 offset:10240
buffer_load_dwordx4 a[152:155], v1, s[32:35], s48 offen offset:2048
s_add_u32 s48, s48, 3072
s_waitcnt lgkmcnt(6)
v_mfma_f32_32x32x16_bf16 v[64:79], a[244:247], a[52:55], v[64:79]
ds_read_b64_tr_b16 a[228:229], v107 offset:8192
ds_read_b64_tr_b16 a[230:231], v107 offset:10240
buffer_load_dwordx4 a[156:159], v1, s[32:35], s48 offen offset:0
buffer_load_dwordx4 a[160:163], v1, s[32:35], s48 offen offset:1024
s_waitcnt lgkmcnt(6)
v_mfma_f32_32x32x16_bf16 v[16:31], a[216:219], a[56:59], v[16:31]
ds_read_b64_tr_b16 a[232:233], v104 offset:12288
ds_read_b64_tr_b16 a[234:235], v104 offset:14336
buffer_load_dwordx4 a[164:167], v1, s[32:35], s48 offen offset:2048
s_add_u32 s48, s48, 3072
s_waitcnt lgkmcnt(6)
v_mfma_f32_32x32x16_bf16 v[32:47], a[220:223], a[56:59], v[32:47]
ds_read_b64_tr_b16 a[236:237], v105 offset:12288
ds_read_b64_tr_b16 a[238:239], v105 offset:14336
s_cmp_eq_u32 s48, s58
s_cselect_b32 s48, s56, s48
s_cselect_b32 s49, s57, s49
s_waitcnt lgkmcnt(6)
v_mfma_f32_32x32x16_bf16 v[48:63], a[224:227], a[56:59], v[48:63]
ds_read_b64_tr_b16 a[240:241], v106 offset:12288
ds_read_b64_tr_b16 a[242:243], v106 offset:14336
s_waitcnt lgkmcnt(6)
v_mfma_f32_32x32x16_bf16 v[64:79], a[228:231], a[56:59], v[64:79]
ds_read_b64_tr_b16 a[244:245], v107 offset:12288
ds_read_b64_tr_b16 a[246:247], v107 offset:14336
s_waitcnt lgkmcnt(6)
v_mfma_f32_32x32x16_bf16 v[16:31], a[232:235], a[60:63], v[16:31]
ds_read_b64_tr_b16 a[216:217], v104 offset:16384
ds_read_b64_tr_b16 a[218:219], v104 offset:18432
s_waitcnt lgkmcnt(6)
v_mfma_f32_32x32x16_bf16 v[32:47], a[236:239], a[60:63], v[32:47]
ds_read_b64_tr_b16 a[220:221], v105 offset:16384
ds_read_b64_tr_b16 a[222:223], v105 offset:18432
s_waitcnt lgkmcnt(6)
v_mfma_f32_32x32x16_bf16 v[48:63], a[240:243], a[60:63], v[48:63]
ds_read_b64_tr_b16 a[224:225], v106 offset:16384
ds_read_b64_tr_b16 a[226:227], v106 offset:18432
s_waitcnt lgkmcnt(6)
v_mfma_f32_32x32x16_bf16 v[64:79], a[244:247], a[60:63], v[64:79]
ds_read_b64_tr_b16 a[228:229], v107 offset:16384
ds_read_b64_tr_b16 a[230:231], v107 offset:18432
s_waitcnt lgkmcnt(6)
v_mfma_f32_32x32x16_bf16 v[16:31], a[216:219], a[64:67], v[16:31]
ds_read_b64_tr_b16 a[232:233], v104 offset:20480
ds_read_b64_tr_b16 a[234:235], v104 offset:22528
s_waitcnt lgkmcnt(6)
v_mfma_f32_32x32x16_bf16 v[32:47], a[220:223], a[64:67], v[32:47]
ds_read_b64_tr_b16 a[236:237], v105 offset:20480
ds_read_b64_tr_b16 a[238:239], v105 offset:22528
s_waitcnt lgkmcnt(6)
v_mfma_f32_32x32x16_bf16 v[48:63], a[224:227], a[64:67], v[48:63]
ds_read_b64_tr_b16 a[240:241], v106 offset:20480
ds_read_b64_tr_b16 a[242:243], v106 offset:22528
s_waitcnt lgkmcnt(6)
v_mfma_f32_32x32x16_bf16 v[64:79], a[228:231], a[64:67], v[64:79]
ds_read_b64_tr_b16 a[244:245], v107 offset:20480
ds_read_b64_tr_b16 a[246:247], v107 offset:22528
s_waitcnt lgkmcnt(6)
v_mfma_f32_32x32x16_bf16 v[16:31], a[232:235], a[68:71], v[16:31]
s_waitcnt vmcnt(36)
s_barrier
ds_read_b64_tr_b16 a[216:217], v104 offset:24576
ds_read_b64_tr_b16 a[218:219], v104 offset:26624
s_add_u32 m0, s50, 24576
s_nop 0
buffer_load_dwordx4 v2, s[36:39], s49 offen lds
s_waitcnt lgkmcnt(6)
v_mfma_f32_32x32x16_bf16 v[32:47], a[236:239], a[68:71], v[32:47]
ds_read_b64_tr_b16 a[220:221], v105 offset:24576
ds_read_b64_tr_b16 a[222:223], v105 offset:26624
s_add_u32 s49, s49, 5120
s_add_u32 m0, s50, 25600
s_waitcnt lgkmcnt(6)
v_mfma_f32_32x32x16_bf16 v[48:63], a[240:243], a[68:71], v[48:63]
ds_read_b64_tr_b16 a[224:225], v106 offset:24576
ds_read_b64_tr_b16 a[226:227], v106 offset:26624
buffer_load_dwordx4 v2, s[36:39], s49 offen lds
s_add_u32 s49, s49, 5120
s_waitcnt lgkmcnt(6)
v_mfma_f32_32x32x16_bf16 v[64:79], a[244:247], a[68:71], v[64:79]
ds_read_b64_tr_b16 a[228:229], v107 offset:24576
ds_read_b64_tr_b16 a[230:231], v107 offset:26624
s_add_u32 m0, s50, 26624
s_nop 0
buffer_load_dwordx4 v2, s[36:39], s49 offen lds
s_waitcnt lgkmcnt(6)
v_mfma_f32_32x32x16_bf16 v[16:31], a[216:219], a[72:75], v[16:31]
ds_read_b64_tr_b16 a[232:233], v104 offset:28672
ds_read_b64_tr_b16 a[234:235], v104 offset:30720
s_add_u32 s49, s49, 5120
s_add_u32 m0, s50, 27648
s_waitcnt lgkmcnt(6)
v_mfma_f32_32x32x16_bf16 v[32:47], a[220:223], a[72:75], v[32:47]
ds_read_b64_tr_b16 a[236:237], v105 offset:28672
ds_read_b64_tr_b16 a[238:239], v105 offset:30720
buffer_load_dwordx4 v2, s[36:39], s49 offen lds
s_add_u32 s49, s49, 5120
s_waitcnt lgkmcnt(6)
v_mfma_f32_32x32x16_bf16 v[48:63], a[224:227], a[72:75], v[48:63]
ds_read_b64_tr_b16 a[240:241], v106 offset:28672
ds_read_b64_tr_b16 a[242:243], v106 offset:30720
s_add_u32 m0, s50, 28672
s_nop 0
buffer_load_dwordx4 v2, s[36:39], s49 offen lds
s_waitcnt lgkmcnt(6)
v_mfma_f32_32x32x16_bf16 v[64:79], a[228:231], a[72:75], v[64:79]
ds_read_b64_tr_b16 a[244:245], v107 offset:28672
ds_read_b64_tr_b16 a[246:247], v107 offset:30720
s_add_u32 s49, s49, 5120
s_add_u32 m0, s50, 29696
s_waitcnt lgkmcnt(6)
v_mfma_f32_32x32x16_bf16 v[16:31], a[232:235], a[76:79], v[16:31]
ds_read_b64_tr_b16 a[216:217], v104 offset:32768
ds_read_b64_tr_b16 a[218:219], v104 offset:34816
buffer_load_dwordx4 v2, s[36:39], s49 offen lds
s_add_u32 s49, s49, 97280
s_waitcnt lgkmcnt(6)
v_mfma_f32_32x32x16_bf16 v[32:47], a[236:239], a[76:79], v[32:47]
ds_read_b64_tr_b16 a[220:221], v105 offset:32768
ds_read_b64_tr_b16 a[222:223], v105 offset:34816
buffer_load_dwordx4 a[168:171], v1, s[32:35], s48 offen offset:0
buffer_load_dwordx4 a[172:175], v1, s[32:35], s48 offen offset:1024
s_waitcnt lgkmcnt(6)
v_mfma_f32_32x32x16_bf16 v[48:63], a[240:243], a[76:79], v[48:63]
ds_read_b64_tr_b16 a[224:225], v106 offset:32768
ds_read_b64_tr_b16 a[226:227], v106 offset:34816
buffer_load_dwordx4 a[176:179], v1, s[32:35], s48 offen offset:2048
s_add_u32 s48, s48, 3072
s_waitcnt lgkmcnt(6)
v_mfma_f32_32x32x16_bf16 v[64:79], a[244:247], a[76:79], v[64:79]
ds_read_b64_tr_b16 a[228:229], v107 offset:32768
ds_read_b64_tr_b16 a[230:231], v107 offset:34816
buffer_load_dwordx4 a[180:183], v1, s[32:35], s48 offen offset:0
buffer_load_dwordx4 a[184:187], v1, s[32:35], s48 offen offset:1024
s_waitcnt lgkmcnt(6)
v_mfma_f32_32x32x16_bf16 v[16:31], a[216:219], a[80:83], v[16:31]
ds_read_b64_tr_b16 a[232:233], v104 offset:36864
ds_read_b64_tr_b16 a[234:235], v104 offset:38912
buffer_load_dwordx4 a[188:191], v1, s[32:35], s48 offen offset:2048
s_add_u32 s48, s48, 3072
s_waitcnt lgkmcnt(6)
v_mfma_f32_32x32x16_bf16 v[32:47], a[220:223], a[80:83], v[32:47]
ds_read_b64_tr_b16 a[236:237], v105 offset:36864
ds_read_b64_tr_b16 a[238:239], v105 offset:38912
s_cmp_eq_u32 s48, s58
s_cselect_b32 s48, s56, s48
s_cselect_b32 s49, s57, s49
s_waitcnt lgkmcnt(6)
v_mfma_f32_32x32x16_bf16 v[48:63], a[224:227], a[80:83], v[48:63]
ds_read_b64_tr_b16 a[240:241], v106 offset:36864
ds_read_b64_tr_b16 a[242:243], v106 offset:38912
s_waitcnt lgkmcnt(6)
v_mfma_f32_32x32x16_bf16 v[64:79], a[228:231], a[80:83], v[64:79]
ds_read_b64_tr_b16 a[244:245], v107 offset:36864
ds_read_b64_tr_b16 a[246:247], v107 offset:38912
s_waitcnt lgkmcnt(6)
v_mfma_f32_32x32x16_bf16 v[16:31], a[232:235], a[84:87], v[16:31]
ds_read_b64_tr_b16 a[216:217], v104 offset:40960
ds_read_b64_tr_b16 a[218:219], v104 offset:43008
s_waitcnt lgkmcnt(6)
v_mfma_f32_32x32x16_bf16 v[32:47], a[236:239], a[84:87], v[32:47]
ds_read_b64_tr_b16 a[220:221], v105 offset:40960
ds_read_b64_tr_b16 a[222:223], v105 offset:43008
s_waitcnt lgkmcnt(6)
v_mfma_f32_32x32x16_bf16 v[48:63], a[240:243], a[84:87], v[48:63]
ds_read_b64_tr_b16 a[224:225], v106 offset:40960
ds_read_b64_tr_b16 a[226:227], v106 offset:43008
s_waitcnt lgkmcnt(6)
v_mfma_f32_32x32x16_bf16 v[64:79], a[244:247], a[84:87], v[64:79]
ds_read_b64_tr_b16 a[228:229], v107 offset:40960
ds_read_b64_tr_b16 a[230:231], v107 offset:43008
s_waitcnt lgkmcnt(6)
v_mfma_f32_32x32x16_bf16 v[16:31], a[216:219], a[88:91], v[16:31]
ds_read_b64_tr_b16 a[232:233], v104 offset:45056
ds_read_b64_tr_b16 a[234:235], v104 offset:47104
s_waitcnt lgkmcnt(6)
v_mfma_f32_32x32x16_bf16 v[32:47], a[220:223], a[88:91], v[32:47]
ds_read_b64_tr_b16 a[236:237], v105 offset:45056
ds_read_b64_tr_b16 a[238:239], v105 offset:47104
s_waitcnt lgkmcnt(6)
v_mfma_f32_32x32x16_bf16 v[48:63], a[224:227], a[88:91], v[48:63]
ds_read_b64_tr_b16 a[240:241], v106 offset:45056
ds_read_b64_tr_b16 a[242:243], v106 offset:47104
s_waitcnt lgkmcnt(6)
v_mfma_f32_32x32x16_bf16 v[64:79], a[228:231], a[88:91], v[64:79]
ds_read_b64_tr_b16 a[244:245], v107 offset:45056
ds_read_b64_tr_b16 a[246:247], v107 offset:47104
s_waitcnt lgkmcnt(6)
v_mfma_f32_32x32x16_bf16 v[16:31], a[232:235], a[92:95], v[16:31]
s_waitcnt vmcnt(36)
s_barrier
ds_read_b64_tr_b16 a[216:217], v108 offset:0
ds_read_b64_tr_b16 a[218:219], v108 offset:2048
s_add_u32 m0, s50, 49152
s_nop 0
buffer_load_dwordx4 v2, s[36:39], s49 offen lds
s_waitcnt lgkmcnt(6)
v_mfma_f32_32x32x16_bf16 v[32:47], a[236:239], a[92:95], v[32:47]
ds_read_b64_tr_b16 a[220:221], v109 offset:0
ds_read_b64_tr_b16 a[222:223], v109 offset:2048
s_add_u32 s49, s49, 5120
s_add_u32 m0, s50, 50176
s_waitcnt lgkmcnt(6)
v_mfma_f32_32x32x16_bf16 v[48:63], a[240:243], a[92:95], v[48:63]
ds_read_b64_tr_b16 a[224:225], v110 offset:0
ds_read_b64_tr_b16 a[226:227], v110 offset:2048
buffer_load_dwordx4 v2, s[36:39], s49 offen lds
s_add_u32 s49, s49, 5120
s_waitcnt lgkmcnt(6)
v_mfma_f32_32x32x16_bf16 v[64:79], a[244:247], a[92:95], v[64:79]
ds_read_b64_tr_b16 a[228:229], v111 offset:0
ds_read_b64_tr_b16 a[230:231], v111 offset:2048
s_add_u32 m0, s50, 51200
s_nop 0
buffer_load_dwordx4 v2, s[36:39], s49 offen lds
s_waitcnt lgkmcnt(6)
v_mfma_f32_32x32x16_bf16 v[16:31], a[216:219], a[96:99], v[16:31]
ds_read_b64_tr_b16 a[232:233], v108 offset:4096
ds_read_b64_tr_b16 a[234:235], v108 offset:6144
s_add_u32 s49, s49, 5120
s_add_u32 m0, s50, 52224
s_waitcnt lgkmcnt(6)
v_mfma_f32_32x32x16_bf16 v[32:47], a[220:223], a[96:99], v[32:47]
ds_read_b64_tr_b16 a[236:237], v109 offset:4096
ds_read_b64_tr_b16 a[238:239], v109 offset:6144
buffer_load_dwordx4 v2, s[36:39], s49 offen lds
s_add_u32 s49, s49, 5120
s_waitcnt lgkmcnt(6)
v_mfma_f32_32x32x16_bf16 v[48:63], a[224:227], a[96:99], v[48:63]
ds_read_b64_tr_b16 a[240:241], v110 offset:4096
ds_read_b64_tr_b16 a[242:243], v110 offset:6144
s_add_u32 m0, s50, 53248
s_nop 0
buffer_load_dwordx4 v2, s[36:39], s49 offen lds
s_waitcnt lgkmcnt(6)
v_mfma_f32_32x32x16_bf16 v[64:79], a[228:231], a[96:99], v[64:79]
ds_read_b64_tr_b16 a[244:245], v111 offset:4096
ds_read_b64_tr_b16 a[246:247], v111 offset:6144
s_add_u32 s49, s49, 5120
s_add_u32 m0, s50, 54272
s_waitcnt lgkmcnt(6)
v_mfma_f32_32x32x16_bf16 v[16:31], a[232:235], a[100:103], v[16:31]
ds_read_b64_tr_b16 a[216:217], v108 offset:8192
ds_read_b64_tr_b16 a[218:219], v108 offset:10240
buffer_load_dwordx4 v2, s[36:39], s49 offen lds
s_add_u32 s49, s49, 97280
s_waitcnt lgkmcnt(6)
v_mfma_f32_32x32x16_bf16 v[32:47], a[236:239], a[100:103], v[32:47]
ds_read_b64_tr_b16 a[220:221], v109 offset:8192
ds_read_b64_tr_b16 a[222:223], v109 offset:10240
buffer_load_dwordx4 a[192:195], v1, s[32:35], s48 offen offset:0
buffer_load_dwordx4 a[196:199], v1, s[32:35], s48 offen offset:1024
s_waitcnt lgkmcnt(6)
v_mfma_f32_32x32x16_bf16 v[48:63], a[240:243], a[100:103], v[48:63]
ds_read_b64_tr_b16 a[224:225], v110 offset:8192
ds_read_b64_tr_b16 a[226:227], v110 offset:10240
buffer_load_dwordx4 a[200:203], v1, s[32:35], s48 offen offset:2048
s_add_u32 s48, s48, 3072
s_waitcnt lgkmcnt(6)
v_mfma_f32_32x32x16_bf16 v[64:79], a[244:247], a[100:103], v[64:79]
ds_read_b64_tr_b16 a[228:229], v111 offset:8192
ds_read_b64_tr_b16 a[230:231], v111 offset:10240
buffer_load_dwordx4 a[204:207], v1, s[32:35], s48 offen offset:0
buffer_load_dwordx4 a[208:211], v1, s[32:35], s48 offen offset:1024
s_waitcnt lgkmcnt(6)
v_mfma_f32_32x32x16_bf16 v[16:31], a[216:219], a[104:107], v[16:31]
ds_read_b64_tr_b16 a[232:233], v108 offset:12288
ds_read_b64_tr_b16 a[234:235], v108 offset:14336
buffer_load_dwordx4 a[212:215], v1, s[32:35], s48 offen offset:2048
s_add_u32 s48, s48, 3072
s_waitcnt lgkmcnt(6)
v_mfma_f32_32x32x16_bf16 v[32:47], a[220:223], a[104:107], v[32:47]
ds_read_b64_tr_b16 a[236:237], v109 offset:12288
ds_read_b64_tr_b16 a[238:239], v109 offset:14336
s_cmp_eq_u32 s48, s58
s_cselect_b32 s48, s56, s48
s_cselect_b32 s49, s57, s49
s_waitcnt lgkmcnt(6)
v_mfma_f32_32x32x16_bf16 v[48:63], a[224:227], a[104:107], v[48:63]
ds_read_b64_tr_b16 a[240:241], v110 offset:12288
ds_read_b64_tr_b16 a[242:243], v110 offset:14336
s_waitcnt lgkmcnt(6)
v_mfma_f32_32x32x16_bf16 v[64:79], a[228:231], a[104:107], v[64:79]
ds_read_b64_tr_b16 a[244:245], v111 offset:12288
ds_read_b64_tr_b16 a[246:247], v111 offset:14336
s_waitcnt lgkmcnt(6)
v_mfma_f32_32x32x16_bf16 v[16:31], a[232:235], a[108:111], v[16:31]
ds_read_b64_tr_b16 a[216:217], v108 offset:16384
ds_read_b64_tr_b16 a[218:219], v108 offset:18432
s_waitcnt lgkmcnt(6)
v_mfma_f32_32x32x16_bf16 v[32:47], a[236:239], a[108:111], v[32:47]
ds_read_b64_tr_b16 a[220:221], v109 offset:16384
ds_read_b64_tr_b16 a[222:223], v109 offset:18432
s_waitcnt lgkmcnt(6)
v_mfma_f32_32x32x16_bf16 v[48:63], a[240:243], a[108:111], v[48:63]
ds_read_b64_tr_b16 a[224:225], v110 offset:16384
ds_read_b64_tr_b16 a[226:227], v110 offset:18432
buffer_load_dwordx4 a[0:3], v1, s[64:67], s69 offen offset:0
s_waitcnt lgkmcnt(6)
v_mfma_f32_32x32x16_bf16 v[64:79], a[244:247], a[108:111], v[64:79]
ds_read_b64_tr_b16 a[228:229], v111 offset:16384
ds_read_b64_tr_b16 a[230:231], v111 offset:18432
s_waitcnt lgkmcnt(6)
v_mfma_f32_32x32x16_bf16 v[16:31], a[216:219], a[112:115], v[16:31]
ds_read_b64_tr_b16 a[232:233], v108 offset:20480
ds_read_b64_tr_b16 a[234:235], v108 offset:22528
s_waitcnt lgkmcnt(6)
v_mfma_f32_32x32x16_bf16 v[32:47], a[220:223], a[112:115], v[32:47]
ds_read_b64_tr_b16 a[236:237], v109 offset:20480
ds_read_b64_tr_b16 a[238:239], v109 offset:22528
buffer_load_dwordx4 a[4:7], v1, s[64:67], s69 offen offset:1024
s_waitcnt lgkmcnt(6)
v_mfma_f32_32x32x16_bf16 v[48:63], a[224:227], a[112:115], v[48:63]
ds_read_b64_tr_b16 a[240:241], v110 offset:20480
ds_read_b64_tr_b16 a[242:243], v110 offset:22528
s_waitcnt lgkmcnt(6)
v_mfma_f32_32x32x16_bf16 v[64:79], a[228:231], a[112:115], v[64:79]
ds_read_b64_tr_b16 a[244:245], v111 offset:20480
ds_read_b64_tr_b16 a[246:247], v111 offset:22528
buffer_load_dwordx4 a[8:11], v1, s[64:67], s69 offen offset:2048
s_waitcnt lgkmcnt(6)
v_mfma_f32_32x32x16_bf16 v[16:31], a[232:235], a[116:119], v[16:31]
s_waitcnt vmcnt(39)
s_barrier
ds_read_b64_tr_b16 a[216:217], v108 offset:24576
ds_read_b64_tr_b16 a[218:219], v108 offset:26624
s_waitcnt lgkmcnt(6)
v_mfma_f32_32x32x16_bf16 v[32:47], a[236:239], a[116:119], v[32:47]
ds_read_b64_tr_b16 a[220:221], v109 offset:24576
ds_read_b64_tr_b16 a[222:223], v109 offset:26624
s_waitcnt lgkmcnt(6)
v_mfma_f32_32x32x16_bf16 v[48:63], a[240:243], a[116:119], v[48:63]
ds_read_b64_tr_b16 a[224:225], v110 offset:24576
ds_read_b64_tr_b16 a[226:227], v110 offset:26624
buffer_load_dwordx4 a[12:15], v1, s[64:67], s69 offen offset:3072
s_add_u32 s69, s69, 4096
s_cmp_eq_u32 s69, s84
s_cselect_b32 s69, s68, s69
s_waitcnt lgkmcnt(6)
v_mfma_f32_32x32x16_bf16 v[64:79], a[244:247], a[116:119], v[64:79]
ds_read_b64_tr_b16 a[228:229], v111 offset:24576
ds_read_b64_tr_b16 a[230:231], v111 offset:26624
s_waitcnt lgkmcnt(6)
v_mfma_f32_32x32x16_bf16 v[16:31], a[216:219], a[120:123], v[16:31]
ds_read_b64_tr_b16 a[232:233], v108 offset:28672
ds_read_b64_tr_b16 a[234:235], v108 offset:30720
buffer_load_dwordx4 a[16:19], v1, s[64:67], s69 offen offset:0
s_waitcnt lgkmcnt(6)
v_mfma_f32_32x32x16_bf16 v[32:47], a[220:223], a[120:123], v[32:47]
ds_read_b64_tr_b16 a[236:237], v109 offset:28672
ds_read_b64_tr_b16 a[238:239], v109 offset:30720
s_waitcnt lgkmcnt(6)
v_mfma_f32_32x32x16_bf16 v[48:63], a[224:227], a[120:123], v[48:63]
ds_read_b64_tr_b16 a[240:241], v110 offset:28672
ds_read_b64_tr_b16 a[242:243], v110 offset:30720
s_waitcnt lgkmcnt(6)
v_mfma_f32_32x32x16_bf16 v[64:79], a[228:231], a[120:123], v[64:79]
ds_read_b64_tr_b16 a[244:245], v111 offset:28672
ds_read_b64_tr_b16 a[246:247], v111 offset:30720
buffer_load_dwordx4 a[20:23], v1, s[64:67], s69 offen offset:1024
s_waitcnt lgkmcnt(6)
v_mfma_f32_32x32x16_bf16 v[16:31], a[232:235], a[124:127], v[16:31]
ds_read_b64_tr_b16 a[216:217], v108 offset:32768
ds_read_b64_tr_b16 a[218:219], v108 offset:34816
s_waitcnt lgkmcnt(6)
v_mfma_f32_32x32x16_bf16 v[32:47], a[236:239], a[124:127], v[32:47]
ds_read_b64_tr_b16 a[220:221], v109 offset:32768
ds_read_b64_tr_b16 a[222:223], v109 offset:34816
s_waitcnt lgkmcnt(6)
v_mfma_f32_32x32x16_bf16 v[48:63], a[240:243], a[124:127], v[48:63]
ds_read_b64_tr_b16 a[224:225], v110 offset:32768
ds_read_b64_tr_b16 a[226:227], v110 offset:34816
buffer_load_dwordx4 a[24:27], v1, s[64:67], s69 offen offset:2048
s_waitcnt lgkmcnt(6)
v_mfma_f32_32x32x16_bf16 v[64:79], a[244:247], a[124:127], v[64:79]
ds_read_b64_tr_b16 a[228:229], v111 offset:32768
ds_read_b64_tr_b16 a[230:231], v111 offset:34816
s_waitcnt lgkmcnt(6)
v_mfma_f32_32x32x16_bf16 v[16:31], a[216:219], a[128:131], v[16:31]
ds_read_b64_tr_b16 a[232:233], v108 offset:36864
ds_read_b64_tr_b16 a[234:235], v108 offset:38912
buffer_load_dwordx4 a[28:31], v1, s[64:67], s69 offen offset:3072
s_add_u32 s69, s69, 4096
s_cmp_eq_u32 s69, s84
s_cselect_b32 s69, s68, s69
s_waitcnt lgkmcnt(6)
v_mfma_f32_32x32x16_bf16 v[32:47], a[220:223], a[128:131], v[32:47]
ds_read_b64_tr_b16 a[236:237], v109 offset:36864
ds_read_b64_tr_b16 a[238:239], v109 offset:38912
s_waitcnt lgkmcnt(6)
v_mfma_f32_32x32x16_bf16 v[48:63], a[224:227], a[128:131], v[48:63]
ds_read_b64_tr_b16 a[240:241], v110 offset:36864
ds_read_b64_tr_b16 a[242:243], v110 offset:38912
s_waitcnt lgkmcnt(6)
v_mfma_f32_32x32x16_bf16 v[64:79], a[228:231], a[128:131], v[64:79]
ds_read_b64_tr_b16 a[244:245], v111 offset:36864
ds_read_b64_tr_b16 a[246:247], v111 offset:38912
buffer_load_dwordx4 a[32:35], v1, s[64:67], s69 offen offset:0
s_waitcnt lgkmcnt(6)
v_mfma_f32_32x32x16_bf16 v[16:31], a[232:235], a[132:135], v[16:31]
ds_read_b64_tr_b16 a[216:217], v108 offset:40960
ds_read_b64_tr_b16 a[218:219], v108 offset:43008
s_waitcnt lgkmcnt(6)
v_mfma_f32_32x32x16_bf16 v[32:47], a[236:239], a[132:135], v[32:47]
ds_read_b64_tr_b16 a[220:221], v109 offset:40960
ds_read_b64_tr_b16 a[222:223], v109 offset:43008
buffer_load_dwordx4 a[36:39], v1, s[64:67], s69 offen offset:1024
s_waitcnt lgkmcnt(6)
v_mfma_f32_32x32x16_bf16 v[48:63], a[240:243], a[132:135], v[48:63]
ds_read_b64_tr_b16 a[224:225], v110 offset:40960
ds_read_b64_tr_b16 a[226:227], v110 offset:43008
s_waitcnt lgkmcnt(6)
v_mfma_f32_32x32x16_bf16 v[64:79], a[244:247], a[132:135], v[64:79]
ds_read_b64_tr_b16 a[228:229], v111 offset:40960
ds_read_b64_tr_b16 a[230:231], v111 offset:43008
s_waitcnt lgkmcnt(6)
v_mfma_f32_32x32x16_bf16 v[16:31], a[216:219], a[136:139], v[16:31]
ds_read_b64_tr_b16 a[232:233], v108 offset:45056
ds_read_b64_tr_b16 a[234:235], v108 offset:47104
buffer_load_dwordx4 a[40:43], v1, s[64:67], s69 offen offset:2048
s_waitcnt lgkmcnt(6)
v_mfma_f32_32x32x16_bf16 v[32:47], a[220:223], a[136:139], v[32:47]
ds_read_b64_tr_b16 a[236:237], v109 offset:45056
ds_read_b64_tr_b16 a[238:239], v109 offset:47104
s_waitcnt lgkmcnt(6)
v_mfma_f32_32x32x16_bf16 v[48:63], a[224:227], a[136:139], v[48:63]
ds_read_b64_tr_b16 a[240:241], v110 offset:45056
ds_read_b64_tr_b16 a[242:243], v110 offset:47104
s_waitcnt lgkmcnt(6)
v_mfma_f32_32x32x16_bf16 v[64:79], a[228:231], a[136:139], v[64:79]
ds_read_b64_tr_b16 a[244:245], v111 offset:45056
ds_read_b64_tr_b16 a[246:247], v111 offset:47104
buffer_load_dwordx4 a[44:47], v1, s[64:67], s69 offen offset:3072
s_add_u32 s69, s69, 4096
s_cmp_eq_u32 s69, s84
s_cselect_b32 s69, s68, s69
s_waitcnt lgkmcnt(6)
v_mfma_f32_32x32x16_bf16 v[16:31], a[232:235], a[140:143], v[16:31]
s_waitcnt vmcnt(36)
s_barrier
ds_read_b64_tr_b16 a[216:217], v100 offset:0
ds_read_b64_tr_b16 a[218:219], v100 offset:2048
s_waitcnt lgkmcnt(6)
v_mfma_f32_32x32x16_bf16 v[32:47], a[236:239], a[140:143], v[32:47]
ds_read_b64_tr_b16 a[220:221], v101 offset:0
ds_read_b64_tr_b16 a[222:223], v101 offset:2048
buffer_load_dwordx4 a[48:51], v1, s[64:67], s69 offen offset:0
s_waitcnt lgkmcnt(6)
v_mfma_f32_32x32x16_bf16 v[48:63], a[240:243], a[140:143], v[48:63]
ds_read_b64_tr_b16 a[224:225], v102 offset:0
ds_read_b64_tr_b16 a[226:227], v102 offset:2048
s_waitcnt lgkmcnt(6)
v_mfma_f32_32x32x16_bf16 v[64:79], a[244:247], a[140:143], v[64:79]
ds_read_b64_tr_b16 a[228:229], v103 offset:0
ds_read_b64_tr_b16 a[230:231], v103 offset:2048
s_waitcnt lgkmcnt(6)
v_mfma_f32_32x32x16_bf16 v[16:31], a[216:219], a[144:147], v[16:31]
ds_read_b64_tr_b16 a[232:233], v100 offset:4096
ds_read_b64_tr_b16 a[234:235], v100 offset:6144
buffer_load_dwordx4 a[52:55], v1, s[64:67], s69 offen offset:1024
s_waitcnt lgkmcnt(6)
v_mfma_f32_32x32x16_bf16 v[32:47], a[220:223], a[144:147], v[32:47]
ds_read_b64_tr_b16 a[236:237], v101 offset:4096
ds_read_b64_tr_b16 a[238:239], v101 offset:6144
s_waitcnt lgkmcnt(6)
v_mfma_f32_32x32x16_bf16 v[48:63], a[224:227], a[144:147], v[48:63]
ds_read_b64_tr_b16 a[240:241], v102 offset:4096
ds_read_b64_tr_b16 a[242:243], v102 offset:6144
buffer_load_dwordx4 a[56:59], v1, s[64:67], s69 offen offset:2048
s_waitcnt lgkmcnt(6)
v_mfma_f32_32x32x16_bf16 v[64:79], a[228:231], a[144:147], v[64:79]
ds_read_b64_tr_b16 a[244:245], v103 offset:4096
ds_read_b64_tr_b16 a[246:247], v103 offset:6144
s_waitcnt lgkmcnt(6)
v_mfma_f32_32x32x16_bf16 v[16:31], a[232:235], a[148:151], v[16:31]
ds_read_b64_tr_b16 a[216:217], v100 offset:8192
ds_read_b64_tr_b16 a[218:219], v100 offset:10240
s_waitcnt lgkmcnt(6)
v_mfma_f32_32x32x16_bf16 v[32:47], a[236:239], a[148:151], v[32:47]
ds_read_b64_tr_b16 a[220:221], v101 offset:8192
ds_read_b64_tr_b16 a[222:223], v101 offset:10240
buffer_load_dwordx4 a[60:63], v1, s[64:67], s69 offen offset:3072
s_add_u32 s69, s69, 4096
s_cmp_eq_u32 s69, s84
s_cselect_b32 s69, s68, s69
s_waitcnt lgkmcnt(6)
v_mfma_f32_32x32x16_bf16 v[48:63], a[240:243], a[148:151], v[48:63]
ds_read_b64_tr_b16 a[224:225], v102 offset:8192
ds_read_b64_tr_b16 a[226:227], v102 offset:10240
s_waitcnt lgkmcnt(6)
v_mfma_f32_32x32x16_bf16 v[64:79], a[244:247], a[148:151], v[64:79]
ds_read_b64_tr_b16 a[228:229], v103 offset:8192
ds_read_b64_tr_b16 a[230:231], v103 offset:10240
s_waitcnt lgkmcnt(6)
v_mfma_f32_32x32x16_bf16 v[16:31], a[216:219], a[152:155], v[16:31]
ds_read_b64_tr_b16 a[232:233], v100 offset:12288
ds_read_b64_tr_b16 a[234:235], v100 offset:14336
buffer_load_dwordx4 a[64:67], v1, s[64:67], s69 offen offset:0
s_waitcnt lgkmcnt(6)
v_mfma_f32_32x32x16_bf16 v[32:47], a[220:223], a[152:155], v[32:47]
ds_read_b64_tr_b16 a[236:237], v101 offset:12288
ds_read_b64_tr_b16 a[238:239], v101 offset:14336
s_waitcnt lgkmcnt(6)
v_mfma_f32_32x32x16_bf16 v[48:63], a[224:227], a[152:155], v[48:63]
ds_read_b64_tr_b16 a[240:241], v102 offset:12288
ds_read_b64_tr_b16 a[242:243], v102 offset:14336
buffer_load_dwordx4 a[68:71], v1, s[64:67], s69 offen offset:1024
s_waitcnt lgkmcnt(6)
v_mfma_f32_32x32x16_bf16 v[64:79], a[228:231], a[152:155], v[64:79]
ds_read_b64_tr_b16 a[244:245], v103 offset:12288
ds_read_b64_tr_b16 a[246:247], v103 offset:14336
s_waitcnt lgkmcnt(6)
v_mfma_f32_32x32x16_bf16 v[16:31], a[232:235], a[156:159], v[16:31]
ds_read_b64_tr_b16 a[216:217], v100 offset:16384
ds_read_b64_tr_b16 a[218:219], v100 offset:18432
s_waitcnt lgkmcnt(6)
v_mfma_f32_32x32x16_bf16 v[32:47], a[236:239], a[156:159], v[32:47]
ds_read_b64_tr_b16 a[220:221], v101 offset:16384
ds_read_b64_tr_b16 a[222:223], v101 offset:18432
buffer_load_dwordx4 a[72:75], v1, s[64:67], s69 offen offset:2048
s_waitcnt lgkmcnt(6)
v_mfma_f32_32x32x16_bf16 v[48:63], a[240:243], a[156:159], v[48:63]
ds_read_b64_tr_b16 a[224:225], v102 offset:16384
ds_read_b64_tr_b16 a[226:227], v102 offset:18432
s_waitcnt lgkmcnt(6)
v_mfma_f32_32x32x16_bf16 v[64:79], a[244:247], a[156:159], v[64:79]
ds_read_b64_tr_b16 a[228:229], v103 offset:16384
ds_read_b64_tr_b16 a[230:231], v103 offset:18432
buffer_load_dwordx4 a[76:79], v1, s[64:67], s69 offen offset:3072
s_add_u32 s69, s69, 4096
s_cmp_eq_u32 s69, s84
s_cselect_b32 s69, s68, s69
s_waitcnt lgkmcnt(6)
v_mfma_f32_32x32x16_bf16 v[16:31], a[216:219], a[160:163], v[16:31]
ds_read_b64_tr_b16 a[232:233], v100 offset:20480
ds_read_b64_tr_b16 a[234:235], v100 offset:22528
s_waitcnt lgkmcnt(6)
v_mfma_f32_32x32x16_bf16 v[32:47], a[220:223], a[160:163], v[32:47]
ds_read_b64_tr_b16 a[236:237], v101 offset:20480
ds_read_b64_tr_b16 a[238:239], v101 offset:22528
s_waitcnt lgkmcnt(6)
v_mfma_f32_32x32x16_bf16 v[48:63], a[224:227], a[160:163], v[48:63]
ds_read_b64_tr_b16 a[240:241], v102 offset:20480
ds_read_b64_tr_b16 a[242:243], v102 offset:22528
buffer_load_dwordx4 a[80:83], v1, s[64:67], s69 offen offset:0
s_waitcnt lgkmcnt(6)
v_mfma_f32_32x32x16_bf16 v[64:79], a[228:231], a[160:163], v[64:79]
ds_read_b64_tr_b16 a[244:245], v103 offset:20480
ds_read_b64_tr_b16 a[246:247], v103 offset:22528
s_waitcnt lgkmcnt(6)
v_mfma_f32_32x32x16_bf16 v[16:31], a[232:235], a[164:167], v[16:31]
s_waitcnt vmcnt(33)
s_barrier
ds_read_b64_tr_b16 a[216:217], v100 offset:24576
ds_read_b64_tr_b16 a[218:219], v100 offset:26624
s_waitcnt lgkmcnt(6)
v_mfma_f32_32x32x16_bf16 v[32:47], a[236:239], a[164:167], v[32:47]
ds_read_b64_tr_b16 a[220:221], v101 offset:24576
ds_read_b64_tr_b16 a[222:223], v101 offset:26624
buffer_load_dwordx4 a[84:87], v1, s[64:67], s69 offen offset:1024
s_waitcnt lgkmcnt(6)
v_mfma_f32_32x32x16_bf16 v[48:63], a[240:243], a[164:167], v[48:63]
ds_read_b64_tr_b16 a[224:225], v102 offset:24576
ds_read_b64_tr_b16 a[226:227], v102 offset:26624
s_waitcnt lgkmcnt(6)
v_mfma_f32_32x32x16_bf16 v[64:79], a[244:247], a[164:167], v[64:79]
ds_read_b64_tr_b16 a[228:229], v103 offset:24576
ds_read_b64_tr_b16 a[230:231], v103 offset:26624
buffer_load_dwordx4 a[88:91], v1, s[64:67], s69 offen offset:2048
s_waitcnt lgkmcnt(6)
v_mfma_f32_32x32x16_bf16 v[16:31], a[216:219], a[168:171], v[16:31]
ds_read_b64_tr_b16 a[232:233], v100 offset:28672
ds_read_b64_tr_b16 a[234:235], v100 offset:30720
s_waitcnt lgkmcnt(6)
v_mfma_f32_32x32x16_bf16 v[32:47], a[220:223], a[168:171], v[32:47]
ds_read_b64_tr_b16 a[236:237], v101 offset:28672
ds_read_b64_tr_b16 a[238:239], v101 offset:30720
s_waitcnt lgkmcnt(6)
v_mfma_f32_32x32x16_bf16 v[48:63], a[224:227], a[168:171], v[48:63]
ds_read_b64_tr_b16 a[240:241], v102 offset:28672
ds_read_b64_tr_b16 a[242:243], v102 offset:30720
buffer_load_dwordx4 a[92:95], v1, s[64:67], s69 offen offset:3072
s_add_u32 s69, s69, 4096
s_cmp_eq_u32 s69, s84
s_cselect_b32 s69, s68, s69
s_waitcnt lgkmcnt(6)
v_mfma_f32_32x32x16_bf16 v[64:79], a[228:231], a[168:171], v[64:79]
ds_read_b64_tr_b16 a[244:245], v103 offset:28672
ds_read_b64_tr_b16 a[246:247], v103 offset:30720
s_waitcnt lgkmcnt(6)
v_mfma_f32_32x32x16_bf16 v[16:31], a[232:235], a[172:175], v[16:31]
ds_read_b64_tr_b16 a[216:217], v100 offset:32768
ds_read_b64_tr_b16 a[218:219], v100 offset:34816
buffer_load_dwordx4 a[96:99], v1, s[64:67], s69 offen offset:0
s_waitcnt lgkmcnt(6)
v_mfma_f32_32x32x16_bf16 v[32:47], a[236:239], a[172:175], v[32:47]
ds_read_b64_tr_b16 a[220:221], v101 offset:32768
ds_read_b64_tr_b16 a[222:223], v101 offset:34816
s_waitcnt lgkmcnt(6)
v_mfma_f32_32x32x16_bf16 v[48:63], a[240:243], a[172:175], v[48:63]
ds_read_b64_tr_b16 a[224:225], v102 offset:32768
ds_read_b64_tr_b16 a[226:227], v102 offset:34816
s_waitcnt lgkmcnt(6)
v_mfma_f32_32x32x16_bf16 v[64:79], a[244:247], a[172:175], v[64:79]
ds_read_b64_tr_b16 a[228:229], v103 offset:32768
ds_read_b64_tr_b16 a[230:231], v103 offset:34816
buffer_load_dwordx4 a[100:103], v1, s[64:67], s69 offen offset:1024
s_waitcnt lgkmcnt(6)
v_mfma_f32_32x32x16_bf16 v[16:31], a[216:219], a[176:179], v[16:31]
ds_read_b64_tr_b16 a[232:233], v100 offset:36864
ds_read_b64_tr_b16 a[234:235], v100 offset:38912
s_waitcnt lgkmcnt(6)
v_mfma_f32_32x32x16_bf16 v[32:47], a[220:223], a[176:179], v[32:47]
ds_read_b64_tr_b16 a[236:237], v101 offset:36864
ds_read_b64_tr_b16 a[238:239], v101 offset:38912
s_waitcnt lgkmcnt(6)
v_mfma_f32_32x32x16_bf16 v[48:63], a[224:227], a[176:179], v[48:63]
ds_read_b64_tr_b16 a[240:241], v102 offset:36864
ds_read_b64_tr_b16 a[242:243], v102 offset:38912
buffer_load_dwordx4 a[104:107], v1, s[64:67], s69 offen offset:2048
s_waitcnt lgkmcnt(6)
v_mfma_f32_32x32x16_bf16 v[64:79], a[228:231], a[176:179], v[64:79]
ds_read_b64_tr_b16 a[244:245], v103 offset:36864
ds_read_b64_tr_b16 a[246:247], v103 offset:38912
s_waitcnt lgkmcnt(6)
v_mfma_f32_32x32x16_bf16 v[16:31], a[232:235], a[180:183], v[16:31]
ds_read_b64_tr_b16 a[216:217], v100 offset:40960
ds_read_b64_tr_b16 a[218:219], v100 offset:43008
buffer_load_dwordx4 a[108:111], v1, s[64:67], s69 offen offset:3072
s_add_u32 s69, s69, 4096
s_cmp_eq_u32 s69, s84
s_cselect_b32 s69, s68, s69
s_waitcnt lgkmcnt(6)
v_mfma_f32_32x32x16_bf16 v[32:47], a[236:239], a[180:183], v[32:47]
ds_read_b64_tr_b16 a[220:221], v101 offset:40960
ds_read_b64_tr_b16 a[222:223], v101 offset:43008
s_waitcnt lgkmcnt(6)
v_mfma_f32_32x32x16_bf16 v[48:63], a[240:243], a[180:183], v[48:63]
ds_read_b64_tr_b16 a[224:225], v102 offset:40960
ds_read_b64_tr_b16 a[226:227], v102 offset:43008
s_waitcnt lgkmcnt(6)
v_mfma_f32_32x32x16_bf16 v[64:79], a[244:247], a[180:183], v[64:79]
ds_read_b64_tr_b16 a[228:229], v103 offset:40960
ds_read_b64_tr_b16 a[230:231], v103 offset:43008
buffer_load_dwordx4 a[112:115], v1, s[64:67], s69 offen offset:0
s_waitcnt lgkmcnt(6)
v_mfma_f32_32x32x16_bf16 v[16:31], a[216:219], a[184:187], v[16:31]
ds_read_b64_tr_b16 a[232:233], v100 offset:45056
ds_read_b64_tr_b16 a[234:235], v100 offset:47104
s_waitcnt lgkmcnt(6)
v_mfma_f32_32x32x16_bf16 v[32:47], a[220:223], a[184:187], v[32:47]
ds_read_b64_tr_b16 a[236:237], v101 offset:45056
ds_read_b64_tr_b16 a[238:239], v101 offset:47104
buffer_load_dwordx4 a[116:119], v1, s[64:67], s69 offen offset:1024
s_waitcnt lgkmcnt(6)
v_mfma_f32_32x32x16_bf16 v[48:63], a[224:227], a[184:187], v[48:63]
ds_read_b64_tr_b16 a[240:241], v102 offset:45056
ds_read_b64_tr_b16 a[242:243], v102 offset:47104
s_waitcnt lgkmcnt(6)
v_mfma_f32_32x32x16_bf16 v[64:79], a[228:231], a[184:187], v[64:79]
ds_read_b64_tr_b16 a[244:245], v103 offset:45056
ds_read_b64_tr_b16 a[246:247], v103 offset:47104
s_waitcnt lgkmcnt(6)
v_mfma_f32_32x32x16_bf16 v[16:31], a[232:235], a[188:191], v[16:31]
s_waitcnt vmcnt(30)
s_barrier
ds_read_b64_tr_b16 a[216:217], v104 offset:0
ds_read_b64_tr_b16 a[218:219], v104 offset:2048
buffer_load_dwordx4 a[120:123], v1, s[64:67], s69 offen offset:2048
s_waitcnt lgkmcnt(6)
v_mfma_f32_32x32x16_bf16 v[32:47], a[236:239], a[188:191], v[32:47]
ds_read_b64_tr_b16 a[220:221], v105 offset:0
ds_read_b64_tr_b16 a[222:223], v105 offset:2048
s_waitcnt lgkmcnt(6)
v_mfma_f32_32x32x16_bf16 v[48:63], a[240:243], a[188:191], v[48:63]
ds_read_b64_tr_b16 a[224:225], v106 offset:0
ds_read_b64_tr_b16 a[226:227], v106 offset:2048
s_waitcnt lgkmcnt(6)
v_mfma_f32_32x32x16_bf16 v[64:79], a[244:247], a[188:191], v[64:79]
ds_read_b64_tr_b16 a[228:229], v107 offset:0
ds_read_b64_tr_b16 a[230:231], v107 offset:2048
buffer_load_dwordx4 a[124:127], v1, s[64:67], s69 offen offset:3072
s_add_u32 s69, s69, 4096
s_cmp_eq_u32 s69, s84
s_cselect_b32 s69, s68, s69
s_waitcnt lgkmcnt(6)
v_mfma_f32_32x32x16_bf16 v[16:31], a[216:219], a[192:195], v[16:31]
ds_read_b64_tr_b16 a[232:233], v104 offset:4096
ds_read_b64_tr_b16 a[234:235], v104 offset:6144
s_waitcnt lgkmcnt(6)
v_mfma_f32_32x32x16_bf16 v[32:47], a[220:223], a[192:195], v[32:47]
ds_read_b64_tr_b16 a[236:237], v105 offset:4096
ds_read_b64_tr_b16 a[238:239], v105 offset:6144
buffer_load_dwordx4 a[128:131], v1, s[64:67], s69 offen offset:0
s_waitcnt lgkmcnt(6)
v_mfma_f32_32x32x16_bf16 v[48:63], a[224:227], a[192:195], v[48:63]
ds_read_b64_tr_b16 a[240:241], v106 offset:4096
ds_read_b64_tr_b16 a[242:243], v106 offset:6144
s_waitcnt lgkmcnt(6)
v_mfma_f32_32x32x16_bf16 v[64:79], a[228:231], a[192:195], v[64:79]
ds_read_b64_tr_b16 a[244:245], v107 offset:4096
ds_read_b64_tr_b16 a[246:247], v107 offset:6144
s_waitcnt lgkmcnt(6)
v_mfma_f32_32x32x16_bf16 v[16:31], a[232:235], a[196:199], v[16:31]
ds_read_b64_tr_b16 a[216:217], v104 offset:8192
ds_read_b64_tr_b16 a[218:219], v104 offset:10240
buffer_load_dwordx4 a[132:135], v1, s[64:67], s69 offen offset:1024
s_waitcnt lgkmcnt(6)
v_mfma_f32_32x32x16_bf16 v[32:47], a[236:239], a[196:199], v[32:47]
ds_read_b64_tr_b16 a[220:221], v105 offset:8192
ds_read_b64_tr_b16 a[222:223], v105 offset:10240
s_waitcnt lgkmcnt(6)
v_mfma_f32_32x32x16_bf16 v[48:63], a[240:243], a[196:199], v[48:63]
ds_read_b64_tr_b16 a[224:225], v106 offset:8192
ds_read_b64_tr_b16 a[226:227], v106 offset:10240
buffer_load_dwordx4 a[136:139], v1, s[64:67], s69 offen offset:2048
s_waitcnt lgkmcnt(6)
v_mfma_f32_32x32x16_bf16 v[64:79], a[244:247], a[196:199], v[64:79]
ds_read_b64_tr_b16 a[228:229], v107 offset:8192
ds_read_b64_tr_b16 a[230:231], v107 offset:10240
s_waitcnt lgkmcnt(6)
v_mfma_f32_32x32x16_bf16 v[16:31], a[216:219], a[200:203], v[16:31]
ds_read_b64_tr_b16 a[232:233], v104 offset:12288
ds_read_b64_tr_b16 a[234:235], v104 offset:14336
s_waitcnt lgkmcnt(6)
v_mfma_f32_32x32x16_bf16 v[32:47], a[220:223], a[200:203], v[32:47]
ds_read_b64_tr_b16 a[236:237], v105 offset:12288
ds_read_b64_tr_b16 a[238:239], v105 offset:14336
buffer_load_dwordx4 a[140:143], v1, s[64:67], s69 offen offset:3072
s_add_u32 s69, s69, 4096
s_cmp_eq_u32 s69, s84
s_cselect_b32 s69, s68, s69
s_waitcnt lgkmcnt(6)
v_mfma_f32_32x32x16_bf16 v[48:63], a[224:227], a[200:203], v[48:63]
ds_read_b64_tr_b16 a[240:241], v106 offset:12288
ds_read_b64_tr_b16 a[242:243], v106 offset:14336
s_waitcnt lgkmcnt(6)
v_mfma_f32_32x32x16_bf16 v[64:79], a[228:231], a[200:203], v[64:79]
ds_read_b64_tr_b16 a[244:245], v107 offset:12288
ds_read_b64_tr_b16 a[246:247], v107 offset:14336
s_waitcnt lgkmcnt(6)
v_mfma_f32_32x32x16_bf16 v[16:31], a[232:235], a[204:207], v[16:31]
ds_read_b64_tr_b16 a[216:217], v104 offset:16384
ds_read_b64_tr_b16 a[218:219], v104 offset:18432
buffer_load_dwordx4 a[144:147], v1, s[64:67], s69 offen offset:0
s_waitcnt lgkmcnt(6)
v_mfma_f32_32x32x16_bf16 v[32:47], a[236:239], a[204:207], v[32:47]
ds_read_b64_tr_b16 a[220:221], v105 offset:16384
ds_read_b64_tr_b16 a[222:223], v105 offset:18432
s_waitcnt lgkmcnt(6)
v_mfma_f32_32x32x16_bf16 v[48:63], a[240:243], a[204:207], v[48:63]
ds_read_b64_tr_b16 a[224:225], v106 offset:16384
ds_read_b64_tr_b16 a[226:227], v106 offset:18432
buffer_load_dwordx4 a[148:151], v1, s[64:67], s69 offen offset:1024
s_waitcnt lgkmcnt(6)
v_mfma_f32_32x32x16_bf16 v[64:79], a[244:247], a[204:207], v[64:79]
ds_read_b64_tr_b16 a[228:229], v107 offset:16384
ds_read_b64_tr_b16 a[230:231], v107 offset:18432
s_waitcnt lgkmcnt(6)
v_mfma_f32_32x32x16_bf16 v[16:31], a[216:219], a[208:211], v[16:31]
ds_read_b64_tr_b16 a[232:233], v104 offset:20480
ds_read_b64_tr_b16 a[234:235], v104 offset:22528
s_waitcnt lgkmcnt(6)
v_mfma_f32_32x32x16_bf16 v[32:47], a[220:223], a[208:211], v[32:47]
ds_read_b64_tr_b16 a[236:237], v105 offset:20480
ds_read_b64_tr_b16 a[238:239], v105 offset:22528
buffer_load_dwordx4 a[152:155], v1, s[64:67], s69 offen offset:2048
s_waitcnt lgkmcnt(6)
v_mfma_f32_32x32x16_bf16 v[48:63], a[224:227], a[208:211], v[48:63]
ds_read_b64_tr_b16 a[240:241], v106 offset:20480
ds_read_b64_tr_b16 a[242:243], v106 offset:22528
s_waitcnt lgkmcnt(6)
v_mfma_f32_32x32x16_bf16 v[64:79], a[228:231], a[208:211], v[64:79]
ds_read_b64_tr_b16 a[244:245], v107 offset:20480
ds_read_b64_tr_b16 a[246:247], v107 offset:22528
buffer_load_dwordx4 a[156:159], v1, s[64:67], s69 offen offset:3072
s_add_u32 s69, s69, 4096
s_cmp_eq_u32 s69, s84
s_cselect_b32 s69, s68, s69
s_waitcnt lgkmcnt(6)
v_mfma_f32_32x32x16_bf16 v[16:31], a[232:235], a[212:215], v[16:31]
s_waitcnt lgkmcnt(4)
v_mfma_f32_32x32x16_bf16 v[32:47], a[236:239], a[212:215], v[32:47]
s_waitcnt lgkmcnt(2)
v_mfma_f32_32x32x16_bf16 v[48:63], a[240:243], a[212:215], v[48:63]
s_waitcnt lgkmcnt(0)
v_mfma_f32_32x32x16_bf16 v[64:79], a[244:247], a[212:215], v[64:79]
s_lshl_b32 s48, s6, 6
s_add_u32 s48, s48, s7
s_mul_i32 s48, s48, 20
s_lshl_b32 s49, s30, 2
s_add_u32 s48, s48, s49
s_lshl_b32 s48, s48, 11
v_cvt_pk_bf16_f32 v128, v16, v17
v_cvt_pk_bf16_f32 v129, v18, v19
v_cvt_pk_bf16_f32 v130, v20, v21
v_cvt_pk_bf16_f32 v131, v22, v23
buffer_store_dwordx4 v[128:131], v1, s[40:43], s48 offen offset:0 sc1
v_cvt_pk_bf16_f32 v132, v24, v25
v_cvt_pk_bf16_f32 v133, v26, v27
v_cvt_pk_bf16_f32 v134, v28, v29
v_cvt_pk_bf16_f32 v135, v30, v31
buffer_store_dwordx4 v[132:135], v1, s[40:43], s48 offen offset:1024 sc1
v_cvt_pk_bf16_f32 v136, v32, v33
v_cvt_pk_bf16_f32 v137, v34, v35
v_cvt_pk_bf16_f32 v138, v36, v37
v_cvt_pk_bf16_f32 v139, v38, v39
buffer_store_dwordx4 v[136:139], v1, s[40:43], s48 offen offset:2048 sc1
v_cvt_pk_bf16_f32 v140, v40, v41
v_cvt_pk_bf16_f32 v141, v42, v43
v_cvt_pk_bf16_f32 v142, v44, v45
v_cvt_pk_bf16_f32 v143, v46, v47
buffer_store_dwordx4 v[140:143], v1, s[40:43], s48 offen offset:3072 sc1
s_add_u32 s48, s48, 4096
v_cvt_pk_bf16_f32 v144, v48, v49
v_cvt_pk_bf16_f32 v145, v50, v51
v_cvt_pk_bf16_f32 v146, v52, v53
v_cvt_pk_bf16_f32 v147, v54, v55
buffer_store_dwordx4 v[144:147], v1, s[40:43], s48 offen offset:0 sc1
v_cvt_pk_bf16_f32 v148, v56, v57
v_cvt_pk_bf16_f32 v149, v58, v59
v_cvt_pk_bf16_f32 v150, v60, v61
v_cvt_pk_bf16_f32 v151, v62, v63
buffer_store_dwordx4 v[148:151], v1, s[40:43], s48 offen offset:1024 sc1
v_cvt_pk_bf16_f32 v152, v64, v65
v_cvt_pk_bf16_f32 v153, v66, v67
v_cvt_pk_bf16_f32 v154, v68, v69
v_cvt_pk_bf16_f32 v155, v70, v71
buffer_store_dwordx4 v[152:155], v1, s[40:43], s48 offen offset:2048 sc1
v_cvt_pk_bf16_f32 v156, v72, v73
v_cvt_pk_bf16_f32 v157, v74, v75
v_cvt_pk_bf16_f32 v158, v76, v77
v_cvt_pk_bf16_f32 v159, v78, v79
buffer_store_dwordx4 v[156:159], v1, s[40:43], s48 offen offset:3072 sc1
s_lshr_b32 s61, s7, 2
s_add_u32 s50, s28, 25165824
s_addc_u32 s51, s29, 0
s_branch PB
P2F:
s_sub_u32 s6, s2, 160
s_cmp_eq_u32 s6, 1
s_cselect_b32 s60, 1, s60
s_lshl_b32 s6, s6, 2
s_add_u32 s6, s6, s3
s_min_u32 s6, s6, 320
s_lshl_b32 s7, s6, 12
s_add_u32 s30, s7, 320*4096
s_cmp_eq_u32 s6, 0
s_cselect_b32 s30, 0x40000000, s30
s_cmp_eq_u32 s6, 320
s_cselect_b32 s30, 0x40000000, s30
v_and_b32 v1, 31, v0
v_lshrrev_b32 v2, 5, v0
v_lshlrev_b32 v2, 4, v2
v_lshl_add_u32 v5, v1, 6, v2
v_lshlrev_b32 v1, 4, v0
v_add_u32 v4, s30, v1
v_add_u32 v3, s7, v1
s_lshl_b32 s31, s3, 13
s_add_u32 s31, s31, 65536
v_add_u32 v5, s31, v5
v_add_u32 v6, s31, v1
s_lshl_b32 s31, s6, 13
s_waitcnt lgkmcnt(0)
s_mov_b32 s32, s28
s_mov_b32 s33, s29
s_mov_b32 s34, 2621440
s_mov_b32 s35, 0x20000
s_getpc_b64 s[36:37]
s_add_u32 s36, s36, TABC@rel32@lo+4
s_addc_u32 s37, s37, TABC@rel32@hi+12
s_mov_b32 s38, 65536
s_mov_b32 s39, 0x20000
s_add_u32 s40, s28, 13631488
s_addc_u32 s41, s29, 0
s_mov_b32 s42, 2621440
s_mov_b32 s43, 0x20000
s_add_u32 s44, s28, 10485760
s_addc_u32 s45, s29, 0
s_mov_b32 s46, 2629632
s_mov_b32 s47, 0x20000
buffer_load_dwordx4 v[16:19], v3, s[32:35], 0 offen offset:0
buffer_load_dwordx4 v[32:35], v4, s[32:35], 0 offen offset:0
buffer_load_dwordx4 v[20:23], v3, s[32:35], 0 offen offset:2048
buffer_load_dwordx4 v[36:39], v4, s[32:35], 0 offen offset:2048
buffer_load_dwordx4 v[24:27], v3, s[32:35], 0 offen offset:1024
buffer_load_dwordx4 v[40:43], v4, s[32:35], 0 offen offset:1024
buffer_load_dwordx4 v[28:31], v3, s[32:35], 0 offen offset:3072
buffer_load_dwordx4 v[44:47], v4, s[32:35], 0 offen offset:3072
s_lshl_b32 s49, s3, 10
s_add_u32 s48, s49, 0
s_mov_b32 m0, s48
s_nop 0
buffer_load_dwordx4 v1, s[36:39], s48 offen lds
s_add_u32 s48, s49, 4096
s_mov_b32 m0, s48
s_nop 0
buffer_load_dwordx4 v1, s[36:39], s48 offen lds
s_add_u32 s48, s49, 8192
s_mov_b32 m0, s48
s_nop 0
buffer_load_dwordx4 v1, s[36:39], s48 offen lds
s_add_u32 s48, s49, 12288
s_mov_b32 m0, s48
s_nop 0
buffer_load_dwordx4 v1, s[36:39], s48 offen lds
s_add_u32 s48, s49, 16384
s_mov_b32 m0, s48
s_nop 0
buffer_load_dwordx4 v1, s[36:39], s48 offen lds
s_add_u32 s48, s49, 20480
s_mov_b32 m0, s48
s_nop 0
buffer_load_dwordx4 v1, s[36:39], s48 offen lds
s_add_u32 s48, s49, 24576
s_mov_b32 m0, s48
s_nop 0
buffer_load_dwordx4 v1, s[36:39], s48 offen lds
s_add_u32 s48, s49, 28672
s_mov_b32 m0, s48
s_nop 0
buffer_load_dwordx4 v1, s[36:39], s48 offen lds
s_add_u32 s48, s49, 32768
s_mov_b32 m0, s48
s_nop 0
buffer_load_dwordx4 v1, s[36:39], s48 offen lds
s_add_u32 s48, s49, 36864
s_mov_b32 m0, s48
s_nop 0
buffer_load_dwordx4 v1, s[36:39], s48 offen lds
s_add_u32 s48, s49, 40960
s_mov_b32 m0, s48
s_nop 0
buffer_load_dwordx4 v1, s[36:39], s48 offen lds
s_add_u32 s48, s49, 45056
s_mov_b32 m0, s48
s_nop 0
buffer_load_dwordx4 v1, s[36:39], s48 offen lds
s_waitcnt vmcnt(6)
s_barrier
ds_read_b128 a[128:131], v1 offset:0
ds_read_b128 a[132:135], v1 offset:1024
ds_read_b128 a[136:139], v1 offset:2048
ds_read_b128 a[140:143], v1 offset:3072
ds_read_b128 a[144:147], v1 offset:4096
ds_read_b128 a[148:151], v1 offset:5120
ds_read_b128 v[144:147], v1 offset:6144
ds_read_b128 v[148:151], v1 offset:7168
ds_read_b128 v[152:155], v1 offset:8192
ds_read_b128 v[156:159], v1 offset:9216
ds_read_b128 v[160:163], v1 offset:10240
ds_read_b128 v[164:167], v1 offset:11264
ds_read_b128 v[168:171], v1 offset:12288
ds_read_b128 v[172:175], v1 offset:13312
ds_read_b128 v[176:179], v1 offset:14336
ds_read_b128 v[180:183], v1 offset:15360
ds_read_b128 v[184:187], v1 offset:16384
ds_read_b128 v[188:191], v1 offset:17408
ds_read_b128 v[192:195], v1 offset:18432
ds_read_b128 v[196:199], v1 offset:19456
ds_read_b128 v[200:203], v1 offset:20480
ds_read_b128 v[204:207], v1 offset:21504
s_add_u32 s48, s49, 49152
s_mov_b32 m0, s48
s_nop 0
buffer_load_dwordx4 v1, s[36:39], s48 offen lds
s_add_u32 s48, s49, 53248
s_mov_b32 m0, s48
s_nop 0
buffer_load_dwordx4 v1, s[36:39], s48 offen lds
s_add_u32 s48, s49, 57344
s_mov_b32 m0, s48
s_nop 0
buffer_load_dwordx4 v1, s[36:39], s48 offen lds
s_add_u32 s48, s49, 61440
s_mov_b32 m0, s48
s_nop 0
buffer_load_dwordx4 v1, s[36:39], s48 offen lds
buffer_load_dwordx4 v[208:211], v1, s[44:47], s31 offen offset:0
buffer_load_dwordx4 v[212:215], v1, s[44:47], s31 offen offset:1024
buffer_load_dwordx4 v[216:219], v1, s[44:47], s31 offen offset:2048
buffer_load_dwordx4 v[220:223], v1, s[44:47], s31 offen offset:3072
s_add_u32 s31, s31, 4096
buffer_load_dwordx4 v[224:227], v1, s[44:47], s31 offen offset:0
buffer_load_dwordx4 v[228:231], v1, s[44:47], s31 offen offset:1024
buffer_load_dwordx4 v[232:235], v1, s[44:47], s31 offen offset:2048
buffer_load_dwordx4 v[236:239], v1, s[44:47], s31 offen offset:3072
s_waitcnt lgkmcnt(15)
v_mfma_f32_32x32x16_bf16 v[80:95], v[16:19], a[128:131], 0
v_mfma_f32_32x32x16_bf16 v[96:111], v[32:35], a[128:131], 0
v_mfma_f32_32x32x16_bf16 v[80:95], v[32:35], a[136:139], v[80:95]
v_mfma_f32_32x32x16_bf16 v[96:111], v[16:19], a[144:147], v[96:111]
v_mfma_f32_32x32x16_bf16 v[80:95], v[20:23], a[132:135], v[80:95]
v_mfma_f32_32x32x16_bf16 v[96:111], v[36:39], a[132:135], v[96:111]
v_mfma_f32_32x32x16_bf16 v[80:95], v[36:39], a[140:143], v[80:95]
v_mfma_f32_32x32x16_bf16 v[96:111], v[20:23], a[148:151], v[96:111]
s_waitcnt vmcnt(12)
s_barrier
s_waitcnt lgkmcnt(0)
v_mfma_f32_32x32x16_bf16 v[112:127], v[24:27], a[128:131], 0
ds_read_b128 a[152:155], v1 offset:24576
ds_read_b128 a[184:187], v1 offset:32768
ds_read_b128 a[216:219], v1 offset:40960
v_mfma_f32_32x32x16_bf16 v[128:143], v[40:43], a[128:131], 0
ds_read_b128 a[156:159], v1 offset:25600
ds_read_b128 a[188:191], v1 offset:33792
ds_read_b128 a[220:223], v1 offset:41984
v_mfma_f32_32x32x16_bf16 v[112:127], v[40:43], a[136:139], v[112:127]
ds_read_b128 a[160:163], v1 offset:26624
ds_read_b128 a[192:195], v1 offset:34816
ds_read_b128 a[224:227], v1 offset:43008
v_mfma_f32_32x32x16_bf16 v[128:143], v[24:27], a[144:147], v[128:143]
ds_read_b128 a[164:167], v1 offset:27648
ds_read_b128 a[196:199], v1 offset:35840
ds_read_b128 a[228:231], v1 offset:44032
v_mfma_f32_32x32x16_bf16 v[112:127], v[28:31], a[132:135], v[112:127]
v_mul_f32 v240, v80, v144
v_mul_f32 v241, v96, v144
v_fma_f32 v240, v96, v148, v240
v_mfma_f32_32x32x16_bf16 v[128:143], v[44:47], a[132:135], v[128:143]
v_fma_f32 v241, -v80, v148, v241
v_mul_f32 v244, v81, v145
v_mul_f32 v245, v97, v145
v_mfma_f32_32x32x16_bf16 v[112:127], v[44:47], a[140:143], v[112:127]
v_fma_f32 v244, v97, v149, v244
v_fma_f32 v245, -v81, v149, v245
v_cvt_pk_bf16_f32 v48, v240, v244
v_mfma_f32_32x32x16_bf16 v[128:143], v[28:31], a[148:151], v[128:143]
v_cvt_pk_bf16_f32 v64, v241, v245
v_mul_f32 v248, v82, v146
v_mul_f32 v249, v98, v146
v_fma_f32 v248, v98, v150, v248
v_fma_f32 v249, -v82, v150, v249
v_mul_f32 v252, v83, v147
v_mul_f32 v253, v99, v147
v_fma_f32 v252, v99, v151, v252
v_fma_f32 v253, -v83, v151, v253
ds_read_b128 a[168:171], v1 offset:28672
v_cvt_pk_bf16_f32 v49, v248, v252
v_cvt_pk_bf16_f32 v65, v249, v253
v_mul_f32 v240, v84, v152
v_mul_f32 v241, v100, v152
v_fma_f32 v240, v100, v156, v240
v_fma_f32 v241, -v84, v156, v241
ds_read_b128 a[200:203], v1 offset:36864
v_mul_f32 v244, v85, v153
v_mul_f32 v245, v101, v153
v_fma_f32 v244, v101, v157, v244
v_fma_f32 v245, -v85, v157, v245
v_cvt_pk_bf16_f32 v50, v240, v244
ds_read_b128 a[232:235], v1 offset:45056
v_cvt_pk_bf16_f32 v66, v241, v245
v_mul_f32 v248, v86, v154
v_mul_f32 v249, v102, v154
v_fma_f32 v248, v102, v158, v248
v_fma_f32 v249, -v86, v158, v249
v_mul_f32 v252, v87, v155
ds_read_b128 a[172:175], v1 offset:29696
v_mul_f32 v253, v103, v155
v_fma_f32 v252, v103, v159, v252
v_fma_f32 v253, -v87, v159, v253
v_cvt_pk_bf16_f32 v51, v248, v252
v_cvt_pk_bf16_f32 v67, v249, v253
v_mul_f32 v240, v88, v160
ds_read_b128 a[204:207], v1 offset:37888
v_mul_f32 v241, v104, v160
v_fma_f32 v240, v104, v164, v240
v_fma_f32 v241, -v88, v164, v241
v_mul_f32 v244, v89, v161
v_mul_f32 v245, v105, v161
ds_read_b128 a[236:239], v1 offset:46080
v_fma_f32 v244, v105, v165, v244
v_fma_f32 v245, -v89, v165, v245
v_cvt_pk_bf16_f32 v52, v240, v244
v_cvt_pk_bf16_f32 v68, v241, v245
v_mul_f32 v248, v90, v162
v_mul_f32 v249, v106, v162
ds_read_b128 a[176:179], v1 offset:30720
v_fma_f32 v248, v106, v166, v248
v_fma_f32 v249, -v90, v166, v249
v_mul_f32 v252, v91, v163
v_mul_f32 v253, v107, v163
v_fma_f32 v252, v107, v167, v252
v_fma_f32 v253, -v91, v167, v253
ds_read_b128 a[208:211], v1 offset:38912
v_cvt_pk_bf16_f32 v53, v248, v252
v_cvt_pk_bf16_f32 v69, v249, v253
v_mul_f32 v240, v92, v168
v_mul_f32 v241, v108, v168
v_fma_f32 v240, v108, v172, v240
ds_read_b128 a[240:243], v1 offset:47104
v_fma_f32 v241, -v92, v172, v241
v_mul_f32 v244, v93, v169
v_mul_f32 v245, v109, v169
v_fma_f32 v244, v109, v173, v244
v_fma_f32 v245, -v93, v173, v245
v_cvt_pk_bf16_f32 v54, v240, v244
ds_read_b128 a[180:183], v1 offset:31744
v_cvt_pk_bf16_f32 v70, v241, v245
v_mul_f32 v248, v94, v170
v_mul_f32 v249, v110, v170
v_fma_f32 v248, v110, v174, v248
v_fma_f32 v249, -v94, v174, v249
v_mul_f32 v252, v95, v171
ds_read_b128 a[212:215], v1 offset:39936
v_mul_f32 v253, v111, v171
v_fma_f32 v252, v111, v175, v252
v_fma_f32 v253, -v95, v175, v253
v_cvt_pk_bf16_f32 v55, v248, v252
v_cvt_pk_bf16_f32 v71, v249, v253
ds_read_b128 a[244:247], v1 offset:48128
s_waitcnt lgkmcnt(0)
buffer_load_dwordx4 a[0:3], v1, s[64:67], s69 offen offset:0
buffer_load_dwordx4 a[4:7], v1, s[64:67], s69 offen offset:1024
buffer_load_dwordx4 a[8:11], v1, s[64:67], s69 offen offset:2048
buffer_load_dwordx4 a[12:15], v1, s[64:67], s69 offen offset:3072
s_add_u32 s69, s69, 4096
s_cmp_eq_u32 s69, s84
s_cselect_b32 s69, s68, s69
buffer_load_dwordx4 a[16:19], v1, s[64:67], s69 offen offset:0
buffer_load_dwordx4 a[20:23], v1, s[64:67], s69 offen offset:1024
buffer_load_dwordx4 a[24:27], v1, s[64:67], s69 offen offset:2048
buffer_load_dwordx4 a[28:31], v1, s[64:67], s69 offen offset:3072
s_add_u32 s69, s69, 4096
s_cmp_eq_u32 s69, s84
s_cselect_b32 s69, s68, s69
v_mfma_f32_32x32x16_bf16 v[80:95], a[152:155], v[48:51], 0
v_mul_f32 v240, v112, v176
v_mul_f32 v241, v128, v176
v_fma_f32 v240, v128, v180, v240
v_fma_f32 v241, -v112, v180, v241
v_mul_f32 v244, v113, v177
v_mul_f32 v245, v129, v177
v_fma_f32 v244, v129, v181, v244
v_fma_f32 v245, -v113, v181, v245
v_cvt_pk_bf16_f32 v56, v240, v244
v_cvt_pk_bf16_f32 v72, v241, v245
v_mfma_f32_32x32x16_bf16 v[96:111], a[152:155], v[64:67], 0
v_mul_f32 v248, v114, v178
v_mul_f32 v249, v130, v178
v_fma_f32 v248, v130, v182, v248
v_fma_f32 v249, -v114, v182, v249
v_mul_f32 v252, v115, v179
v_mul_f32 v253, v131, v179
v_fma_f32 v252, v131, v183, v252
v_fma_f32 v253, -v115, v183, v253
v_cvt_pk_bf16_f32 v57, v248, v252
v_cvt_pk_bf16_f32 v73, v249, v253
v_mfma_f32_32x32x16_bf16 v[80:95], a[184:187], v[64:67], v[80:95]
v_mul_f32 v240, v116, v184
v_mul_f32 v241, v132, v184
v_fma_f32 v240, v132, v188, v240
v_fma_f32 v241, -v116, v188, v241
v_mul_f32 v244, v117, v185
v_mul_f32 v245, v133, v185
v_fma_f32 v244, v133, v189, v244
v_fma_f32 v245, -v117, v189, v245
v_cvt_pk_bf16_f32 v58, v240, v244
v_cvt_pk_bf16_f32 v74, v241, v245
v_mfma_f32_32x32x16_bf16 v[96:111], a[216:219], v[48:51], v[96:111]
v_mul_f32 v248, v118, v186
v_mul_f32 v249, v134, v186
v_fma_f32 v248, v134, v190, v248
v_fma_f32 v249, -v118, v190, v249
v_mul_f32 v252, v119, v187
v_mul_f32 v253, v135, v187
v_fma_f32 v252, v135, v191, v252
v_fma_f32 v253, -v119, v191, v253
v_cvt_pk_bf16_f32 v59, v248, v252
v_cvt_pk_bf16_f32 v75, v249, v253
v_mfma_f32_32x32x16_bf16 v[80:95], a[156:159], v[52:55], v[80:95]
v_mul_f32 v240, v120, v192
v_mul_f32 v241, v136, v192
v_fma_f32 v240, v136, v196, v240
v_fma_f32 v241, -v120, v196, v241
v_mul_f32 v244, v121, v193
v_mul_f32 v245, v137, v193
v_fma_f32 v244, v137, v197, v244
v_fma_f32 v245, -v121, v197, v245
v_cvt_pk_bf16_f32 v60, v240, v244
v_cvt_pk_bf16_f32 v76, v241, v245
v_mfma_f32_32x32x16_bf16 v[96:111], a[156:159], v[68:71], v[96:111]
v_mul_f32 v248, v122, v194
v_mul_f32 v249, v138, v194
v_fma_f32 v248, v138, v198, v248
v_fma_f32 v249, -v122, v198, v249
v_mul_f32 v252, v123, v195
v_mul_f32 v253, v139, v195
v_fma_f32 v252, v139, v199, v252
v_fma_f32 v253, -v123, v199, v253
v_cvt_pk_bf16_f32 v61, v248, v252
v_cvt_pk_bf16_f32 v77, v249, v253
v_mfma_f32_32x32x16_bf16 v[80:95], a[188:191], v[68:71], v[80:95]
v_mul_f32 v240, v124, v200
v_mul_f32 v241, v140, v200
v_fma_f32 v240, v140, v204, v240
v_fma_f32 v241, -v124, v204, v241
v_mul_f32 v244, v125, v201
v_mul_f32 v245, v141, v201
v_fma_f32 v244, v141, v205, v244
v_fma_f32 v245, -v125, v205, v245
v_cvt_pk_bf16_f32 v62, v240, v244
v_cvt_pk_bf16_f32 v78, v241, v245
v_mfma_f32_32x32x16_bf16 v[96:111], a[220:223], v[52:55], v[96:111]
v_mul_f32 v248, v126, v202
v_mul_f32 v249, v142, v202
v_fma_f32 v248, v142, v206, v248
v_fma_f32 v249, -v126, v206, v249
v_mul_f32 v252, v127, v203
v_mul_f32 v253, v143, v203
v_fma_f32 v252, v143, v207, v252
v_fma_f32 v253, -v127, v207, v253
v_cvt_pk_bf16_f32 v63, v248, v252
v_cvt_pk_bf16_f32 v79, v249, v253
s_waitcnt vmcnt(16)
s_barrier
buffer_load_dwordx4 a[32:35], v1, s[64:67], s69 offen offset:0
buffer_load_dwordx4 a[36:39], v1, s[64:67], s69 offen offset:1024
buffer_load_dwordx4 a[40:43], v1, s[64:67], s69 offen offset:2048
buffer_load_dwordx4 a[44:47], v1, s[64:67], s69 offen offset:3072
s_add_u32 s69, s69, 4096
s_cmp_eq_u32 s69, s84
s_cselect_b32 s69, s68, s69
buffer_load_dwordx4 a[48:51], v1, s[64:67], s69 offen offset:0
buffer_load_dwordx4 a[52:55], v1, s[64:67], s69 offen offset:1024
buffer_load_dwordx4 a[56:59], v1, s[64:67], s69 offen offset:2048
buffer_load_dwordx4 a[60:63], v1, s[64:67], s69 offen offset:3072
s_add_u32 s69, s69, 4096
s_cmp_eq_u32 s69, s84
s_cselect_b32 s69, s68, s69
v_mfma_f32_32x32x16_bf16 v[80:95], a[160:163], v[56:59], v[80:95]
ds_read_b128 v[144:147], v1 offset:49152
ds_read_b128 v[148:151], v1 offset:50176
v_mfma_f32_32x32x16_bf16 v[96:111], a[160:163], v[72:75], v[96:111]
ds_read_b128 v[152:155], v1 offset:51200
ds_read_b128 v[156:159], v1 offset:52224
v_mfma_f32_32x32x16_bf16 v[80:95], a[192:195], v[72:75], v[80:95]
ds_read_b128 v[160:163], v1 offset:53248
ds_read_b128 v[164:167], v1 offset:54272
v_mfma_f32_32x32x16_bf16 v[96:111], a[224:227], v[56:59], v[96:111]
ds_read_b128 v[168:171], v1 offset:55296
ds_read_b128 v[172:175], v1 offset:56320
v_mfma_f32_32x32x16_bf16 v[80:95], a[164:167], v[60:63], v[80:95]
ds_read_b128 v[176:179], v1 offset:57344
ds_read_b128 v[180:183], v1 offset:58368
v_mfma_f32_32x32x16_bf16 v[96:111], a[164:167], v[76:79], v[96:111]
ds_read_b128 v[184:187], v1 offset:59392
ds_read_b128 v[188:191], v1 offset:60416
v_mfma_f32_32x32x16_bf16 v[80:95], a[196:199], v[76:79], v[80:95]
ds_read_b128 v[192:195], v1 offset:61440
ds_read_b128 v[196:199], v1 offset:62464
v_mfma_f32_32x32x16_bf16 v[96:111], a[228:231], v[60:63], v[96:111]
ds_read_b128 v[200:203], v1 offset:63488
ds_read_b128 v[204:207], v1 offset:64512
s_waitcnt vmcnt(16)
v_mfma_f32_32x32x16_bf16 v[112:127], a[168:171], v[48:51], 0
v_mfma_f32_32x32x16_bf16 v[128:143], a[168:171], v[64:67], 0
v_mfma_f32_32x32x16_bf16 v[112:127], a[200:203], v[64:67], v[112:127]
v_mfma_f32_32x32x16_bf16 v[128:143], a[232:235], v[48:51], v[128:143]
v_lshlrev_b32 v242, 16, v208
v_and_b32 v243, 0xffff0000, v208
v_mul_f32 v240, v80, v242
v_mul_f32 v241, v80, v243
s_nop 0
v_fma_f32 v240, -v96, v243, v240
v_fma_f32 v241, v96, v242, v241
v_lshlrev_b32 v246, 16, v209
v_and_b32 v247, 0xffff0000, v209
v_mfma_f32_32x32x16_bf16 v[112:127], a[172:175], v[52:55], v[112:127]
v_mul_f32 v244, v81, v246
v_mul_f32 v245, v81, v247
v_fma_f32 v244, -v97, v247, v244
v_fma_f32 v245, v97, v246, v245
v_cvt_pk_bf16_f32 v16, v240, v244
v_cvt_pk_bf16_f32 v32, v241, v245
v_lshlrev_b32 v250, 16, v210
v_and_b32 v251, 0xffff0000, v210
v_mul_f32 v248, v82, v250
v_mfma_f32_32x32x16_bf16 v[128:143], a[172:175], v[68:71], v[128:143]
v_mul_f32 v249, v82, v251
v_fma_f32 v248, -v98, v251, v248
v_fma_f32 v249, v98, v250, v249
v_lshlrev_b32 v254, 16, v211
v_and_b32 v255, 0xffff0000, v211
v_mul_f32 v252, v83, v254
v_mul_f32 v253, v83, v255
v_fma_f32 v252, -v99, v255, v252
v_mfma_f32_32x32x16_bf16 v[112:127], a[204:207], v[68:71], v[112:127]
v_fma_f32 v253, v99, v254, v253
v_cvt_pk_bf16_f32 v17, v248, v252
v_cvt_pk_bf16_f32 v33, v249, v253
v_lshlrev_b32 v242, 16, v212
v_and_b32 v243, 0xffff0000, v212
v_mul_f32 v240, v84, v242
v_mul_f32 v241, v84, v243
v_fma_f32 v240, -v100, v243, v240
v_fma_f32 v241, v100, v242, v241
v_mfma_f32_32x32x16_bf16 v[128:143], a[236:239], v[52:55], v[128:143]
v_lshlrev_b32 v246, 16, v213
v_and_b32 v247, 0xffff0000, v213
v_mul_f32 v244, v85, v246
v_mul_f32 v245, v85, v247
v_fma_f32 v244, -v101, v247, v244
v_fma_f32 v245, v101, v246, v245
v_cvt_pk_bf16_f32 v18, v240, v244
v_cvt_pk_bf16_f32 v34, v241, v245
v_lshlrev_b32 v250, 16, v214
v_mfma_f32_32x32x16_bf16 v[112:127], a[176:179], v[56:59], v[112:127]
v_and_b32 v251, 0xffff0000, v214
v_mul_f32 v248, v86, v250
v_mul_f32 v249, v86, v251
v_fma_f32 v248, -v102, v251, v248
v_fma_f32 v249, v102, v250, v249
v_lshlrev_b32 v254, 16, v215
v_and_b32 v255, 0xffff0000, v215
v_mul_f32 v252, v87, v254
v_mfma_f32_32x32x16_bf16 v[128:143], a[176:179], v[72:75], v[128:143]
v_mul_f32 v253, v87, v255
v_fma_f32 v252, -v103, v255, v252
v_fma_f32 v253, v103, v254, v253
v_cvt_pk_bf16_f32 v19, v248, v252
v_cvt_pk_bf16_f32 v35, v249, v253
v_lshlrev_b32 v242, 16, v216
v_and_b32 v243, 0xffff0000, v216
v_mul_f32 v240, v88, v242
v_mul_f32 v241, v88, v243
v_mfma_f32_32x32x16_bf16 v[112:127], a[208:211], v[72:75], v[112:127]
v_fma_f32 v240, -v104, v243, v240
v_fma_f32 v241, v104, v242, v241
v_lshlrev_b32 v246, 16, v217
v_and_b32 v247, 0xffff0000, v217
v_mul_f32 v244, v89, v246
v_mul_f32 v245, v89, v247
v_fma_f32 v244, -v105, v247, v244
v_fma_f32 v245, v105, v246, v245
v_mfma_f32_32x32x16_bf16 v[128:143], a[240:243], v[56:59], v[128:143]
v_cvt_pk_bf16_f32 v20, v240, v244
v_cvt_pk_bf16_f32 v36, v241, v245
v_lshlrev_b32 v250, 16, v218
v_and_b32 v251, 0xffff0000, v218
v_mul_f32 v248, v90, v250
v_mul_f32 v249, v90, v251
v_fma_f32 v248, -v106, v251, v248
v_fma_f32 v249, v106, v250, v249
v_lshlrev_b32 v254, 16, v219
v_mfma_f32_32x32x16_bf16 v[112:127], a[180:183], v[60:63], v[112:127]
v_and_b32 v255, 0xffff0000, v219
v_mul_f32 v252, v91, v254
v_mul_f32 v253, v91, v255
v_fma_f32 v252, -v107, v255, v252
v_fma_f32 v253, v107, v254, v253
v_cvt_pk_bf16_f32 v21, v248, v252
v_cvt_pk_bf16_f32 v37, v249, v253
v_lshlrev_b32 v242, 16, v220
v_and_b32 v243, 0xffff0000, v220
v_mfma_f32_32x32x16_bf16 v[128:143], a[180:183], v[76:79], v[128:143]
v_mul_f32 v240, v92, v242
v_mul_f32 v241, v92, v243
v_fma_f32 v240, -v108, v243, v240
v_fma_f32 v241, v108, v242, v241
v_lshlrev_b32 v246, 16, v221
v_and_b32 v247, 0xffff0000, v221
v_mul_f32 v244, v93, v246
v_mul_f32 v245, v93, v247
v_mfma_f32_32x32x16_bf16 v[112:127], a[212:215], v[76:79], v[112:127]
v_fma_f32 v244, -v109, v247, v244
v_fma_f32 v245, v109, v246, v245
v_cvt_pk_bf16_f32 v22, v240, v244
v_cvt_pk_bf16_f32 v38, v241, v245
v_lshlrev_b32 v250, 16, v222
v_and_b32 v251, 0xffff0000, v222
v_mul_f32 v248, v94, v250
v_mul_f32 v249, v94, v251
v_fma_f32 v248, -v110, v251, v248
v_mfma_f32_32x32x16_bf16 v[128:143], a[244:247], v[60:63], v[128:143]
v_fma_f32 v249, v110, v250, v249
v_lshlrev_b32 v254, 16, v223
v_and_b32 v255, 0xffff0000, v223
v_mul_f32 v252, v95, v254
v_mul_f32 v253, v95, v255
v_fma_f32 v252, -v111, v255, v252
v_fma_f32 v253, v111, v254, v253
v_cvt_pk_bf16_f32 v23, v248, v252
v_cvt_pk_bf16_f32 v39, v249, v253
v_mfma_f32_32x32x16_bf16 v[80:95], v[16:19], a[152:155], 0
v_lshlrev_b32 v242, 16, v224
v_and_b32 v243, 0xffff0000, v224
v_mul_f32 v240, v112, v242
v_mul_f32 v241, v112, v243
v_fma_f32 v240, -v128, v243, v240
v_fma_f32 v241, v128, v242, v241
v_lshlrev_b32 v246, 16, v225
v_and_b32 v247, 0xffff0000, v225
v_mul_f32 v244, v113, v246
v_mul_f32 v245, v113, v247
v_fma_f32 v244, -v129, v247, v244
v_fma_f32 v245, v129, v246, v245
v_cvt_pk_bf16_f32 v24, v240, v244
v_cvt_pk_bf16_f32 v40, v241, v245
v_mfma_f32_32x32x16_bf16 v[96:111], v[32:35], a[152:155], 0
v_lshlrev_b32 v250, 16, v226
v_and_b32 v251, 0xffff0000, v226
v_mul_f32 v248, v114, v250
v_mul_f32 v249, v114, v251
v_fma_f32 v248, -v130, v251, v248
v_fma_f32 v249, v130, v250, v249
v_lshlrev_b32 v254, 16, v227
v_and_b32 v255, 0xffff0000, v227
v_mul_f32 v252, v115, v254
v_mul_f32 v253, v115, v255
v_fma_f32 v252, -v131, v255, v252
v_fma_f32 v253, v131, v254, v253
v_cvt_pk_bf16_f32 v25, v248, v252
v_cvt_pk_bf16_f32 v41, v249, v253
v_mfma_f32_32x32x16_bf16 v[80:95], v[32:35], a[216:219], v[80:95]
v_lshlrev_b32 v242, 16, v228
v_and_b32 v243, 0xffff0000, v228
v_mul_f32 v240, v116, v242
v_mul_f32 v241, v116, v243
v_fma_f32 v240, -v132, v243, v240
v_fma_f32 v241, v132, v242, v241
v_lshlrev_b32 v246, 16, v229
v_and_b32 v247, 0xffff0000, v229
v_mul_f32 v244, v117, v246
v_mul_f32 v245, v117, v247
v_fma_f32 v244, -v133, v247, v244
v_fma_f32 v245, v133, v246, v245
v_cvt_pk_bf16_f32 v26, v240, v244
v_cvt_pk_bf16_f32 v42, v241, v245
v_mfma_f32_32x32x16_bf16 v[96:111], v[16:19], a[184:187], v[96:111]
v_lshlrev_b32 v250, 16, v230
v_and_b32 v251, 0xffff0000, v230
v_mul_f32 v248, v118, v250
v_mul_f32 v249, v118, v251
v_fma_f32 v248, -v134, v251, v248
v_fma_f32 v249, v134, v250, v249
v_lshlrev_b32 v254, 16, v231
v_and_b32 v255, 0xffff0000, v231
v_mul_f32 v252, v119, v254
v_mul_f32 v253, v119, v255
v_fma_f32 v252, -v135, v255, v252
v_fma_f32 v253, v135, v254, v253
v_cvt_pk_bf16_f32 v27, v248, v252
v_cvt_pk_bf16_f32 v43, v249, v253
v_mfma_f32_32x32x16_bf16 v[80:95], v[20:23], a[156:159], v[80:95]
v_lshlrev_b32 v242, 16, v232
v_and_b32 v243, 0xffff0000, v232
v_mul_f32 v240, v120, v242
v_mul_f32 v241, v120, v243
v_fma_f32 v240, -v136, v243, v240
v_fma_f32 v241, v136, v242, v241
v_lshlrev_b32 v246, 16, v233
v_and_b32 v247, 0xffff0000, v233
v_mul_f32 v244, v121, v246
v_mul_f32 v245, v121, v247
v_fma_f32 v244, -v137, v247, v244
v_fma_f32 v245, v137, v246, v245
v_cvt_pk_bf16_f32 v28, v240, v244
v_cvt_pk_bf16_f32 v44, v241, v245
v_mfma_f32_32x32x16_bf16 v[96:111], v[36:39], a[156:159], v[96:111]
v_lshlrev_b32 v250, 16, v234
v_and_b32 v251, 0xffff0000, v234
v_mul_f32 v248, v122, v250
v_mul_f32 v249, v122, v251
v_fma_f32 v248, -v138, v251, v248
v_fma_f32 v249, v138, v250, v249
v_lshlrev_b32 v254, 16, v235
v_and_b32 v255, 0xffff0000, v235
v_mul_f32 v252, v123, v254
v_mul_f32 v253, v123, v255
v_fma_f32 v252, -v139, v255, v252
v_fma_f32 v253, v139, v254, v253
v_cvt_pk_bf16_f32 v29, v248, v252
v_cvt_pk_bf16_f32 v45, v249, v253
v_mfma_f32_32x32x16_bf16 v[80:95], v[36:39], a[220:223], v[80:95]
v_lshlrev_b32 v242, 16, v236
v_and_b32 v243, 0xffff0000, v236
v_mul_f32 v240, v124, v242
v_mul_f32 v241, v124, v243
v_fma_f32 v240, -v140, v243, v240
v_fma_f32 v241, v140, v242, v241
v_lshlrev_b32 v246, 16, v237
v_and_b32 v247, 0xffff0000, v237
v_mul_f32 v244, v125, v246
v_mul_f32 v245, v125, v247
v_fma_f32 v244, -v141, v247, v244
v_fma_f32 v245, v141, v246, v245
v_cvt_pk_bf16_f32 v30, v240, v244
v_cvt_pk_bf16_f32 v46, v241, v245
v_mfma_f32_32x32x16_bf16 v[96:111], v[20:23], a[188:191], v[96:111]
v_lshlrev_b32 v250, 16, v238
v_and_b32 v251, 0xffff0000, v238
v_mul_f32 v248, v126, v250
v_mul_f32 v249, v126, v251
v_fma_f32 v248, -v142, v251, v248
v_fma_f32 v249, v142, v250, v249
v_lshlrev_b32 v254, 16, v239
v_and_b32 v255, 0xffff0000, v239
v_mul_f32 v252, v127, v254
v_mul_f32 v253, v127, v255
v_fma_f32 v252, -v143, v255, v252
v_fma_f32 v253, v143, v254, v253
v_cvt_pk_bf16_f32 v31, v248, v252
v_cvt_pk_bf16_f32 v47, v249, v253
v_mfma_f32_32x32x16_bf16 v[80:95], v[24:27], a[160:163], v[80:95]
v_mfma_f32_32x32x16_bf16 v[96:111], v[40:43], a[160:163], v[96:111]
v_mfma_f32_32x32x16_bf16 v[80:95], v[40:43], a[224:227], v[80:95]
v_mfma_f32_32x32x16_bf16 v[96:111], v[24:27], a[192:195], v[96:111]
v_mfma_f32_32x32x16_bf16 v[80:95], v[28:31], a[164:167], v[80:95]
v_mfma_f32_32x32x16_bf16 v[96:111], v[44:47], a[164:167], v[96:111]
v_mfma_f32_32x32x16_bf16 v[80:95], v[44:47], a[228:231], v[80:95]
v_mfma_f32_32x32x16_bf16 v[96:111], v[28:31], a[196:199], v[96:111]
s_waitcnt lgkmcnt(0)
v_mfma_f32_32x32x16_bf16 v[112:127], v[16:19], a[168:171], 0
v_mfma_f32_32x32x16_bf16 v[128:143], v[32:35], a[168:171], 0
v_mfma_f32_32x32x16_bf16 v[112:127], v[32:35], a[232:235], v[112:127]
v_mfma_f32_32x32x16_bf16 v[128:143], v[16:19], a[200:203], v[128:143]
s_nop 5
v_mul_f32 v240, v80, v144
v_mul_f32 v241, v96, v144
v_fma_f32 v240, -v96, v148, v240
v_fma_f32 v241, v80, v148, v241
v_mul_f32 v244, v81, v145
v_mul_f32 v245, v97, v145
v_mfma_f32_32x32x16_bf16 v[112:127], v[20:23], a[172:175], v[112:127]
v_fma_f32 v244, -v97, v149, v244
v_fma_f32 v245, v81, v149, v245
v_cvt_pk_bf16_f32 v48, v240, v244
v_cvt_pk_bf16_f32 v64, v241, v245
v_mul_f32 v248, v82, v146
v_mul_f32 v249, v98, v146
v_mfma_f32_32x32x16_bf16 v[128:143], v[36:39], a[172:175], v[128:143]
v_fma_f32 v248, -v98, v150, v248
v_fma_f32 v249, v82, v150, v249
v_mul_f32 v252, v83, v147
v_mul_f32 v253, v99, v147
v_fma_f32 v252, -v99, v151, v252
v_fma_f32 v253, v83, v151, v253
v_mfma_f32_32x32x16_bf16 v[112:127], v[36:39], a[236:239], v[112:127]
v_cvt_pk_bf16_f32 v49, v248, v252
v_cvt_pk_bf16_f32 v65, v249, v253
v_mul_f32 v240, v84, v152
v_mul_f32 v241, v100, v152
v_fma_f32 v240, -v100, v156, v240
v_fma_f32 v241, v84, v156, v241
v_mfma_f32_32x32x16_bf16 v[128:143], v[20:23], a[204:207], v[128:143]
v_mul_f32 v244, v85, v153
v_mul_f32 v245, v101, v153
v_fma_f32 v244, -v101, v157, v244
v_fma_f32 v245, v85, v157, v245
v_cvt_pk_bf16_f32 v50, v240, v244
v_cvt_pk_bf16_f32 v66, v241, v245
v_mfma_f32_32x32x16_bf16 v[112:127], v[24:27], a[176:179], v[112:127]
v_mul_f32 v248, v86, v154
v_mul_f32 v249, v102, v154
v_fma_f32 v248, -v102, v158, v248
v_fma_f32 v249, v86, v158, v249
v_mul_f32 v252, v87, v155
v_mul_f32 v253, v103, v155
v_mfma_f32_32x32x16_bf16 v[128:143], v[40:43], a[176:179], v[128:143]
v_fma_f32 v252, -v103, v159, v252
v_fma_f32 v253, v87, v159, v253
v_cvt_pk_bf16_f32 v51, v248, v252
v_cvt_pk_bf16_f32 v67, v249, v253
v_mul_f32 v240, v88, v160
v_mul_f32 v241, v104, v160
v_fma_f32 v240, -v104, v164, v240
v_mfma_f32_32x32x16_bf16 v[112:127], v[40:43], a[240:243], v[112:127]
v_fma_f32 v241, v88, v164, v241
v_mul_f32 v244, v89, v161
v_mul_f32 v245, v105, v161
v_fma_f32 v244, -v105, v165, v244
v_fma_f32 v245, v89, v165, v245
v_cvt_pk_bf16_f32 v52, v240, v244
v_mfma_f32_32x32x16_bf16 v[128:143], v[24:27], a[208:211], v[128:143]
v_cvt_pk_bf16_f32 v68, v241, v245
v_mul_f32 v248, v90, v162
v_mul_f32 v249, v106, v162
v_fma_f32 v248, -v106, v166, v248
v_fma_f32 v249, v90, v166, v249
v_mul_f32 v252, v91, v163
v_mfma_f32_32x32x16_bf16 v[112:127], v[28:31], a[180:183], v[112:127]
v_mul_f32 v253, v107, v163
v_fma_f32 v252, -v107, v167, v252
v_fma_f32 v253, v91, v167, v253
v_cvt_pk_bf16_f32 v53, v248, v252
v_cvt_pk_bf16_f32 v69, v249, v253
v_mul_f32 v240, v92, v168
v_mfma_f32_32x32x16_bf16 v[128:143], v[44:47], a[180:183], v[128:143]
v_mul_f32 v241, v108, v168
v_fma_f32 v240, -v108, v172, v240
v_fma_f32 v241, v92, v172, v241
v_mul_f32 v244, v93, v169
v_mul_f32 v245, v109, v169
v_fma_f32 v244, -v109, v173, v244
v_mfma_f32_32x32x16_bf16 v[112:127], v[44:47], a[244:247], v[112:127]
v_fma_f32 v245, v93, v173, v245
v_cvt_pk_bf16_f32 v54, v240, v244
v_cvt_pk_bf16_f32 v70, v241, v245
v_mul_f32 v248, v94, v170
v_mul_f32 v249, v110, v170
v_fma_f32 v248, -v110, v174, v248
v_mfma_f32_32x32x16_bf16 v[128:143], v[28:31], a[212:215], v[128:143]
v_fma_f32 v249, v94, v174, v249
v_mul_f32 v252, v95, v171
v_mul_f32 v253, v111, v171
v_fma_f32 v252, -v111, v175, v252
v_fma_f32 v253, v95, v175, v253
v_cvt_pk_bf16_f32 v55, v248, v252
v_cvt_pk_bf16_f32 v71, v249, v253
v_mfma_f32_32x32x16_bf16 v[80:95], a[128:131], v[48:51], 0
v_mul_f32 v240, v112, v176
s_nop 2
v_mul_f32 v241, v128, v176
v_fma_f32 v240, -v128, v180, v240
v_fma_f32 v241, v112, v180, v241
v_mul_f32 v244, v113, v177
v_mul_f32 v245, v129, v177
v_fma_f32 v244, -v129, v181, v244
v_fma_f32 v245, v113, v181, v245
v_cvt_pk_bf16_f32 v56, v240, v244
v_cvt_pk_bf16_f32 v72, v241, v245
v_mfma_f32_32x32x16_bf16 v[96:111], a[128:131], v[64:67], 0
v_mul_f32 v248, v114, v178
v_mul_f32 v249, v130, v178
v_fma_f32 v248, -v130, v182, v248
v_fma_f32 v249, v114, v182, v249
v_mul_f32 v252, v115, v179
v_mul_f32 v253, v131, v179
v_fma_f32 v252, -v131, v183, v252
v_fma_f32 v253, v115, v183, v253
v_cvt_pk_bf16_f32 v57, v248, v252
v_cvt_pk_bf16_f32 v73, v249, v253
v_mfma_f32_32x32x16_bf16 v[80:95], a[144:147], v[64:67], v[80:95]
v_mul_f32 v240, v116, v184
v_mul_f32 v241, v132, v184
v_fma_f32 v240, -v132, v188, v240
v_fma_f32 v241, v116, v188, v241
v_mul_f32 v244, v117, v185
v_mul_f32 v245, v133, v185
v_fma_f32 v244, -v133, v189, v244
v_fma_f32 v245, v117, v189, v245
v_cvt_pk_bf16_f32 v58, v240, v244
v_cvt_pk_bf16_f32 v74, v241, v245
v_mfma_f32_32x32x16_bf16 v[96:111], a[136:139], v[48:51], v[96:111]
v_mul_f32 v248, v118, v186
v_mul_f32 v249, v134, v186
v_fma_f32 v248, -v134, v190, v248
v_fma_f32 v249, v118, v190, v249
v_mul_f32 v252, v119, v187
v_mul_f32 v253, v135, v187
v_fma_f32 v252, -v135, v191, v252
v_fma_f32 v253, v119, v191, v253
v_cvt_pk_bf16_f32 v59, v248, v252
v_cvt_pk_bf16_f32 v75, v249, v253
v_mfma_f32_32x32x16_bf16 v[80:95], a[132:135], v[52:55], v[80:95]
v_mul_f32 v240, v120, v192
v_mul_f32 v241, v136, v192
v_fma_f32 v240, -v136, v196, v240
v_fma_f32 v241, v120, v196, v241
v_mul_f32 v244, v121, v193
v_mul_f32 v245, v137, v193
v_fma_f32 v244, -v137, v197, v244
v_fma_f32 v245, v121, v197, v245
v_cvt_pk_bf16_f32 v60, v240, v244
v_cvt_pk_bf16_f32 v76, v241, v245
v_mfma_f32_32x32x16_bf16 v[96:111], a[132:135], v[68:71], v[96:111]
v_mul_f32 v248, v122, v194
v_mul_f32 v249, v138, v194
v_fma_f32 v248, -v138, v198, v248
v_fma_f32 v249, v122, v198, v249
v_mul_f32 v252, v123, v195
v_mul_f32 v253, v139, v195
v_fma_f32 v252, -v139, v199, v252
v_fma_f32 v253, v123, v199, v253
v_cvt_pk_bf16_f32 v61, v248, v252
v_cvt_pk_bf16_f32 v77, v249, v253
v_mfma_f32_32x32x16_bf16 v[80:95], a[148:151], v[68:71], v[80:95]
v_mul_f32 v240, v124, v200
v_mul_f32 v241, v140, v200
v_fma_f32 v240, -v140, v204, v240
v_fma_f32 v241, v124, v204, v241
v_mul_f32 v244, v125, v201
v_mul_f32 v245, v141, v201
v_fma_f32 v244, -v141, v205, v244
v_fma_f32 v245, v125, v205, v245
v_cvt_pk_bf16_f32 v62, v240, v244
v_cvt_pk_bf16_f32 v78, v241, v245
v_mfma_f32_32x32x16_bf16 v[96:111], a[140:143], v[52:55], v[96:111]
v_mul_f32 v248, v126, v202
v_mul_f32 v249, v142, v202
v_fma_f32 v248, -v142, v206, v248
v_fma_f32 v249, v126, v206, v249
v_mul_f32 v252, v127, v203
v_mul_f32 v253, v143, v203
v_fma_f32 v252, -v143, v207, v252
v_fma_f32 v253, v127, v207, v253
v_cvt_pk_bf16_f32 v63, v248, v252
v_cvt_pk_bf16_f32 v79, v249, v253
v_mfma_f32_32x32x16_bf16 v[112:127], a[128:131], v[56:59], 0
v_mfma_f32_32x32x16_bf16 v[128:143], a[128:131], v[72:75], 0
v_mfma_f32_32x32x16_bf16 v[112:127], a[144:147], v[72:75], v[112:127]
v_mfma_f32_32x32x16_bf16 v[128:143], a[136:139], v[56:59], v[128:143]
v_cvt_pk_bf16_f32 v144, v80, v81
v_cvt_pk_bf16_f32 v145, v82, v83
v_cvt_pk_bf16_f32 v146, v84, v85
v_cvt_pk_bf16_f32 v147, v86, v87
v_mfma_f32_32x32x16_bf16 v[112:127], a[132:135], v[60:63], v[112:127]
ds_write_b128 v5, v[144:147] offset:0
v_cvt_pk_bf16_f32 v148, v88, v89
v_cvt_pk_bf16_f32 v149, v90, v91
v_cvt_pk_bf16_f32 v150, v92, v93
v_mfma_f32_32x32x16_bf16 v[128:143], a[132:135], v[76:79], v[128:143]
v_cvt_pk_bf16_f32 v151, v94, v95
ds_write_b128 v5, v[148:151] offset:32
v_cvt_pk_bf16_f32 v152, v96, v97
v_cvt_pk_bf16_f32 v153, v98, v99
v_mfma_f32_32x32x16_bf16 v[112:127], a[148:151], v[76:79], v[112:127]
v_cvt_pk_bf16_f32 v154, v100, v101
v_cvt_pk_bf16_f32 v155, v102, v103
ds_write_b128 v5, v[152:155] offset:4096
v_cvt_pk_bf16_f32 v156, v104, v105
v_mfma_f32_32x32x16_bf16 v[128:143], a[140:143], v[60:63], v[128:143]
v_cvt_pk_bf16_f32 v157, v106, v107
v_cvt_pk_bf16_f32 v158, v108, v109
v_cvt_pk_bf16_f32 v159, v110, v111
ds_write_b128 v5, v[156:159] offset:4128
s_waitcnt lgkmcnt(0)
ds_read_b128 v[16:19], v6 offset:0
ds_read_b128 v[20:23], v6 offset:1024
ds_read_b128 v[24:27], v6 offset:4096
ds_read_b128 v[28:31], v6 offset:5120
v_cvt_pk_bf16_f32 v160, v112, v113
v_cvt_pk_bf16_f32 v161, v114, v115
v_cvt_pk_bf16_f32 v162, v116, v117
v_cvt_pk_bf16_f32 v163, v118, v119
s_waitcnt lgkmcnt(3)
buffer_store_dwordx4 v[16:19], v3, s[40:43], 0 offen offset:0 sc1
s_waitcnt lgkmcnt(2)
buffer_store_dwordx4 v[20:23], v3, s[40:43], 0 offen offset:1024 sc1
s_waitcnt lgkmcnt(1)
buffer_store_dwordx4 v[24:27], v4, s[40:43], 0 offen offset:0 sc1
s_waitcnt lgkmcnt(0)
buffer_store_dwordx4 v[28:31], v4, s[40:43], 0 offen offset:1024 sc1
ds_write_b128 v5, v[160:163] offset:2048
v_cvt_pk_bf16_f32 v164, v120, v121
v_cvt_pk_bf16_f32 v165, v122, v123
v_cvt_pk_bf16_f32 v166, v124, v125
v_cvt_pk_bf16_f32 v167, v126, v127
ds_write_b128 v5, v[164:167] offset:2080
v_cvt_pk_bf16_f32 v168, v128, v129
v_cvt_pk_bf16_f32 v169, v130, v131
v_cvt_pk_bf16_f32 v170, v132, v133
v_cvt_pk_bf16_f32 v171, v134, v135
ds_write_b128 v5, v[168:171] offset:6144
v_cvt_pk_bf16_f32 v172, v136, v137
v_cvt_pk_bf16_f32 v173, v138, v139
v_cvt_pk_bf16_f32 v174, v140, v141
v_cvt_pk_bf16_f32 v175, v142, v143
ds_write_b128 v5, v[172:175] offset:6176
s_waitcnt lgkmcnt(0)
ds_read_b128 v[32:35], v6 offset:2048
ds_read_b128 v[36:39], v6 offset:3072
ds_read_b128 v[40:43], v6 offset:6144
ds_read_b128 v[44:47], v6 offset:7168
s_waitcnt lgkmcnt(3)
buffer_store_dwordx4 v[32:35], v3, s[40:43], 0 offen offset:2048 sc1
s_waitcnt lgkmcnt(2)
buffer_store_dwordx4 v[36:39], v3, s[40:43], 0 offen offset:3072 sc1
s_waitcnt lgkmcnt(1)
buffer_store_dwordx4 v[40:43], v4, s[40:43], 0 offen offset:2048 sc1
s_waitcnt lgkmcnt(0)
buffer_store_dwordx4 v[44:47], v4, s[40:43], 0 offen offset:3072 sc1
v_lshlrev_b32 v1, 4, v0
s_waitcnt vmcnt(0)
s_barrier
v_lshlrev_b32 v2, 7, v0
s_mov_b32 s49, 0xff
s_add_u32 s50, s28, 25165824
s_addc_u32 s51, s29, 0
s_cmp_eq_u32 s3, 0
s_cbranch_scc0 PF
s_mov_b32 exec_lo, s49
s_mov_b32 exec_hi, 0
v_mov_b32 v9, 1
global_atomic_add v2, v9, s[50:51] sc1
s_mov_b64 exec, -1
PF:
buffer_load_dwordx4 a[64:67], v1, s[64:67], s69 offen offset:0
buffer_load_dwordx4 a[68:71], v1, s[64:67], s69 offen offset:1024
buffer_load_dwordx4 a[72:75], v1, s[64:67], s69 offen offset:2048
buffer_load_dwordx4 a[76:79], v1, s[64:67], s69 offen offset:3072
s_add_u32 s69, s69, 4096
s_cmp_eq_u32 s69, s84
s_cselect_b32 s69, s68, s69
buffer_load_dwordx4 a[80:83], v1, s[64:67], s69 offen offset:0
buffer_load_dwordx4 a[84:87], v1, s[64:67], s69 offen offset:1024
buffer_load_dwordx4 a[88:91], v1, s[64:67], s69 offen offset:2048
buffer_load_dwordx4 a[92:95], v1, s[64:67], s69 offen offset:3072
s_add_u32 s69, s69, 4096
s_cmp_eq_u32 s69, s84
s_cselect_b32 s69, s68, s69
buffer_load_dwordx4 a[96:99], v1, s[64:67], s69 offen offset:0
buffer_load_dwordx4 a[100:103], v1, s[64:67], s69 offen offset:1024
buffer_load_dwordx4 a[104:107], v1, s[64:67], s69 offen offset:2048
buffer_load_dwordx4 a[108:111], v1, s[64:67], s69 offen offset:3072
s_add_u32 s69, s69, 4096
s_cmp_eq_u32 s69, s84
s_cselect_b32 s69, s68, s69
buffer_load_dwordx4 a[112:115], v1, s[64:67], s69 offen offset:0
buffer_load_dwordx4 a[116:119], v1, s[64:67], s69 offen offset:1024
buffer_load_dwordx4 a[120:123], v1, s[64:67], s69 offen offset:2048
buffer_load_dwordx4 a[124:127], v1, s[64:67], s69 offen offset:3072
s_add_u32 s69, s69, 4096
s_cmp_eq_u32 s69, s84
s_cselect_b32 s69, s68, s69
buffer_load_dwordx4 a[128:131], v1, s[64:67], s69 offen offset:0
buffer_load_dwordx4 a[132:135], v1, s[64:67], s69 offen offset:1024
buffer_load_dwordx4 a[136:139], v1, s[64:67], s69 offen offset:2048
buffer_load_dwordx4 a[140:143], v1, s[64:67], s69 offen offset:3072
s_add_u32 s69, s69, 4096
s_cmp_eq_u32 s69, s84
s_cselect_b32 s69, s68, s69
buffer_load_dwordx4 a[144:147], v1, s[64:67], s69 offen offset:0
buffer_load_dwordx4 a[148:151], v1, s[64:67], s69 offen offset:1024
buffer_load_dwordx4 a[152:155], v1, s[64:67], s69 offen offset:2048
buffer_load_dwordx4 a[156:159], v1, s[64:67], s69 offen offset:3072
s_add_u32 s69, s69, 4096
s_cmp_eq_u32 s69, s84
s_cselect_b32 s69, s68, s69
s_branch PB
P2I:
s_waitcnt lgkmcnt(0)
s_add_u32 s50, s28, 25165824
s_addc_u32 s51, s29, 0
buffer_load_dwordx4 a[0:3], v1, s[64:67], s69 offen offset:0
buffer_load_dwordx4 a[4:7], v1, s[64:67], s69 offen offset:1024
buffer_load_dwordx4 a[8:11], v1, s[64:67], s69 offen offset:2048
buffer_load_dwordx4 a[12:15], v1, s[64:67], s69 offen offset:3072
s_add_u32 s69, s69, 4096
s_cmp_eq_u32 s69, s84
s_cselect_b32 s69, s68, s69
buffer_load_dwordx4 a[16:19], v1, s[64:67], s69 offen offset:0
buffer_load_dwordx4 a[20:23], v1, s[64:67], s69 offen offset:1024
buffer_load_dwordx4 a[24:27], v1, s[64:67], s69 offen offset:2048
buffer_load_dwordx4 a[28:31], v1, s[64:67], s69 offen offset:3072
s_add_u32 s69, s69, 4096
s_cmp_eq_u32 s69, s84
s_cselect_b32 s69, s68, s69
buffer_load_dwordx4 a[32:35], v1, s[64:67], s69 offen offset:0
buffer_load_dwordx4 a[36:39], v1, s[64:67], s69 offen offset:1024
buffer_load_dwordx4 a[40:43], v1, s[64:67], s69 offen offset:2048
buffer_load_dwordx4 a[44:47], v1, s[64:67], s69 offen offset:3072
s_add_u32 s69, s69, 4096
s_cmp_eq_u32 s69, s84
s_cselect_b32 s69, s68, s69
buffer_load_dwordx4 a[48:51], v1, s[64:67], s69 offen offset:0
buffer_load_dwordx4 a[52:55], v1, s[64:67], s69 offen offset:1024
buffer_load_dwordx4 a[56:59], v1, s[64:67], s69 offen offset:2048
buffer_load_dwordx4 a[60:63], v1, s[64:67], s69 offen offset:3072
s_add_u32 s69, s69, 4096
s_cmp_eq_u32 s69, s84
s_cselect_b32 s69, s68, s69
buffer_load_dwordx4 a[64:67], v1, s[64:67], s69 offen offset:0
buffer_load_dwordx4 a[68:71], v1, s[64:67], s69 offen offset:1024
buffer_load_dwordx4 a[72:75], v1, s[64:67], s69 offen offset:2048
buffer_load_dwordx4 a[76:79], v1, s[64:67], s69 offen offset:3072
s_add_u32 s69, s69, 4096
s_cmp_eq_u32 s69, s84
s_cselect_b32 s69, s68, s69
buffer_load_dwordx4 a[80:83], v1, s[64:67], s69 offen offset:0
buffer_load_dwordx4 a[84:87], v1, s[64:67], s69 offen offset:1024
buffer_load_dwordx4 a[88:91], v1, s[64:67], s69 offen offset:2048
buffer_load_dwordx4 a[92:95], v1, s[64:67], s69 offen offset:3072
s_add_u32 s69, s69, 4096
s_cmp_eq_u32 s69, s84
s_cselect_b32 s69, s68, s69
buffer_load_dwordx4 a[96:99], v1, s[64:67], s69 offen offset:0
buffer_load_dwordx4 a[100:103], v1, s[64:67], s69 offen offset:1024
buffer_load_dwordx4 a[104:107], v1, s[64:67], s69 offen offset:2048
buffer_load_dwordx4 a[108:111], v1, s[64:67], s69 offen offset:3072
s_add_u32 s69, s69, 4096
s_cmp_eq_u32 s69, s84
s_cselect_b32 s69, s68, s69
buffer_load_dwordx4 a[112:115], v1, s[64:67], s69 offen offset:0
buffer_load_dwordx4 a[116:119], v1, s[64:67], s69 offen offset:1024
buffer_load_dwordx4 a[120:123], v1, s[64:67], s69 offen offset:2048
buffer_load_dwordx4 a[124:127], v1, s[64:67], s69 offen offset:3072
s_add_u32 s69, s69, 4096
s_cmp_eq_u32 s69, s84
s_cselect_b32 s69, s68, s69
buffer_load_dwordx4 a[128:131], v1, s[64:67], s69 offen offset:0
buffer_load_dwordx4 a[132:135], v1, s[64:67], s69 offen offset:1024
buffer_load_dwordx4 a[136:139], v1, s[64:67], s69 offen offset:2048
buffer_load_dwordx4 a[140:143], v1, s[64:67], s69 offen offset:3072
s_add_u32 s69, s69, 4096
s_cmp_eq_u32 s69, s84
s_cselect_b32 s69, s68, s69
buffer_load_dwordx4 a[144:147], v1, s[64:67], s69 offen offset:0
buffer_load_dwordx4 a[148:151], v1, s[64:67], s69 offen offset:1024
buffer_load_dwordx4 a[152:155], v1, s[64:67], s69 offen offset:2048
buffer_load_dwordx4 a[156:159], v1, s[64:67], s69 offen offset:3072
s_add_u32 s69, s69, 4096
s_cmp_eq_u32 s69, s84
s_cselect_b32 s69, s68, s69
PB:
s_lshl_b32 s6, s4, 3
s_and_b32 s7, s5, 7
s_add_u32 s6, s6, s7
s_add_u32 s7, s63, s3
s_add_u32 s30, s63, 4
s_mul_i32 s48, s3, 10
s_add_u32 s47, s62, s48
s_add_u32 s32, s28, 13631488
s_addc_u32 s33, s29, 0
s_mov_b32 s34, 2621440
s_mov_b32 s35, 0x20000
s_mov_b32 s40, s8
s_mov_b32 s41, s9
s_mov_b32 s42, 2621440
s_mov_b32 s43, 0x20000
s_getpc_b64 s[36:37]
s_add_u32 s36, s36, TABG@rel32@lo+4
s_addc_u32 s37, s37, TABG@rel32@hi+12
s_mov_b32 s38, 819200
s_mov_b32 s39, 0x20000
s_add_u32 s52, s28, 16777216
s_addc_u32 s53, s29, 0
s_mov_b32 s54, 5242880
s_mov_b32 s55, 0x20000
s_mov_b32 s56, s22
s_mov_b32 s57, s23
s_mov_b32 s58, 1280
s_mov_b32 s59, 0x20000
s_mov_b32 s68, 52429
s_lshl_b32 s69, s63, 6
s_add_u32 s48, s3, 0
s_min_u32 s48, s48, 9
s_lshl_b32 s48, s48, 10
v_add_u32 v8, s48, v1
v_add_u32 v136, 73728, v8
v_lshrrev_b32 v9, 6, v8
v_mul_lo_u32 v9, v9, s68
v_lshrrev_b32 v9, 18, v9
v_mul_u32_u24 v10, 320, v9
v_sub_u32 v8, v8, v10
v_and_b32 v10, 19, v9
v_and_b32 v11, 4, v9
v_lshl_or_b32 v10, v11, 1, v10
v_and_b32 v11, 8, v9
v_lshrrev_b32 v11, 1, v11
v_or_b32 v10, v10, v11
v_lshlrev_b32 v10, 6, v10
v_add_u32 v10, s6, v10
v_mul_u32_u24 v10, 1280, v10
v_add3_u32 v12, v10, v8, s69
s_add_u32 s48, s3, 4
s_min_u32 s48, s48, 9
s_lshl_b32 s48, s48, 10
v_add_u32 v8, s48, v1
v_add_u32 v137, 73728, v8
v_lshrrev_b32 v9, 6, v8
v_mul_lo_u32 v9, v9, s68
v_lshrrev_b32 v9, 18, v9
v_mul_u32_u24 v10, 320, v9
v_sub_u32 v8, v8, v10
v_and_b32 v10, 19, v9
v_and_b32 v11, 4, v9
v_lshl_or_b32 v10, v11, 1, v10
v_and_b32 v11, 8, v9
v_lshrrev_b32 v11, 1, v11
v_or_b32 v10, v10, v11
v_lshlrev_b32 v10, 6, v10
v_add_u32 v10, s6, v10
v_mul_u32_u24 v10, 1280, v10
v_add3_u32 v13, v10, v8, s69
s_add_u32 s48, s3, 8
s_min_u32 s48, s48, 9
s_lshl_b32 s48, s48, 10
v_add_u32 v8, s48, v1
v_add_u32 v138, 73728, v8
v_lshrrev_b32 v9, 6, v8
v_mul_lo_u32 v9, v9, s68
v_lshrrev_b32 v9, 18, v9
v_mul_u32_u24 v10, 320, v9
v_sub_u32 v8, v8, v10
v_and_b32 v10, 19, v9
v_and_b32 v11, 4, v9
v_lshl_or_b32 v10, v11, 1, v10
v_and_b32 v11, 8, v9
v_lshrrev_b32 v11, 1, v11
v_or_b32 v10, v10, v11
v_lshlrev_b32 v10, 6, v10
v_add_u32 v10, s6, v10
v_mul_u32_u24 v10, 1280, v10
v_add3_u32 v14, v10, v8, s69
v_lshrrev_b32 v5, 5, v0
v_lshlrev_b32 v5, 4, v5
v_and_b32 v4, 31, v0
v_mul_u32_u24 v4, 320, v4
v_add_u32 v4, v4, v5
v_add_u32 v4, 73728, v4
s_lshr_b32 s48, s3, 1
s_lshl_b32 s48, s48, 5
s_and_b32 s49, s3, 1
s_lshl_b32 s49, s49, 3
s_add_u32 s48, s48, s49
s_add_u32 s31, s48, 256
v_add_u32 v139, s31, v4
s_add_u32 s31, s31, s69
v_add_u32 v140, s31, v5
s_lshl_b32 s31, s3, 6
v_add_u32 v4, s31, v4
s_lshl_b32 s31, s7, 6
v_add_u32 v5, s31, v5
s_lshr_b32 s48, s3, 1
s_lshl_b32 s48, s48, 10
s_add_u32 s48, s48, s49
v_add_u32 v141, s48, v1
s_mul_i32 s67, s6, 20
s_add_u32 s30, s67, s30
s_lshl_b32 s30, s30, 11
s_add_u32 s67, s67, s7
s_lshl_b32 s67, s67, 11
s_add_u32 s66, s67, 64*20*2048
s_add_u32 s31, s30, 64*20*2048
v_lshrrev_b32 v2, 2, v0
v_lshlrev_b32 v2, 12, v2
v_and_b32 v3, 3, v0
v_lshl_add_u32 v2, v3, 4, v2
v_lshrrev_b32 v6, 5, v0
v_lshlrev_b32 v6, 3, v6
v_bfe_u32 v7, v0, 2, 2
v_add_u32 v6, v6, v7
v_lshlrev_b32 v6, 6, v6
v_bfe_u32 v7, v0, 4, 1
v_lshl_add_u32 v6, v7, 5, v6
v_lshl_add_u32 v6, v3, 3, v6
s_mul_i32 s48, s3, 10240
v_add_u32 v15, s48, v6
s_lshl_b32 s48, s3, 12
s_add_u32 s48, s48, 73728
v_add_u32 v142, s48, v1
s_lshl_b32 s48, s3, 10
s_add_u32 s48, s48, 73728
v_add_u32 v143, s48, v1
s_lshl_b32 s49, s4, 7
s_cmp_eq_u32 s3, 0
s_cbranch_scc0 PAW
v_mov_b32 v8, s49
s_mov_b64 exec, 1
s_mov_b32 s48, 30000
PAL:
global_load_dword v10, v8, s[50:51] sc1
s_waitcnt vmcnt(0)
v_cmp_gt_u32 vcc, 81, v10
s_sub_u32 s48, s48, 1
s_cbranch_scc1 PAO
s_cbranch_vccnz PAL
PAO:
s_mov_b64 exec, -1
PAW:
s_waitcnt vmcnt(0)
s_barrier
s_cmp_lt_u32 s2, 160
s_cbranch_scc0 PG
s_lshl_b32 s48, s61, 7
s_add_u32 s48, s48, 1024
v_mov_b32 v8, s48
s_mov_b32 s49, 1
s_add_u32 s50, s28, 25165824
s_addc_u32 s51, s29, 0
s_cmp_eq_u32 s3, 0
s_cbranch_scc0 PG
s_mov_b32 exec_lo, s49
s_mov_b32 exec_hi, 0
v_mov_b32 v9, 1
global_atomic_add v8, v9, s[50:51] sc1
s_mov_b64 exec, -1
PG:
s_add_u32 s63, s62, s3
s_lshl_b32 s49, s3, 10
s_lshl_b32 s46, s6, 6
s_cmp_ge_u32 s63, 40
s_cselect_b32 s48, 40, 0
s_sub_u32 s63, s63, s48
s_lshl_b32 s48, s63, 16
s_add_u32 s48, s48, s46
s_add_u32 m0, s49, 0
s_nop 0
buffer_load_dwordx4 v2, s[32:35], s48 offen lds
s_add_u32 s63, s63, 4
s_cmp_ge_u32 s63, 40
s_cselect_b32 s48, 40, 0
s_sub_u32 s63, s63, s48
s_lshl_b32 s48, s63, 16
s_add_u32 s48, s48, s46
s_add_u32 m0, s49, 4096
s_nop 0
buffer_load_dwordx4 v2, s[32:35], s48 offen lds
s_add_u32 s63, s63, 4
s_cmp_ge_u32 s63, 40
s_cselect_b32 s48, 40, 0
s_sub_u32 s63, s63, s48
s_lshl_b32 s48, s63, 16
s_add_u32 s48, s48, s46
s_add_u32 m0, s49, 8192
s_nop 0
buffer_load_dwordx4 v2, s[32:35], s48 offen lds
s_add_u32 s63, s63, 4
s_cmp_ge_u32 s63, 40
s_cselect_b32 s48, 40, 0
s_sub_u32 s63, s63, s48
s_lshl_b32 s48, s63, 16
s_add_u32 s48, s48, s46
s_add_u32 m0, s49, 12288
s_nop 0
buffer_load_dwordx4 v2, s[32:35], s48 offen lds
s_add_u32 s63, s63, 4
s_cmp_ge_u32 s63, 40
s_cselect_b32 s48, 40, 0
s_sub_u32 s63, s63, s48
s_lshl_b32 s48, s63, 16
s_add_u32 s48, s48, s46
s_add_u32 m0, s49, 16384
s_nop 0
buffer_load_dwordx4 v2, s[32:35], s48 offen lds
s_add_u32 s63, s63, 4
s_cmp_ge_u32 s63, 40
s_cselect_b32 s48, 40, 0
s_sub_u32 s63, s63, s48
s_lshl_b32 s48, s63, 16
s_add_u32 s48, s48, s46
s_add_u32 m0, s49, 20480
s_nop 0
buffer_load_dwordx4 v2, s[32:35], s48 offen lds
s_add_u32 s63, s63, 4
s_cmp_ge_u32 s63, 40
s_cselect_b32 s48, 40, 0
s_sub_u32 s63, s63, s48
s_lshl_b32 s48, s63, 16
s_add_u32 s48, s48, s46
s_add_u32 m0, s49, 24576
s_nop 0
buffer_load_dwordx4 v2, s[32:35], s48 offen lds
s_add_u32 s63, s63, 4
s_cmp_ge_u32 s63, 40
s_cselect_b32 s48, 40, 0
s_sub_u32 s63, s63, s48
s_lshl_b32 s48, s63, 16
s_add_u32 s48, s48, s46
s_add_u32 m0, s49, 28672
s_nop 0
buffer_load_dwordx4 v2, s[32:35], s48 offen lds
s_add_u32 s63, s63, 4
s_cmp_ge_u32 s63, 40
s_cselect_b32 s48, 40, 0
s_sub_u32 s63, s63, s48
s_lshl_b32 s48, s63, 16
s_add_u32 s48, s48, s46
s_add_u32 m0, s49, 32768
s_nop 0
buffer_load_dwordx4 v2, s[32:35], s48 offen lds
s_add_u32 s63, s63, 4
s_cmp_ge_u32 s63, 40
s_cselect_b32 s48, 40, 0
s_sub_u32 s63, s63, s48
s_lshl_b32 s48, s63, 16
s_add_u32 s48, s48, s46
s_add_u32 m0, s49, 36864
s_nop 0
buffer_load_dwordx4 v2, s[32:35], s48 offen lds
s_add_u32 s63, s63, 4
s_mov_b32 s65, s47
s_lshr_b32 s69, s5, 3
s_mul_i32 s69, s69, 5*40960
s_add_u32 s69, s69, 4*40960
s_cmp_ge_u32 s65, 40
s_cselect_b32 s48, 40, 0
s_sub_u32 s65, s65, s48
s_lshl_b32 s48, s65, 10
s_add_u32 s48, s48, s69
buffer_load_dwordx4 a[160:163], v1, s[36:39], s48 offen
s_add_u32 s65, s65, 1
s_cmp_ge_u32 s65, 40
s_cselect_b32 s48, 40, 0
s_sub_u32 s65, s65, s48
s_lshl_b32 s48, s65, 10
s_add_u32 s48, s48, s69
buffer_load_dwordx4 a[164:167], v1, s[36:39], s48 offen
s_add_u32 s65, s65, 1
s_cmp_ge_u32 s65, 40
s_cselect_b32 s48, 40, 0
s_sub_u32 s65, s65, s48
s_lshl_b32 s48, s65, 10
s_add_u32 s48, s48, s69
buffer_load_dwordx4 a[168:171], v1, s[36:39], s48 offen
s_add_u32 s65, s65, 1
s_cmp_ge_u32 s65, 40
s_cselect_b32 s48, 40, 0
s_sub_u32 s65, s65, s48
s_lshl_b32 s48, s65, 10
s_add_u32 s48, s48, s69
buffer_load_dwordx4 a[172:175], v1, s[36:39], s48 offen
s_add_u32 s65, s65, 1
s_cmp_ge_u32 s65, 40
s_cselect_b32 s48, 40, 0
s_sub_u32 s65, s65, s48
s_lshl_b32 s48, s65, 10
s_add_u32 s48, s48, s69
buffer_load_dwordx4 a[176:179], v1, s[36:39], s48 offen
s_add_u32 s65, s65, 1
s_cmp_ge_u32 s65, 40
s_cselect_b32 s48, 40, 0
s_sub_u32 s65, s65, s48
s_lshl_b32 s48, s65, 10
s_add_u32 s48, s48, s69
buffer_load_dwordx4 a[180:183], v1, s[36:39], s48 offen
s_add_u32 s65, s65, 1
s_cmp_ge_u32 s65, 40
s_cselect_b32 s48, 40, 0
s_sub_u32 s65, s65, s48
s_lshl_b32 s48, s65, 10
s_add_u32 s48, s48, s69
buffer_load_dwordx4 a[184:187], v1, s[36:39], s48 offen
s_add_u32 s65, s65, 1
s_cmp_ge_u32 s65, 40
s_cselect_b32 s48, 40, 0
s_sub_u32 s65, s65, s48
s_lshl_b32 s48, s65, 10
s_add_u32 s48, s48, s69
buffer_load_dwordx4 a[188:191], v1, s[36:39], s48 offen
s_add_u32 s65, s65, 1
s_cmp_ge_u32 s65, 40
s_cselect_b32 s48, 40, 0
s_sub_u32 s65, s65, s48
s_lshl_b32 s48, s65, 10
s_add_u32 s48, s48, s69
buffer_load_dwordx4 a[192:195], v1, s[36:39], s48 offen
s_add_u32 s65, s65, 1
s_cmp_ge_u32 s65, 40
s_cselect_b32 s48, 40, 0
s_sub_u32 s65, s65, s48
s_lshl_b32 s48, s65, 10
s_add_u32 s48, s48, s69
buffer_load_dwordx4 a[196:199], v1, s[36:39], s48 offen
s_add_u32 s65, s65, 1
s_add_u32 s48, s3, 0
s_min_u32 s48, s48, 9
s_lshl_b32 s48, s48, 10
s_add_u32 m0, s48, 73728
s_nop 0
buffer_load_dwordx4 v12, s[40:43], 0 offen lds
s_add_u32 s48, s3, 4
s_min_u32 s48, s48, 9
s_lshl_b32 s48, s48, 10
s_add_u32 m0, s48, 73728
s_nop 0
buffer_load_dwordx4 v13, s[40:43], 0 offen lds
s_add_u32 s48, s3, 8
s_min_u32 s48, s48, 9
s_lshl_b32 s48, s48, 10
s_add_u32 m0, s48, 73728
s_nop 0
buffer_load_dwordx4 v14, s[40:43], 0 offen lds
buffer_load_dwordx4 v[56:59], v5, s[56:59], 0 offen offset:0
buffer_load_dwordx4 v[60:63], v5, s[56:59], 0 offen offset:32
buffer_load_dwordx2 v[130:131], v140, s[56:59], 0 offen
s_mov_b32 s44, s24
s_mov_b32 s45, s25
s_mov_b32 s46, 2621440
s_mov_b32 s47, 0x20000
s_waitcnt vmcnt(21)
s_barrier
ds_read_b64_tr_b16 v[80:81], v6 offset:0
ds_read_b64_tr_b16 v[82:83], v6 offset:256
ds_read_b64_tr_b16 v[84:85], v6 offset:1024
ds_read_b64_tr_b16 v[86:87], v6 offset:1280
ds_read_b64_tr_b16 v[88:89], v6 offset:2048
ds_read_b64_tr_b16 v[90:91], v6 offset:2304
ds_read_b64_tr_b16 v[92:93], v6 offset:3072
ds_read_b64_tr_b16 v[94:95], v6 offset:3328
s_waitcnt lgkmcnt(6)
v_mfma_f32_32x32x16_bf16 v[16:31], a[0:3], v[80:83], 0
ds_read_b64_tr_b16 v[80:81], v6 offset:4096
ds_read_b64_tr_b16 v[82:83], v6 offset:4352
s_waitcnt lgkmcnt(6)
v_mfma_f32_32x32x16_bf16 v[160:175], a[4:7], v[84:87], 0
ds_read_b64_tr_b16 v[84:85], v6 offset:5120
ds_read_b64_tr_b16 v[86:87], v6 offset:5376
s_waitcnt lgkmcnt(6)
v_mfma_f32_32x32x16_bf16 v[16:31], a[8:11], v[88:91], v[16:31]
ds_read_b64_tr_b16 v[88:89], v6 offset:6144
ds_read_b64_tr_b16 v[90:91], v6 offset:6400
s_waitcnt lgkmcnt(6)
v_mfma_f32_32x32x16_bf16 v[160:175], a[12:15], v[92:95], v[160:175]
ds_read_b64_tr_b16 v[92:93], v6 offset:7168
ds_read_b64_tr_b16 v[94:95], v6 offset:7424
s_waitcnt lgkmcnt(6)
v_mfma_f32_32x32x16_bf16 v[16:31], a[16:19], v[80:83], v[16:31]
ds_read_b64_tr_b16 v[80:81], v6 offset:8192
ds_read_b64_tr_b16 v[82:83], v6 offset:8448
s_waitcnt lgkmcnt(6)
v_mfma_f32_32x32x16_bf16 v[160:175], a[20:23], v[84:87], v[160:175]
ds_read_b64_tr_b16 v[84:85], v6 offset:9216
ds_read_b64_tr_b16 v[86:87], v6 offset:9472
s_waitcnt lgkmcnt(6)
v_mfma_f32_32x32x16_bf16 v[16:31], a[24:27], v[88:91], v[16:31]
ds_read_b64_tr_b16 v[88:89], v6 offset:10240
ds_read_b64_tr_b16 v[90:91], v6 offset:10496
s_waitcnt lgkmcnt(6)
v_mfma_f32_32x32x16_bf16 v[160:175], a[28:31], v[92:95], v[160:175]
ds_read_b64_tr_b16 v[92:93], v6 offset:11264
ds_read_b64_tr_b16 v[94:95], v6 offset:11520
s_waitcnt lgkmcnt(6)
v_mfma_f32_32x32x16_bf16 v[16:31], a[32:35], v[80:83], v[16:31]
ds_read_b64_tr_b16 v[80:81], v6 offset:12288
ds_read_b64_tr_b16 v[82:83], v6 offset:12544
s_waitcnt lgkmcnt(6)
v_mfma_f32_32x32x16_bf16 v[160:175], a[36:39], v[84:87], v[160:175]
ds_read_b64_tr_b16 v[84:85], v6 offset:13312
ds_read_b64_tr_b16 v[86:87], v6 offset:13568
s_waitcnt lgkmcnt(6)
v_mfma_f32_32x32x16_bf16 v[16:31], a[40:43], v[88:91], v[16:31]
ds_read_b64_tr_b16 v[88:89], v6 offset:14336
ds_read_b64_tr_b16 v[90:91], v6 offset:14592
s_waitcnt lgkmcnt(6)
v_mfma_f32_32x32x16_bf16 v[160:175], a[44:47], v[92:95], v[160:175]
ds_read_b64_tr_b16 v[92:93], v6 offset:15360
ds_read_b64_tr_b16 v[94:95], v6 offset:15616
s_waitcnt lgkmcnt(6)
v_mfma_f32_32x32x16_bf16 v[16:31], a[48:51], v[80:83], v[16:31]
ds_read_b64_tr_b16 v[80:81], v6 offset:16384
ds_read_b64_tr_b16 v[82:83], v6 offset:16640
s_waitcnt lgkmcnt(6)
v_mfma_f32_32x32x16_bf16 v[160:175], a[52:55], v[84:87], v[160:175]
ds_read_b64_tr_b16 v[84:85], v6 offset:17408
ds_read_b64_tr_b16 v[86:87], v6 offset:17664
s_waitcnt lgkmcnt(6)
v_mfma_f32_32x32x16_bf16 v[16:31], a[56:59], v[88:91], v[16:31]
ds_read_b64_tr_b16 v[88:89], v6 offset:18432
ds_read_b64_tr_b16 v[90:91], v6 offset:18688
s_waitcnt lgkmcnt(6)
v_mfma_f32_32x32x16_bf16 v[160:175], a[60:63], v[92:95], v[160:175]
ds_read_b64_tr_b16 v[92:93], v6 offset:19456
ds_read_b64_tr_b16 v[94:95], v6 offset:19712
s_waitcnt lgkmcnt(6)
v_mfma_f32_32x32x16_bf16 v[16:31], a[64:67], v[80:83], v[16:31]
s_lshr_b32 s49, s6, 2
s_lshl_b32 s49, s49, 7
s_add_u32 s49, s49, 1024
s_cmp_eq_u32 s3, 0
s_cbranch_scc0 PCW
v_mov_b32 v8, s49
s_mov_b64 exec, 1
s_mov_b32 s48, 30000
PCL:
global_load_dword v10, v8, s[50:51] sc1
s_waitcnt vmcnt(0)
v_cmp_gt_u32 vcc, 10, v10
s_sub_u32 s48, s48, 1
s_cbranch_scc1 PCO
s_cbranch_vccnz PCL
PCO:
s_mov_b64 exec, -1
PCW:
s_waitcnt vmcnt(0)
s_barrier
buffer_load_dwordx4 v[64:67], v1, s[52:55], s67 offen offset:0
buffer_load_dwordx4 v[72:75], v1, s[52:55], s66 offen offset:0
buffer_load_dwordx4 v[68:71], v1, s[52:55], s67 offen offset:1024
buffer_load_dwordx4 v[76:79], v1, s[52:55], s66 offen offset:1024
buffer_load_dwordx2 v[132:133], v141, s[52:55], s30 offen
buffer_load_dwordx2 v[134:135], v141, s[52:55], s31 offen
ds_read_b64_tr_b16 v[80:81], v6 offset:20480
ds_read_b64_tr_b16 v[82:83], v6 offset:20736
s_waitcnt lgkmcnt(6)
v_mfma_f32_32x32x16_bf16 v[160:175], a[68:71], v[84:87], v[160:175]
ds_read_b64_tr_b16 v[84:85], v15 offset:0
ds_read_b64_tr_b16 v[86:87], v15 offset:256
s_waitcnt lgkmcnt(6)
v_mfma_f32_32x32x16_bf16 v[16:31], a[72:75], v[88:91], v[16:31]
ds_read_b64_tr_b16 v[88:89], v6 offset:21504
ds_read_b64_tr_b16 v[90:91], v6 offset:21760
s_waitcnt lgkmcnt(6)
v_mfma_f32_32x32x16_bf16 v[160:175], a[76:79], v[92:95], v[160:175]
ds_read_b64_tr_b16 v[92:93], v6 offset:22528
ds_read_b64_tr_b16 v[94:95], v6 offset:22784
s_waitcnt lgkmcnt(6)
v_mfma_f32_32x32x16_bf16 v[16:31], a[80:83], v[80:83], v[16:31]
ds_read_b64_tr_b16 v[80:81], v15 offset:1024
ds_read_b64_tr_b16 v[82:83], v15 offset:1280
s_waitcnt lgkmcnt(6)
v_mfma_f32_32x32x16_bf16 v[96:111], a[160:163], v[84:87], 0
ds_read_b64_tr_b16 v[84:85], v6 offset:23552
ds_read_b64_tr_b16 v[86:87], v6 offset:23808
s_waitcnt lgkmcnt(6)
v_mfma_f32_32x32x16_bf16 v[160:175], a[84:87], v[88:91], v[160:175]
ds_read_b64_tr_b16 v[88:89], v6 offset:24576
ds_read_b64_tr_b16 v[90:91], v6 offset:24832
s_waitcnt lgkmcnt(6)
v_mfma_f32_32x32x16_bf16 v[16:31], a[88:91], v[92:95], v[16:31]
ds_read_b64_tr_b16 v[92:93], v15 offset:2048
ds_read_b64_tr_b16 v[94:95], v15 offset:2304
s_waitcnt lgkmcnt(6)
v_mfma_f32_32x32x16_bf16 v[96:111], a[164:167], v[80:83], v[96:111]
ds_read_b64_tr_b16 v[80:81], v6 offset:25600
ds_read_b64_tr_b16 v[82:83], v6 offset:25856
s_waitcnt lgkmcnt(6)
v_mfma_f32_32x32x16_bf16 v[160:175], a[92:95], v[84:87], v[160:175]
ds_read_b64_tr_b16 v[84:85], v6 offset:26624
ds_read_b64_tr_b16 v[86:87], v6 offset:26880
s_waitcnt lgkmcnt(6)
v_mfma_f32_32x32x16_bf16 v[16:31], a[96:99], v[88:91], v[16:31]
ds_read_b64_tr_b16 v[88:89], v15 offset:3072
ds_read_b64_tr_b16 v[90:91], v15 offset:3328
s_waitcnt lgkmcnt(6)
v_mfma_f32_32x32x16_bf16 v[96:111], a[168:171], v[92:95], v[96:111]
ds_read_b64_tr_b16 v[92:93], v6 offset:27648
ds_read_b64_tr_b16 v[94:95], v6 offset:27904
s_waitcnt lgkmcnt(6)
v_mfma_f32_32x32x16_bf16 v[160:175], a[100:103], v[80:83], v[160:175]
ds_read_b64_tr_b16 v[80:81], v6 offset:28672
ds_read_b64_tr_b16 v[82:83], v6 offset:28928
s_waitcnt lgkmcnt(6)
v_mfma_f32_32x32x16_bf16 v[16:31], a[104:107], v[84:87], v[16:31]
ds_read_b64_tr_b16 v[84:85], v15 offset:4096
ds_read_b64_tr_b16 v[86:87], v15 offset:4352
s_waitcnt lgkmcnt(6)
v_mfma_f32_32x32x16_bf16 v[96:111], a[172:175], v[88:91], v[96:111]
ds_read_b64_tr_b16 v[88:89], v6 offset:29696
ds_read_b64_tr_b16 v[90:91], v6 offset:29952
s_waitcnt lgkmcnt(6)
v_mfma_f32_32x32x16_bf16 v[160:175], a[108:111], v[92:95], v[160:175]
ds_read_b64_tr_b16 v[92:93], v6 offset:30720
ds_read_b64_tr_b16 v[94:95], v6 offset:30976
s_waitcnt lgkmcnt(6)
v_mfma_f32_32x32x16_bf16 v[16:31], a[112:115], v[80:83], v[16:31]
ds_read_b64_tr_b16 v[80:81], v15 offset:5120
ds_read_b64_tr_b16 v[82:83], v15 offset:5376
s_waitcnt lgkmcnt(6)
v_mfma_f32_32x32x16_bf16 v[96:111], a[176:179], v[84:87], v[96:111]
ds_read_b64_tr_b16 v[84:85], v6 offset:31744
ds_read_b64_tr_b16 v[86:87], v6 offset:32000
s_waitcnt lgkmcnt(6)
v_mfma_f32_32x32x16_bf16 v[160:175], a[116:119], v[88:91], v[160:175]
ds_read_b64_tr_b16 v[88:89], v6 offset:32768
ds_read_b64_tr_b16 v[90:91], v6 offset:33024
s_waitcnt lgkmcnt(6)
v_mfma_f32_32x32x16_bf16 v[16:31], a[120:123], v[92:95], v[16:31]
ds_read_b64_tr_b16 v[92:93], v15 offset:6144
ds_read_b64_tr_b16 v[94:95], v15 offset:6400
s_waitcnt lgkmcnt(6)
v_mfma_f32_32x32x16_bf16 v[96:111], a[180:183], v[80:83], v[96:111]
ds_read_b64_tr_b16 v[80:81], v6 offset:33792
ds_read_b64_tr_b16 v[82:83], v6 offset:34048
s_waitcnt lgkmcnt(6)
v_mfma_f32_32x32x16_bf16 v[160:175], a[124:127], v[84:87], v[160:175]
ds_read_b64_tr_b16 v[84:85], v6 offset:34816
ds_read_b64_tr_b16 v[86:87], v6 offset:35072
s_waitcnt lgkmcnt(6)
v_mfma_f32_32x32x16_bf16 v[16:31], a[128:131], v[88:91], v[16:31]
ds_read_b64_tr_b16 v[88:89], v15 offset:7168
ds_read_b64_tr_b16 v[90:91], v15 offset:7424
s_waitcnt lgkmcnt(6)
v_mfma_f32_32x32x16_bf16 v[96:111], a[184:187], v[92:95], v[96:111]
ds_read_b64_tr_b16 v[92:93], v6 offset:35840
ds_read_b64_tr_b16 v[94:95], v6 offset:36096
s_waitcnt lgkmcnt(6)
v_mfma_f32_32x32x16_bf16 v[160:175], a[132:135], v[80:83], v[160:175]
ds_read_b64_tr_b16 v[80:81], v6 offset:36864
ds_read_b64_tr_b16 v[82:83], v6 offset:37120
s_waitcnt lgkmcnt(6)
v_mfma_f32_32x32x16_bf16 v[16:31], a[136:139], v[84:87], v[16:31]
ds_read_b64_tr_b16 v[84:85], v15 offset:8192
ds_read_b64_tr_b16 v[86:87], v15 offset:8448
s_waitcnt lgkmcnt(6)
v_mfma_f32_32x32x16_bf16 v[96:111], a[188:191], v[88:91], v[96:111]
ds_read_b64_tr_b16 v[88:89], v6 offset:37888
ds_read_b64_tr_b16 v[90:91], v6 offset:38144
s_waitcnt lgkmcnt(6)
v_mfma_f32_32x32x16_bf16 v[160:175], a[140:143], v[92:95], v[160:175]
ds_read_b64_tr_b16 v[92:93], v6 offset:38912
ds_read_b64_tr_b16 v[94:95], v6 offset:39168
s_waitcnt lgkmcnt(6)
v_mfma_f32_32x32x16_bf16 v[16:31], a[144:147], v[80:83], v[16:31]
ds_read_b64_tr_b16 v[80:81], v15 offset:9216
ds_read_b64_tr_b16 v[82:83], v15 offset:9472
s_waitcnt lgkmcnt(6)
v_mfma_f32_32x32x16_bf16 v[96:111], a[192:195], v[84:87], v[96:111]
ds_read_b64_tr_b16 v[84:85], v6 offset:39936
ds_read_b64_tr_b16 v[86:87], v6 offset:40192
s_waitcnt lgkmcnt(6)
v_mfma_f32_32x32x16_bf16 v[160:175], a[148:151], v[88:91], v[160:175]
s_waitcnt lgkmcnt(4)
v_mfma_f32_32x32x16_bf16 v[16:31], a[152:155], v[92:95], v[16:31]
s_waitcnt lgkmcnt(2)
v_mfma_f32_32x32x16_bf16 v[96:111], a[196:199], v[80:83], v[96:111]
s_waitcnt lgkmcnt(0)
v_mfma_f32_32x32x16_bf16 v[160:175], a[156:159], v[84:87], v[160:175]
s_waitcnt vmcnt(6)
v_lshlrev_b32 v32, 16, v56
v_and_b32 v33, 0xffff0000, v56
v_lshlrev_b32 v34, 16, v57
v_and_b32 v35, 0xffff0000, v57
v_lshlrev_b32 v36, 16, v58
v_and_b32 v37, 0xffff0000, v58
v_lshlrev_b32 v38, 16, v59
v_and_b32 v39, 0xffff0000, v59
v_lshlrev_b32 v40, 16, v60
v_and_b32 v41, 0xffff0000, v60
v_lshlrev_b32 v42, 16, v61
v_and_b32 v43, 0xffff0000, v61
v_lshlrev_b32 v44, 16, v62
v_and_b32 v45, 0xffff0000, v62
v_lshlrev_b32 v46, 16, v63
v_and_b32 v47, 0xffff0000, v63
v_lshlrev_b32 v144, 16, v130
v_and_b32 v145, 0xffff0000, v130
v_lshlrev_b32 v146, 16, v131
v_and_b32 v147, 0xffff0000, v131
ds_write_b128 v142, v[96:99] offset:11264
ds_write_b128 v142, v[100:103] offset:12288
ds_write_b128 v142, v[104:107] offset:13312
ds_write_b128 v142, v[108:111] offset:14336
s_waitcnt lgkmcnt(0)
s_barrier
ds_read_b128 v[48:51], v4 offset:0
ds_read_b128 v[52:55], v4 offset:32
ds_read_b64 v[128:129], v139 offset:0
ds_read_b128 v[112:115], v143 offset:11264
ds_read_b128 v[116:119], v143 offset:15360
ds_read_b128 v[120:123], v143 offset:19456
ds_read_b128 v[124:127], v143 offset:23552
v_add_f32 v16, v16, v32
v_add_f32 v17, v17, v33
v_add_f32 v18, v18, v34
v_add_f32 v19, v19, v35
v_add_f32 v20, v20, v36
v_add_f32 v21, v21, v37
v_add_f32 v22, v22, v38
v_add_f32 v23, v23, v39
v_add_f32 v24, v24, v40
v_add_f32 v25, v25, v41
v_add_f32 v26, v26, v42
v_add_f32 v27, v27, v43
v_add_f32 v28, v28, v44
v_add_f32 v29, v29, v45
v_add_f32 v30, v30, v46
v_add_f32 v31, v31, v47
v_add_f32 v16, v16, v160
v_add_f32 v17, v17, v161
v_add_f32 v18, v18, v162
v_add_f32 v19, v19, v163
v_add_f32 v20, v20, v164
v_add_f32 v21, v21, v165
v_add_f32 v22, v22, v166
v_add_f32 v23, v23, v167
v_add_f32 v24, v24, v168
v_add_f32 v25, v25, v169
v_add_f32 v26, v26, v170
v_add_f32 v27, v27, v171
v_add_f32 v28, v28, v172
v_add_f32 v29, v29, v173
v_add_f32 v30, v30, v174
v_add_f32 v31, v31, v175
s_waitcnt vmcnt(0)
v_lshlrev_b32 v8, 16, v64
v_and_b32 v9, 0xffff0000, v64
v_add_f32 v16, v8, v16
v_add_f32 v17, v9, v17
v_lshlrev_b32 v8, 16, v65
v_and_b32 v9, 0xffff0000, v65
v_add_f32 v18, v8, v18
v_add_f32 v19, v9, v19
v_lshlrev_b32 v8, 16, v66
v_and_b32 v9, 0xffff0000, v66
v_add_f32 v20, v8, v20
v_add_f32 v21, v9, v21
v_lshlrev_b32 v8, 16, v67
v_and_b32 v9, 0xffff0000, v67
v_add_f32 v22, v8, v22
v_add_f32 v23, v9, v23
v_lshlrev_b32 v8, 16, v68
v_and_b32 v9, 0xffff0000, v68
v_add_f32 v24, v8, v24
v_add_f32 v25, v9, v25
v_lshlrev_b32 v8, 16, v69
v_and_b32 v9, 0xffff0000, v69
v_add_f32 v26, v8, v26
v_add_f32 v27, v9, v27
v_lshlrev_b32 v8, 16, v70
v_and_b32 v9, 0xffff0000, v70
v_add_f32 v28, v8, v28
v_add_f32 v29, v9, v29
v_lshlrev_b32 v8, 16, v71
v_and_b32 v9, 0xffff0000, v71
v_add_f32 v30, v8, v30
v_add_f32 v31, v9, v31
v_lshlrev_b32 v8, 16, v72
v_and_b32 v9, 0xffff0000, v72
v_add_f32 v16, v8, v16
v_add_f32 v17, v9, v17
v_lshlrev_b32 v8, 16, v73
v_and_b32 v9, 0xffff0000, v73
v_add_f32 v18, v8, v18
v_add_f32 v19, v9, v19
v_lshlrev_b32 v8, 16, v74
v_and_b32 v9, 0xffff0000, v74
v_add_f32 v20, v8, v20
v_add_f32 v21, v9, v21
v_lshlrev_b32 v8, 16, v75
v_and_b32 v9, 0xffff0000, v75
v_add_f32 v22, v8, v22
v_add_f32 v23, v9, v23
v_lshlrev_b32 v8, 16, v76
v_and_b32 v9, 0xffff0000, v76
v_add_f32 v24, v8, v24
v_add_f32 v25, v9, v25
v_lshlrev_b32 v8, 16, v77
v_and_b32 v9, 0xffff0000, v77
v_add_f32 v26, v8, v26
v_add_f32 v27, v9, v27
v_lshlrev_b32 v8, 16, v78
v_and_b32 v9, 0xffff0000, v78
v_add_f32 v28, v8, v28
v_add_f32 v29, v9, v29
v_lshlrev_b32 v8, 16, v79
v_and_b32 v9, 0xffff0000, v79
v_add_f32 v30, v8, v30
v_add_f32 v31, v9, v31
v_lshlrev_b32 v8, 16, v132
v_and_b32 v9, 0xffff0000, v132
v_add_f32 v144, v8, v144
v_add_f32 v145, v9, v145
v_lshlrev_b32 v8, 16, v133
v_and_b32 v9, 0xffff0000, v133
v_add_f32 v146, v8, v146
v_add_f32 v147, v9, v147
v_lshlrev_b32 v8, 16, v134
v_and_b32 v9, 0xffff0000, v134
v_add_f32 v144, v8, v144
v_add_f32 v145, v9, v145
v_lshlrev_b32 v8, 16, v135
v_and_b32 v9, 0xffff0000, v135
v_add_f32 v146, v8, v146
v_add_f32 v147, v9, v147
s_waitcnt lgkmcnt(0)
v_lshlrev_b32 v8, 16, v48
v_and_b32 v9, 0xffff0000, v48
v_add_f32 v16, v8, v16
v_add_f32 v17, v9, v17
v_lshlrev_b32 v8, 16, v49
v_and_b32 v9, 0xffff0000, v49
v_add_f32 v18, v8, v18
v_add_f32 v19, v9, v19
v_lshlrev_b32 v8, 16, v50
v_and_b32 v9, 0xffff0000, v50
v_add_f32 v20, v8, v20
v_add_f32 v21, v9, v21
v_lshlrev_b32 v8, 16, v51
v_and_b32 v9, 0xffff0000, v51
v_add_f32 v22, v8, v22
v_add_f32 v23, v9, v23
v_lshlrev_b32 v8, 16, v52
v_and_b32 v9, 0xffff0000, v52
v_add_f32 v24, v8, v24
v_add_f32 v25, v9, v25
v_lshlrev_b32 v8, 16, v53
v_and_b32 v9, 0xffff0000, v53
v_add_f32 v26, v8, v26
v_add_f32 v27, v9, v27
v_lshlrev_b32 v8, 16, v54
v_and_b32 v9, 0xffff0000, v54
v_add_f32 v28, v8, v28
v_add_f32 v29, v9, v29
v_lshlrev_b32 v8, 16, v55
v_and_b32 v9, 0xffff0000, v55
v_add_f32 v30, v8, v30
v_add_f32 v31, v9, v31
v_lshlrev_b32 v8, 16, v128
v_and_b32 v9, 0xffff0000, v128
v_add_f32 v144, v8, v144
v_add_f32 v145, v9, v145
v_lshlrev_b32 v8, 16, v129
v_and_b32 v9, 0xffff0000, v129
v_add_f32 v146, v8, v146
v_add_f32 v147, v9, v147
v_cvt_pk_bf16_f32 v48, v16, v17
v_cvt_pk_bf16_f32 v49, v18, v19
v_cvt_pk_bf16_f32 v50, v20, v21
v_cvt_pk_bf16_f32 v51, v22, v23
ds_write_b128 v4, v[48:51] offset:0
v_cvt_pk_bf16_f32 v52, v24, v25
v_cvt_pk_bf16_f32 v53, v26, v27
v_cvt_pk_bf16_f32 v54, v28, v29
v_cvt_pk_bf16_f32 v55, v30, v31
ds_write_b128 v4, v[52:55] offset:32
s_waitcnt lgkmcnt(2)
v_add_f32 v144, v144, v112
v_add_f32 v145, v145, v113
v_add_f32 v146, v146, v114
v_add_f32 v147, v147, v115
v_add_f32 v144, v144, v116
v_add_f32 v145, v145, v117
v_add_f32 v146, v146, v118
v_add_f32 v147, v147, v119
v_add_f32 v144, v144, v120
v_add_f32 v145, v145, v121
v_add_f32 v146, v146, v122
v_add_f32 v147, v147, v123
v_add_f32 v144, v144, v124
v_add_f32 v145, v145, v125
v_add_f32 v146, v146, v126
v_add_f32 v147, v147, v127
v_cvt_pk_bf16_f32 v144, v144, v145
v_cvt_pk_bf16_f32 v145, v146, v147
ds_write_b64 v139, v[144:145] offset:0
s_waitcnt lgkmcnt(0)
s_barrier
ds_read_b128 v[48:51], v136 offset:0
ds_read_b128 v[52:55], v137 offset:0
ds_read_b128 v[56:59], v138 offset:0
s_waitcnt lgkmcnt(2)
buffer_store_dwordx4 v[48:51], v12, s[44:47], 0 offen sc1
s_waitcnt lgkmcnt(1)
buffer_store_dwordx4 v[52:55], v13, s[44:47], 0 offen sc1
s_waitcnt lgkmcnt(0)
buffer_store_dwordx4 v[56:59], v14, s[44:47], 0 offen sc1
EXIT_p2_kernel:
s_endpgm
END_p2_kernel:
.section .rodata,"a"
.p2align 6
.amdhsa_kernel p1_kernel
  .amdhsa_next_free_vgpr 344
  .amdhsa_next_free_sgpr 96
  .amdhsa_accum_offset 256
  .amdhsa_group_segment_fixed_size 0
  .amdhsa_kernarg_size 88
  .amdhsa_user_sgpr_count 2
  .amdhsa_user_sgpr_kernarg_segment_ptr 1
  .amdhsa_system_sgpr_workgroup_id_x 1
.end_amdhsa_kernel
.p2align 6
.amdhsa_kernel p2_kernel
  .amdhsa_next_free_vgpr 504
  .amdhsa_next_free_sgpr 96
  .amdhsa_accum_offset 256
  .amdhsa_group_segment_fixed_size 0
  .amdhsa_kernarg_size 88
  .amdhsa_user_sgpr_count 2
  .amdhsa_user_sgpr_kernarg_segment_ptr 1
  .amdhsa_system_sgpr_workgroup_id_x 1
.end_amdhsa_kernel
.altmacro
.set T0,16256
.set T640,16128
.set T1,16256
.set T641,16128
.set T2,16256
.set T642,16128
.set T3,16256
.set T643,16128
.set T4,16256
.set T644,16128
.set T5,16256
.set T645,16128
.set T6,16256
.set T646,16128
.set T7,16255
.set T647,16127
.set T8,16255
.set T648,16127
.set T9,16255
.set T649,16127
.set T10,16255
.set T650,16127
.set T11,16255
.set T651,16127
.set T12,16254
.set T652,16126
.set T13,16254
.set T653,16126
.set T14,16254
.set T654,16126
.set T15,16253
.set T655,16125
.set T16,16253
.set T656,16125
.set T17,16252
.set T657,16124
.set T18,16252
.set T658,16124
.set T19,16252
.set T659,16124
.set T20,16251
.set T660,16123
.set T21,16251
.set T661,16123
.set T22,16250
.set T662,16122
.set T23,16250
.set T663,16122
.set T24,16249
.set T664,16121
.set T25,16248
.set T665,16120
.set T26,16248
.set T666,16120
.set T27,16247
.set T667,16119
.set T28,16246
.set T668,16118
.set T29,16246
.set T669,16118
.set T30,16245
.set T670,16117
.set T31,16244
.set T671,16116
.set T32,16243
.set T672,16115
.set T33,16243
.set T673,16115
.set T34,16242
.set T674,16114
.set T35,16241
.set T675,16113
.set T36,16240
.set T676,16112
.set T37,16239
.set T677,16111
.set T38,16238
.set T678,16110
.set T39,16237
.set T679,16109
.set T40,16237
.set T680,16109
.set T41,16236
.set T681,16108
.set T42,16235
.set T682,16107
.set T43,16234
.set T683,16106
.set T44,16232
.set T684,16104
.set T45,16231
.set T685,16103
.set T46,16230
.set T686,16102
.set T47,16229
.set T687,16101
.set T48,16228
.set T688,16100
.set T49,16227
.set T689,16099
.set T50,16226
.set T690,16098
.set T51,16225
.set T691,16097
.set T52,16223
.set T692,16095
.set T53,16222
.set T693,16094
.set T54,16221
.set T694,16093
.set T55,16220
.set T695,16092
.set T56,16218
.set T696,16090
.set T57,16217
.set T697,16089
.set T58,16216
.set T698,16088
.set T59,16214
.set T699,16086
.set T60,16213
.set T700,16085
.set T61,16211
.set T701,16083
.set T62,16210
.set T702,16082
.set T63,16209
.set T703,16081
.set T64,16207
.set T704,16079
.set T65,16206
.set T705,16078
.set T66,16204
.set T706,16076
.set T67,16203
.set T707,16075
.set T68,16201
.set T708,16073
.set T69,16199
.set T709,16071
.set T70,16198
.set T710,16070
.set T71,16196
.set T711,16068
.set T72,16195
.set T712,16067
.set T73,16193
.set T713,16065
.set T74,16191
.set T714,16063
.set T75,16190
.set T715,16062
.set T76,16188
.set T716,16060
.set T77,16186
.set T717,16058
.set T78,16185
.set T718,16057
.set T79,16183
.set T719,16055
.set T80,16181
.set T720,16053
.set T81,16179
.set T721,16051
.set T82,16177
.set T722,16049
.set T83,16176
.set T723,16048
.set T84,16174
.set T724,16046
.set T85,16172
.set T725,16044
.set T86,16170
.set T726,16042
.set T87,16168
.set T727,16040
.set T88,16166
.set T728,16038
.set T89,16164
.set T729,16036
.set T90,16162
.set T730,16034
.set T91,16160
.set T731,16032
.set T92,16158
.set T732,16030
.set T93,16157
.set T733,16029
.set T94,16155
.set T734,16027
.set T95,16152
.set T735,16024
.set T96,16150
.set T736,16022
.set T97,16148
.set T737,16020
.set T98,16146
.set T738,16018
.set T99,16144
.set T739,16016
.set T100,16142
.set T740,16014
.set T101,16140
.set T741,16012
.set T102,16138
.set T742,16010
.set T103,16136
.set T743,16008
.set T104,16134
.set T744,16006
.set T105,16132
.set T745,16004
.set T106,16129
.set T746,16001
.set T107,16127
.set T747,15999
.set T108,16122
.set T748,15994
.set T109,16118
.set T749,15990
.set T110,16113
.set T750,15985
.set T111,16109
.set T751,15981
.set T112,16104
.set T752,15976
.set T113,16100
.set T753,15972
.set T114,16095
.set T754,15967
.set T115,16091
.set T755,15963
.set T116,16086
.set T756,15958
.set T117,16082
.set T757,15954
.set T118,16077
.set T758,15949
.set T119,16073
.set T759,15945
.set T120,16068
.set T760,15940
.set T121,16063
.set T761,15935
.set T122,16059
.set T762,15931
.set T123,16054
.set T763,15926
.set T124,16049
.set T764,15921
.set T125,16044
.set T765,15916
.set T126,16040
.set T766,15912
.set T127,16035
.set T767,15907
.set T128,16030
.set T768,15902
.set T129,16025
.set T769,15897
.set T130,16021
.set T770,15893
.set T131,16016
.set T771,15888
.set T132,16011
.set T772,15883
.set T133,16006
.set T773,15878
.set T134,16001
.set T774,15873
.set T135,15993
.set T775,15865
.set T136,15983
.set T776,15855
.set T137,15973
.set T777,15845
.set T138,15963
.set T778,15835
.set T139,15954
.set T779,15826
.set T140,15944
.set T780,15816
.set T141,15934
.set T781,15806
.set T142,15924
.set T782,15796
.set T143,15914
.set T783,15786
.set T144,15904
.set T784,15776
.set T145,15894
.set T785,15766
.set T146,15884
.set T786,15756
.set T147,15874
.set T787,15746
.set T148,15857
.set T788,15729
.set T149,15837
.set T789,15709
.set T150,15817
.set T790,15689
.set T151,15797
.set T791,15669
.set T152,15777
.set T792,15649
.set T153,15757
.set T793,15629
.set T154,15729
.set T794,15601
.set T155,15689
.set T795,15561
.set T156,15649
.set T796,15521
.set T157,15601
.set T797,15473
.set T158,15521
.set T798,15393
.set T159,15393
.set T799,15265
.set T160,0
.set T800,0
.set T161,48161
.set T801,48033
.set T162,48289
.set T802,48161
.set T163,48369
.set T803,48241
.set T164,48417
.set T804,48289
.set T165,48457
.set T805,48329
.set T166,48497
.set T806,48369
.set T167,48525
.set T807,48397
.set T168,48545
.set T808,48417
.set T169,48565
.set T809,48437
.set T170,48585
.set T810,48457
.set T171,48605
.set T811,48477
.set T172,48625
.set T812,48497
.set T173,48642
.set T813,48514
.set T174,48652
.set T814,48524
.set T175,48662
.set T815,48534
.set T176,48672
.set T816,48544
.set T177,48682
.set T817,48554
.set T178,48692
.set T818,48564
.set T179,48702
.set T819,48574
.set T180,48712
.set T820,48584
.set T181,48722
.set T821,48594
.set T182,48731
.set T822,48603
.set T183,48741
.set T823,48613
.set T184,48751
.set T824,48623
.set T185,48761
.set T825,48633
.set T186,48769
.set T826,48641
.set T187,48774
.set T827,48646
.set T188,48779
.set T828,48651
.set T189,48784
.set T829,48656
.set T190,48789
.set T830,48661
.set T191,48793
.set T831,48665
.set T192,48798
.set T832,48670
.set T193,48803
.set T833,48675
.set T194,48808
.set T834,48680
.set T195,48812
.set T835,48684
.set T196,48817
.set T836,48689
.set T197,48822
.set T837,48694
.set T198,48827
.set T838,48699
.set T199,48831
.set T839,48703
.set T200,48836
.set T840,48708
.set T201,48841
.set T841,48713
.set T202,48845
.set T842,48717
.set T203,48850
.set T843,48722
.set T204,48854
.set T844,48726
.set T205,48859
.set T845,48731
.set T206,48863
.set T846,48735
.set T207,48868
.set T847,48740
.set T208,48872
.set T848,48744
.set T209,48877
.set T849,48749
.set T210,48881
.set T850,48753
.set T211,48886
.set T851,48758
.set T212,48890
.set T852,48762
.set T213,48895
.set T853,48767
.set T214,48897
.set T854,48769
.set T215,48900
.set T855,48772
.set T216,48902
.set T856,48774
.set T217,48904
.set T857,48776
.set T218,48906
.set T858,48778
.set T219,48908
.set T859,48780
.set T220,48910
.set T860,48782
.set T221,48912
.set T861,48784
.set T222,48914
.set T862,48786
.set T223,48916
.set T863,48788
.set T224,48918
.set T864,48790
.set T225,48920
.set T865,48792
.set T226,48923
.set T866,48795
.set T227,48925
.set T867,48797
.set T228,48926
.set T868,48798
.set T229,48928
.set T869,48800
.set T230,48930
.set T870,48802
.set T231,48932
.set T871,48804
.set T232,48934
.set T872,48806
.set T233,48936
.set T873,48808
.set T234,48938
.set T874,48810
.set T235,48940
.set T875,48812
.set T236,48942
.set T876,48814
.set T237,48944
.set T877,48816
.set T238,48945
.set T878,48817
.set T239,48947
.set T879,48819
.set T240,48949
.set T880,48821
.set T241,48951
.set T881,48823
.set T242,48953
.set T882,48825
.set T243,48954
.set T883,48826
.set T244,48956
.set T884,48828
.set T245,48958
.set T885,48830
.set T246,48959
.set T886,48831
.set T247,48961
.set T887,48833
.set T248,48963
.set T888,48835
.set T249,48964
.set T889,48836
.set T250,48966
.set T890,48838
.set T251,48967
.set T891,48839
.set T252,48969
.set T892,48841
.set T253,48971
.set T893,48843
.set T254,48972
.set T894,48844
.set T255,48974
.set T895,48846
.set T256,48975
.set T896,48847
.set T257,48977
.set T897,48849
.set T258,48978
.set T898,48850
.set T259,48979
.set T899,48851
.set T260,48981
.set T900,48853
.set T261,48982
.set T901,48854
.set T262,48984
.set T902,48856
.set T263,48985
.set T903,48857
.set T264,48986
.set T904,48858
.set T265,48988
.set T905,48860
.set T266,48989
.set T906,48861
.set T267,48990
.set T907,48862
.set T268,48991
.set T908,48863
.set T269,48993
.set T909,48865
.set T270,48994
.set T910,48866
.set T271,48995
.set T911,48867
.set T272,48996
.set T912,48868
.set T273,48997
.set T913,48869
.set T274,48998
.set T914,48870
.set T275,48999
.set T915,48871
.set T276,49000
.set T916,48872
.set T277,49002
.set T917,48874
.set T278,49003
.set T918,48875
.set T279,49004
.set T919,48876
.set T280,49005
.set T920,48877
.set T281,49005
.set T921,48877
.set T282,49006
.set T922,48878
.set T283,49007
.set T923,48879
.set T284,49008
.set T924,48880
.set T285,49009
.set T925,48881
.set T286,49010
.set T926,48882
.set T287,49011
.set T927,48883
.set T288,49011
.set T928,48883
.set T289,49012
.set T929,48884
.set T290,49013
.set T930,48885
.set T291,49014
.set T931,48886
.set T292,49014
.set T932,48886
.set T293,49015
.set T933,48887
.set T294,49016
.set T934,48888
.set T295,49016
.set T935,48888
.set T296,49017
.set T936,48889
.set T297,49018
.set T937,48890
.set T298,49018
.set T938,48890
.set T299,49019
.set T939,48891
.set T300,49019
.set T940,48891
.set T301,49020
.set T941,48892
.set T302,49020
.set T942,48892
.set T303,49020
.set T943,48892
.set T304,49021
.set T944,48893
.set T305,49021
.set T945,48893
.set T306,49022
.set T946,48894
.set T307,49022
.set T947,48894
.set T308,49022
.set T948,48894
.set T309,49023
.set T949,48895
.set T310,49023
.set T950,48895
.set T311,49023
.set T951,48895
.set T312,49023
.set T952,48895
.set T313,49023
.set T953,48895
.set T314,49024
.set T954,48896
.set T315,49024
.set T955,48896
.set T316,49024
.set T956,48896
.set T317,49024
.set T957,48896
.set T318,49024
.set T958,48896
.set T319,49024
.set T959,48896
.set T320,49024
.set T960,48896
.set T321,49024
.set T961,48896
.set T322,49024
.set T962,48896
.set T323,49024
.set T963,48896
.set T324,49024
.set T964,48896
.set T325,49024
.set T965,48896
.set T326,49024
.set T966,48896
.set T327,49023
.set T967,48895
.set T328,49023
.set T968,48895
.set T329,49023
.set T969,48895
.set T330,49023
.set T970,48895
.set T331,49023
.set T971,48895
.set T332,49022
.set T972,48894
.set T333,49022
.set T973,48894
.set T334,49022
.set T974,48894
.set T335,49021
.set T975,48893
.set T336,49021
.set T976,48893
.set T337,49020
.set T977,48892
.set T338,49020
.set T978,48892
.set T339,49020
.set T979,48892
.set T340,49019
.set T980,48891
.set T341,49019
.set T981,48891
.set T342,49018
.set T982,48890
.set T343,49018
.set T983,48890
.set T344,49017
.set T984,48889
.set T345,49016
.set T985,48888
.set T346,49016
.set T986,48888
.set T347,49015
.set T987,48887
.set T348,49014
.set T988,48886
.set T349,49014
.set T989,48886
.set T350,49013
.set T990,48885
.set T351,49012
.set T991,48884
.set T352,49011
.set T992,48883
.set T353,49011
.set T993,48883
.set T354,49010
.set T994,48882
.set T355,49009
.set T995,48881
.set T356,49008
.set T996,48880
.set T357,49007
.set T997,48879
.set T358,49006
.set T998,48878
.set T359,49005
.set T999,48877
.set T360,49005
.set T1000,48877
.set T361,49004
.set T1001,48876
.set T362,49003
.set T1002,48875
.set T363,49002
.set T1003,48874
.set T364,49000
.set T1004,48872
.set T365,48999
.set T1005,48871
.set T366,48998
.set T1006,48870
.set T367,48997
.set T1007,48869
.set T368,48996
.set T1008,48868
.set T369,48995
.set T1009,48867
.set T370,48994
.set T1010,48866
.set T371,48993
.set T1011,48865
.set T372,48991
.set T1012,48863
.set T373,48990
.set T1013,48862
.set T374,48989
.set T1014,48861
.set T375,48988
.set T1015,48860
.set T376,48986
.set T1016,48858
.set T377,48985
.set T1017,48857
.set T378,48984
.set T1018,48856
.set T379,48982
.set T1019,48854
.set T380,48981
.set T1020,48853
.set T381,48979
.set T1021,48851
.set T382,48978
.set T1022,48850
.set T383,48977
.set T1023,48849
.set T384,48975
.set T1024,48847
.set T385,48974
.set T1025,48846
.set T386,48972
.set T1026,48844
.set T387,48971
.set T1027,48843
.set T388,48969
.set T1028,48841
.set T389,48967
.set T1029,48839
.set T390,48966
.set T1030,48838
.set T391,48964
.set T1031,48836
.set T392,48963
.set T1032,48835
.set T393,48961
.set T1033,48833
.set T394,48959
.set T1034,48831
.set T395,48958
.set T1035,48830
.set T396,48956
.set T1036,48828
.set T397,48954
.set T1037,48826
.set T398,48953
.set T1038,48825
.set T399,48951
.set T1039,48823
.set T400,48949
.set T1040,48821
.set T401,48947
.set T1041,48819
.set T402,48945
.set T1042,48817
.set T403,48944
.set T1043,48816
.set T404,48942
.set T1044,48814
.set T405,48940
.set T1045,48812
.set T406,48938
.set T1046,48810
.set T407,48936
.set T1047,48808
.set T408,48934
.set T1048,48806
.set T409,48932
.set T1049,48804
.set T410,48930
.set T1050,48802
.set T411,48928
.set T1051,48800
.set T412,48926
.set T1052,48798
.set T413,48925
.set T1053,48797
.set T414,48923
.set T1054,48795
.set T415,48920
.set T1055,48792
.set T416,48918
.set T1056,48790
.set T417,48916
.set T1057,48788
.set T418,48914
.set T1058,48786
.set T419,48912
.set T1059,48784
.set T420,48910
.set T1060,48782
.set T421,48908
.set T1061,48780
.set T422,48906
.set T1062,48778
.set T423,48904
.set T1063,48776
.set T424,48902
.set T1064,48774
.set T425,48900
.set T1065,48772
.set T426,48897
.set T1066,48769
.set T427,48895
.set T1067,48767
.set T428,48890
.set T1068,48762
.set T429,48886
.set T1069,48758
.set T430,48881
.set T1070,48753
.set T431,48877
.set T1071,48749
.set T432,48872
.set T1072,48744
.set T433,48868
.set T1073,48740
.set T434,48863
.set T1074,48735
.set T435,48859
.set T1075,48731
.set T436,48854
.set T1076,48726
.set T437,48850
.set T1077,48722
.set T438,48845
.set T1078,48717
.set T439,48841
.set T1079,48713
.set T440,48836
.set T1080,48708
.set T441,48831
.set T1081,48703
.set T442,48827
.set T1082,48699
.set T443,48822
.set T1083,48694
.set T444,48817
.set T1084,48689
.set T445,48812
.set T1085,48684
.set T446,48808
.set T1086,48680
.set T447,48803
.set T1087,48675
.set T448,48798
.set T1088,48670
.set T449,48793
.set T1089,48665
.set T450,48789
.set T1090,48661
.set T451,48784
.set T1091,48656
.set T452,48779
.set T1092,48651
.set T453,48774
.set T1093,48646
.set T454,48769
.set T1094,48641
.set T455,48761
.set T1095,48633
.set T456,48751
.set T1096,48623
.set T457,48741
.set T1097,48613
.set T458,48731
.set T1098,48603
.set T459,48722
.set T1099,48594
.set T460,48712
.set T1100,48584
.set T461,48702
.set T1101,48574
.set T462,48692
.set T1102,48564
.set T463,48682
.set T1103,48554
.set T464,48672
.set T1104,48544
.set T465,48662
.set T1105,48534
.set T466,48652
.set T1106,48524
.set T467,48642
.set T1107,48514
.set T468,48625
.set T1108,48497
.set T469,48605
.set T1109,48477
.set T470,48585
.set T1110,48457
.set T471,48565
.set T1111,48437
.set T472,48545
.set T1112,48417
.set T473,48525
.set T1113,48397
.set T474,48497
.set T1114,48369
.set T475,48457
.set T1115,48329
.set T476,48417
.set T1116,48289
.set T477,48369
.set T1117,48241
.set T478,48289
.set T1118,48161
.set T479,48161
.set T1119,48033
.set T480,32768
.set T1120,32768
.set T481,15393
.set T1121,15265
.set T482,15521
.set T1122,15393
.set T483,15601
.set T1123,15473
.set T484,15649
.set T1124,15521
.set T485,15689
.set T1125,15561
.set T486,15729
.set T1126,15601
.set T487,15757
.set T1127,15629
.set T488,15777
.set T1128,15649
.set T489,15797
.set T1129,15669
.set T490,15817
.set T1130,15689
.set T491,15837
.set T1131,15709
.set T492,15857
.set T1132,15729
.set T493,15874
.set T1133,15746
.set T494,15884
.set T1134,15756
.set T495,15894
.set T1135,15766
.set T496,15904
.set T1136,15776
.set T497,15914
.set T1137,15786
.set T498,15924
.set T1138,15796
.set T499,15934
.set T1139,15806
.set T500,15944
.set T1140,15816
.set T501,15954
.set T1141,15826
.set T502,15963
.set T1142,15835
.set T503,15973
.set T1143,15845
.set T504,15983
.set T1144,15855
.set T505,15993
.set T1145,15865
.set T506,16001
.set T1146,15873
.set T507,16006
.set T1147,15878
.set T508,16011
.set T1148,15883
.set T509,16016
.set T1149,15888
.set T510,16021
.set T1150,15893
.set T511,16025
.set T1151,15897
.set T512,16030
.set T1152,15902
.set T513,16035
.set T1153,15907
.set T514,16040
.set T1154,15912
.set T515,16044
.set T1155,15916
.set T516,16049
.set T1156,15921
.set T517,16054
.set T1157,15926
.set T518,16059
.set T1158,15931
.set T519,16063
.set T1159,15935
.set T520,16068
.set T1160,15940
.set T521,16073
.set T1161,15945
.set T522,16077
.set T1162,15949
.set T523,16082
.set T1163,15954
.set T524,16086
.set T1164,15958
.set T525,16091
.set T1165,15963
.set T526,16095
.set T1166,15967
.set T527,16100
.set T1167,15972
.set T528,16104
.set T1168,15976
.set T529,16109
.set T1169,15981
.set T530,16113
.set T1170,15985
.set T531,16118
.set T1171,15990
.set T532,16122
.set T1172,15994
.set T533,16127
.set T1173,15999
.set T534,16129
.set T1174,16001
.set T535,16132
.set T1175,16004
.set T536,16134
.set T1176,16006
.set T537,16136
.set T1177,16008
.set T538,16138
.set T1178,16010
.set T539,16140
.set T1179,16012
.set T540,16142
.set T1180,16014
.set T541,16144
.set T1181,16016
.set T542,16146
.set T1182,16018
.set T543,16148
.set T1183,16020
.set T544,16150
.set T1184,16022
.set T545,16152
.set T1185,16024
.set T546,16155
.set T1186,16027
.set T547,16157
.set T1187,16029
.set T548,16158
.set T1188,16030
.set T549,16160
.set T1189,16032
.set T550,16162
.set T1190,16034
.set T551,16164
.set T1191,16036
.set T552,16166
.set T1192,16038
.set T553,16168
.set T1193,16040
.set T554,16170
.set T1194,16042
.set T555,16172
.set T1195,16044
.set T556,16174
.set T1196,16046
.set T557,16176
.set T1197,16048
.set T558,16177
.set T1198,16049
.set T559,16179
.set T1199,16051
.set T560,16181
.set T1200,16053
.set T561,16183
.set T1201,16055
.set T562,16185
.set T1202,16057
.set T563,16186
.set T1203,16058
.set T564,16188
.set T1204,16060
.set T565,16190
.set T1205,16062
.set T566,16191
.set T1206,16063
.set T567,16193
.set T1207,16065
.set T568,16195
.set T1208,16067
.set T569,16196
.set T1209,16068
.set T570,16198
.set T1210,16070
.set T571,16199
.set T1211,16071
.set T572,16201
.set T1212,16073
.set T573,16203
.set T1213,16075
.set T574,16204
.set T1214,16076
.set T575,16206
.set T1215,16078
.set T576,16207
.set T1216,16079
.set T577,16209
.set T1217,16081
.set T578,16210
.set T1218,16082
.set T579,16211
.set T1219,16083
.set T580,16213
.set T1220,16085
.set T581,16214
.set T1221,16086
.set T582,16216
.set T1222,16088
.set T583,16217
.set T1223,16089
.set T584,16218
.set T1224,16090
.set T585,16220
.set T1225,16092
.set T586,16221
.set T1226,16093
.set T587,16222
.set T1227,16094
.set T588,16223
.set T1228,16095
.set T589,16225
.set T1229,16097
.set T590,16226
.set T1230,16098
.set T591,16227
.set T1231,16099
.set T592,16228
.set T1232,16100
.set T593,16229
.set T1233,16101
.set T594,16230
.set T1234,16102
.set T595,16231
.set T1235,16103
.set T596,16232
.set T1236,16104
.set T597,16234
.set T1237,16106
.set T598,16235
.set T1238,16107
.set T599,16236
.set T1239,16108
.set T600,16237
.set T1240,16109
.set T601,16237
.set T1241,16109
.set T602,16238
.set T1242,16110
.set T603,16239
.set T1243,16111
.set T604,16240
.set T1244,16112
.set T605,16241
.set T1245,16113
.set T606,16242
.set T1246,16114
.set T607,16243
.set T1247,16115
.set T608,16243
.set T1248,16115
.set T609,16244
.set T1249,16116
.set T610,16245
.set T1250,16117
.set T611,16246
.set T1251,16118
.set T612,16246
.set T1252,16118
.set T613,16247
.set T1253,16119
.set T614,16248
.set T1254,16120
.set T615,16248
.set T1255,16120
.set T616,16249
.set T1256,16121
.set T617,16250
.set T1257,16122
.set T618,16250
.set T1258,16122
.set T619,16251
.set T1259,16123
.set T620,16251
.set T1260,16123
.set T621,16252
.set T1261,16124
.set T622,16252
.set T1262,16124
.set T623,16252
.set T1263,16124
.set T624,16253
.set T1264,16125
.set T625,16253
.set T1265,16125
.set T626,16254
.set T1266,16126
.set T627,16254
.set T1267,16126
.set T628,16254
.set T1268,16126
.set T629,16255
.set T1269,16127
.set T630,16255
.set T1270,16127
.set T631,16255
.set T1271,16127
.set T632,16255
.set T1272,16127
.set T633,16255
.set T1273,16127
.set T634,16256
.set T1274,16128
.set T635,16256
.set T1275,16128
.set T636,16256
.set T1276,16128
.set T637,16256
.set T1277,16128
.set T638,16256
.set T1278,16128
.set T639,16256
.set T1279,16128
.macro E8 Z1,Z2,Z3,Z4,Z5,Z6,Z7,Z8
.short T\Z1,T\Z2,T\Z3,T\Z4,T\Z5,T\Z6,T\Z7,T\Z8
.endm
.p2align 12
TABF:
.set ZD,0
.rept 640
.set ZK,0
.rept 80
E8 %((ZD*((ZK+0)-320*(((ZK+0)+191)>>9))+160*(((ZK+0)+191)>>9))%640),%((ZD*((ZK+1)-320*(((ZK+1)+191)>>9))+160*(((ZK+1)+191)>>9))%640),%((ZD*((ZK+2)-320*(((ZK+2)+191)>>9))+160*(((ZK+2)+191)>>9))%640),%((ZD*((ZK+3)-320*(((ZK+3)+191)>>9))+160*(((ZK+3)+191)>>9))%640),%((ZD*((ZK+4)-320*(((ZK+4)+191)>>9))+160*(((ZK+4)+191)>>9))%640),%((ZD*((ZK+5)-320*(((ZK+5)+191)>>9))+160*(((ZK+5)+191)>>9))%640),%((ZD*((ZK+6)-320*(((ZK+6)+191)>>9))+160*(((ZK+6)+191)>>9))%640),%((ZD*((ZK+7)-320*(((ZK+7)+191)>>9))+160*(((ZK+7)+191)>>9))%640)
.set ZK,ZK+8
.endr
.set ZD,ZD+1
.endr
TABG:
.set ZT,0
.rept 20
.set ZK,0
.rept 80
.set ZM,0
.rept 32
.set ZD,32*ZT+(ZM&19)+((ZM&4)<<1)+((ZM&8)>>1)
E8 %((ZD*((ZK+0)-320*(((ZK+0)+191)>>9))+160*(((ZK+0)+191)>>9))%640+640*(1-((((ZK+0)%320)+511)>>9))),%((ZD*((ZK+1)-320*(((ZK+1)+191)>>9))+160*(((ZK+1)+191)>>9))%640+640*(1-((((ZK+1)%320)+511)>>9))),%((ZD*((ZK+2)-320*(((ZK+2)+191)>>9))+160*(((ZK+2)+191)>>9))%640+640*(1-((((ZK+2)%320)+511)>>9))),%((ZD*((ZK+3)-320*(((ZK+3)+191)>>9))+160*(((ZK+3)+191)>>9))%640+640*(1-((((ZK+3)%320)+511)>>9))),%((ZD*((ZK+4)-320*(((ZK+4)+191)>>9))+160*(((ZK+4)+191)>>9))%640+640*(1-((((ZK+4)%320)+511)>>9))),%((ZD*((ZK+5)-320*(((ZK+5)+191)>>9))+160*(((ZK+5)+191)>>9))%640+640*(1-((((ZK+5)%320)+511)>>9))),%((ZD*((ZK+6)-320*(((ZK+6)+191)>>9))+160*(((ZK+6)+191)>>9))%640+640*(1-((((ZK+6)%320)+511)>>9))),%((ZD*((ZK+7)-320*(((ZK+7)+191)>>9))+160*(((ZK+7)+191)>>9))%640+640*(1-((((ZK+7)%320)+511)>>9)))
.set ZM,ZM+1
.endr
.set ZK,ZK+8
.endr
.set ZT,ZT+1
.endr
.noaltmacro
TABC:
.quad 0x3f803f803f803f80,0x3f803f803f803f80,0x3f553f6d3f7b3f80,0xbf0ebec4be480000,0x3ec43f353f6d3f80,0xbec4bf35bf6dbf80,0xbe483ec43f553f80,0x3f7b3f6d3f0e8000
.quad 0xbf3500003f353f80,0xbf3500003f353f80,0xbf7bbec43f0e3f80,0xbe48bf6dbf550000,0xbf6dbf353ec43f80,0x3f6d3f35bec4bf80,0xbf0ebf6d3e483f80,0xbf553ec43f7b8000
.quad 0x8000bf8000003f80,0x8000bf8000003f80,0x3f0ebf6dbe483f80,0x3f553ec4bf7b0000,0x3f6dbf35bec43f80,0xbf6d3f353ec4bf80,0x3f7bbec4bf0e3f80,0x3e48bf6d3f558000
.quad 0x3f358000bf353f80,0x3f358000bf353f80,0x3e483ec4bf553f80,0xbf7b3f6dbf0e0000,0xbec43f35bf6d3f80,0x3ec4bf353f6dbf80,0xbf553f6dbf7b3f80,0x3f0ebec43e488000
.quad 0xbf803f80bf803f80,0xbf803f80bf803f80,0xbf553f6dbf7b3f80,0x3f0ebec43e480000,0xbec43f35bf6d3f80,0x3ec4bf353f6dbf80,0x3e483ec4bf553f80,0xbf7b3f6dbf0e8000
.quad 0x3f350000bf353f80,0x3f350000bf353f80,0x3f7bbec4bf0e3f80,0x3e48bf6d3f550000,0x3f6dbf35bec43f80,0xbf6d3f353ec4bf80,0x3f0ebf6dbe483f80,0x3f553ec4bf7b8000
.quad 0xbf8080003f80,0xbf8080003f80,0xbf0ebf6d3e483f80,0xbf553ec43f7b0000,0xbf6dbf353ec43f80,0x3f6d3f35bec4bf80,0xbf7bbec43f0e3f80,0xbe48bf6dbf558000
.quad 0xbf3580003f353f80,0xbf3580003f353f80,0xbe483ec43f553f80,0x3f7b3f6d3f0e0000,0x3ec43f353f6d3f80,0xbec4bf35bf6dbf80,0x3f553f6d3f7b3f80,0xbf0ebec4be488000
.quad 0x3f803f803f803f80,0x3f803f803f803f80,0x3e483ec43f0e3f35,0xbf7bbf6dbf55bf35,0xbf6dbf35bec40000,0x3f6d3f353ec48000,0xbf0ebf6dbf7bbf35,0xbf55bec43e483f35
.quad 0x3f358000bf35bf80,0x3f358000bf35bf80,0x3f553f6d3e48bf35,0xbf0e3ec43f7b3f35,0xbec43f353f6d8000,0x3ec4bf35bf6d0000,0xbf7bbec43f553f35,0xbe483f6d3f0ebf35
.quad 0x8000bf8000003f80,0x8000bf8000003f80,0x3f7bbec4bf553f35,0x3e483f6dbf0ebf35,0x3ec43f35bf6d0000,0xbec4bf353f6d8000,0xbf553f6dbe48bf35,0x3f0e3ec4bf7b3f35
.quad 0xbf3500003f35bf80,0xbf3500003f35bf80,0x3f0ebf6d3f7bbf35,0x3f55bec4be483f35,0x3f6dbf353ec48000,0xbf6d3f35bec40000,0xbe483ec4bf0e3f35,0x3f7bbf6d3f55bf35
.quad 0xbf803f80bf803f80,0xbf803f80bf803f80,0xbe483ec4bf0e3f35,0x3f7bbf6d3f55bf35,0x3f6dbf353ec40000,0xbf6d3f35bec48000,0x3f0ebf6d3f7bbf35,0x3f55bec4be483f35
.quad 0xbf3580003f35bf80,0xbf3580003f35bf80,0xbf553f6dbe48bf35,0x3f0e3ec4bf7b3f35,0x3ec43f35bf6d8000,0xbec4bf353f6d0000,0x3f7bbec4bf553f35,0x3e483f6dbf0ebf35
.quad 0xbf8080003f80,0xbf8080003f80,0xbf7bbec43f553f35,0xbe483f6d3f0ebf35,0xbec43f353f6d0000,0x3ec4bf35bf6d8000,0x3f553f6d3e48bf35,0xbf0e3ec43f7b3f35
.quad 0x3f350000bf35bf80,0x3f350000bf35bf80,0xbf0ebf6dbf7bbf35,0xbf55bec43e483f35,0xbf6dbf35bec48000,0x3f6d3f353ec40000,0x3e483ec43f0e3f35,0xbf7bbf6dbf55bf35
.quad 0x3f803f803f803f80,0x3f803f803f803f80,0xbf55bf6dbf7bbf80,0x3f0e3ec43e488000,0x3ec43f353f6d3f80,0xbec4bf35bf6dbf80,0x3e48bec4bf55bf80,0xbf7bbf6dbf0e0000
.quad 0xbf3500003f353f80,0xbf3500003f353f80,0x3f7b3ec4bf0ebf80,0x3e483f6d3f558000,0xbf6dbf353ec43f80,0x3f6d3f35bec4bf80,0x3f0e3f6dbe48bf80,0x3f55bec4bf7b0000
.quad 0x8000bf8000003f80,0x8000bf8000003f80,0xbf0e3f6d3e48bf80,0xbf55bec43f7b8000,0x3f6dbf35bec43f80,0xbf6d3f353ec4bf80,0xbf7b3ec43f0ebf80,0xbe483f6dbf550000
.quad 0x3f358000bf353f80,0x3f358000bf353f80,0xbe48bec43f55bf80,0x3f7bbf6d3f0e8000,0xbec43f35bf6d3f80,0x3ec4bf353f6dbf80,0x3f55bf6d3f7bbf80,0xbf0e3ec4be480000
.quad 0xbf803f80bf803f80,0xbf803f80bf803f80,0x3f55bf6d3f7bbf80,0xbf0e3ec4be488000,0xbec43f35bf6d3f80,0x3ec4bf353f6dbf80,0xbe48bec43f55bf80,0x3f7bbf6d3f0e0000
.quad 0x3f350000bf353f80,0x3f350000bf353f80,0xbf7b3ec43f0ebf80,0xbe483f6dbf558000,0x3f6dbf35bec43f80,0xbf6d3f353ec4bf80,0xbf0e3f6d3e48bf80,0xbf55bec43f7b0000
.quad 0xbf8080003f80,0xbf8080003f80,0x3f0e3f6dbe48bf80,0x3f55bec4bf7b8000,0xbf6dbf353ec43f80,0x3f6d3f35bec4bf80,0x3f7b3ec4bf0ebf80,0x3e483f6d3f550000
.quad 0xbf3580003f353f80,0xbf3580003f353f80,0x3e48bec4bf55bf80,0xbf7bbf6dbf0e8000,0x3ec43f353f6d3f80,0xbec4bf35bf6dbf80,0xbf55bf6dbf7bbf80,0x3f0e3ec43e480000
.quad 0x3f803f803f803f80,0x3f803f803f803f80,0xbe48bec4bf0ebf35,0x3f7b3f6d3f553f35,0xbf6dbf35bec40000,0x3f6d3f353ec48000,0x3f0e3f6d3f7b3f35,0x3f553ec4be48bf35
.quad 0x3f358000bf35bf80,0x3f358000bf35bf80,0xbf55bf6dbe483f35,0x3f0ebec4bf7bbf35,0xbec43f353f6d8000,0x3ec4bf35bf6d0000,0x3f7b3ec4bf55bf35,0x3e48bf6dbf0e3f35
.quad 0x8000bf8000003f80,0x8000bf8000003f80,0xbf7b3ec43f55bf35,0xbe48bf6d3f0e3f35,0x3ec43f35bf6d0000,0xbec4bf353f6d8000,0x3f55bf6d3e483f35,0xbf0ebec43f7bbf35
.quad 0xbf3500003f35bf80,0xbf3500003f35bf80,0xbf0e3f6dbf7b3f35,0xbf553ec43e48bf35,0x3f6dbf353ec48000,0xbf6d3f35bec40000,0x3e48bec43f0ebf35,0xbf7b3f6dbf553f35
.quad 0xbf803f80bf803f80,0xbf803f80bf803f80,0x3e48bec43f0ebf35,0xbf7b3f6dbf553f35,0x3f6dbf353ec40000,0xbf6d3f35bec48000,0xbf0e3f6dbf7b3f35,0xbf553ec43e48bf35
.quad 0xbf3580003f35bf80,0xbf3580003f35bf80,0x3f55bf6d3e483f35,0xbf0ebec43f7bbf35,0x3ec43f35bf6d8000,0xbec4bf353f6d0000,0xbf7b3ec43f55bf35,0xbe48bf6d3f0e3f35
.quad 0xbf8080003f80,0xbf8080003f80,0x3f7b3ec4bf55bf35,0x3e48bf6dbf0e3f35,0xbec43f353f6d0000,0x3ec4bf35bf6d8000,0xbf55bf6dbe483f35,0x3f0ebec4bf7bbf35
.quad 0x3f350000bf35bf80,0x3f350000bf35bf80,0x3f0e3f6d3f7b3f35,0x3f553ec4be48bf35,0xbf6dbf35bec48000,0x3f6d3f353ec40000,0xbe48bec4bf0ebf35,0x3f7b3f6d3f553f35
.quad 0x0,0x0,0x3f0e3ec43e480000,0x3f553f6d3f7b3f80,0x3f6d3f353ec40000,0xbf6dbf35bec40000,0x3f7b3f6d3f0e0000,0x3e48bec4bf55bf80
.quad 0x3f353f803f350000,0x3f353f803f350000,0x3e483f6d3f550000,0xbf7bbec43f0e3f80,0xbec43f353f6d0000,0x3ec4bf35bf6d0000,0xbf553ec43f7b0000,0x3f0e3f6dbe48bf80
.quad 0xbf8000003f800000,0xbf8000003f800000,0xbf55bec43f7b0000,0x3f0ebf6dbe483f80,0xbec4bf353f6d0000,0x3ec43f35bf6d0000,0x3e48bf6d3f550000,0xbf7b3ec43f0ebf80
.quad 0x3f35bf803f350000,0x3f35bf803f350000,0x3f7bbf6d3f0e0000,0x3e483ec4bf553f80,0x3f6dbf353ec40000,0xbf6d3f35bec40000,0x3f0ebec43e480000,0x3f55bf6d3f7bbf80
.quad 0x0,0x0,0xbf0e3ec4be480000,0xbf553f6dbf7b3f80,0xbf6d3f35bec40000,0x3f6dbf353ec40000,0xbf7b3f6dbf0e0000,0xbe48bec43f55bf80
.quad 0xbf353f80bf350000,0xbf353f80bf350000,0xbe483f6dbf550000,0x3f7bbec4bf0e3f80,0x3ec43f35bf6d0000,0xbec4bf353f6d0000,0x3f553ec4bf7b0000,0xbf0e3f6d3e48bf80
.quad 0x3f800000bf800000,0x3f800000bf800000,0x3f55bec4bf7b0000,0xbf0ebf6d3e483f80,0x3ec4bf35bf6d0000,0xbec43f353f6d0000,0xbe48bf6dbf550000,0x3f7b3ec4bf0ebf80
.quad 0xbf35bf80bf350000,0xbf35bf80bf350000,0xbf7bbf6dbf0e0000,0xbe483ec43f553f80,0xbf6dbf35bec40000,0x3f6d3f353ec40000,0xbf0ebec4be480000,0xbf55bf6dbf7bbf80
.quad 0x0,0x0,0x3f7b3f6d3f553f35,0x3e483ec43f0e3f35,0x3ec43f353f6d3f80,0xbec4bf35bf6dbf80,0xbf55bec43e483f35,0x3f0e3f6d3f7b3f35
.quad 0xbf35bf80bf350000,0xbf35bf80bf350000,0x3f0ebec4bf7bbf35,0x3f553f6d3e48bf35,0x3f6d3f35bec4bf80,0xbf6dbf353ec43f80,0xbe483f6d3f0ebf35,0x3f7b3ec4bf55bf35
.quad 0xbf8000003f800000,0xbf8000003f800000,0xbe48bf6d3f0e3f35,0x3f7bbec4bf553f35,0x3f6dbf35bec43f80,0xbf6d3f353ec4bf80,0x3f0e3ec4bf7b3f35,0x3f55bf6d3e483f35
.quad 0xbf353f80bf350000,0xbf353f80bf350000,0xbf553ec43e48bf35,0x3f0ebf6d3f7bbf35,0x3ec4bf353f6dbf80,0xbec43f35bf6d3f80,0x3f7bbf6d3f55bf35,0x3e48bec43f0ebf35
.quad 0x0,0x0,0xbf7b3f6dbf553f35,0xbe483ec4bf0e3f35,0xbec43f35bf6d3f80,0x3ec4bf353f6dbf80,0x3f55bec4be483f35,0xbf0e3f6dbf7b3f35
.quad 0x3f35bf803f350000,0x3f35bf803f350000,0xbf0ebec43f7bbf35,0xbf553f6dbe48bf35,0xbf6d3f353ec4bf80,0x3f6dbf35bec43f80,0x3e483f6dbf0ebf35,0xbf7b3ec43f55bf35
.quad 0x3f800000bf800000,0x3f800000bf800000,0x3e48bf6dbf0e3f35,0xbf7bbec43f553f35,0xbf6dbf353ec43f80,0x3f6d3f35bec4bf80,0xbf0e3ec43f7b3f35,0xbf55bf6dbe483f35
.quad 0x3f353f803f350000,0x3f353f803f350000,0x3f553ec4be48bf35,0xbf0ebf6dbf7bbf35,0xbec4bf35bf6dbf80,0x3ec43f353f6d3f80,0xbf7bbf6dbf55bf35,0xbe48bec4bf0ebf35
.quad 0x0,0x0,0xbf0ebec4be480000,0xbf55bf6dbf7bbf80,0x3f6d3f353ec40000,0xbf6dbf35bec40000,0xbf7bbf6dbf0e0000,0xbe483ec43f553f80
.quad 0x3f353f803f350000,0x3f353f803f350000,0xbe48bf6dbf550000,0x3f7b3ec4bf0ebf80,0xbec43f353f6d0000,0x3ec4bf35bf6d0000,0x3f55bec4bf7b0000,0xbf0ebf6d3e483f80
.quad 0xbf8000003f800000,0xbf8000003f800000,0x3f553ec4bf7b0000,0xbf0e3f6d3e48bf80,0xbec4bf353f6d0000,0x3ec43f35bf6d0000,0xbe483f6dbf550000,0x3f7bbec4bf0e3f80
.quad 0x3f35bf803f350000,0x3f35bf803f350000,0xbf7b3f6dbf0e0000,0xbe48bec43f55bf80,0x3f6dbf353ec40000,0xbf6d3f35bec40000,0xbf0e3ec4be480000,0xbf553f6dbf7b3f80
.quad 0x0,0x0,0x3f0ebec43e480000,0x3f55bf6d3f7bbf80,0xbf6d3f35bec40000,0x3f6dbf353ec40000,0x3f7bbf6d3f0e0000,0x3e483ec4bf553f80
.quad 0xbf353f80bf350000,0xbf353f80bf350000,0x3e48bf6d3f550000,0xbf7b3ec43f0ebf80,0x3ec43f35bf6d0000,0xbec4bf353f6d0000,0xbf55bec43f7b0000,0x3f0ebf6dbe483f80
.quad 0x3f800000bf800000,0x3f800000bf800000,0xbf553ec43f7b0000,0x3f0e3f6dbe48bf80,0x3ec4bf35bf6d0000,0xbec43f353f6d0000,0x3e483f6d3f550000,0xbf7bbec43f0e3f80
.quad 0xbf35bf80bf350000,0xbf35bf80bf350000,0x3f7b3f6d3f0e0000,0x3e48bec4bf55bf80,0xbf6dbf35bec40000,0x3f6d3f353ec40000,0x3f0e3ec43e480000,0x3f553f6d3f7b3f80
.quad 0x0,0x0,0xbf7bbf6dbf55bf35,0xbe48bec4bf0ebf35,0x3ec43f353f6d3f80,0xbec4bf35bf6dbf80,0x3f553ec4be48bf35,0xbf0ebf6dbf7bbf35
.quad 0xbf35bf80bf350000,0xbf35bf80bf350000,0xbf0e3ec43f7b3f35,0xbf55bf6dbe483f35,0x3f6d3f35bec4bf80,0xbf6dbf353ec43f80,0x3e48bf6dbf0e3f35,0xbf7bbec43f553f35
.quad 0xbf8000003f800000,0xbf8000003f800000,0x3e483f6dbf0ebf35,0xbf7b3ec43f55bf35,0x3f6dbf35bec43f80,0xbf6d3f353ec4bf80,0xbf0ebec43f7bbf35,0xbf553f6dbe48bf35
.quad 0xbf353f80bf350000,0xbf353f80bf350000,0x3f55bec4be483f35,0xbf0e3f6dbf7b3f35,0x3ec4bf353f6dbf80,0xbec43f35bf6d3f80,0xbf7b3f6dbf553f35,0xbe483ec4bf0e3f35
.quad 0x0,0x0,0x3f7bbf6d3f55bf35,0x3e48bec43f0ebf35,0xbec43f35bf6d3f80,0x3ec4bf353f6dbf80,0xbf553ec43e48bf35,0x3f0ebf6d3f7bbf35
.quad 0x3f35bf803f350000,0x3f35bf803f350000,0x3f0e3ec4bf7b3f35,0x3f55bf6d3e483f35,0xbf6d3f353ec4bf80,0x3f6dbf35bec43f80,0xbe48bf6d3f0e3f35,0x3f7bbec4bf553f35
.quad 0x3f800000bf800000,0x3f800000bf800000,0xbe483f6d3f0ebf35,0x3f7b3ec4bf55bf35,0xbf6dbf353ec43f80,0x3f6d3f35bec4bf80,0x3f0ebec4bf7bbf35,0x3f553f6d3e48bf35
.quad 0x3f353f803f350000,0x3f353f803f350000,0xbf55bec43e483f35,0x3f0e3f6d3f7b3f35,0xbec4bf35bf6dbf80,0x3ec43f353f6d3f80,0x3f7b3f6d3f553f35,0x3e483ec43f0e3f35
.quad 0x8000800080008000,0x8000800080008000,0xbf0ebec4be488000,0xbf55bf6dbf7bbf80,0xbf6dbf35bec48000,0x3f6d3f353ec48000,0xbf7bbf6dbf0e8000,0xbe483ec43f553f80
.quad 0xbf35bf80bf358000,0xbf35bf80bf358000,0xbe48bf6dbf558000,0x3f7b3ec4bf0ebf80,0x3ec4bf35bf6d8000,0xbec43f353f6d8000,0x3f55bec4bf7b8000,0xbf0ebf6d3e483f80
.quad 0x3f808000bf808000,0x3f808000bf808000,0x3f553ec4bf7b8000,0xbf0e3f6d3e48bf80,0x3ec43f35bf6d8000,0xbec4bf353f6d8000,0xbe483f6dbf558000,0x3f7bbec4bf0e3f80
.quad 0xbf353f80bf358000,0xbf353f80bf358000,0xbf7b3f6dbf0e8000,0xbe48bec43f55bf80,0xbf6d3f35bec48000,0x3f6dbf353ec48000,0xbf0e3ec4be488000,0xbf553f6dbf7b3f80
.quad 0x8000800080008000,0x8000800080008000,0x3f0ebec43e488000,0x3f55bf6d3f7bbf80,0x3f6dbf353ec48000,0xbf6d3f35bec48000,0x3f7bbf6d3f0e8000,0x3e483ec4bf553f80
.quad 0x3f35bf803f358000,0x3f35bf803f358000,0x3e48bf6d3f558000,0xbf7b3ec43f0ebf80,0xbec4bf353f6d8000,0x3ec43f35bf6d8000,0xbf55bec43f7b8000,0x3f0ebf6dbe483f80
.quad 0xbf8080003f808000,0xbf8080003f808000,0xbf553ec43f7b8000,0x3f0e3f6dbe48bf80,0xbec43f353f6d8000,0x3ec4bf35bf6d8000,0x3e483f6d3f558000,0xbf7bbec43f0e3f80
.quad 0x3f353f803f358000,0x3f353f803f358000,0x3f7b3f6d3f0e8000,0x3e48bec4bf55bf80,0x3f6d3f353ec48000,0xbf6dbf35bec48000,0x3f0e3ec43e488000,0x3f553f6d3f7b3f80
.quad 0x8000800080008000,0x8000800080008000,0xbf7bbf6dbf55bf35,0xbe48bec4bf0ebf35,0xbec4bf35bf6dbf80,0x3ec43f353f6d3f80,0x3f553ec4be48bf35,0xbf0ebf6dbf7bbf35
.quad 0x3f353f803f358000,0x3f353f803f358000,0xbf0e3ec43f7b3f35,0xbf55bf6dbe483f35,0xbf6dbf353ec43f80,0x3f6d3f35bec4bf80,0x3e48bf6dbf0e3f35,0xbf7bbec43f553f35
.quad 0x3f808000bf808000,0x3f808000bf808000,0x3e483f6dbf0ebf35,0xbf7b3ec43f55bf35,0xbf6d3f353ec4bf80,0x3f6dbf35bec43f80,0xbf0ebec43f7bbf35,0xbf553f6dbe48bf35
.quad 0x3f35bf803f358000,0x3f35bf803f358000,0x3f55bec4be483f35,0xbf0e3f6dbf7b3f35,0xbec43f35bf6d3f80,0x3ec4bf353f6dbf80,0xbf7b3f6dbf553f35,0xbe483ec4bf0e3f35
.quad 0x8000800080008000,0x8000800080008000,0x3f7bbf6d3f55bf35,0x3e48bec43f0ebf35,0x3ec4bf353f6dbf80,0xbec43f35bf6d3f80,0xbf553ec43e48bf35,0x3f0ebf6d3f7bbf35
.quad 0xbf353f80bf358000,0xbf353f80bf358000,0x3f0e3ec4bf7b3f35,0x3f55bf6d3e483f35,0x3f6dbf35bec43f80,0xbf6d3f353ec4bf80,0xbe48bf6d3f0e3f35,0x3f7bbec4bf553f35
.quad 0xbf8080003f808000,0xbf8080003f808000,0xbe483f6d3f0ebf35,0x3f7b3ec4bf55bf35,0x3f6d3f35bec4bf80,0xbf6dbf353ec43f80,0x3f0ebec4bf7bbf35,0x3f553f6d3e48bf35
.quad 0xbf35bf80bf358000,0xbf35bf80bf358000,0xbf55bec43e483f35,0x3f0e3f6d3f7b3f35,0x3ec43f353f6d3f80,0xbec4bf35bf6dbf80,0x3f7b3f6d3f553f35,0x3e483ec43f0e3f35
.quad 0x8000800080008000,0x8000800080008000,0x3f0e3ec43e488000,0x3f553f6d3f7b3f80,0xbf6dbf35bec48000,0x3f6d3f353ec48000,0x3f7b3f6d3f0e8000,0x3e48bec4bf55bf80
.quad 0xbf35bf80bf358000,0xbf35bf80bf358000,0x3e483f6d3f558000,0xbf7bbec43f0e3f80,0x3ec4bf35bf6d8000,0xbec43f353f6d8000,0xbf553ec43f7b8000,0x3f0e3f6dbe48bf80
.quad 0x3f808000bf808000,0x3f808000bf808000,0xbf55bec43f7b8000,0x3f0ebf6dbe483f80,0x3ec43f35bf6d8000,0xbec4bf353f6d8000,0x3e48bf6d3f558000,0xbf7b3ec43f0ebf80
.quad 0xbf353f80bf358000,0xbf353f80bf358000,0x3f7bbf6d3f0e8000,0x3e483ec4bf553f80,0xbf6d3f35bec48000,0x3f6dbf353ec48000,0x3f0ebec43e488000,0x3f55bf6d3f7bbf80
.quad 0x8000800080008000,0x8000800080008000,0xbf0e3ec4be488000,0xbf553f6dbf7b3f80,0x3f6dbf353ec48000,0xbf6d3f35bec48000,0xbf7b3f6dbf0e8000,0xbe48bec43f55bf80
.quad 0x3f35bf803f358000,0x3f35bf803f358000,0xbe483f6dbf558000,0x3f7bbec4bf0e3f80,0xbec4bf353f6d8000,0x3ec43f35bf6d8000,0x3f553ec4bf7b8000,0xbf0e3f6d3e48bf80
.quad 0xbf8080003f808000,0xbf8080003f808000,0x3f55bec4bf7b8000,0xbf0ebf6d3e483f80,0xbec43f353f6d8000,0x3ec4bf35bf6d8000,0xbe48bf6dbf558000,0x3f7b3ec4bf0ebf80
.quad 0x3f353f803f358000,0x3f353f803f358000,0xbf7bbf6dbf0e8000,0xbe483ec43f553f80,0x3f6d3f353ec48000,0xbf6dbf35bec48000,0xbf0ebec4be488000,0xbf55bf6dbf7bbf80
.quad 0x8000800080008000,0x8000800080008000,0x3f7b3f6d3f553f35,0x3e483ec43f0e3f35,0xbec4bf35bf6dbf80,0x3ec43f353f6d3f80,0xbf55bec43e483f35,0x3f0e3f6d3f7b3f35
.quad 0x3f353f803f358000,0x3f353f803f358000,0x3f0ebec4bf7bbf35,0x3f553f6d3e48bf35,0xbf6dbf353ec43f80,0x3f6d3f35bec4bf80,0xbe483f6d3f0ebf35,0x3f7b3ec4bf55bf35
.quad 0x3f808000bf808000,0x3f808000bf808000,0xbe48bf6d3f0e3f35,0x3f7bbec4bf553f35,0xbf6d3f353ec4bf80,0x3f6dbf35bec43f80,0x3f0e3ec4bf7b3f35,0x3f55bf6d3e483f35
.quad 0x3f35bf803f358000,0x3f35bf803f358000,0xbf553ec43e48bf35,0x3f0ebf6d3f7bbf35,0xbec43f35bf6d3f80,0x3ec4bf353f6dbf80,0x3f7bbf6d3f55bf35,0x3e48bec43f0ebf35
.quad 0x8000800080008000,0x8000800080008000,0xbf7b3f6dbf553f35,0xbe483ec4bf0e3f35,0x3ec4bf353f6dbf80,0xbec43f35bf6d3f80,0x3f55bec4be483f35,0xbf0e3f6dbf7b3f35
.quad 0xbf353f80bf358000,0xbf353f80bf358000,0xbf0ebec43f7bbf35,0xbf553f6dbe48bf35,0x3f6dbf35bec43f80,0xbf6d3f353ec4bf80,0x3e483f6dbf0ebf35,0xbf7b3ec43f55bf35
.quad 0xbf8080003f808000,0xbf8080003f808000,0x3e48bf6dbf0e3f35,0xbf7bbec43f553f35,0x3f6d3f35bec4bf80,0xbf6dbf353ec43f80,0xbf0e3ec43f7b3f35,0xbf55bf6dbe483f35
.quad 0xbf35bf80bf358000,0xbf35bf80bf358000,0x3f553ec4be48bf35,0xbf0ebf6dbf7bbf35,0x3ec43f353f6d3f80,0xbec4bf35bf6dbf80,0xbf7bbf6dbf55bf35,0xbe48bec4bf0ebf35
.quad 0x3f8000003f800000,0x3f8000003f800000,0x3f7fffb13f800000,0x3f7ffd393f7ffec4,0x3f7ffec43f800000,0x3f7ff4e63f7ffb11,0x3f7ffd393f800000,0x3f7fe7053f7ff4e6
.quad 0x3f7ffb113f800000,0x3f7fd3973f7fec43,0x3f7ff84a3f800000,0x3f7fba9e3f7fe129,0x3f7ff4e63f800000,0x3f7f9c183f7fd397,0x3f7ff0e33f800000,0x3f7f78083f7fc38f
.quad 0x3f7fec433f800000,0x3f7f4e6d3f7fb10f,0x3f7fe7053f800000,0x3f7f1f493f7f9c18,0x3f7fe1293f800000,0x3f7eea9d3f7f84ab,0x3f7fdaaf3f800000,0x3f7eb0693f7f6ac7
.quad 0x3f7fd3973f800000,0x3f7e70b03f7f4e6d,0x3f7fcbe23f800000,0x3f7e2b723f7f2f9d,0x3f7fc38f3f800000,0x3f7de0b13f7f0e58,0x3f7fba9e3f800000,0x3f7d906e3f7eea9d
.quad 0x3f7fb10f3f800000,0x3f7d3aac3f7ec46d,0x3f7fa6e33f800000,0x3f7cdf6c3f7e9bc9,0x3f7f9c183f800000,0x3f7c7eb03f7e70b0,0x3f7f90b13f800000,0x3f7c187a3f7e4323
.quad 0x3f7f84ab3f800000,0x3f7baccd3f7e1324,0x3f7f78083f800000,0x3f7b3bab3f7de0b1,0x3f7f6ac73f800000,0x3f7ac5163f7dabcc,0x3f7f5ce93f800000,0x3f7a49103f7d7474
.quad 0x3f7f4e6d3f800000,0x3f79c79d3f7d3aac,0x3f7f3f543f800000,0x3f7940c03f7cfe73,0x3f7f2f9d3f800000,0x3f78b47b3f7cbfc9,0x3f7f1f493f800000,0x3f7822d13f7c7eb0
.quad 0x3f7f0e583f800000,0x3f778bc53f7c3b28,0x3f7efcc93f800000,0x3f76ef5b3f7bf531,0x3f7eea9d3f800000,0x3f764d973f7baccd,0x3f7ed7d43f800000,0x3f75a67b3f7b61fc
.quad 0x3f8000003f800000,0x3f8000003f800000,0x3f7ff84a3f7ffb11,0x3f7ff0e33f7ff4e6,0x3f7fe1293f7fec43,0x3f7fc38f3f7fd397,0x3f7fba9e3f7fd397,0x3f7f78083f7f9c18
.quad 0x3f7f84ab3f7fb10f,0x3f7f0e583f7f4e6d,0x3f7f3f543f7f84ab,0x3f7e868b3f7eea9d,0x3f7eea9d3f7f4e6d,0x3f7de0b13f7e70b0,0x3f7e868b3f7f0e58,0x3f7d1cdd3f7de0b1
.quad 0x3f7e13243f7ec46d,0x3f7c3b283f7d3aac,0x3f7d906e3f7e70b0,0x3f7b3bab3f7c7eb0,0x3f7cfe733f7e1324,0x3f7a1e843f7baccd,0x3f7c5d3a3f7dabcc,0x3f78e3d63f7ac516
.quad 0x3f7baccd3f7d3aac,0x3f778bc53f79c79d,0x3f7aed373f7cbfc9,0x3f76167a3f78b47b,0x3f7a1e843f7c3b28,0x3f7484223f778bc5,0x3f7940c03f7baccd,0x3f72d4eb3f764d97
.quad 0x3f7853f83f7b14be,0x3f7109083f74fa0b,0x3f77583a3f7a7302,0x3f6f20b03f73913f,0x3f764d973f79c79d,0x3f6d1c1d3f721352,0x3f75341d3f791298,0x3f6afb8c3f708066
.quad 0x3f740bdd3f7853f8,0x3f68bf3c3f6ed89e,0x3f72d4eb3f778bc5,0x3f6667713f6d1c1d,0x3f718f573f76ba07,0x3f63f4733f6b4b0c,0x3f703b373f75dec6,0x3f61668a3f696591
.quad 0x3f6ed89e3f74fa0b,0x3f5ebe053f676bd8,0x3f6d67a13f740bdd,0x3f5bfb343f655e0b,0x3f6be8583f731447,0x3f591e6a3f633c5a,0x3f6a5ad93f721352,0x3f5627fe3f6106f2
.quad 0x3f68bf3c3f710908,0x3f5318493f5ebe05,0x3f6715993f6ff573,0x3f4fefa83f5c61c7,0x3f655e0b3f6ed89e,0x3f4cae793f59f26a,0x3f6398ac3f6db293,0x3f4955213f577026
.quad 0x0,0x0,0x3b490fc600000000,0x3c16cb583bc90f88,0x3bc90f8800000000,0x3c96c9b63c490e90,0x3c16cb5800000000,0x3ce22a7a3c96c9b6
.quad 0x3c490e9000000000,0x3d16c32c3cc90ab0,0x3c7b514b00000000,0x3d3c6dd53cfb49ba,0x3c96c9b600000000,0x3d6214693d16c32c,0x3cafea6900000000,0x3d83db0a3d2fe007
.quad 0x3cc90ab000000000,0x3d96a9053d48fb30,0x3ce22a7a00000000,0x3da973ba3d621469,0x3cfb49ba00000000,0x3dbc3ac33d7b2b74,0x3d0a342f00000000,0x3dcefdb73d8a200a
.quad 0x3d16c32c00000000,0x3de1bc2e3d96a905,0x3d2351cb00000000,0x3df475c03da3308c,0x3d2fe00700000000,0x3e0395023dafb680,0x3d3c6dd500000000,0x3e0cec4a3dbc3ac3
.quad 0x3d48fb3000000000,0x3e1640833dc8bd36,0x3d55880e00000000,0x3e1f917b3dd53db9,0x3d62146900000000,0x3e28defc3de1bc2e,0x3d6ea03800000000,0x3e3228d43dee3876
.quad 0x3d7b2b7400000000,0x3e3b6ecf3dfab273,0x3d83db0a00000000,0x3e44b0b93e039502,0x3d8a200a00000000,0x3e4dee603e09cf86,0x3d9064b400000000,0x3e57278f3e1008b7
.quad 0x3d96a90500000000,0x3e605c133e164083,0x3d9cecf900000000,0x3e698bba3e1c76de,0x3da3308c00000000,0x3e72b6513e22abb6,0x3da973ba00000000,0x3e7bdba43e28defc
.quad 0x3dafb68000000000,0x3e827dc03e2f10a2,0x3db5f8da00000000,0x3e870ada3e354098,0x3dbc3ac300000000,0x3e8b95073e3b6ecf,0x3dc27c3900000000,0x3e901c2c3e419b37
.quad 0x0,0x0,0x3c7b514b3c490e90,0x3cafea693c96c9b6,0x3cfb49ba3cc90ab0,0x3d2fe0073d16c32c,0x3d3c6dd53d16c32c,0x3d83db0a3d621469
.quad 0x3d7b2b743d48fb30,0x3dafb6803d96a905,0x3d9cecf93d7b2b74,0x3ddb7d373dbc3ac3,0x3dbc3ac33d96a905,0x3e0395023de1bc2e,0x3ddb7d373dafb680,0x3e195be03e039502
.quad 0x3dfab2733dc8bd36,0x3e2f10a23e164083,0x3e0cec4a3de1bc2e,0x3e44b0b93e28defc,0x3e1c76de3dfab273,0x3e5a39973e3b6ecf,0x3e2bf8043e09cf86,0x3e6fa8b23e4dee60
.quad 0x3e3b6ecf3e164083,0x3e827dc03e605c13,0x3e4ada4f3e22abb6,0x3e8d17c03e72b651,0x3e5a39973e2f10a2,0x3e97a1173e827dc0,0x3e698bba3e3b6ecf,0x3ea218873e8b9507
.quad 0x3e78cfcc3e47c5c2,0x3eac7cd43e94a031,0x3e8402703e541501,0x3eb6ccc33e9d9e78,0x3e8b95073e605c13,0x3ec1071e3ea68f12,0x3e931f353e6c9a7f,0x3ecb2aae3eaf713a
.quad 0x3e9aa0863e78cfcc,0x3ed536413eb8442a,0x3ea218873e827dc0,0x3edf28a93ec1071e,0x3ea986c43e888e93,0x3ee900b73ec9b953,0x3eb0eacb3e8e9a22,0x3ef2bd433ed25a09
.quad 0x3eb8442a3e94a031,0x3efc5d273edae880,0x3ebf926f3e9aa086,0x3f02ef9f3ee363fa,0x3ec6d5293ea09ae5,0x3f07a1363eebcbbb,0x3ece0bea3ea68f12,0x3f0c42c93ef41f07
.quad 0x3ed536413eac7cd4,0x3f10d3cd3efc5d27,0x3edc53c13eb263ef,0x3f1553b73f0242b1,0x3ee363fa3eb8442a,0x3f19c2003f064b82,0x3eea66813ebe1d4a,0x3f1e1e223f0a48ad
.quad 0x3f8000003f800000,0x3f8000003f800000,0x3f7fe7053f7fec43,0x3f7fdaaf3f7fe129,0x3f7f9c183f7fb10f,0x3f7f6ac73f7f84ab,0x3f7f1f493f7f4e6d,0x3f7eb0693f7eea9d
.quad 0x3f7e70b03f7ec46d,0x3f7dabcc3f7e1324,0x3f7d906e3f7e1324,0x3f7c5d3a3f7cfe73,0x3f7c7eb03f7d3aac,0x3f7ac5163f7baccd,0x3f7b3bab3f7c3b28,0x3f78e3d63f7a1e84
.quad 0x3f79c79d3f7b14be,0x3f76ba073f7853f8,0x3f7822d13f79c79d,0x3f74484b3f764d97,0x3f764d973f7853f8,0x3f718f573f740bdd,0x3f74484b3f76ba07,0x3f6e8ff83f718f57
.quad 0x3f7213523f74fa0b,0x3f6b4b0c3f6ed89e,0x3f6faf1b3f731447,0x3f67c1873f6be858,0x3f6d1c1d3f710908,0x3f63f4733f68bf3c,0x3f6a5ad93f6ed89e,0x3f5fe4e93f655e0b
.quad 0x3f676bd83f6c835e,0x3f5b941a3f61c598,0x3f644fac3f6a09a7,0x3f5703483f5df6be,0x3f6106f23f676bd8,0x3f5233c63f59f26a,0x3f5d924d3f64aa59,0x3f4d26fd3f55b993
.quad 0x3f59f26a3f61c598,0x3f47de653f514d3d,0x3f5627fe3f5ebe05,0x3f425b893f4cae79,0x3f5233c63f5b941a,0x3f3ca0033f47de65,0x3f4e16893f584853,0x3f36ad7f3f42de29
.quad 0x3f49d1123f54db31,0x3f3085bb3f3daef9,0x3f4564393f514d3d,0x3f2a2a803f385216,0x3f40d0da3f4d9f02,0x3f239da93f32c8c9,0x3f3c17d93f49d112,0x3f1ce11f3f2d1469
.quad 0x3f373a233f45e403,0x3f15f6d93f273656,0x3f3238aa3f41d870,0x3f0ee0db3f212ff9,0x3f2d14693f3daef9,0x3f07a1363f1b02c6,0x3f27ce613f396842,0x3f003a063f14b039
.quad 0x3f8000003f800000,0x3f8000003f800000,0x3f7fcbe23f7fd397,0x3f7fba9e3f7fc38f,0x3f7f2f9d3f7f4e6d,0x3f7eea9d3f7f0e58,0x3f7e2b723f7e70b0,0x3f7d906e3f7de0b1
.quad 0x3f7cbfc93f7d3aac,0x3f7baccd3f7c3b28,0x3f7aed373f7baccd,0x3f7940c03f7a1e84,0x3f78b47b3f79c79d,0x3f764d973f778bc5,0x3f76167a3f778bc5,0x3f72d4eb3f748422
.quad 0x3f7314473f74fa0b,0x3f6ed89e3f710908,0x3f6faf1b3f721352,0x3f6a5ad93f6d1c1d,0x3f6be8583f6ed89e,0x3f655e0b3f68bf3c,0x3f67c1873f6b4b0c,0x3f5fe4e93f63f473
.quad 0x3f633c5a3f676bd8,0x3f59f26a3f5ebe05,0x3f5e5aa63f633c5a,0x3f5389c73f591e6a,0x3f591e6a3f5ebe05,0x3f4cae793f531849,0x3f5389c73f59f26a,0x3f4564393f4cae79
.quad 0x3f4d9f023f54db31,0x3f3daef93f45e403,0x3f4760853f4f7a1f,0x3f3592e73f3ebc1b,0x3f40d0da3f49d112,0x3f2d14693f373a23,0x3f39f2ac3f43e200,0x3f24381a3f2f61a5
.quad 0x3f32c8c93f3daef9,0x3f1b02c63f273656,0x3f2b561b3f373a23,0x3f11796b3f1ebc12,0x3f239da93f3085bb,0x3f07a1363f15f6d9,0x3f1ba2993f299415,0x3efafef73f0cead0
.quad 0x3f13682a3f226799,0x3ee633753f039c3d,0x3f0af1b73f1b02c6,0x3ed0eb2a3ef41f07,0x3f0242b13f13682a,0x3ebb31a03ee0924f,0x3ef2bd433f0b9a6b,0x3ea5129f3ecc9b8b
.quad 0x3ee0924f3f039c3d,0x3e8e9a223eb8442a,0x3ece0bea3ef6e0cb,0x3e6fa8b23ea395c5,0x3ebb31a03ee63375,0x3e419b373e8e9a22,0x3ea80b1f3ed53641,0x3e1324ca3e72b651
.quad 0x0,0x0,0x3ce22a7a3cc90ab0,0x3d0a342f3cfb49ba,0x3d6214693d48fb30,0x3d8a200a3d7b2b74,0x3da973ba3d96a905,0x3dcefdb73dbc3ac3
.quad 0x3de1bc2e3dc8bd36,0x3e09cf863dfab273,0x3e0cec4a3dfab273,0x3e2bf8043e1c76de,0x3e28defc3e164083,0x3e4dee603e3b6ecf,0x3e44b0b93e2f10a2,0x3e6fa8b23e5a3997
.quad 0x3e605c133e47c5c2,0x3e888e933e78cfcc,0x3e7bdba43e605c13,0x3e9920fe3e8b9507,0x3e8b95073e78cfcc,0x3ea986c43e9aa086,0x3e9920fe3e888e93,0x3eb9bb1e3ea986c4
.quad 0x3ea68f123e94a031,0x3ec9b9533eb8442a,0x3eb3dca53ea09ae5,0x3ed97cb93ec6d529,0x3ec1071e3eac7cd4,0x3ee900b73ed53641,0x3ece0bea3eb8442a,0x3ef840c83ee363fa
.quad 0x3edae8803ec3ef15,0x3f039c3d3ef15aea,0x3ee79a5d3ecf7bca,0x3f0af1b73eff17b2,0x3ef41f073edae880,0x3f121eb03f064b82,0x3f003a063ee63375,0x3f19210f3f0cead0
.quad 0x3f064b823ef15aea,0x3f1ff6cb3f13682a,0x3f0c42c93efc5d27,0x3f269de33f19c200,0x3f121eb03f039c3d,0x3f2d14693f1ff6cb,0x3f17de123f08f59b,0x3f33587a3f26050a
.quad 0x3f1d7fd13f0e39da,0x3f3968423f2beb4a,0x3f2302d33f13682a,0x3f3f41fc3f31a81d,0x3f2866053f187fc0,0x3f44e3f53f373a23,0x3f2da8593f1d7fd1,0x3f4a4c873f3ca003
.quad 0x3f32c8c93f226799,0x3f4f7a1f3f41d870,0x3f37c6553f273656,0x3f546b3b3f46e22a,0x3f3ca0033f2beb4a,0x3f591e6a3f4bbbf8,0x3f4154e13f3085bb,0x3f5d924d3f5064af
.quad 0x0,0x0,0x3d2351cb3d16c32c,0x3d3c6dd53d2fe007,0x3da3308c3d96a905,0x3dbc3ac33dafb680,0x3df475c03de1bc2e,0x3e0cec4a3e039502
.quad 0x3e22abb63e164083,0x3e3b6ecf3e2f10a2,0x3e4ada4f3e3b6ecf,0x3e698bba3e5a3997,0x3e72b6513e605c13,0x3e8b95073e827dc0,0x3e8d17c03e827dc0,0x3ea218873e97a117
.quad 0x3ea09ae53e94a031,0x3eb8442a3eac7cd4,0x3eb3dca53ea68f12,0x3ece0bea3ec1071e,0x3ec6d5293eb8442a,0x3ee363fa3ed53641,0x3ed97cb93ec9b953,0x3ef840c83ee900b7
.quad 0x3eebcbbb3edae880,0x3f064b823efc5d27,0x3efdbabb3eebcbbb,0x3f102dd53f07a136,0x3f07a1363efc5d27,0x3f19c2003f10d3cd,0x3f102dd53f064b82,0x3f2302d33f19c200
.quad 0x3f187fc03f0e39da,0x3f2beb4a3f226799,0x3f2093933f15f6d9,0x3f34768f3f2ac082,0x3f2866053f1d7fd1,0x3f3ca0033f32c8c9,0x3f2ff3e63f24d225,0x3f4463373f3a7ca4
.quad 0x3f373a233f2beb4a,0x3f4bbbf83f41d870,0x3f3e35c53f32c8c9,0x3f52a6493f48d8b3,0x3f44e3f53f396842,0x3f591e6a3f4f7a1f,0x3f4b41fa3f3fc767,0x3f5f20db3f55b993
.quad 0x3f514d3d3f45e403,0x3f64aa593f5b941a,0x3f5703483f4bbbf8,0x3f69b7e43f6106f2,0x3f5c61c73f514d3d,0x3f6e46be3f660f88,0x3f61668a3f5695e5,0x3f7254703f6aab7b
.quad 0x3f660f883f5b941a,0x3f75dec63f6ed89e,0x3f6a5ad93f604621,0x3f78e3d63f7294f8,0x3f6e46be3f64aa59,0x3f7b61fc3f75dec6,0x3f71d19f3f68bf3c,0x3f7d57de3f78b47b
.quad 0x3f8000003f800000,0x3f8000003f800000,0x3f7fa6e33f7fb10f,0x3f7f90b13f7f9c18,0x3f7e9bc93f7ec46d,0x3f7e43233f7e70b0,0x3f7cdf6c3f7d3aac,0x3f7c187a3f7c7eb0
.quad 0x3f7a73023f7b14be,0x3f7912983f79c79d,0x3f77583a3f7853f8,0x3f75341d3f764d97,0x3f73913f3f74fa0b,0x3f7080663f721352,0x3f6f20b03f710908,0x3f6afb8c3f6d1c1d
.quad 0x3f6a09a73f6c835e,0x3f64aa593f676bd8,0x3f644fac3f676bd8,0x3f5d924d3f6106f2,0x3f5df6be3f61c598,0x3f55b9933f59f26a,0x3f5703483f5b941a,0x3f4d26fd3f5233c6
.quad 0x3f4f7a1f3f54db31,0x3f43e2003f49d112,0x3f4760853f4d9f02,0x3f39f2ac3f40d0da,0x3f3ebc1b3f45e403,0x3f2f61a53f373a23,0x3f3592e73f3daef9,0x3f24381a3f2d1469
.quad 0x3f2beb4a3f3504f3,0x3f187fc03f226799,0x3f21cbfb3f2beb4a,0x3f0c42c93f173c07,0x3f173c073f226799,0x3eff17b23f0b9a6b,0x3f0c42c93f187fc0,0x3ee4cbfe3eff17b2
.quad 0x3f00e7e43f0e39da,0x3ec9b9533ee63375,0x3eea66813f039c3d,0x3eadf73c3ecc9b8b,0x3ed25a093ef15aea,0x3e919ddd3eb263ef,0x3eb9bb1e3edae880,0x3e698bba3e97a117
.quad 0x3ea09ae53ec3ef15,0x3e2f10a23e78cfcc,0x3e870ada3eac7cd4,0x3de7fa9a3e419b37,0x3e5a39973e94a031,0x3d6214693e09cf86,0x3e25c58c3e78cfcc,0xbb490fc63da3308c
.quad 0x3de1bc2e3e47c5c2,0xbd7b2b743cc90ab0,0x3d6ea0383e164083,0xbdf475c0bcfb49ba,0x3bc90f883dc8bd36,0xbe354098bdafb680,0xbd3c6dd53d48fb30,0xbe6fa8b2be1008b7
.quad 0x3f8000003f800000,0x3f8000003f800000,0x3f7f78083f7f84ab,0x3f7f5ce93f7f6ac7,0x3f7de0b13f7e1324,0x3f7d74743f7dabcc,0x3f7b3bab3f7baccd,0x3f7a49103f7ac516
.quad 0x3f778bc53f7853f8,0x3f75dec63f76ba07,0x3f72d4eb3f740bdd,0x3f703b373f718f57,0x3f6d1c1d3f6ed89e,0x3f6965913f6b4b0c,0x3f6667713f68bf3c,0x3f61668a3f63f473
.quad 0x3f5ebe053f61c598,0x3f5848533f5b941a,0x3f5627fe3f59f26a,0x3f4e16893f5233c6,0x3f4cae793f514d3d,0x3f42de293f47de65,0x3f425b893f47de65,0x3f36ad7f3f3ca003
.quad 0x3f373a233f3daef9,0x3f2994153f3085bb,0x3f2b561b3f32c8c9,0x3f1ba2993f239da9,0x3f1ebc123f273656,0x3f0cead03f15f6d9,0x3f11796b3f1b02c6,0x3efafef73f07a136
.quad 0x3f039c3d3f0e39da,0x3edae8803ef15aea,0x3eea66813f00e7e4,0x3eb9bb1e3ed25a09,0x3ecc9b8b3ee63375,0x3e97a1173eb263ef,0x3eadf73c3ec9b953,0x3e698bba3e919ddd
.quad 0x3e8e9a223eac7cd4,0x3e22abb63e605c13,0x3e5d4b1a3e8e9a22,0x3db5f8da3e1c76de,0x3e1c76de3e605c13,0x3c96c9b63dafb680,0x3db5f8da3e22abb6,0xbd55880e3c96c9b6
.quad 0x3cc90ab03dc8bd36,0xbdfab273bd48fb30,0xbd2351cb3d16c32c,0xbe44b0b9bdee3876,0xbdd53db9bcc90ab0,0xbe8586cebe3b6ecf,0xbe2bf804bdafb680,0xbea80b1fbe7ee6e1
.quad 0xbe6c9a7fbe164083,0xbec9b953bea09ae5,0xbe9620d2be541501,0xbeea6681bec1071e,0xbeb554ecbe888e93,0xbf04f484bee0924f,0xbed3c867bea68f12,0xbf140c5fbeff17b2
.quad 0x0,0x0,0x3d55880e3d48fb30,0x3d6ea0383d621469,0x3dd53db93dc8bd36,0x3dee38763de1bc2e,0x3e1f917b3e164083,0x3e3228d43e28defc
.quad 0x3e5415013e47c5c2,0x3e6c9a7f3e605c13,0x3e8402703e78cfcc,0x3e931f353e8b9507,0x3e9d9e783e94a031,0x3eaf713a3ea68f12,0x3eb6ccc33eac7cd4,0x3ecb2aae3ec1071e
.quad 0x3ecf7bca3ec3ef15,0x3ee633753edae880,0x3ee79a5d3edae880,0x3f003a063ef41f07,0x3eff17b23ef15aea,0x3f0cead03f064b82,0x3f0af1b73f039c3d,0x3f19210f3f121eb0
.quad 0x3f15f6d93f0e39da,0x3f24d2253f1d7fd1,0x3f2093933f187fc0,0x3f2ff3e63f286605,0x3f2ac0823f226799,0x3f3a7ca43f32c8c9,0x3f34768f3f2beb4a,0x3f4463373f3ca003
.quad 0x3f3daef93f3504f3,0x3f4d9f023f45e403,0x3f4663543f3daef9,0x3f5627fe3f4e8d90,0x3f4e8d903f45e403,0x3f5df6be3f5695e5,0x3f5627fe3f4d9f02,0x3f6504793f5df6be
.quad 0x3f5d2d533f54db31,0x3f6b4b0c3f64aa59,0x3f6398ac3f5b941a,0x3f70c5013f6aab7b,0x3f6965913f61c598,0x3f756d973f6ff573,0x3f6e8ff83f676bd8,0x3f7940c03f748422
.quad 0x3f7314473f6c835e,0x3f7c3b283f7853f8,0x3f76ef5b3f710908,0x3f7e5a383f7b61fc,0x3f7a1e843f74fa0b,0x3f7f9c183f7dabcc,0x3f7c9f8a3f7853f8,0x3f7fffb13f7f2f9d
.quad 0x3f7e70b03f7b14be,0x3f7f84ab3f7fec43,0x3f7f90b13f7d3aac,0x3f7e2b723f7fe129,0x3f7ffec43f7ec46d,0x3f7bf5313f7f0e58,0x3f7fba9e3f7fb10f,0x3f78e3d63f7d7474
.quad 0x0,0x0,0x3d83db0a3d7b2b74,0x3d9064b43d8a200a,0x3e0395023dfab273,0x3e1008b73e09cf86,0x3e44b0b93e3b6ecf,0x3e57278f3e4dee60
.quad 0x3e827dc03e78cfcc,0x3e8e9a223e888e93,0x3ea218873e9aa086,0x3eb0eacb3ea986c4,0x3ec1071e3eb8442a,0x3ed25a093ec9b953,0x3edf28a93ed53641,0x3ef2bd433ee900b7
.quad 0x3efc5d273ef15aea,0x3f08f59b3f039c3d,0x3f0c42c93f064b82,0x3f17de123f121eb0,0x3f19c2003f13682a,0x3f26050a3f1ff6cb,0x3f269de33f1ff6cb,0x3f33587a3f2d1469
.quad 0x3f32c8c93f2beb4a,0x3f3fc7673f396842,0x3f3e35c53f373a23,0x3f4b41fa3f44e3f5,0x3f48d8b33f41d870,0x3f55b9933f4f7a1f,0x3f52a6493f4bbbf8,0x3f5f20db3f591e6a
.quad 0x3f5b941a3f54db31,0x3f676bd83f61c598,0x3f6398ac3f5d2d53,0x3f6e8ff83f696591,0x3f6aab7b3f64aa59,0x3f7484223f6ff573,0x3f70c5013f6b4b0c,0x3f7940c03f756d97
.quad 0x3f75dec63f710908,0x3f7cbfc93f79c79d,0x3f79f35e3f75dec6,0x3f7efcc93f7cfe73,0x3f7cfe733f79c79d,0x3f7ff4e63f7f0e58,0x3f7efcc93f7cbfc9,0x3f7fa6e33f7ff4e6
.quad 0x3f7fec433f7ec46d,0x3f7e13243f7fb10f,0x3f7fcbe23f7fd397,0x3f7b3bab3f7e4323,0x3f7e9bc93f7fec43,0x3f7724173f7baccd,0x3f7c5d3a3f7f0e58,0x3f71d19f3f77f110
.quad 0x3f7912983f7d3aac,0x3f6b4b0c3f731447,0x3f74bf623f7a7302,0x3f6398ac3f6d1c1d,0x3f6f68303f76ba07,0x3f5ac4503f660f88,0x3f6912ae3f721352,0x3f50d9373f5df6be
.quad 0x3f8000003f800000,0x3f8000003f800000,0x3f7f3f543f7f4e6d,0x3f7f1f493f7f2f9d,0x3f7cfe733f7d3aac,0x3f7c7eb03f7cbfc9,0x3f7940c03f79c79d,0x3f7822d13f78b47b
.quad 0x3f740bdd3f74fa0b,0x3f7213523f731447,0x3f6d67a13f6ed89e,0x3f6a5ad93f6be858,0x3f655e0b3f676bd8,0x3f6106f23f633c5a,0x3f5bfb343f5ebe05,0x3f5627fe3f591e6a
.quad 0x3f514d3d3f54db31,0x3f49d1123f4d9f02,0x3f4564393f49d112,0x3f3c17d93f40d0da,0x3f3852163f3daef9,0x3f2d14693f32c8c9,0x3f2a2a803f3085bb,0x3f1ce11f3f239da9
.quad 0x3f1b02c63f226799,0x3f0b9a6b3f13682a,0x3f0af1b73f13682a,0x3ef2bd433f0242b1,0x3ef41f073f039c3d,0x3ecc9b8b3ee0924f,0x3ed0eb2a3ee63375,0x3ea5129f3ebb31a0
.quad 0x3eac7cd43ec3ef15,0x3e78cfcc3e94a031,0x3e870ada3ea09ae5,0x3e25c58c3e5a3997,0x3e419b373e78cfcc,0x3da3308c3e09cf86,0x3de7fa9a3e2f10a2,0xbb490fc63d621469
.quad 0x3d16c32c3dc8bd36,0xbdafb680bcc90ab0,0xbd2351cb3cc90ab0,0xbe2bf804bdd53db9,0xbdee3876bd48fb30,0xbe7ee6e1be3b6ecf,0xbe44b0b9bdfab273,0xbea80b1fbe8586ce
.quad 0xbe888e93be47c5c2,0xbecf7bcabeac7cd4,0xbeadf73cbe888e93,0xbef58035bed25a09,0xbed25a09beac7cd4,0xbf0cead0bef6e0cb,0xbef58035becf7bca,0xbf1e1e22bf0cead0
.quad 0xbf0b9a6bbef15aea,0xbf2e3bdebf1d7fd1,0xbf1ba299bf08f59b,0xbf3d27b8bf2d1469,0xbf2ac082bf187fc0,0xbf4ac77fbf3b8f3b,0xbf38dd65bf273656,0xbf570348bf48d8b3
.quad 0x3f8000003f800000,0x3f8000003f800000,0x3f7efcc93f7f0e58,0x3f7ed7d43f7eea9d,0x3f7bf5313f7c3b28,0x3f7b61fc3f7baccd,0x3f76ef5b3f778bc5,0x3f75a67b3f764d97
.quad 0x3f6ff5733f710908,0x3f6db2933f6ed89e,0x3f6715993f68bf3c,0x3f6398ac3f655e0b,0x3f5c61c73f5ebe05,0x3f5770263f59f26a,0x3f4fefa83f531849,0x3f4955213f4cae79
.quad 0x3f41d8703f45e403,0x3f3968423f3daef9,0x3f3238aa3f373a23,0x3f27ce613f2d1469,0x3f212ff93f273656,0x3f14b0393f1b02c6,0x3f0ee0db3f15f6d9,0x3f003a063f07a136
.quad 0x3ef6e0cb3f039c3d,0x3ed536413ee63375,0x3ece0bea3ee0924f,0x3ea80b1f3ebb31a0,0x3ea395c53eb8442a,0x3e72b6513e8e9a22,0x3e6fa8b23e8e9a22,0x3e1324ca3e419b37
.quad 0x3e1640833e47c5c2,0x3d48fb303dc8bd36,0x3d6ea0383de1bc2e,0xbd3c6dd53bc90f88,0xbcfb49ba3cc90ab0,0xbe1008b7bdafb680,0xbdf475c0bd7b2b74,0xbe6fa8b2be354098
.quad 0xbe541501be164083,0xbea68f12be888e93,0xbe9620d2be6c9a7f,0xbed3c867beb554ec,0xbec1071ebea09ae5,0xbeff17b2bee0924f,0xbeea6681bec9b953,0xbf140c5fbf04f484
.quad 0xbf08f59bbef15aea,0xbf273656bf187fc0,0xbf1ba299bf0b9a6b,0xbf38dd65bf2ac082,0xbf2d1469bf1d7fd1,0xbf48d8b3bf3b8f3b,0xbf3d27b8bf2e3bde,0xbf570348bf4ac77f
.quad 0xbf4bbbf8bf3daef9,0xbf633c5abf584853,0xbf58b3a1bf4bbbf8,0xbf6d67a1bf63f473,0xbf63f473bf584853,0xbf756d97bf6db293,0xbf6d67a1bf633c5a,0xbf7b3babbf756d97
.quad 0x0,0x0,0x3d9cecf93d96a905,0x3da973ba3da3308c,0x3e1c76de3e164083,0x3e28defc3e22abb6,0x3e698bba3e605c13,0x3e7bdba43e72b651
.quad 0x3e9aa0863e94a031,0x3ea68f123ea09ae5,0x3ebf926f3eb8442a,0x3ece0bea3ec6d529,0x3ee363fa3edae880,0x3ef41f073eebcbbb,0x3f02ef9f3efc5d27,0x3f0c42c93f07a136
.quad 0x3f13682a3f0e39da,0x3f1d7fd13f187fc0,0x3f2302d33f1d7fd1,0x3f2da8593f286605,0x3f31a81d3f2beb4a,0x3f3ca0033f373a23,0x3f3f41fc3f396842,0x3f4a4c873f44e3f5
.quad 0x3f4bbbf83f45e403,0x3f5695e53f514d3d,0x3f5703483f514d3d,0x3f61668a3f5c61c7,0x3f6106f23f5b941a,0x3f6aab7b3f660f88,0x3f69b7e43f64aa59,0x3f7254703f6e46be
.quad 0x3f7109083f6c835e,0x3f7853f83f74fa0b,0x3f76ef5b3f731447,0x3f7c9f8a3f7a1e84,0x3f7b61fc3f7853f8,0x3f7f2f9d3f7dabcc,0x3f7e5a383f7c3b28,0x3f7fffb13f7f9c18
.quad 0x3f7fd3973f7ec46d,0x3f7f0e583f7fec43,0x3f7fcbe23f7fec43,0x3f7c5d3a3f7e9bc9,0x3f7e43233f7fb10f,0x3f77f1103f7baccd,0x3f7b3bab3f7e1324,0x3f71d19f3f772417
.quad 0x3f76ba073f7b14be,0x3f6a09a73f710908,0x3f70c5013f76ba07,0x3f60a6cf3f696591,0x3f6965913f710908,0x3f55b9933f604621,0x3f60a6cf3f6a09a7,0x3f4955213f55b993
.quad 0x3f5695e53f61c598,0x3f3b8f3b3f49d112,0x3f4b41fa3f584853,0x3f2c800f3f3ca003,0x3f3ebc1b3f4d9f02,0x3f1c420c3f2e3bde,0x3f3117223f41d870,0x3f0af1b73f1ebc12
.quad 0x0,0x0,0x3db5f8da3dafb680,0x3dc27c393dbc3ac3,0x3e3540983e2f10a2,0x3e419b373e3b6ecf,0x3e870ada3e827dc0,0x3e901c2c3e8b9507
.quad 0x3eb263ef3eac7cd4,0x3ebe1d4a3eb8442a,0x3edc53c13ed53641,0x3eea66813ee363fa,0x3f0242b13efc5d27,0x3f0a48ad3f064b82,0x3f1553b73f10d3cd,0x3f1e1e223f19c200
.quad 0x3f2736563f226799,0x3f3085bb3f2beb4a,0x3f37c6553f32c8c9,0x3f4154e13f3ca003,0x3f46e22a3f41d870,0x3f5064af3f4bbbf8,0x3f546b3b3f4f7a1f,0x3f5d924d3f591e6a
.quad 0x3f6046213f5b941a,0x3f68bf3c3f64aa59,0x3f6a5ad93f660f88,0x3f71d19f3f6e46be,0x3f7294f83f6ed89e,0x3f78b47b3f75dec6,0x3f78e3d63f75dec6,0x3f7d57de3f7b61fc
.quad 0x3f7d3aac3f7b14be,0x3f7fb10f3f7ec46d,0x3f7f90b13f7e70b0,0x3f7fba9e3f7ffec4,0x3f7fe1293f7fec43,0x3f7d74743f7f0e58,0x3f7e2b723f7f84ab,0x3f78e3d63f7bf531
.quad 0x3f7a73023f7d3aac,0x3f7213523f76ba07,0x3f74bf623f791298,0x3f6912ae3f6f6830,0x3f6d1c1d3f731447,0x3f5df6be3f660f88,0x3f6398ac3f6b4b0c,0x3f50d9373f5ac450
.quad 0x3f5848533f61c598,0x3f41d8703f4d9f02,0x3f4b41fa3f5695e5,0x3f3117223f3ebc1b,0x3f3ca0033f49d112,0x3f1ebc123f2e3bde,0x3f2c800f3f3b8f3b,0x3f0af1b73f1c420c
.quad 0x3f1b02c63f2beb4a,0x3eebcbbb3f08f59b,0x3f084b923f1b02c6,0x3ebf926f3ee900b7,0x3ee900b73f08f59b,0x3e919ddd3ebe1d4a,0x3ebf926f3eebcbbb,0x3e44b0b93e919ddd
.quad 0x3f8000003f800000,0x3f8000003f800000,0x3f7eb0693f7ec46d,0x3f7e868b3f7e9bc9,0x3f7ac5163f7b14be,0x3f7a1e843f7a7302,0x3f74484b3f74fa0b,0x3f72d4eb3f73913f
.quad 0x3f6b4b0c3f6c835e,0x3f68bf3c3f6a09a7,0x3f5fe4e93f61c598,0x3f5bfb343f5df6be,0x3f5233c63f54db31,0x3f4cae793f4f7a1f,0x3f425b893f45e403,0x3f3b06293f3ebc1b
.quad 0x3f3085bb3f3504f3,0x3f2736563f2beb4a,0x3f1ce11f3f226799,0x3f11796b3f173c07,0x3f07a1363f0e39da,0x3ef41f073f00e7e4,0x3ee1fb6a3ef15aea,0x3ec27b553ed25a09
.quad 0x3eb263ef3ec3ef15,0x3e8e9a223ea09ae5,0x3e80f8c03e94a031,0x3e3228d43e5a3997,0x3e1c76de3e47c5c2,0x3d8a200a3de1bc2e,0x3d55880e3dc8bd36,0xbd2351cb3bc90f88
.quad 0xbd48fb30248d3132,0xbe164083bdc8bd36,0xbe195be0bdc8bd36,0xbe80f8c0be4dee60,0xbe7ee6e1be47c5c2,0xbeb554ecbe9aa086,0xbeb0eacbbe94a031,0xbee79a5dbecc9b8b
.quad 0xbee0924fbec3ef15,0xbf0b9a6bbefc5d27,0xbf06f686bef15aea,0xbf21cbfbbf14b039,0xbf1c420cbf0e39da,0xbf36206cbf299415,0xbf2ff3e6bf226799,0xbf485bcabf3ca003
.quad 0xbf41d870bf3504f3,0xbf584853bf4d9f02,0xbf51c0c2bf45e403,0xbf65b710bf5c61c7,0xbf5f8327bf54db31,0xbf708066bf68bf3c,0xbf6afb8cbf61c598,0xbf788486bf7294f8
.quad 0xbf740bddbf6c835e,0xbf7dabccbf79c79d,0xbf7a9c59bf74fa0b,0xbf7fe705bf7e4323,0xbf7e9bc9bf7b14be,0xbf7f2f9dbf7ffb11,0xbf7fffb1bf7ec46d,0xbf7b87b2bf7eea9d
.quad 0x3f8000003f800000,0x3f8000003f800000,0x3f7e5a383f7e70b0,0x3f7e2b723f7e4323,0x3f796e4e3f79c79d,0x3f78b47b3f791298,0x3f714c7a3f721352,0x3f6faf1b3f708066
.quad 0x3f660f883f676bd8,0x3f633c5a3f64aa59,0x3f57dc7f3f59f26a,0x3f5389c73f55b993,0x3f46e22a3f49d112,0x3f40d0da3f43e200,0x3f33587a3f373a23,0x3f2b561b3f2f61a5
.quad 0x3f1d7fd13f226799,0x3f13682a3f187fc0,0x3f05a02c3f0b9a6b,0x3ef2bd433eff17b2,0x3ed8106b3ee63375,0x3ebb31a03ec9b953,0x3ea218873eb263ef,0x3e80f8c03e919ddd
.quad 0x3e5415013e78cfcc,0x3e09cf863e2f10a2,0x3dc27c393e09cf86,0x3c7b514b3d621469,0xbc96c9b63cc90ab0,0xbdd53db9bd7b2b74,0xbe06b26ebdafb680,0xbe636c83be354098
.quad 0xbe78cfccbe47c5c2,0xbeac7cd4be94a031,0xbeb3dca5be9aa086,0xbee4cbfebecc9b8b,0xbee900b7becf7bca,0xbf0cead0bf00e7e4,0xbf0d9281bf00e7e4,0xbf256bcbbf19c200
.quad 0xbf24d225bf187fc0,0xbf3b8f3bbf3085bb,0xbf39f2acbf2e3bde,0xbf4f0417bf44e3f5,0xbf4cae79bf41d870,0xbf5f8327bf5695e5,0xbf5cc7d1bf531849,0xbf6cd007bf655e0b
.quad 0xbf6a09a7bf61c598,0xbf76ba07bf710908,0xbf74484bbf6db293,0xbf7d1cddbf796e4e,0xbf7b61fcbf76ba07,0xbf7fe129bf7e70b0,0xbf7f3f54bf7cbfc9,0xbf7efcc9bf7ffec4
.quad 0xbf7fd397bf7fb10f,0xbf7a7302bf7e1324,0xbf7d1cddbf7f84ab,0xbf725470bf78b47b,0xbf772417bf7c3b28,0xbf66beccbf6ff573,0xbf6dfcf2bf75dec6,0xbf57dc7fbf63f473
.quad 0x0,0x0,0x3dcefdb73dc8bd36,0x3ddb7d373dd53db9,0x3e4dee603e47c5c2,0x3e5a39973e541501,0x3e9920fe3e94a031,0x3ea218873e9d9e78
.quad 0x3ec9b9533ec3ef15,0x3ed536413ecf7bca,0x3ef840c83ef15aea,0x3f02ef9f3eff17b2,0x3f121eb03f0e39da,0x3f19c2003f15f6d9,0x3f269de33f226799,0x3f2ecef73f2ac082
.quad 0x3f3968423f3504f3,0x3f41d8703f3daef9,0x3f4a4c873f45e403,0x3f52a6493f4e8d90,0x3f591e6a3f54db31,0x3f6106f23f5d2d53,0x3f65b7103f61c598,0x3f6cd0073f696591
.quad 0x3f6ff5733f6c835e,0x3f75dec63f731447,0x3f77beb73f74fa0b,0x3f7c187a3f7a1e84,0x3f7cfe733f7b14be,0x3f7f6ac73f7e70b0,0x3f7fa6e33f7ec46d,0x3f7fcbe23f7ffec4
.quad 0x3f7fb10f3f800000,0x3f7d3aac3f7ec46d,0x3f7d1cdd3f7ec46d,0x3f77beb73f7ac516,0x3f77f1103f7b14be,0x3f6f68303f740bdd,0x3f703b373f74fa0b,0x3f644fac3f6aab7b
.quad 0x3f660f883f6c835e,0x3f5695e53f5ebe05,0x3f5988ad3f61c598,0x3f4663543f5064af,0x3f4ac77f3f54db31,0x3f33e7bc3f3fc767,0x3f39f2ac3f45e403,0x3f1f599f3f2d1469
.quad 0x3f2736563f3504f3,0x3f08f59b3f187fc0,0x3f12c39a3f226799,0x3ee1fb6a3f0242b1,0x3ef9a02d3f0e39da,0x3eaf713a3ed53641,0x3ecb2aae3ef15aea,0x3e75c35a3ea395c5
.quad 0x3e9aa0863ec3ef15,0x3e09cf863e605c13,0x3e5101f13e94a031,0x3ce22a7a3dee3876,0x3dd53db93e47c5c2,0xbda3308c3c490e90,0x3b490fc63dc8bd36,0xbe3e853ebdbc3ac3
.quad 0x0,0x0,0x3de7fa9a3de1bc2e,0x3df475c03dee3876,0x3e667c663e605c13,0x3e72b6513e6c9a7f,0x3eab02013ea68f12,0x3eb3dca53eaf713a
.quad 0x3ee0924f3edae880,0x3eebcbbb3ee63375,0x3f099f4e3f064b82,0x3f102dd53f0cead0,0x3f212ff93f1d7fd1,0x3f2866053f24d225,0x3f36ad7f3f32c8c9,0x3f3e35c53f3a7ca4
.quad 0x3f49d1123f45e403,0x3f514d3d3f4d9f02,0x3f5a5ba03f5695e5,0x3f61668a3f5df6be,0x3f6816a83f64aa59,0x3f6e46be3f6b4b0c,0x3f72d4eb3f6ff573,0x3f77beb73f756d97
.quad 0x3f7a73023f7853f8,0x3f7dabcc3f7c3b28,0x3f7ed7d43f7dabcc,0x3f7ff84a3f7f9c18,0x3f7ff4e63f7fec43,0x3f7e9bc93f7f84ab,0x3f7dc68c3f7f0e58,0x3f799b433f7bf531
.quad 0x3f7853f83f7b14be,0x3f7109083f74fa0b,0x3f6faf1b3f740bdd,0x3f6504793f6aab7b,0x3f63f4733f6a09a7,0x3f55b9933f5d2d53,0x3f554aa43f5d2d53,0x3f4360513f4cae79
.quad 0x3f43e2003f4d9f02,0x3f2e3bde3f396842,0x3f2ff3e63f3b8f3b,0x3f16999f3f239da9,0x3f19c2003f273656,0x3ef9a02d3f0b9a6b,0x3f0195733f10d3cd,0x3ec27b553ee363fa
.quad 0x3ecf7bca3ef15aea,0x3e888e933eac7cd4,0x3e9920fe3ebe1d4a,0x3e195be03e667c66,0x3e419b373e888e93,0x3cfb49ba3de1bc2e,0x3d9cecf93e22abb6,0xbdb5f8dabbc90f88
.quad 0xbd16c32c3d48fb30,0xbe541501bdfab273,0xbe195be0bd7b2b74,0xbea5129fbe72b651,0xbe8586cebe2f10a2,0xbeddbe79beb263ef,0xbebca7afbe8e9a22,0xbf099f4ebee900b7
.quad 0x3f8000003f800000,0x3f8000003f800000,0x3f7dfa383f7e1324,0x3f7dc68c3f7de0b1,0x3f77f1103f7853f8,0x3f7724173f778bc5,0x3f6dfcf23f6ed89e,0x3f6c36243f6d1c1d
.quad 0x3f6046213f61c598,0x3f5d2d533f5ebe05,0x3f4f04173f514d3d,0x3f4a4c873f4cae79,0x3f3a7ca43f3daef9,0x3f33e7bc3f373a23,0x3f2302d33f273656,0x3f1a62933f1ebc12
.quad 0x3f08f59b3f0e39da,0x3efc5d273f039c3d,0x3ed97cb93ee63375,0x3ebf926f3ecc9b8b,0x3e9d9e783eac7cd4,0x3e7ee6e13e8e9a22,0x3e3e853e3e605c13,0x3df475c03e1c76de
.quad 0x3d7b2b743dc8bd36,0xbc490e903cc90ab0,0xbd83db0abcc90ab0,0xbe1324cabdd53db9,0xbe419b37be164083,0xbe8b9507be6c9a7f,0xbe9f1cdfbe888e93,0xbecb2aaebeb554ec
.quad 0xbedae880bec3ef15,0xbf039c3dbef15aea,0xbf099f4ebefc5d27,0xbf1f599fbf14b039,0xbf239da9bf187fc0,0xbf385216bf2e3bde,0xbf3b0629bf3085bb,0xbf4e1689bf44e3f5
.quad 0xbf4f7a1fbf45e403,0xbf604621bf584853,0xbf60a6cfbf584853,0xbf6e8ff8bf6816a8,0xbf6e46bebf676bd8,0xbf78b47bbf740bdd,0xbf7822d1bf731447,0xbf7e868bbf7bf531
.quad 0xbf7e1324bf7b14be,0xbf7fec43bf7fb10f,0xbf7fffb1bf7f4e6d,0xbf7cdf6cbf7f2f9d,0xbf7de0b1bf7fb10f,0xbf756d97bf7a7302,0xbf77beb7bf7c3b28,0xbf69b7e4bf718f57
.quad 0xbf6db293bf74fa0b,0xbf59f26abf64aa59,0xbf5fe4e9bf6a09a7,0xbf466354bf53fac3,0xbf4e8d90bf5b941a,0xbf2f61a5bf3fc767,0xbf39f2acbf49d112,0xbf1553b7bf286605
.quad 0x3f8000003f800000,0x3f8000003f800000,0x3f7d906e3f7dabcc,0x3f7d57de3f7d7474,0x3f764d973f76ba07,0x3f756d973f75dec6,0x3f6a5ad93f6b4b0c,0x3f686b393f696591
.quad 0x3f59f26a3f5b941a,0x3f5695e53f584853,0x3f4564393f47de65,0x3f404c5c3f42de29,0x3f2d14693f3085bb,0x3f26050a3f299415,0x3f11796b3f15f6d9,0x3f084b923f0cead0
.quad 0x3ee633753ef15aea,0x3ecf7bca3edae880,0x3ea5129f3eb263ef,0x3e8a11f73e97a117,0x3e419b373e605c13,0x3e0395023e22abb6,0x3d55880e3dafb680,0xbc7b514b3c96c9b6
.quad 0xbdafb680bd48fb30,0xbe22abb6bdfab273,0xbe636c83be3b6ecf,0xbe9920febe8586ce,0xbeb554ecbea09ae5,0xbeddbe79bec9b953,0xbef58035bee0924f,0xbf0ee0dbbf04f484
.quad 0xbf187fc0bf0e39da,0xbf2beb4abf226799,0xbf33587abf299415,0xbf456439bf3ca003,0xbf4ac77fbf41d870,0xbf5ac450bf531849,0xbf5e5aa6bf5695e5,0xbf6b99fbbf655e0b
.quad 0xbf6db293bf676bd8,0xbf778bc5bf731447,0xbf788486bf740bdd,0xbf7e5a38bf7bf531,0xbf7e9bc9bf7c3b28,0xbf7fe129bf7fd397,0xbf7fdaafbf7fd397,0xbf7c187abf7e9bc9
.quad 0xbf7c3b28bf7ec46d,0xbf731447bf7853f8,0xbf73ced9bf791298,0xbf650479bf6d1c1d,0xbf66beccbf6ed89e,0xbf5233c6bf5d2d53,0xbf554aa4bf604621,0xbf3b0629bf48d8b3
.quad 0xbf3fc767bf4d9f02,0xbf1ff6cbbf3085bb,0xbf269de3bf373a23,0xbf019573bf14b039,0xbf0a48adbf1d7fd1,0xbec1071ebeebcbbb,0xbed6a399bf00e7e4,0xbe75c35abea986c4
.quad 0x0,0x0,0x3e0077453dfab273,0x3e06b26e3e039502,0x3e7ee6e13e78cfcc,0x3e8586ce3e827dc0,0x3ebca7af3eb8442a,0x3ec5625c3ec1071e
.quad 0x3ef6e0cb3ef15aea,0x3f00e7e43efc5d27,0x3f16999f3f13682a,0x3f1ce11f3f19c200,0x3f2f61a53f2beb4a,0x3f36206c3f32c8c9,0x3f4564393f41d870,0x3f4c35783f48d8b3
.quad 0x3f5848533f54db31,0x3f5ebe053f5b941a,0x3f67c1873f64aa59,0x3f6d67a13f6aab7b,0x3f73913f3f710908,0x3f77f1103f75dec6,0x3f7b87b23f79c79d,0x3f7e2b723f7cfe73
.quad 0x3f7f84ab3f7ec46d,0x3f7ffb113f7fec43,0x3f7f78083f7fec43,0x3f7d57de3f7e9bc9,0x3f7b61fc3f7d3aac,0x3f764d973f791298,0x3f73530e3f76ba07,0x3f6afb8c3f6f6830
.quad 0x3f676bd83f6c835e,0x3f5b941a3f61c598,0x3f57dc7f3f5ebe05,0x3f485bca3f5064af,0x3f44e3f53f4d9f02,0x3f31a81d3f3b8f3b,0x3f2ecef73f396842,0x3f17de123f239da9
.quad 0x3f15f6d93f226799,0x3ef6e0cb3f08f59b,0x3ef580353f08f59b,0x3eb9bb1e3ed8106b,0x3ebb31a03edae880,0x3e72b6513e9aa086,0x3e7bdba43ea09ae5,0x3ddb7d373e354098
.quad 0x3dfab2733e47c5c2,0xbcc90ab03d48fb30,0xbb490fc63d96a905,0xbe1f917bbda3308c,0xbe039502bd48fb30,0xbe919dddbe541501,0xbe80f8c0be2f10a2,0xbed0eb2abea986c4
.quad 0xbebe1d4abe94a031,0xbf064b82bee63375,0xbef840c8becf7bca,0xbf21cbfbbf0f8784,0xbf173c07bf039c3d,0xbf3a7ca4bf299415,0xbf2ff3e6bf1d7fd1,0xbf4fefa8bf40d0da
.quad 0x0,0x0,0x3e0cec4a3e09cf86,0x3e1324ca3e1008b7,0x3e8b95073e888e93,0x3e919ddd3e8e9a22,0x3ece0bea3ec9b953,0x3ed6a3993ed25a09
.quad 0x3f064b823f039c3d,0x3f0b9a6b3f08f59b,0x3f2302d33f1ff6cb,0x3f28fd413f26050a,0x3f3ca0033f396842,0x3f42de293f3fc767,0x3f52a6493f4f7a1f,0x3f58b3a13f55b993
.quad 0x3f64aa593f61c598,0x3f6a09a73f676bd8,0x3f7254703f6ff573,0x3f76841b3f748422,0x3f7b61fc3f79c79d,0x3f7de0b13f7cbfc9,0x3f7fa6e33f7f0e58,0x3f7ff84a3f7ff4e6
.quad 0x3f7f0e583f7fb10f,0x3f7cbfc93f7e1324,0x3f799b433f7baccd,0x3f74484b3f772417,0x3f6f68303f731447,0x3f66becc3f6b4b0c,0x3f60a6cf3f660f88,0x3f546b3b3f5ac450
.quad 0x3f4d9f023f54db31,0x3f3daef93f45e403,0x3f36ad7f3f3fc767,0x3f2302d33f2d1469,0x3f1c420c3f273656,0x3f04f4843f10d3cd,0x3efdbabb3f0b9a6b,0x3ec8477c3ee363fa
.quad 0x3ebe1d4a3edae880,0x3e827dc03ea09ae5,0x3e75c35a3e9aa086,0x3de7fa9a3e354098,0x3dd53db93e2f10a2,0xbcfb49ba3d16c32c,0xbd0a342f3d16c32c,0xbe3228d4bdd53db9
.quad 0xbe2f10a2bdc8bd36,0xbea09ae5be78cfcc,0xbe9c1fafbe6c9a7f,0xbee4cbfebec1071e,0xbeddbe79beb8442a,0xbf121eb0bf00e7e4,0xbf0d9281bef6e0cb,0xbf2ecef7bf1ebc12
.quad 0xbf299415bf187fc0,0xbf47de65bf396842,0xbf425b89bf32c8c9,0xbf5cc7d1bf5064af,0xbf577026bf49d112,0xbf6d1c1dbf633c5a,0xbf686b39bf5d2d53,0xbf788486bf718f57
.quad 0x3f8000003f800000,0x3f8000003f800000,0x3f7d1cdd3f7d3aac,0x3f7cdf6c3f7cfe73,0x3f7484223f74fa0b,0x3f73913f3f740bdd,0x3f6667713f676bd8,0x3f644fac3f655e0b
.quad 0x3f5318493f54db31,0x3f4f7a1f3f514d3d,0x3f3b06293f3daef9,0x3f3592e73f385216,0x3f1ebc123f226799,0x3f173c073f1b02c6,0x3efdbabb3f039c3d,0x3eea66813ef41f07
.quad 0x3eb8442a3ec3ef15,0x3ea09ae53eac7cd4,0x3e5d4b1a3e78cfcc,0x3e25c58c3e419b37,0x3d8a200a3dc8bd36,0x3bc90f883d16c32c,0xbda973babd48fb30,0xbe195be0bdee3876
.quad 0xbe6c9a7fbe47c5c2,0xbe9aa086be888e93,0xbebf926fbeac7cd4,0xbee4cbfebed25a09,0xbf0242b1bef15aea,0xbf14b039bf0b9a6b,0xbf21cbfbbf187fc0,0xbf33587abf2ac082
.quad 0xbf3daef9bf3504f3,0xbf4d9f02bf45e403,0xbf554aa4bf4d9f02,0xbf62df7bbf5c61c7,0xbf6816a8bf61c598,0xbf7294f8bf6db293,0xbf75a67bbf710908,0xbf7c5d3abf796e4e
.quad 0xbf7dabccbf7b14be,0xbf7ffb11bf7f4e6d,0xbf7ff84abf7fb10f,0xbf7d57debf7f2f9d,0xbf7c7eb0bf7ec46d,0xbf748422bf791298,0xbf73530ebf7853f8,0xbf65b710bf6d1c1d
.quad 0xbf64aa59bf6c835e,0xbf514d3dbf5b941a,0xbf50d937bf5b941a,0xbf37c655bf44e3f5,0xbf385216bf45e403,0xbf19c200bf299415,0xbf1ba299bf2beb4a,0xbeeff7fbbf0a48ad
.quad 0xbef6e0cbbf0e39da,0xbea68f12becf7bca,0xbeb0eacbbedae880,0xbe3228d4be8586ce,0xbe4dee60be94a031,0xbc96c9b6bde1bc2e,0xbd55880ebe164083,0x3e0cec4a3d2fe007
.quad 0x3f8000003f800000,0x3f8000003f800000,0x3f7c9f8a3f7cbfc9,0x3f7c5d3a3f7c7eb0,0x3f7294f83f731447,0x3f718f573f721352,0x3f62241a3f633c5a,0x3f5fe4e93f6106f2
.quad 0x3f4bbbf83f4d9f02,0x3f47de653f49d112,0x3f2ff3e63f32c8c9,0x3f2a2a803f2d1469,0x3f0f87843f13682a,0x3f07a1363f0b9a6b,0x3ed6a3993ee0924f,0x3ec27b553ecc9b8b
.quad 0x3e888e933e94a031,0x3e605c133e78cfcc,0x3ddb7d373e09cf86,0x3d55880e3da3308c,0xbd621469bcc90ab0,0xbdee3876bdafb680,0xbe5d4b1abe3b6ecf,0xbe901c2cbe7ee6e1
.quad 0xbebe1d4abeac7cd4,0xbee0924fbecf7bca,0xbf044889bef6e0cb,0xbf1553b7bf0cead0,0xbf26050abf1d7fd1,0xbf36206cbf2e3bde,0xbf436051bf3b8f3b,0xbf51c0c2bf4ac77f
.quad 0xbf5b941abf54db31,0xbf676bd8bf61c598,0xbf6dfcf2bf68bf3c,0xbf76841bbf7294f8,0xbf7a1e84bf76ba07,0xbf7e9bc9bf7cbfc9,0xbf7fa6e3bf7e70b0,0xbf7f7808bf7ffec4
.quad 0xbf7e70b0bf7fb10f,0xbf791298bf7c3b28,0xbf76841bbf7a7302,0xbf6b99fbbf718f57,0xbf6816a8bf6ed89e,0xbf577026bf604621,0xbf5389c7bf5d2d53,0xbf3d27b8bf48d8b3
.quad 0xbf396842bf45e403,0xbf1d7fd1bf2beb4a,0xbf1a6293bf299415,0xbef2bd43bf0a48ad,0xbeee9479bf08f59b,0xbea395c5bec9b953,0xbea21887bec9b953,0xbe1f917bbe72b651
.quad 0xbe22abb6be78cfcc,0x3c490e90bd96a905,0x3b490fc6bdafb680,0x3e3857ec3dbc3ac3,0x3e28defc3d96a905,0x3eaf713a3e827dc0,0x3ea5129f3e6c9a7f,0x3efdbabb3ed25a09
.quad 0x0,0x0,0x3e195be03e164083,0x3e1f917b3e1c76de,0x3e97a1173e94a031,0x3e9d9e783e9aa086,0x3edf28a93edae880,0x3ee79a5d3ee363fa
.quad 0x3f10d3cd3f0e39da,0x3f15f6d93f13682a,0x3f2ecef73f2beb4a,0x3f34768f3f31a81d,0x3f48d8b33f45e403,0x3f4e8d903f4bbbf8,0x3f5e5aa63f5b941a,0x3f6398ac3f6106f2
.quad 0x3f6ed89e3f6c835e,0x3f7314473f710908,0x3f79f35e3f7853f8,0x3f7c9f8a3f7b61fc,0x3f7f6ac73f7ec46d,0x3f7ffec43f7fd397,0x3f7f1f493f7fb10f,0x3f7d1cdd3f7e4323
.quad 0x3f7912983f7b14be,0x3f740bdd3f76ba07,0x3f6d67a13f710908,0x3f6504793f696591,0x3f5c61c73f61c598,0x3f5064af3f5695e5,0x3f4663543f4d9f02,0x3f36ad7f3f3ebc1b
.quad 0x3f2beb4a3f3504f3,0x3f187fc03f226799,0x3f0d92813f187fc0,0x3eed30633f0242b1,0x3ed8106b3ef15aea,0x3ea395c53ebe1d4a,0x3e901c2c3eac7cd4,0x3e2bf8043e667c66
.quad 0x3e09cf863e47c5c2,0x3c490e903d96a905,0xbc7b514b3d48fb30,0xbe1324cabda3308c,0xbe28defcbdc8bd36,0xbe97a117be6c9a7f,0xbe9f1cdfbe78cfcc,0xbee1fb6abec1071e
.quad 0xbee63375bec3ef15,0xbf13682abf039c3d,0xbf140c5fbf039c3d,0xbf3238aabf239da9,0xbf31a81dbf226799,0xbf4cae79bf3fc767,0xbf4b41fabf3daef9,0xbf62241abf577026
.quad 0xbf604621bf54db31,0xbf721352bf6a09a7,0xbf703b37bf676bd8,0xbf7c187abf772417,0xbf7ac516bf74fa0b,0xbf7ff4e6bf7e70b0,0xbf7fa6e3bf7d3aac,0xbf7d906ebf7fc38f
.quad 0x0,0x0,0x3e25c58c3e22abb6,0x3e2bf8043e28defc,0x3ea395c53ea09ae5,0x3ea986c43ea68f12,0x3eeff7fb3eebcbbb,0x3ef840c83ef41f07
.quad 0x3f1b02c63f187fc0,0x3f1ff6cb3f1d7fd1,0x3f39f2ac3f373a23,0x3f3f41fc3f3ca003,0x3f53fac33f514d3d,0x3f591e6a3f5695e5,0x3f686b393f660f88,0x3f6cd0073f6aab7b
.quad 0x3f76ba073f74fa0b,0x3f79c79d3f7853f8,0x3f7e868b3f7dabcc,0x3f7fa6e33f7f2f9d,0x3f7f9c183f7fec43,0x3f7e43233f7f0e58,0x3f79f35e3f7baccd,0x3f75a67b3f77f110
.quad 0x3f6db2933f710908,0x3f660f883f6a09a7,0x3f5b2c793f604621,0x3f4fefa83f55b993,0x3f42de293f49d112,0x3f33e7bc3f3b8f3b,0x3f256bcb3f2e3bde,0x3f12c39a3f1c420c
.quad 0x3f039c3d3f0e39da,0x3edae8803ef15aea,0x3ebca7af3ed53641,0x3e8a11f73ea395c5,0x3e5a39973e888e93,0x3dd53db93e22abb6,0x3d55880e3de1bc2e,0xbd83db0abbc90f88
.quad 0xbde1bc2ebd48fb30,0xbe6c9a7fbe2f10a2,0xbe8a11f7be541501,0xbec8477cbea986c4,0xbed8106bbeb8442a,0xbf0a48adbef6e0cb,0xbf102dd5bf00e7e4,0xbf2c800fbf1ebc12
.quad 0xbf3085bbbf226799,0xbf49d112bf3daef9,0xbf4c3578bf3fc767,0xbf61668abf577026,0xbf628210bf584853,0xbf7294f8bf6b4b0c,0xbf72d4ebbf6b4b0c,0xbf7cdf6cbf78b47b
.quad 0xbf7cbfc9bf7853f8,0xbf7ffb11bf7f4e6d,0xbf7fffb1bf7f0e58,0xbf7bd14dbf7eea9d,0xbf7c7eb0bf7f4e6d,0xbf708066bf778bc5,0xbf725470bf791298,0xbf5e5aa6bf696591
.quad 0x3f8000003f800000,0x3f8000003f800000,0x3f7c187a3f7c3b28,0x3f7bd14d3f7bf531,0x3f7080663f710908,0x3f6f68303f6ff573,0x3f5d924d3f5ebe05,0x3f5b2c793f5c61c7
.quad 0x3f43e2003f45e403,0x3f3fc7673f41d870,0x3f24381a3f273656,0x3f1e1e223f212ff9,0x3eff17b23f039c3d,0x3eee94793ef6e0cb,0x3eadf73c3eb8442a,0x3e9920fe3ea395c5
.quad 0x3e2f10a23e47c5c2,0x3dfab2733e164083,0xbb490fc63cc90ab0,0xbd6ea038bcfb49ba,0xbe354098be164083,0xbe72b651be541501,0xbeb0eacbbea09ae5,0xbed0eb2abec1071e
.quad 0xbf00e7e4bef15aea,0xbf10d3cdbf08f59b,0xbf256bcbbf1d7fd1,0xbf34768fbf2d1469,0xbf44e3f5bf3daef9,0xbf5233c6bf4bbbf8,0xbf5e5aa6bf584853,0xbf6912aebf63f473
.quad 0xbf710908bf6c835e,0xbf7853f8bf74fa0b,0xbf7c5d3abf79c79d,0xbf7f7808bf7e4323,0xbf7ffec4bf7fb10f,0xbf7e4323bf7f84ab,0xbf7bd14dbf7e1324,0xbf74bf62bf78b47b
.quad 0xbf6ff573bf74fa0b,0xbf633c5abf6a09a7,0xbf5cc7d1bf64aa59,0xbf4a4c87bf53fac3,0xbf42de29bf4d9f02,0xbf2ac082bf373a23,0xbf2302d3bf3085bb,0xbf05a02cbf14b039
.quad 0xbefc5d27bf0e39da,0xbeb8442abedae880,0xbeab0201becf7bca,0xbe3e853ebe8586ce,0xbe28defcbe78cfcc,0xbbc90f88bdafb680,0x3c16cb58bd96a905,0x3e3228d43dbc3ac3
.quad 0x3e3b6ecf3dc8bd36,0x3eb263ef3e888e93,0x3eb3dca53e888e93,0x3f02ef9f3eddbe79,0x3f0242b13edae880,0x3f2866053f15f6d9,0x3f269de33f13682a,0x3f485bca3f385216
.quad 0x3f8000003f800000,0x3f8000003f800000,0x3f7b87b23f7baccd,0x3f7b3bab3f7b61fc,0x3f6e46be3f6ed89e,0x3f6d1c1d3f6db293,0x3f58b3a13f59f26a,0x3f5627fe3f577026
.quad 0x3f3b8f3b3f3daef9,0x3f373a233f396842,0x3f17de123f1b02c6,0x3f11796b3f14b039,0x3eddbe793ee63375,0x3ecc9b8b3ed53641,0x3e8402703e8e9a22,0x3e5d4b1a3e72b651
.quad 0x3d96a9053dc8bd36,0x3cc90ab03d48fb30,0xbde7fa9abdafb680,0xbe2bf804be1008b7,0xbe97a117be888e93,0xbeb554ecbea68f12,0xbeeff7fbbee0924f,0xbf06f686beff17b2
.quad 0xbf1ff6cbbf187fc0,0xbf2e3bdebf273656,0xbf425b89bf3b8f3b,0xbf4f0417bf48d8b3,0xbf5df6bebf584853,0xbf6816a8bf633c5a,0xbf71d19fbf6db293,0xbf788486bf756d97
.quad 0xbf7d3aacbf7b14be,0xbf7fb10fbf7ec46d,0xbf7fcbe2bf7ffb11,0xbf7d57debf7eea9d,0xbf796e4ebf7c3b28,0xbf718f57bf75dec6,0xbf6a5ad9bf6ff573,0xbf5cc7d1bf63f473
.quad 0xbf531849bf5b941a,0xbf3fc767bf49d112,0xbf34768fbf3fc767,0xbf1ba299bf286605,0xbf0f8784bf1d7fd1,0xbee363fabf00e7e4,0xbecb2aaebeebcbbb,0xbe870adabea986c4
.quad 0xbe605c13be94a031,0xbd96a905be164083,0xbd0a342fbde1bc2e,0x3df475c03d2fe007,0x3e1c76de3d96a905,0x3e9d9e783e6c9a7f,0x3eab02013e827dc0,0x3ef840c83ed25a09
.quad 0x3f00e7e43edae880,0x3f24d2253f13682a,0x3f27ce613f15f6d9,0x3f4760853f385216,0x3f48d8b33f396842,0x3f6282103f5695e5,0x3f62df7b3f5695e5,0x3f75341d3f6d1c1d
.quad 0x0,0x0,0x3e3228d43e2f10a2,0x3e3857ec3e354098,0x3eaf713a3eac7cd4,0x3eb554ec3eb263ef,0x3f003a063efc5d27,0x3f0448893f0242b1
.quad 0x3f24d2253f226799,0x3f2994153f273656,0x3f4463373f41d870,0x3f4955213f46e22a,0x3f5df6be3f5b941a,0x3f6282103f604621,0x3f70c5013f6ed89e,0x3f74484b3f7294f8
.quad 0x3f7c3b283f7b14be,0x3f7e13243f7d3aac,0x3f7fffb13f7fec43,0x3f7f90b13f7fe129,0x3f7bf5313f7d3aac,0x3f78b47b3f7a7302,0x3f703b373f731447,0x3f69b7e43f6d1c1d
.quad 0x3f5d2d533f61c598,0x3f5318493f584853,0x3f4360513f49d112,0x3f3592e73f3ca003,0x3f239da93f2beb4a,0x3f121eb03f1b02c6,0x3efdbabb3f08f59b,0x3ed3c8673ee900b7
.quad 0x3eac7cd43ec3ef15,0x3e78cfcc3e94a031,0x3e2bf8043e605c13,0x3d83db0a3dee3876,0xbbc90f883d48fb30,0xbdee3876bd7b2b74,0xbe3857ecbdfab273,0xbe9620d2be72b651
.quad 0xbeb263efbe94a031,0xbeebcbbbbecf7bca,0xbf019573bee63375,0xbf1ce11fbf0f8784,0xbf26050abf187fc0,0xbf3ebc1bbf32c8c9,0xbf456439bf396842,0xbf5a5ba0bf5064af
.quad 0xbf5ebe05bf54db31,0xbf6ed89ebf676bd8,0xbf714c7abf6a09a7,0xbf7b87b2bf772417,0xbf7c7eb0bf7853f8,0xbf7ffec4bf7f0e58,0xbf7ffd39bf7f4e6d,0xbf7c187abf7eea9d
.quad 0xbf7baccdbf7ec46d,0xbf6ff573bf76ba07,0xbf6faf1bbf76ba07,0xbf5bfb34bf66becc,0xbf5c61c7bf676bd8,0xbf40d0dabf4f7a1f,0xbf425b89bf514d3d,0xbf1f599fbf31a81d
.quad 0x0,0x0,0x3e3e853e3e3b6ecf,0x3e44b0b93e419b37,0x3ebb31a03eb8442a,0x3ec1071e3ebe1d4a,0x3f084b923f064b82,0x3f0c42c93f0a48ad
.quad 0x3f2e3bde3f2beb4a,0x3f32c8c93f3085bb,0x3f4e16893f4bbbf8,0x3f52a6493f5064af,0x3f66becc3f64aa59,0x3f6aab7b3f68bf3c,0x3f77583a3f75dec6,0x3f79f35e3f78b47b
.quad 0x3f7f4e6d3f7ec46d,0x3f7fec433f7fb10f,0x3f7e5a383f7f0e58,0x3f7c5d3a3f7d7474,0x3f7484223f76ba07,0x3f6f68303f721352,0x3f62241a3f660f88,0x3f5988ad3f5df6be
.quad 0x3f47de653f4d9f02,0x3f3b8f3b3f41d870,0x3f269de33f2e3bde,0x3f16999f3f1ebc12,0x3eff17b23f08f59b,0x3ed8106b3eebcbbb,0x3ea80b1f3ebe1d4a,0x3e75c35a3e919ddd
.quad 0x3e1640833e47c5c2,0x3d48fb303dc8bd36,0xbd2351cb3c490e90,0xbe1324cabdbc3ac3,0xbe667c66be2f10a2,0xbea986c4be8e9a22,0xbece0beabeb263ef,0xbf019573bee900b7
.quad 0xbf10d3cdbf039c3d,0xbf299415bf1d7fd1,0xbf3592e7bf299415,0xbf4b41fabf40d0da,0xbf53fac3bf49d112,0xbf655e0bbf5d2d53,0xbf6afb8cbf633c5a,0xbf76ef5bbf718f57
.quad 0xbf79c79dbf74fa0b,0xbf7f4e6dbf7d3aac,0xbf7fdaafbf7e70b0,0xbf7e2b72bf7fc38f,0xbf7cfe73bf7f4e6d,0xbf73913fbf791298,0xbf714c7abf778bc5,0xbf5fe4e9bf696591
.quad 0xbf5d2d53bf676bd8,0xbf43e200bf514d3d,0xbf4154e1bf4f7a1f,0xbf209393bf31a81d,0xbf1ebc12bf3085bb,0xbeee9479bf0b9a6b,0xbeed3063bf0b9a6b,0xbe931f35bec1071e
.quad 0x3f803f803f803f80,0x3f803f803f803f80,0x3f553f6d3f7b3f80,0xbf0ebec4be480000,0x3ec43f353f6d3f80,0xbec4bf35bf6dbf80,0xbe483ec43f553f80,0x3f7b3f6d3f0e8000
.quad 0xbf3500003f353f80,0xbf3500003f353f80,0xbf7bbec43f0e3f80,0xbe48bf6dbf550000,0xbf6dbf353ec43f80,0x3f6d3f35bec4bf80,0xbf0ebf6d3e483f80,0xbf553ec43f7b8000
.quad 0x8000bf8000003f80,0x8000bf8000003f80,0x3f0ebf6dbe483f80,0x3f553ec4bf7b0000,0x3f6dbf35bec43f80,0xbf6d3f353ec4bf80,0x3f7bbec4bf0e3f80,0x3e48bf6d3f558000
.quad 0x3f358000bf353f80,0x3f358000bf353f80,0x3e483ec4bf553f80,0xbf7b3f6dbf0e0000,0xbec43f35bf6d3f80,0x3ec4bf353f6dbf80,0xbf553f6dbf7b3f80,0x3f0ebec43e488000
.quad 0xbf803f80bf803f80,0xbf803f80bf803f80,0xbf553f6dbf7b3f80,0x3f0ebec43e480000,0xbec43f35bf6d3f80,0x3ec4bf353f6dbf80,0x3e483ec4bf553f80,0xbf7b3f6dbf0e8000
.quad 0x3f350000bf353f80,0x3f350000bf353f80,0x3f7bbec4bf0e3f80,0x3e48bf6d3f550000,0x3f6dbf35bec43f80,0xbf6d3f353ec4bf80,0x3f0ebf6dbe483f80,0x3f553ec4bf7b8000
.quad 0xbf8080003f80,0xbf8080003f80,0xbf0ebf6d3e483f80,0xbf553ec43f7b0000,0xbf6dbf353ec43f80,0x3f6d3f35bec4bf80,0xbf7bbec43f0e3f80,0xbe48bf6dbf558000
.quad 0xbf3580003f353f80,0xbf3580003f353f80,0xbe483ec43f553f80,0x3f7b3f6d3f0e0000,0x3ec43f353f6d3f80,0xbec4bf35bf6dbf80,0x3f553f6d3f7b3f80,0xbf0ebec4be488000
.quad 0x3f803f803f803f80,0x3f803f803f803f80,0x3e483ec43f0e3f35,0xbf7bbf6dbf55bf35,0xbf6dbf35bec40000,0x3f6d3f353ec48000,0xbf0ebf6dbf7bbf35,0xbf55bec43e483f35
.quad 0x3f358000bf35bf80,0x3f358000bf35bf80,0x3f553f6d3e48bf35,0xbf0e3ec43f7b3f35,0xbec43f353f6d8000,0x3ec4bf35bf6d0000,0xbf7bbec43f553f35,0xbe483f6d3f0ebf35
.quad 0x8000bf8000003f80,0x8000bf8000003f80,0x3f7bbec4bf553f35,0x3e483f6dbf0ebf35,0x3ec43f35bf6d0000,0xbec4bf353f6d8000,0xbf553f6dbe48bf35,0x3f0e3ec4bf7b3f35
.quad 0xbf3500003f35bf80,0xbf3500003f35bf80,0x3f0ebf6d3f7bbf35,0x3f55bec4be483f35,0x3f6dbf353ec48000,0xbf6d3f35bec40000,0xbe483ec4bf0e3f35,0x3f7bbf6d3f55bf35
.quad 0xbf803f80bf803f80,0xbf803f80bf803f80,0xbe483ec4bf0e3f35,0x3f7bbf6d3f55bf35,0x3f6dbf353ec40000,0xbf6d3f35bec48000,0x3f0ebf6d3f7bbf35,0x3f55bec4be483f35
.quad 0xbf3580003f35bf80,0xbf3580003f35bf80,0xbf553f6dbe48bf35,0x3f0e3ec4bf7b3f35,0x3ec43f35bf6d8000,0xbec4bf353f6d0000,0x3f7bbec4bf553f35,0x3e483f6dbf0ebf35
.quad 0xbf8080003f80,0xbf8080003f80,0xbf7bbec43f553f35,0xbe483f6d3f0ebf35,0xbec43f353f6d0000,0x3ec4bf35bf6d8000,0x3f553f6d3e48bf35,0xbf0e3ec43f7b3f35
.quad 0x3f350000bf35bf80,0x3f350000bf35bf80,0xbf0ebf6dbf7bbf35,0xbf55bec43e483f35,0xbf6dbf35bec48000,0x3f6d3f353ec40000,0x3e483ec43f0e3f35,0xbf7bbf6dbf55bf35
.quad 0x3f803f803f803f80,0x3f803f803f803f80,0xbf55bf6dbf7bbf80,0x3f0e3ec43e488000,0x3ec43f353f6d3f80,0xbec4bf35bf6dbf80,0x3e48bec4bf55bf80,0xbf7bbf6dbf0e0000
.quad 0xbf3500003f353f80,0xbf3500003f353f80,0x3f7b3ec4bf0ebf80,0x3e483f6d3f558000,0xbf6dbf353ec43f80,0x3f6d3f35bec4bf80,0x3f0e3f6dbe48bf80,0x3f55bec4bf7b0000
.quad 0x8000bf8000003f80,0x8000bf8000003f80,0xbf0e3f6d3e48bf80,0xbf55bec43f7b8000,0x3f6dbf35bec43f80,0xbf6d3f353ec4bf80,0xbf7b3ec43f0ebf80,0xbe483f6dbf550000
.quad 0x3f358000bf353f80,0x3f358000bf353f80,0xbe48bec43f55bf80,0x3f7bbf6d3f0e8000,0xbec43f35bf6d3f80,0x3ec4bf353f6dbf80,0x3f55bf6d3f7bbf80,0xbf0e3ec4be480000
.quad 0xbf803f80bf803f80,0xbf803f80bf803f80,0x3f55bf6d3f7bbf80,0xbf0e3ec4be488000,0xbec43f35bf6d3f80,0x3ec4bf353f6dbf80,0xbe48bec43f55bf80,0x3f7bbf6d3f0e0000
.quad 0x3f350000bf353f80,0x3f350000bf353f80,0xbf7b3ec43f0ebf80,0xbe483f6dbf558000,0x3f6dbf35bec43f80,0xbf6d3f353ec4bf80,0xbf0e3f6d3e48bf80,0xbf55bec43f7b0000
.quad 0xbf8080003f80,0xbf8080003f80,0x3f0e3f6dbe48bf80,0x3f55bec4bf7b8000,0xbf6dbf353ec43f80,0x3f6d3f35bec4bf80,0x3f7b3ec4bf0ebf80,0x3e483f6d3f550000
.quad 0xbf3580003f353f80,0xbf3580003f353f80,0x3e48bec4bf55bf80,0xbf7bbf6dbf0e8000,0x3ec43f353f6d3f80,0xbec4bf35bf6dbf80,0xbf55bf6dbf7bbf80,0x3f0e3ec43e480000
.quad 0x3f803f803f803f80,0x3f803f803f803f80,0xbe48bec4bf0ebf35,0x3f7b3f6d3f553f35,0xbf6dbf35bec40000,0x3f6d3f353ec48000,0x3f0e3f6d3f7b3f35,0x3f553ec4be48bf35
.quad 0x3f358000bf35bf80,0x3f358000bf35bf80,0xbf55bf6dbe483f35,0x3f0ebec4bf7bbf35,0xbec43f353f6d8000,0x3ec4bf35bf6d0000,0x3f7b3ec4bf55bf35,0x3e48bf6dbf0e3f35
.quad 0x8000bf8000003f80,0x8000bf8000003f80,0xbf7b3ec43f55bf35,0xbe48bf6d3f0e3f35,0x3ec43f35bf6d0000,0xbec4bf353f6d8000,0x3f55bf6d3e483f35,0xbf0ebec43f7bbf35
.quad 0xbf3500003f35bf80,0xbf3500003f35bf80,0xbf0e3f6dbf7b3f35,0xbf553ec43e48bf35,0x3f6dbf353ec48000,0xbf6d3f35bec40000,0x3e48bec43f0ebf35,0xbf7b3f6dbf553f35
.quad 0xbf803f80bf803f80,0xbf803f80bf803f80,0x3e48bec43f0ebf35,0xbf7b3f6dbf553f35,0x3f6dbf353ec40000,0xbf6d3f35bec48000,0xbf0e3f6dbf7b3f35,0xbf553ec43e48bf35
.quad 0xbf3580003f35bf80,0xbf3580003f35bf80,0x3f55bf6d3e483f35,0xbf0ebec43f7bbf35,0x3ec43f35bf6d8000,0xbec4bf353f6d0000,0xbf7b3ec43f55bf35,0xbe48bf6d3f0e3f35
.quad 0xbf8080003f80,0xbf8080003f80,0x3f7b3ec4bf55bf35,0x3e48bf6dbf0e3f35,0xbec43f353f6d0000,0x3ec4bf35bf6d8000,0xbf55bf6dbe483f35,0x3f0ebec4bf7bbf35
.quad 0x3f350000bf35bf80,0x3f350000bf35bf80,0x3f0e3f6d3f7b3f35,0x3f553ec4be48bf35,0xbf6dbf35bec48000,0x3f6d3f353ec40000,0xbe48bec4bf0ebf35,0x3f7b3f6d3f553f35
.quad 0x3f803f803f803f80,0x3f803f803f803f80,0x3f753f7b3f7f3f80,0x3ef13f0e3f223f35,0x3f553f6d3f7b3f80,0xbf0ebec4be480000,0x3f223f553f753f80,0xbf7fbf7bbf62bf35
.quad 0x3ec43f353f6d3f80,0xbec4bf35bf6dbf80,0x3dc93f0e3f623f80,0x3f223e48be95bf35,0xbe483ec43f553f80,0x3f7b3f6d3f0e8000,0xbef13e483f463f80,0x3e953f553f7f3f35
.quad 0xbf3500003f353f80,0xbf3500003f353f80,0xbf62be483f223f80,0xbf75bf55bdc93f35,0xbf7bbec43f0e3f80,0xbe48bf6dbf550000,0xbf7fbf0e3ef13f80,0x3f46be48bf75bf35
.quad 0xbf6dbf353ec43f80,0x3f6d3f35bec4bf80,0xbf46bf553e953f80,0x3dc93f7b3ef1bf35,0xbf0ebf6d3e483f80,0xbf553ec43f7b8000,0xbe95bf7b3dc93f80,0xbf62bf0e3f463f35
.quad 0x8000bf8000003f80,0x8000bf8000003f80,0x3e95bf7bbdc93f80,0x3f62bf0ebf463f35,0x3f0ebf6dbe483f80,0x3f553ec4bf7b0000,0x3f46bf55be953f80,0xbdc93f7bbef1bf35
.quad 0x3f6dbf35bec43f80,0xbf6d3f353ec4bf80,0x3f7fbf0ebef13f80,0xbf46be483f75bf35,0x3f7bbec4bf0e3f80,0x3e48bf6d3f558000,0x3f62be48bf223f80,0x3f75bf553dc93f35
.quad 0x3f358000bf353f80,0x3f358000bf353f80,0x3ef13e48bf463f80,0xbe953f55bf7f3f35,0x3e483ec4bf553f80,0xbf7b3f6dbf0e0000,0xbdc93f0ebf623f80,0xbf223e483e95bf35
.quad 0xbec43f35bf6d3f80,0x3ec4bf353f6dbf80,0xbf223f55bf753f80,0x3f7fbf7b3f62bf35,0xbf553f6dbf7b3f80,0x3f0ebec43e488000,0xbf753f7bbf7f3f80,0xbef13f0ebf223f35
.quad 0x3f803f803f803f80,0x3f803f803f803f80,0x3f463f553f623f6d,0x3dc93e483e953ec4,0x3e483ec43f0e3f35,0xbf7bbf6dbf55bf35,0xbef1be483dc93ec4,0xbe95bf0ebf46bf6d
.quad 0xbf6dbf35bec40000,0x3f6d3f353ec48000,0xbf75bf7bbf46bec4,0x3ef13f553f7f3f6d,0xbf0ebf6dbf7bbf35,0xbf55bec43e483f35,0x3dc9bf0ebf75bf6d,0xbf22bf7bbf62bec4
.quad 0x3f358000bf35bf80,0x3f358000bf35bf80,0x3f7f3f0ebe95bf6d,0x3f463f7b3ef1bec4,0x3f553f6d3e48bf35,0xbf0e3ec43f7b3f35,0x3e953f7b3f22bec4,0xbf62bf553dc93f6d
.quad 0xbec43f353f6d8000,0x3ec4bf35bf6d0000,0xbf623e483f7f3ec4,0x3f753f0ebf22bf6d,0xbf7bbec43f553f35,0xbe483f6d3f0ebf35,0xbf22bf553ef13f6d,0xbf7fbe483f753ec4
.quad 0x8000bf8000003f80,0x8000bf8000003f80,0x3f22bf55bef13f6d,0x3f7fbe48bf753ec4,0x3f7bbec4bf553f35,0x3e483f6dbf0ebf35,0x3f623e48bf7f3ec4,0xbf753f0e3f22bf6d
.quad 0x3ec43f35bf6d0000,0xbec4bf353f6d8000,0xbe953f7bbf22bec4,0x3f62bf55bdc93f6d,0xbf553f6dbe48bf35,0x3f0e3ec4bf7b3f35,0xbf7f3f0e3e95bf6d,0xbf463f7bbef1bec4
.quad 0xbf3500003f35bf80,0xbf3500003f35bf80,0xbdc9bf0e3f75bf6d,0x3f22bf7b3f62bec4,0x3f0ebf6d3f7bbf35,0x3f55bec4be483f35,0x3f75bf7b3f46bec4,0xbef13f55bf7f3f6d
.quad 0x3f6dbf353ec48000,0xbf6d3f35bec40000,0x3ef1be48bdc93ec4,0x3e95bf0e3f46bf6d,0xbe483ec4bf0e3f35,0x3f7bbf6d3f55bf35,0xbf463f55bf623f6d,0xbdc93e48be953ec4
.quad 0x3f803f803f803f80,0x3f803f803f803f80,0xbe95be48bdc90000,0xbf62bf55bf46bf35,0xbf55bf6dbf7bbf80,0x3f0e3ec43e488000,0x3f463f0e3e958000,0xbdc93e483ef13f35
.quad 0x3ec43f353f6d3f80,0xbec4bf35bf6dbf80,0xbf7fbf55bef10000,0x3f463f7b3f753f35,0x3e48bec4bf55bf80,0xbf7bbf6dbf0e0000,0x3f623f7b3f228000,0x3f753f0ebdc9bf35
.quad 0xbf3500003f353f80,0xbf3500003f353f80,0xbef1bf7bbf460000,0x3e95bf0ebf7fbf35,0x3f7b3ec4bf0ebf80,0x3e483f6d3f558000,0xbdc93f553f628000,0xbf22bf7bbe953f35
.quad 0xbf6dbf353ec43f80,0x3f6d3f35bec4bf80,0x3f22bf0ebf750000,0xbf7fbe483f623f35,0x3f0e3f6dbe48bf80,0x3f55bec4bf7b0000,0xbf753e483f7f8000,0xbef13f553f22bf35
.quad 0x8000bf8000003f80,0x8000bf8000003f80,0x3f753e48bf7f0000,0x3ef13f55bf22bf35,0xbf0e3f6d3e48bf80,0xbf55bec43f7b8000,0xbf22bf0e3f758000,0x3f7fbe48bf623f35
.quad 0x3f6dbf35bec43f80,0xbf6d3f353ec4bf80,0x3dc93f55bf620000,0x3f22bf7b3e953f35,0xbf7b3ec43f0ebf80,0xbe483f6dbf550000,0x3ef1bf7b3f468000,0xbe95bf0e3f7fbf35
.quad 0x3f358000bf353f80,0x3f358000bf353f80,0xbf623f7bbf220000,0xbf753f0e3dc9bf35,0xbe48bec43f55bf80,0x3f7bbf6d3f0e8000,0x3f7fbf553ef18000,0xbf463f7bbf753f35
.quad 0xbec43f35bf6d3f80,0x3ec4bf353f6dbf80,0xbf463f0ebe950000,0x3dc93e48bef13f35,0x3f55bf6d3f7bbf80,0xbf0e3ec4be480000,0x3e95be483dc98000,0x3f62bf553f46bf35
.quad 0x3f803f803f803f80,0x3f803f803f803f80,0xbf22bf0ebef1bec4,0xbf7fbf7bbf75bf6d,0xbe48bec4bf0ebf35,0x3f7b3f6d3f553f35,0x3f623f7b3f7f3f6d,0xbf75bf55bf22bec4
.quad 0xbf6dbf35bec40000,0x3f6d3f353ec48000,0x3e95be48bf22bf6d,0xbf62bf0ebdc93ec4,0x3f0e3f6d3f7b3f35,0x3f553ec4be48bf35,0xbf7fbf55be953ec4,0xbf46be483ef13f6d
.quad 0x3f358000bf35bf80,0x3f358000bf35bf80,0x3dc93f553f753ec4,0xbf223e483f623f6d,0xbf55bf6dbe483f35,0x3f0ebec4bf7bbf35,0x3f753e48bf46bf6d,0xbef13f0e3f7f3ec4
.quad 0xbec43f353f6d8000,0x3ec4bf35bf6d0000,0xbef1bf7bbdc93f6d,0xbe953f553f46bec4,0x3f7b3ec4bf55bf35,0x3e48bf6dbf0e3f35,0xbf463f0e3f62bec4,0xbdc93f7b3e95bf6d
.quad 0x8000bf8000003f80,0x8000bf8000003f80,0x3f463f0ebf62bec4,0x3dc93f7bbe95bf6d,0xbf7b3ec43f55bf35,0xbe48bf6d3f0e3f35,0x3ef1bf7b3dc93f6d,0x3e953f55bf46bec4
.quad 0x3ec43f35bf6d0000,0xbec4bf353f6d8000,0xbf753e483f46bf6d,0x3ef13f0ebf7f3ec4,0x3f55bf6d3e483f35,0xbf0ebec43f7bbf35,0xbdc93f55bf753ec4,0x3f223e48bf623f6d
.quad 0xbf3500003f35bf80,0xbf3500003f35bf80,0x3f7fbf553e953ec4,0x3f46be48bef13f6d,0xbf0e3f6dbf7b3f35,0xbf553ec43e48bf35,0xbe95be483f22bf6d,0x3f62bf0e3dc93ec4
.quad 0x3f6dbf353ec48000,0xbf6d3f35bec40000,0xbf623f7bbf7f3f6d,0x3f75bf553f22bec4,0x3e48bec43f0ebf35,0xbf7b3f6dbf553f35,0x3f22bf0e3ef1bec4,0x3f7fbf7b3f75bf6d
.quad 0x3f803f803f803f80,0x3f803f803f803f80,0xbf75bf7bbf7fbf80,0xbef1bf0ebf22bf35,0x3f553f6d3f7b3f80,0xbf0ebec4be480000,0xbf22bf55bf75bf80,0x3f7f3f7b3f623f35
.quad 0x3ec43f353f6d3f80,0xbec4bf35bf6dbf80,0xbdc9bf0ebf62bf80,0xbf22be483e953f35,0xbe483ec43f553f80,0x3f7b3f6d3f0e8000,0x3ef1be48bf46bf80,0xbe95bf55bf7fbf35
.quad 0xbf3500003f353f80,0xbf3500003f353f80,0x3f623e48bf22bf80,0x3f753f553dc9bf35,0xbf7bbec43f0e3f80,0xbe48bf6dbf550000,0x3f7f3f0ebef1bf80,0xbf463e483f753f35
.quad 0xbf6dbf353ec43f80,0x3f6d3f35bec4bf80,0x3f463f55be95bf80,0xbdc9bf7bbef13f35,0xbf0ebf6d3e483f80,0xbf553ec43f7b8000,0x3e953f7bbdc9bf80,0x3f623f0ebf46bf35
.quad 0x8000bf8000003f80,0x8000bf8000003f80,0xbe953f7b3dc9bf80,0xbf623f0e3f46bf35,0x3f0ebf6dbe483f80,0x3f553ec4bf7b0000,0xbf463f553e95bf80,0x3dc9bf7b3ef13f35
.quad 0x3f6dbf35bec43f80,0xbf6d3f353ec4bf80,0xbf7f3f0e3ef1bf80,0x3f463e48bf753f35,0x3f7bbec4bf0e3f80,0x3e48bf6d3f558000,0xbf623e483f22bf80,0xbf753f55bdc9bf35
.quad 0x3f358000bf353f80,0x3f358000bf353f80,0xbef1be483f46bf80,0x3e95bf553f7fbf35,0x3e483ec4bf553f80,0xbf7b3f6dbf0e0000,0x3dc9bf0e3f62bf80,0x3f22be48be953f35
.quad 0xbec43f35bf6d3f80,0x3ec4bf353f6dbf80,0x3f22bf553f75bf80,0xbf7f3f7bbf623f35,0xbf553f6dbf7b3f80,0x3f0ebec43e488000,0x3f75bf7b3f7fbf80,0x3ef1bf0e3f22bf35
.quad 0x3f803f803f803f80,0x3f803f803f803f80,0xbf46bf55bf62bf6d,0xbdc9be48be95bec4,0x3e483ec43f0e3f35,0xbf7bbf6dbf55bf35,0x3ef13e48bdc9bec4,0x3e953f0e3f463f6d
.quad 0xbf6dbf35bec40000,0x3f6d3f353ec48000,0x3f753f7b3f463ec4,0xbef1bf55bf7fbf6d,0xbf0ebf6dbf7bbf35,0xbf55bec43e483f35,0xbdc93f0e3f753f6d,0x3f223f7b3f623ec4
.quad 0x3f358000bf35bf80,0x3f358000bf35bf80,0xbf7fbf0e3e953f6d,0xbf46bf7bbef13ec4,0x3f553f6d3e48bf35,0xbf0e3ec43f7b3f35,0xbe95bf7bbf223ec4,0x3f623f55bdc9bf6d
.quad 0xbec43f353f6d8000,0x3ec4bf35bf6d0000,0x3f62be48bf7fbec4,0xbf75bf0e3f223f6d,0xbf7bbec43f553f35,0xbe483f6d3f0ebf35,0x3f223f55bef1bf6d,0x3f7f3e48bf75bec4
.quad 0x8000bf8000003f80,0x8000bf8000003f80,0xbf223f553ef1bf6d,0xbf7f3e483f75bec4,0x3f7bbec4bf553f35,0x3e483f6dbf0ebf35,0xbf62be483f7fbec4,0x3f75bf0ebf223f6d
.quad 0x3ec43f35bf6d0000,0xbec4bf353f6d8000,0x3e95bf7b3f223ec4,0xbf623f553dc9bf6d,0xbf553f6dbe48bf35,0x3f0e3ec4bf7b3f35,0x3f7fbf0ebe953f6d,0x3f46bf7b3ef13ec4
.quad 0xbf3500003f35bf80,0xbf3500003f35bf80,0x3dc93f0ebf753f6d,0xbf223f7bbf623ec4,0x3f0ebf6d3f7bbf35,0x3f55bec4be483f35,0xbf753f7bbf463ec4,0x3ef1bf553f7fbf6d
.quad 0x3f6dbf353ec48000,0xbf6d3f35bec40000,0xbef13e483dc9bec4,0xbe953f0ebf463f6d,0xbe483ec4bf0e3f35,0x3f7bbf6d3f55bf35,0x3f46bf553f62bf6d,0x3dc9be483e95bec4
.quad 0x3f803f803f803f80,0x3f803f803f803f80,0x3e953e483dc98000,0x3f623f553f463f35,0xbf55bf6dbf7bbf80,0x3f0e3ec43e488000,0xbf46bf0ebe950000,0x3dc9be48bef1bf35
.quad 0x3ec43f353f6d3f80,0xbec4bf35bf6dbf80,0x3f7f3f553ef18000,0xbf46bf7bbf75bf35,0x3e48bec4bf55bf80,0xbf7bbf6dbf0e0000,0xbf62bf7bbf220000,0xbf75bf0e3dc93f35
.quad 0xbf3500003f353f80,0xbf3500003f353f80,0x3ef13f7b3f468000,0xbe953f0e3f7f3f35,0x3f7b3ec4bf0ebf80,0x3e483f6d3f558000,0x3dc9bf55bf620000,0x3f223f7b3e95bf35
.quad 0xbf6dbf353ec43f80,0x3f6d3f35bec4bf80,0xbf223f0e3f758000,0x3f7f3e48bf62bf35,0x3f0e3f6dbe48bf80,0x3f55bec4bf7b0000,0x3f75be48bf7f0000,0x3ef1bf55bf223f35
.quad 0x8000bf8000003f80,0x8000bf8000003f80,0xbf75be483f7f8000,0xbef1bf553f223f35,0xbf0e3f6d3e48bf80,0xbf55bec43f7b8000,0x3f223f0ebf750000,0xbf7f3e483f62bf35
.quad 0x3f6dbf35bec43f80,0xbf6d3f353ec4bf80,0xbdc9bf553f628000,0xbf223f7bbe95bf35,0xbf7b3ec43f0ebf80,0xbe483f6dbf550000,0xbef13f7bbf460000,0x3e953f0ebf7f3f35
.quad 0x3f358000bf353f80,0x3f358000bf353f80,0x3f62bf7b3f228000,0x3f75bf0ebdc93f35,0xbe48bec43f55bf80,0x3f7bbf6d3f0e8000,0xbf7f3f55bef10000,0x3f46bf7b3f75bf35
.quad 0xbec43f35bf6d3f80,0x3ec4bf353f6dbf80,0x3f46bf0e3e958000,0xbdc9be483ef1bf35,0x3f55bf6d3f7bbf80,0xbf0e3ec4be480000,0xbe953e48bdc90000,0xbf623f55bf463f35
.quad 0x3f803f803f803f80,0x3f803f803f803f80,0x3f223f0e3ef13ec4,0x3f7f3f7b3f753f6d,0xbe48bec4bf0ebf35,0x3f7b3f6d3f553f35,0xbf62bf7bbf7fbf6d,0x3f753f553f223ec4
.quad 0xbf6dbf35bec40000,0x3f6d3f353ec48000,0xbe953e483f223f6d,0x3f623f0e3dc9bec4,0x3f0e3f6d3f7b3f35,0x3f553ec4be48bf35,0x3f7f3f553e95bec4,0x3f463e48bef1bf6d
.quad 0x3f358000bf35bf80,0x3f358000bf35bf80,0xbdc9bf55bf75bec4,0x3f22be48bf62bf6d,0xbf55bf6dbe483f35,0x3f0ebec4bf7bbf35,0xbf75be483f463f6d,0x3ef1bf0ebf7fbec4
.quad 0xbec43f353f6d8000,0x3ec4bf35bf6d0000,0x3ef13f7b3dc9bf6d,0x3e95bf55bf463ec4,0x3f7b3ec4bf55bf35,0x3e48bf6dbf0e3f35,0x3f46bf0ebf623ec4,0x3dc9bf7bbe953f6d
.quad 0x8000bf8000003f80,0x8000bf8000003f80,0xbf46bf0e3f623ec4,0xbdc9bf7b3e953f6d,0xbf7b3ec43f55bf35,0xbe48bf6d3f0e3f35,0xbef13f7bbdc9bf6d,0xbe95bf553f463ec4
.quad 0x3ec43f35bf6d0000,0xbec4bf353f6d8000,0x3f75be48bf463f6d,0xbef1bf0e3f7fbec4,0x3f55bf6d3e483f35,0xbf0ebec43f7bbf35,0x3dc9bf553f75bec4,0xbf22be483f62bf6d
.quad 0xbf3500003f35bf80,0xbf3500003f35bf80,0xbf7f3f55be95bec4,0xbf463e483ef1bf6d,0xbf0e3f6dbf7b3f35,0xbf553ec43e48bf35,0x3e953e48bf223f6d,0xbf623f0ebdc9bec4
.quad 0x3f6dbf353ec48000,0xbf6d3f35bec40000,0x3f62bf7b3f7fbf6d,0xbf753f55bf223ec4,0x3e48bec43f0ebf35,0xbf7b3f6dbf553f35,0xbf223f0ebef13ec4,0xbf7f3f7bbf753f6d
.quad 0xbf803f80bf803f80,0xbf803f80bf803f80,0xbf753f7bbf7f3f80,0xbef13f0ebf223f35,0xbf553f6dbf7b3f80,0x3f0ebec43e480000,0xbf223f55bf753f80,0x3f7fbf7b3f62bf35
.quad 0xbec43f35bf6d3f80,0x3ec4bf353f6dbf80,0xbdc93f0ebf623f80,0xbf223e483e95bf35,0x3e483ec4bf553f80,0xbf7b3f6dbf0e8000,0x3ef13e48bf463f80,0xbe953f55bf7f3f35
.quad 0x3f350000bf353f80,0x3f350000bf353f80,0x3f62be48bf223f80,0x3f75bf553dc93f35,0x3f7bbec4bf0e3f80,0x3e48bf6d3f550000,0x3f7fbf0ebef13f80,0xbf46be483f75bf35
.quad 0x3f6dbf35bec43f80,0xbf6d3f353ec4bf80,0x3f46bf55be953f80,0xbdc93f7bbef1bf35,0x3f0ebf6dbe483f80,0x3f553ec4bf7b8000,0x3e95bf7bbdc93f80,0x3f62bf0ebf463f35
.quad 0xbf8080003f80,0xbf8080003f80,0xbe95bf7b3dc93f80,0xbf62bf0e3f463f35,0xbf0ebf6d3e483f80,0xbf553ec43f7b0000,0xbf46bf553e953f80,0x3dc93f7b3ef1bf35
.quad 0xbf6dbf353ec43f80,0x3f6d3f35bec4bf80,0xbf7fbf0e3ef13f80,0x3f46be48bf75bf35,0xbf7bbec43f0e3f80,0xbe48bf6dbf558000,0xbf62be483f223f80,0xbf75bf55bdc93f35
.quad 0xbf3580003f353f80,0xbf3580003f353f80,0xbef13e483f463f80,0x3e953f553f7f3f35,0xbe483ec43f553f80,0x3f7b3f6d3f0e0000,0x3dc93f0e3f623f80,0x3f223e48be95bf35
.quad 0x3ec43f353f6d3f80,0xbec4bf35bf6dbf80,0x3f223f553f753f80,0xbf7fbf7bbf62bf35,0x3f553f6d3f7b3f80,0xbf0ebec4be488000,0x3f753f7b3f7f3f80,0x3ef13f0e3f223f35
.quad 0xbf803f80bf803f80,0xbf803f80bf803f80,0xbf463f55bf623f6d,0xbdc93e48be953ec4,0xbe483ec4bf0e3f35,0x3f7bbf6d3f55bf35,0x3ef1be48bdc93ec4,0x3e95bf0e3f46bf6d
.quad 0x3f6dbf353ec40000,0xbf6d3f35bec48000,0x3f75bf7b3f46bec4,0xbef13f55bf7f3f6d,0x3f0ebf6d3f7bbf35,0x3f55bec4be483f35,0xbdc9bf0e3f75bf6d,0x3f22bf7b3f62bec4
.quad 0xbf3580003f35bf80,0xbf3580003f35bf80,0xbf7f3f0e3e95bf6d,0xbf463f7bbef1bec4,0xbf553f6dbe48bf35,0x3f0e3ec4bf7b3f35,0xbe953f7bbf22bec4,0x3f62bf55bdc93f6d
.quad 0x3ec43f35bf6d8000,0xbec4bf353f6d0000,0x3f623e48bf7f3ec4,0xbf753f0e3f22bf6d,0x3f7bbec4bf553f35,0x3e483f6dbf0ebf35,0x3f22bf55bef13f6d,0x3f7fbe48bf753ec4
.quad 0xbf8080003f80,0xbf8080003f80,0xbf22bf553ef13f6d,0xbf7fbe483f753ec4,0xbf7bbec43f553f35,0xbe483f6d3f0ebf35,0xbf623e483f7f3ec4,0x3f753f0ebf22bf6d
.quad 0xbec43f353f6d0000,0x3ec4bf35bf6d8000,0x3e953f7b3f22bec4,0xbf62bf553dc93f6d,0x3f553f6d3e48bf35,0xbf0e3ec43f7b3f35,0x3f7f3f0ebe95bf6d,0x3f463f7b3ef1bec4
.quad 0x3f350000bf35bf80,0x3f350000bf35bf80,0x3dc9bf0ebf75bf6d,0xbf22bf7bbf62bec4,0xbf0ebf6dbf7bbf35,0xbf55bec43e483f35,0xbf75bf7bbf46bec4,0x3ef13f553f7f3f6d
.quad 0xbf6dbf35bec48000,0x3f6d3f353ec40000,0xbef1be483dc93ec4,0xbe95bf0ebf46bf6d,0x3e483ec43f0e3f35,0xbf7bbf6dbf55bf35,0x3f463f553f623f6d,0x3dc93e483e953ec4
.quad 0xbf803f80bf803f80,0xbf803f80bf803f80,0x3e95be483dc90000,0x3f62bf553f46bf35,0x3f55bf6d3f7bbf80,0xbf0e3ec4be488000,0xbf463f0ebe958000,0x3dc93e48bef13f35
.quad 0xbec43f35bf6d3f80,0x3ec4bf353f6dbf80,0x3f7fbf553ef10000,0xbf463f7bbf753f35,0xbe48bec43f55bf80,0x3f7bbf6d3f0e0000,0xbf623f7bbf228000,0xbf753f0e3dc9bf35
.quad 0x3f350000bf353f80,0x3f350000bf353f80,0x3ef1bf7b3f460000,0xbe95bf0e3f7fbf35,0xbf7b3ec43f0ebf80,0xbe483f6dbf558000,0x3dc93f55bf628000,0x3f22bf7b3e953f35
.quad 0x3f6dbf35bec43f80,0xbf6d3f353ec4bf80,0xbf22bf0e3f750000,0x3f7fbe48bf623f35,0xbf0e3f6d3e48bf80,0xbf55bec43f7b0000,0x3f753e48bf7f8000,0x3ef13f55bf22bf35
.quad 0xbf8080003f80,0xbf8080003f80,0xbf753e483f7f0000,0xbef13f553f22bf35,0x3f0e3f6dbe48bf80,0x3f55bec4bf7b8000,0x3f22bf0ebf758000,0xbf7fbe483f623f35
.quad 0xbf6dbf353ec43f80,0x3f6d3f35bec4bf80,0xbdc93f553f620000,0xbf22bf7bbe953f35,0x3f7b3ec4bf0ebf80,0x3e483f6d3f550000,0xbef1bf7bbf468000,0x3e95bf0ebf7fbf35
.quad 0xbf3580003f353f80,0xbf3580003f353f80,0x3f623f7b3f220000,0x3f753f0ebdc9bf35,0x3e48bec4bf55bf80,0xbf7bbf6dbf0e8000,0xbf7fbf55bef18000,0x3f463f7b3f753f35
.quad 0x3ec43f353f6d3f80,0xbec4bf35bf6dbf80,0x3f463f0e3e950000,0xbdc93e483ef13f35,0xbf55bf6dbf7bbf80,0x3f0e3ec43e480000,0xbe95be48bdc98000,0xbf62bf55bf46bf35
.quad 0xbf803f80bf803f80,0xbf803f80bf803f80,0x3f22bf0e3ef1bec4,0x3f7fbf7b3f75bf6d,0x3e48bec43f0ebf35,0xbf7b3f6dbf553f35,0xbf623f7bbf7f3f6d,0x3f75bf553f22bec4
.quad 0x3f6dbf353ec40000,0xbf6d3f35bec48000,0xbe95be483f22bf6d,0x3f62bf0e3dc93ec4,0xbf0e3f6dbf7b3f35,0xbf553ec43e48bf35,0x3f7fbf553e953ec4,0x3f46be48bef13f6d
.quad 0xbf3580003f35bf80,0xbf3580003f35bf80,0xbdc93f55bf753ec4,0x3f223e48bf623f6d,0x3f55bf6d3e483f35,0xbf0ebec43f7bbf35,0xbf753e483f46bf6d,0x3ef13f0ebf7f3ec4
.quad 0x3ec43f35bf6d8000,0xbec4bf353f6d0000,0x3ef1bf7b3dc93f6d,0x3e953f55bf46bec4,0xbf7b3ec43f55bf35,0xbe48bf6d3f0e3f35,0x3f463f0ebf62bec4,0x3dc93f7bbe95bf6d
.quad 0xbf8080003f80,0xbf8080003f80,0xbf463f0e3f62bec4,0xbdc93f7b3e95bf6d,0x3f7b3ec4bf55bf35,0x3e48bf6dbf0e3f35,0xbef1bf7bbdc93f6d,0xbe953f553f46bec4
.quad 0xbec43f353f6d0000,0x3ec4bf35bf6d8000,0x3f753e48bf46bf6d,0xbef13f0e3f7f3ec4,0xbf55bf6dbe483f35,0x3f0ebec4bf7bbf35,0x3dc93f553f753ec4,0xbf223e483f623f6d
.quad 0x3f350000bf35bf80,0x3f350000bf35bf80,0xbf7fbf55be953ec4,0xbf46be483ef13f6d,0x3f0e3f6d3f7b3f35,0x3f553ec4be48bf35,0x3e95be48bf22bf6d,0xbf62bf0ebdc93ec4
.quad 0xbf6dbf35bec48000,0x3f6d3f353ec40000,0x3f623f7b3f7f3f6d,0xbf75bf55bf22bec4,0xbe48bec4bf0ebf35,0x3f7b3f6d3f553f35,0xbf22bf0ebef1bec4,0xbf7fbf7bbf75bf6d
.quad 0xbf803f80bf803f80,0xbf803f80bf803f80,0x3f75bf7b3f7fbf80,0x3ef1bf0e3f22bf35,0xbf553f6dbf7b3f80,0x3f0ebec43e480000,0x3f22bf553f75bf80,0xbf7f3f7bbf623f35
.quad 0xbec43f35bf6d3f80,0x3ec4bf353f6dbf80,0x3dc9bf0e3f62bf80,0x3f22be48be953f35,0x3e483ec4bf553f80,0xbf7b3f6dbf0e8000,0xbef1be483f46bf80,0x3e95bf553f7fbf35
.quad 0x3f350000bf353f80,0x3f350000bf353f80,0xbf623e483f22bf80,0xbf753f55bdc9bf35,0x3f7bbec4bf0e3f80,0x3e48bf6d3f550000,0xbf7f3f0e3ef1bf80,0x3f463e48bf753f35
.quad 0x3f6dbf35bec43f80,0xbf6d3f353ec4bf80,0xbf463f553e95bf80,0x3dc9bf7b3ef13f35,0x3f0ebf6dbe483f80,0x3f553ec4bf7b8000,0xbe953f7b3dc9bf80,0xbf623f0e3f46bf35
.quad 0xbf8080003f80,0xbf8080003f80,0x3e953f7bbdc9bf80,0x3f623f0ebf46bf35,0xbf0ebf6d3e483f80,0xbf553ec43f7b0000,0x3f463f55be95bf80,0xbdc9bf7bbef13f35
.quad 0xbf6dbf353ec43f80,0x3f6d3f35bec4bf80,0x3f7f3f0ebef1bf80,0xbf463e483f753f35,0xbf7bbec43f0e3f80,0xbe48bf6dbf558000,0x3f623e48bf22bf80,0x3f753f553dc9bf35
.quad 0xbf3580003f353f80,0xbf3580003f353f80,0x3ef1be48bf46bf80,0xbe95bf55bf7fbf35,0xbe483ec43f553f80,0x3f7b3f6d3f0e0000,0xbdc9bf0ebf62bf80,0xbf22be483e953f35
.quad 0x3ec43f353f6d3f80,0xbec4bf35bf6dbf80,0xbf22bf55bf75bf80,0x3f7f3f7b3f623f35,0x3f553f6d3f7b3f80,0xbf0ebec4be488000,0xbf75bf7bbf7fbf80,0xbef1bf0ebf22bf35
.quad 0xbf803f80bf803f80,0xbf803f80bf803f80,0x3f46bf553f62bf6d,0x3dc9be483e95bec4,0xbe483ec4bf0e3f35,0x3f7bbf6d3f55bf35,0xbef13e483dc9bec4,0xbe953f0ebf463f6d
.quad 0x3f6dbf353ec40000,0xbf6d3f35bec48000,0xbf753f7bbf463ec4,0x3ef1bf553f7fbf6d,0x3f0ebf6d3f7bbf35,0x3f55bec4be483f35,0x3dc93f0ebf753f6d,0xbf223f7bbf623ec4
.quad 0xbf3580003f35bf80,0xbf3580003f35bf80,0x3f7fbf0ebe953f6d,0x3f46bf7b3ef13ec4,0xbf553f6dbe48bf35,0x3f0e3ec4bf7b3f35,0x3e95bf7b3f223ec4,0xbf623f553dc9bf6d
.quad 0x3ec43f35bf6d8000,0xbec4bf353f6d0000,0xbf62be483f7fbec4,0x3f75bf0ebf223f6d,0x3f7bbec4bf553f35,0x3e483f6dbf0ebf35,0xbf223f553ef1bf6d,0xbf7f3e483f75bec4
.quad 0xbf8080003f80,0xbf8080003f80,0x3f223f55bef1bf6d,0x3f7f3e48bf75bec4,0xbf7bbec43f553f35,0xbe483f6d3f0ebf35,0x3f62be48bf7fbec4,0xbf75bf0e3f223f6d
.quad 0xbec43f353f6d0000,0x3ec4bf35bf6d8000,0xbe95bf7bbf223ec4,0x3f623f55bdc9bf6d,0x3f553f6d3e48bf35,0xbf0e3ec43f7b3f35,0xbf7fbf0e3e953f6d,0xbf46bf7bbef13ec4
.quad 0x3f350000bf35bf80,0x3f350000bf35bf80,0xbdc93f0e3f753f6d,0x3f223f7b3f623ec4,0xbf0ebf6dbf7bbf35,0xbf55bec43e483f35,0x3f753f7b3f463ec4,0xbef1bf55bf7fbf6d
.quad 0xbf6dbf35bec48000,0x3f6d3f353ec40000,0x3ef13e48bdc9bec4,0x3e953f0e3f463f6d,0x3e483ec43f0e3f35,0xbf7bbf6dbf55bf35,0xbf46bf55bf62bf6d,0xbdc9be48be95bec4
.quad 0xbf803f80bf803f80,0xbf803f80bf803f80,0xbe953e48bdc98000,0xbf623f55bf463f35,0x3f55bf6d3f7bbf80,0xbf0e3ec4be488000,0x3f46bf0e3e950000,0xbdc9be483ef1bf35
.quad 0xbec43f35bf6d3f80,0x3ec4bf353f6dbf80,0xbf7f3f55bef18000,0x3f46bf7b3f75bf35,0xbe48bec43f55bf80,0x3f7bbf6d3f0e0000,0x3f62bf7b3f220000,0x3f75bf0ebdc93f35
.quad 0x3f350000bf353f80,0x3f350000bf353f80,0xbef13f7bbf468000,0x3e953f0ebf7f3f35,0xbf7b3ec43f0ebf80,0xbe483f6dbf558000,0xbdc9bf553f620000,0xbf223f7bbe95bf35
.quad 0x3f6dbf35bec43f80,0xbf6d3f353ec4bf80,0x3f223f0ebf758000,0xbf7f3e483f62bf35,0xbf0e3f6d3e48bf80,0xbf55bec43f7b0000,0xbf75be483f7f0000,0xbef1bf553f223f35
.quad 0xbf8080003f80,0xbf8080003f80,0x3f75be48bf7f8000,0x3ef1bf55bf223f35,0x3f0e3f6dbe48bf80,0x3f55bec4bf7b8000,0xbf223f0e3f750000,0x3f7f3e48bf62bf35
.quad 0xbf6dbf353ec43f80,0x3f6d3f35bec4bf80,0x3dc9bf55bf628000,0x3f223f7b3e95bf35,0x3f7b3ec4bf0ebf80,0x3e483f6d3f550000,0x3ef13f7b3f460000,0xbe953f0e3f7f3f35
.quad 0xbf3580003f353f80,0xbf3580003f353f80,0xbf62bf7bbf228000,0xbf75bf0e3dc93f35,0x3e48bec4bf55bf80,0xbf7bbf6dbf0e8000,0x3f7f3f553ef10000,0xbf46bf7bbf75bf35
.quad 0x3ec43f353f6d3f80,0xbec4bf35bf6dbf80,0xbf46bf0ebe958000,0x3dc9be48bef1bf35,0xbf55bf6dbf7bbf80,0x3f0e3ec43e480000,0x3e953e483dc90000,0x3f623f553f463f35
.quad 0xbf803f80bf803f80,0xbf803f80bf803f80,0xbf223f0ebef13ec4,0xbf7f3f7bbf753f6d,0x3e48bec43f0ebf35,0xbf7b3f6dbf553f35,0x3f62bf7b3f7fbf6d,0xbf753f55bf223ec4
.quad 0x3f6dbf353ec40000,0xbf6d3f35bec48000,0x3e953e48bf223f6d,0xbf623f0ebdc9bec4,0xbf0e3f6dbf7b3f35,0xbf553ec43e48bf35,0xbf7f3f55be95bec4,0xbf463e483ef1bf6d
.quad 0xbf3580003f35bf80,0xbf3580003f35bf80,0x3dc9bf553f75bec4,0xbf22be483f62bf6d,0x3f55bf6d3e483f35,0xbf0ebec43f7bbf35,0x3f75be48bf463f6d,0xbef1bf0e3f7fbec4
.quad 0x3ec43f35bf6d8000,0xbec4bf353f6d0000,0xbef13f7bbdc9bf6d,0xbe95bf553f463ec4,0xbf7b3ec43f55bf35,0xbe48bf6d3f0e3f35,0xbf46bf0e3f623ec4,0xbdc9bf7b3e953f6d
.quad 0xbf8080003f80,0xbf8080003f80,0x3f46bf0ebf623ec4,0x3dc9bf7bbe953f6d,0x3f7b3ec4bf55bf35,0x3e48bf6dbf0e3f35,0x3ef13f7b3dc9bf6d,0x3e95bf55bf463ec4
.quad 0xbec43f353f6d0000,0x3ec4bf35bf6d8000,0xbf75be483f463f6d,0x3ef1bf0ebf7fbec4,0xbf55bf6dbe483f35,0x3f0ebec4bf7bbf35,0xbdc9bf55bf75bec4,0x3f22be48bf62bf6d
.quad 0x3f350000bf35bf80,0x3f350000bf35bf80,0x3f7f3f553e95bec4,0x3f463e48bef1bf6d,0x3f0e3f6d3f7b3f35,0x3f553ec4be48bf35,0xbe953e483f223f6d,0x3f623f0e3dc9bec4
.quad 0xbf6dbf35bec48000,0x3f6d3f353ec40000,0xbf62bf7bbf7fbf6d,0x3f753f553f223ec4,0xbe48bec4bf0ebf35,0x3f7b3f6d3f553f35,0x3f223f0e3ef13ec4,0x3f7f3f7b3f753f6d
.quad 0x0,0x0,0x3e953e483dc90000,0x3f623f553f463f35,0x3f0e3ec43e480000,0x3f553f6d3f7b3f80,0x3f463f0e3e950000,0xbdc93e483ef13f35
.quad 0x3f6d3f353ec40000,0xbf6dbf35bec40000,0x3f7f3f553ef10000,0xbf46bf7bbf75bf35,0x3f7b3f6d3f0e0000,0x3e48bec4bf55bf80,0x3f623f7b3f220000,0x3f753f0ebdc9bf35
.quad 0x3f353f803f350000,0x3f353f803f350000,0x3ef13f7b3f460000,0xbe953f0e3f7f3f35,0x3e483f6d3f550000,0xbf7bbec43f0e3f80,0xbdc93f553f620000,0xbf22bf7bbe953f35
.quad 0xbec43f353f6d0000,0x3ec4bf35bf6d0000,0xbf223f0e3f750000,0x3f7f3e48bf62bf35,0xbf553ec43f7b0000,0x3f0e3f6dbe48bf80,0xbf753e483f7f0000,0xbef13f553f22bf35
.quad 0xbf8000003f800000,0xbf8000003f800000,0xbf75be483f7f0000,0xbef1bf553f223f35,0xbf55bec43f7b0000,0x3f0ebf6dbe483f80,0xbf22bf0e3f750000,0x3f7fbe48bf623f35
.quad 0xbec4bf353f6d0000,0x3ec43f35bf6d0000,0xbdc9bf553f620000,0xbf223f7bbe95bf35,0x3e48bf6d3f550000,0xbf7b3ec43f0ebf80,0x3ef1bf7b3f460000,0xbe95bf0e3f7fbf35
.quad 0x3f35bf803f350000,0x3f35bf803f350000,0x3f62bf7b3f220000,0x3f75bf0ebdc93f35,0x3f7bbf6d3f0e0000,0x3e483ec4bf553f80,0x3f7fbf553ef10000,0xbf463f7bbf753f35
.quad 0x3f6dbf353ec40000,0xbf6d3f35bec40000,0x3f46bf0e3e950000,0xbdc9be483ef1bf35,0x3f0ebec43e480000,0x3f55bf6d3f7bbf80,0x3e95be483dc90000,0x3f62bf553f46bf35
.quad 0x0,0x0,0x3f223f0e3ef13ec4,0x3f7f3f7b3f753f6d,0x3f7b3f6d3f553f35,0x3e483ec43f0e3f35,0x3f623f7b3f7f3f6d,0xbf75bf55bf22bec4
.quad 0x3ec43f353f6d3f80,0xbec4bf35bf6dbf80,0xbe953e483f223f6d,0x3f623f0e3dc9bec4,0xbf55bec43e483f35,0x3f0e3f6d3f7b3f35,0xbf7fbf55be953ec4,0xbf46be483ef13f6d
.quad 0xbf35bf80bf350000,0xbf35bf80bf350000,0xbdc9bf55bf75bec4,0x3f22be48bf62bf6d,0x3f0ebec4bf7bbf35,0x3f553f6d3e48bf35,0x3f753e48bf46bf6d,0xbef13f0e3f7f3ec4
.quad 0x3f6d3f35bec4bf80,0xbf6dbf353ec43f80,0x3ef13f7b3dc9bf6d,0x3e95bf55bf463ec4,0xbe483f6d3f0ebf35,0x3f7b3ec4bf55bf35,0xbf463f0e3f62bec4,0xbdc93f7b3e95bf6d
.quad 0xbf8000003f800000,0xbf8000003f800000,0xbf46bf0e3f623ec4,0xbdc9bf7b3e953f6d,0xbe48bf6d3f0e3f35,0x3f7bbec4bf553f35,0x3ef1bf7b3dc93f6d,0x3e953f55bf46bec4
.quad 0x3f6dbf35bec43f80,0xbf6d3f353ec4bf80,0x3f75be48bf463f6d,0xbef1bf0e3f7fbec4,0x3f0e3ec4bf7b3f35,0x3f55bf6d3e483f35,0xbdc93f55bf753ec4,0x3f223e48bf623f6d
.quad 0xbf353f80bf350000,0xbf353f80bf350000,0xbf7f3f55be95bec4,0xbf463e483ef1bf6d,0xbf553ec43e48bf35,0x3f0ebf6d3f7bbf35,0xbe95be483f22bf6d,0x3f62bf0e3dc93ec4
.quad 0x3ec4bf353f6dbf80,0xbec43f35bf6d3f80,0x3f62bf7b3f7fbf6d,0xbf753f55bf223ec4,0x3f7bbf6d3f55bf35,0x3e48bec43f0ebf35,0x3f22bf0e3ef1bec4,0x3f7fbf7b3f75bf6d
.quad 0x0,0x0,0x3f753f7b3f7f3f80,0x3ef13f0e3f223f35,0xbf0ebec4be480000,0xbf55bf6dbf7bbf80,0xbf22bf55bf75bf80,0x3f7f3f7b3f623f35
.quad 0x3f6d3f353ec40000,0xbf6dbf35bec40000,0x3dc93f0e3f623f80,0x3f223e48be95bf35,0xbf7bbf6dbf0e0000,0xbe483ec43f553f80,0x3ef1be48bf46bf80,0xbe95bf55bf7fbf35
.quad 0x3f353f803f350000,0x3f353f803f350000,0xbf62be483f223f80,0xbf75bf55bdc93f35,0xbe48bf6dbf550000,0x3f7b3ec4bf0ebf80,0x3f7f3f0ebef1bf80,0xbf463e483f753f35
.quad 0xbec43f353f6d0000,0x3ec4bf35bf6d0000,0xbf46bf553e953f80,0x3dc93f7b3ef1bf35,0x3f55bec4bf7b0000,0xbf0ebf6d3e483f80,0x3e953f7bbdc9bf80,0x3f623f0ebf46bf35
.quad 0xbf8000003f800000,0xbf8000003f800000,0x3e95bf7bbdc93f80,0x3f62bf0ebf463f35,0x3f553ec4bf7b0000,0xbf0e3f6d3e48bf80,0xbf463f553e95bf80,0x3dc9bf7b3ef13f35
.quad 0xbec4bf353f6d0000,0x3ec43f35bf6d0000,0x3f7fbf0ebef13f80,0xbf46be483f75bf35,0xbe483f6dbf550000,0x3f7bbec4bf0e3f80,0xbf623e483f22bf80,0xbf753f55bdc9bf35
.quad 0x3f35bf803f350000,0x3f35bf803f350000,0x3ef13e48bf463f80,0xbe953f55bf7f3f35,0xbf7b3f6dbf0e0000,0xbe48bec43f55bf80,0x3dc9bf0e3f62bf80,0x3f22be48be953f35
.quad 0x3f6dbf353ec40000,0xbf6d3f35bec40000,0xbf223f55bf753f80,0x3f7fbf7b3f62bf35,0xbf0e3ec4be480000,0xbf553f6dbf7b3f80,0x3f75bf7b3f7fbf80,0x3ef1bf0e3f22bf35
.quad 0x0,0x0,0x3f463f553f623f6d,0x3dc93e483e953ec4,0xbf7bbf6dbf55bf35,0xbe48bec4bf0ebf35,0x3ef13e48bdc9bec4,0x3e953f0e3f463f6d
.quad 0x3ec43f353f6d3f80,0xbec4bf35bf6dbf80,0xbf75bf7bbf46bec4,0x3ef13f553f7f3f6d,0x3f553ec4be48bf35,0xbf0ebf6dbf7bbf35,0xbdc93f0e3f753f6d,0x3f223f7b3f623ec4
.quad 0xbf35bf80bf350000,0xbf35bf80bf350000,0x3f7f3f0ebe95bf6d,0x3f463f7b3ef1bec4,0xbf0e3ec43f7b3f35,0xbf55bf6dbe483f35,0xbe95bf7bbf223ec4,0x3f623f55bdc9bf6d
.quad 0x3f6d3f35bec4bf80,0xbf6dbf353ec43f80,0xbf623e483f7f3ec4,0x3f753f0ebf22bf6d,0x3e48bf6dbf0e3f35,0xbf7bbec43f553f35,0x3f223f55bef1bf6d,0x3f7f3e48bf75bec4
.quad 0xbf8000003f800000,0xbf8000003f800000,0x3f22bf55bef13f6d,0x3f7fbe48bf753ec4,0x3e483f6dbf0ebf35,0xbf7b3ec43f55bf35,0xbf62be483f7fbec4,0x3f75bf0ebf223f6d
.quad 0x3f6dbf35bec43f80,0xbf6d3f353ec4bf80,0xbe953f7bbf22bec4,0x3f62bf55bdc93f6d,0xbf0ebec43f7bbf35,0xbf553f6dbe48bf35,0x3f7fbf0ebe953f6d,0x3f46bf7b3ef13ec4
.quad 0xbf353f80bf350000,0xbf353f80bf350000,0xbdc9bf0e3f75bf6d,0x3f22bf7b3f62bec4,0x3f55bec4be483f35,0xbf0e3f6dbf7b3f35,0xbf753f7bbf463ec4,0x3ef1bf553f7fbf6d
.quad 0x3ec4bf353f6dbf80,0xbec43f35bf6d3f80,0x3ef1be48bdc93ec4,0x3e95bf0e3f46bf6d,0xbf7b3f6dbf553f35,0xbe483ec4bf0e3f35,0x3f46bf553f62bf6d,0x3dc9be483e95bec4
.quad 0x0,0x0,0xbe95be48bdc90000,0xbf62bf55bf46bf35,0x3f0e3ec43e480000,0x3f553f6d3f7b3f80,0xbf46bf0ebe950000,0x3dc9be48bef1bf35
.quad 0x3f6d3f353ec40000,0xbf6dbf35bec40000,0xbf7fbf55bef10000,0x3f463f7b3f753f35,0x3f7b3f6d3f0e0000,0x3e48bec4bf55bf80,0xbf62bf7bbf220000,0xbf75bf0e3dc93f35
.quad 0x3f353f803f350000,0x3f353f803f350000,0xbef1bf7bbf460000,0x3e95bf0ebf7fbf35,0x3e483f6d3f550000,0xbf7bbec43f0e3f80,0x3dc9bf55bf620000,0x3f223f7b3e95bf35
.quad 0xbec43f353f6d0000,0x3ec4bf35bf6d0000,0x3f22bf0ebf750000,0xbf7fbe483f623f35,0xbf553ec43f7b0000,0x3f0e3f6dbe48bf80,0x3f75be48bf7f0000,0x3ef1bf55bf223f35
.quad 0xbf8000003f800000,0xbf8000003f800000,0x3f753e48bf7f0000,0x3ef13f55bf22bf35,0xbf55bec43f7b0000,0x3f0ebf6dbe483f80,0x3f223f0ebf750000,0xbf7f3e483f62bf35
.quad 0xbec4bf353f6d0000,0x3ec43f35bf6d0000,0x3dc93f55bf620000,0x3f22bf7b3e953f35,0x3e48bf6d3f550000,0xbf7b3ec43f0ebf80,0xbef13f7bbf460000,0x3e953f0ebf7f3f35
.quad 0x3f35bf803f350000,0x3f35bf803f350000,0xbf623f7bbf220000,0xbf753f0e3dc9bf35,0x3f7bbf6d3f0e0000,0x3e483ec4bf553f80,0xbf7f3f55bef10000,0x3f46bf7b3f75bf35
.quad 0x3f6dbf353ec40000,0xbf6d3f35bec40000,0xbf463f0ebe950000,0x3dc93e48bef13f35,0x3f0ebec43e480000,0x3f55bf6d3f7bbf80,0xbe953e48bdc90000,0xbf623f55bf463f35
.quad 0x0,0x0,0xbf22bf0ebef1bec4,0xbf7fbf7bbf75bf6d,0x3f7b3f6d3f553f35,0x3e483ec43f0e3f35,0xbf62bf7bbf7fbf6d,0x3f753f553f223ec4
.quad 0x3ec43f353f6d3f80,0xbec4bf35bf6dbf80,0x3e95be48bf22bf6d,0xbf62bf0ebdc93ec4,0xbf55bec43e483f35,0x3f0e3f6d3f7b3f35,0x3f7f3f553e95bec4,0x3f463e48bef1bf6d
.quad 0xbf35bf80bf350000,0xbf35bf80bf350000,0x3dc93f553f753ec4,0xbf223e483f623f6d,0x3f0ebec4bf7bbf35,0x3f553f6d3e48bf35,0xbf75be483f463f6d,0x3ef1bf0ebf7fbec4
.quad 0x3f6d3f35bec4bf80,0xbf6dbf353ec43f80,0xbef1bf7bbdc93f6d,0xbe953f553f46bec4,0xbe483f6d3f0ebf35,0x3f7b3ec4bf55bf35,0x3f46bf0ebf623ec4,0x3dc9bf7bbe953f6d
.quad 0xbf8000003f800000,0xbf8000003f800000,0x3f463f0ebf62bec4,0x3dc93f7bbe95bf6d,0xbe48bf6d3f0e3f35,0x3f7bbec4bf553f35,0xbef13f7bbdc9bf6d,0xbe95bf553f463ec4
.quad 0x3f6dbf35bec43f80,0xbf6d3f353ec4bf80,0xbf753e483f46bf6d,0x3ef13f0ebf7f3ec4,0x3f0e3ec4bf7b3f35,0x3f55bf6d3e483f35,0x3dc9bf553f75bec4,0xbf22be483f62bf6d
.quad 0xbf353f80bf350000,0xbf353f80bf350000,0x3f7fbf553e953ec4,0x3f46be48bef13f6d,0xbf553ec43e48bf35,0x3f0ebf6d3f7bbf35,0x3e953e48bf223f6d,0xbf623f0ebdc9bec4
.quad 0x3ec4bf353f6dbf80,0xbec43f35bf6d3f80,0xbf623f7bbf7f3f6d,0x3f75bf553f22bec4,0x3f7bbf6d3f55bf35,0x3e48bec43f0ebf35,0xbf223f0ebef13ec4,0xbf7f3f7bbf753f6d
.quad 0x0,0x0,0xbf75bf7bbf7fbf80,0xbef1bf0ebf22bf35,0xbf0ebec4be480000,0xbf55bf6dbf7bbf80,0x3f223f553f753f80,0xbf7fbf7bbf62bf35
.quad 0x3f6d3f353ec40000,0xbf6dbf35bec40000,0xbdc9bf0ebf62bf80,0xbf22be483e953f35,0xbf7bbf6dbf0e0000,0xbe483ec43f553f80,0xbef13e483f463f80,0x3e953f553f7f3f35
.quad 0x3f353f803f350000,0x3f353f803f350000,0x3f623e48bf22bf80,0x3f753f553dc9bf35,0xbe48bf6dbf550000,0x3f7b3ec4bf0ebf80,0xbf7fbf0e3ef13f80,0x3f46be48bf75bf35
.quad 0xbec43f353f6d0000,0x3ec4bf35bf6d0000,0x3f463f55be95bf80,0xbdc9bf7bbef13f35,0x3f55bec4bf7b0000,0xbf0ebf6d3e483f80,0xbe95bf7b3dc93f80,0xbf62bf0e3f463f35
.quad 0xbf8000003f800000,0xbf8000003f800000,0xbe953f7b3dc9bf80,0xbf623f0e3f46bf35,0x3f553ec4bf7b0000,0xbf0e3f6d3e48bf80,0x3f46bf55be953f80,0xbdc93f7bbef1bf35
.quad 0xbec4bf353f6d0000,0x3ec43f35bf6d0000,0xbf7f3f0e3ef1bf80,0x3f463e48bf753f35,0xbe483f6dbf550000,0x3f7bbec4bf0e3f80,0x3f62be48bf223f80,0x3f75bf553dc93f35
.quad 0x3f35bf803f350000,0x3f35bf803f350000,0xbef1be483f46bf80,0x3e95bf553f7fbf35,0xbf7b3f6dbf0e0000,0xbe48bec43f55bf80,0xbdc93f0ebf623f80,0xbf223e483e95bf35
.quad 0x3f6dbf353ec40000,0xbf6d3f35bec40000,0x3f22bf553f75bf80,0xbf7f3f7bbf623f35,0xbf0e3ec4be480000,0xbf553f6dbf7b3f80,0xbf753f7bbf7f3f80,0xbef13f0ebf223f35
.quad 0x0,0x0,0xbf46bf55bf62bf6d,0xbdc9be48be95bec4,0xbf7bbf6dbf55bf35,0xbe48bec4bf0ebf35,0xbef1be483dc93ec4,0xbe95bf0ebf46bf6d
.quad 0x3ec43f353f6d3f80,0xbec4bf35bf6dbf80,0x3f753f7b3f463ec4,0xbef1bf55bf7fbf6d,0x3f553ec4be48bf35,0xbf0ebf6dbf7bbf35,0x3dc9bf0ebf75bf6d,0xbf22bf7bbf62bec4
.quad 0xbf35bf80bf350000,0xbf35bf80bf350000,0xbf7fbf0e3e953f6d,0xbf46bf7bbef13ec4,0xbf0e3ec43f7b3f35,0xbf55bf6dbe483f35,0x3e953f7b3f22bec4,0xbf62bf553dc93f6d
.quad 0x3f6d3f35bec4bf80,0xbf6dbf353ec43f80,0x3f62be48bf7fbec4,0xbf75bf0e3f223f6d,0x3e48bf6dbf0e3f35,0xbf7bbec43f553f35,0xbf22bf553ef13f6d,0xbf7fbe483f753ec4
.quad 0xbf8000003f800000,0xbf8000003f800000,0xbf223f553ef1bf6d,0xbf7f3e483f75bec4,0x3e483f6dbf0ebf35,0xbf7b3ec43f55bf35,0x3f623e48bf7f3ec4,0xbf753f0e3f22bf6d
.quad 0x3f6dbf35bec43f80,0xbf6d3f353ec4bf80,0x3e95bf7b3f223ec4,0xbf623f553dc9bf6d,0xbf0ebec43f7bbf35,0xbf553f6dbe48bf35,0xbf7f3f0e3e95bf6d,0xbf463f7bbef1bec4
.quad 0xbf353f80bf350000,0xbf353f80bf350000,0x3dc93f0ebf753f6d,0xbf223f7bbf623ec4,0x3f55bec4be483f35,0xbf0e3f6dbf7b3f35,0x3f75bf7b3f46bec4,0xbef13f55bf7f3f6d
.quad 0x3ec4bf353f6dbf80,0xbec43f35bf6d3f80,0xbef13e483dc9bec4,0xbe953f0ebf463f6d,0xbf7b3f6dbf553f35,0xbe483ec4bf0e3f35,0xbf463f55bf623f6d,0xbdc93e48be953ec4
.quad 0x0,0x0,0xbe953e48bdc90000,0xbf623f55bf463f35,0xbf0e3ec4be480000,0xbf553f6dbf7b3f80,0xbf463f0ebe950000,0x3dc93e48bef13f35
.quad 0xbf6d3f35bec40000,0x3f6dbf353ec40000,0xbf7f3f55bef10000,0x3f46bf7b3f75bf35,0xbf7b3f6dbf0e0000,0xbe48bec43f55bf80,0xbf623f7bbf220000,0xbf753f0e3dc9bf35
.quad 0xbf353f80bf350000,0xbf353f80bf350000,0xbef13f7bbf460000,0x3e953f0ebf7f3f35,0xbe483f6dbf550000,0x3f7bbec4bf0e3f80,0x3dc93f55bf620000,0x3f22bf7b3e953f35
.quad 0x3ec43f35bf6d0000,0xbec4bf353f6d0000,0x3f223f0ebf750000,0xbf7f3e483f62bf35,0x3f553ec4bf7b0000,0xbf0e3f6d3e48bf80,0x3f753e48bf7f0000,0x3ef13f55bf22bf35
.quad 0x3f800000bf800000,0x3f800000bf800000,0x3f75be48bf7f0000,0x3ef1bf55bf223f35,0x3f55bec4bf7b0000,0xbf0ebf6d3e483f80,0x3f22bf0ebf750000,0xbf7fbe483f623f35
.quad 0x3ec4bf35bf6d0000,0xbec43f353f6d0000,0x3dc9bf55bf620000,0x3f223f7b3e95bf35,0xbe48bf6dbf550000,0x3f7b3ec4bf0ebf80,0xbef1bf7bbf460000,0x3e95bf0ebf7fbf35
.quad 0xbf35bf80bf350000,0xbf35bf80bf350000,0xbf62bf7bbf220000,0xbf75bf0e3dc93f35,0xbf7bbf6dbf0e0000,0xbe483ec43f553f80,0xbf7fbf55bef10000,0x3f463f7b3f753f35
.quad 0xbf6dbf35bec40000,0x3f6d3f353ec40000,0xbf46bf0ebe950000,0x3dc9be48bef1bf35,0xbf0ebec4be480000,0xbf55bf6dbf7bbf80,0xbe95be48bdc90000,0xbf62bf55bf46bf35
.quad 0x0,0x0,0xbf223f0ebef13ec4,0xbf7f3f7bbf753f6d,0xbf7b3f6dbf553f35,0xbe483ec4bf0e3f35,0xbf623f7bbf7f3f6d,0x3f75bf553f22bec4
.quad 0xbec43f35bf6d3f80,0x3ec4bf353f6dbf80,0x3e953e48bf223f6d,0xbf623f0ebdc9bec4,0x3f55bec4be483f35,0xbf0e3f6dbf7b3f35,0x3f7fbf553e953ec4,0x3f46be48bef13f6d
.quad 0x3f35bf803f350000,0x3f35bf803f350000,0x3dc9bf553f75bec4,0xbf22be483f62bf6d,0xbf0ebec43f7bbf35,0xbf553f6dbe48bf35,0xbf753e483f46bf6d,0x3ef13f0ebf7f3ec4
.quad 0xbf6d3f353ec4bf80,0x3f6dbf35bec43f80,0xbef13f7bbdc9bf6d,0xbe95bf553f463ec4,0x3e483f6dbf0ebf35,0xbf7b3ec43f55bf35,0x3f463f0ebf62bec4,0x3dc93f7bbe95bf6d
.quad 0x3f800000bf800000,0x3f800000bf800000,0x3f46bf0ebf623ec4,0x3dc9bf7bbe953f6d,0x3e48bf6dbf0e3f35,0xbf7bbec43f553f35,0xbef1bf7bbdc93f6d,0xbe953f553f46bec4
.quad 0xbf6dbf353ec43f80,0x3f6d3f35bec4bf80,0xbf75be483f463f6d,0x3ef1bf0ebf7fbec4,0xbf0e3ec43f7b3f35,0xbf55bf6dbe483f35,0x3dc93f553f753ec4,0xbf223e483f623f6d
.quad 0x3f353f803f350000,0x3f353f803f350000,0x3f7f3f553e95bec4,0x3f463e48bef1bf6d,0x3f553ec4be48bf35,0xbf0ebf6dbf7bbf35,0x3e95be48bf22bf6d,0xbf62bf0ebdc93ec4
.quad 0xbec4bf35bf6dbf80,0x3ec43f353f6d3f80,0xbf62bf7bbf7fbf6d,0x3f753f553f223ec4,0xbf7bbf6dbf55bf35,0xbe48bec4bf0ebf35,0xbf22bf0ebef1bec4,0xbf7fbf7bbf75bf6d
.quad 0x0,0x0,0xbf753f7bbf7f3f80,0xbef13f0ebf223f35,0x3f0ebec43e480000,0x3f55bf6d3f7bbf80,0x3f22bf553f75bf80,0xbf7f3f7bbf623f35
.quad 0xbf6d3f35bec40000,0x3f6dbf353ec40000,0xbdc93f0ebf623f80,0xbf223e483e95bf35,0x3f7bbf6d3f0e0000,0x3e483ec4bf553f80,0xbef1be483f46bf80,0x3e95bf553f7fbf35
.quad 0xbf353f80bf350000,0xbf353f80bf350000,0x3f62be48bf223f80,0x3f75bf553dc93f35,0x3e48bf6d3f550000,0xbf7b3ec43f0ebf80,0xbf7f3f0e3ef1bf80,0x3f463e48bf753f35
.quad 0x3ec43f35bf6d0000,0xbec4bf353f6d0000,0x3f46bf55be953f80,0xbdc93f7bbef1bf35,0xbf55bec43f7b0000,0x3f0ebf6dbe483f80,0xbe953f7b3dc9bf80,0xbf623f0e3f46bf35
.quad 0x3f800000bf800000,0x3f800000bf800000,0xbe95bf7b3dc93f80,0xbf62bf0e3f463f35,0xbf553ec43f7b0000,0x3f0e3f6dbe48bf80,0x3f463f55be95bf80,0xbdc9bf7bbef13f35
.quad 0x3ec4bf35bf6d0000,0xbec43f353f6d0000,0xbf7fbf0e3ef13f80,0x3f46be48bf75bf35,0x3e483f6d3f550000,0xbf7bbec43f0e3f80,0x3f623e48bf22bf80,0x3f753f553dc9bf35
.quad 0xbf35bf80bf350000,0xbf35bf80bf350000,0xbef13e483f463f80,0x3e953f553f7f3f35,0x3f7b3f6d3f0e0000,0x3e48bec4bf55bf80,0xbdc9bf0ebf62bf80,0xbf22be483e953f35
.quad 0xbf6dbf35bec40000,0x3f6d3f353ec40000,0x3f223f553f753f80,0xbf7fbf7bbf62bf35,0x3f0e3ec43e480000,0x3f553f6d3f7b3f80,0xbf75bf7bbf7fbf80,0xbef1bf0ebf22bf35
.quad 0x0,0x0,0xbf463f55bf623f6d,0xbdc93e48be953ec4,0x3f7bbf6d3f55bf35,0x3e48bec43f0ebf35,0xbef13e483dc9bec4,0xbe953f0ebf463f6d
.quad 0xbec43f35bf6d3f80,0x3ec4bf353f6dbf80,0x3f75bf7b3f46bec4,0xbef13f55bf7f3f6d,0xbf553ec43e48bf35,0x3f0ebf6d3f7bbf35,0x3dc93f0ebf753f6d,0xbf223f7bbf623ec4
.quad 0x3f35bf803f350000,0x3f35bf803f350000,0xbf7f3f0e3e95bf6d,0xbf463f7bbef1bec4,0x3f0e3ec4bf7b3f35,0x3f55bf6d3e483f35,0x3e95bf7b3f223ec4,0xbf623f553dc9bf6d
.quad 0xbf6d3f353ec4bf80,0x3f6dbf35bec43f80,0x3f623e48bf7f3ec4,0xbf753f0e3f22bf6d,0xbe48bf6d3f0e3f35,0x3f7bbec4bf553f35,0xbf223f553ef1bf6d,0xbf7f3e483f75bec4
.quad 0x3f800000bf800000,0x3f800000bf800000,0xbf22bf553ef13f6d,0xbf7fbe483f753ec4,0xbe483f6d3f0ebf35,0x3f7b3ec4bf55bf35,0x3f62be48bf7fbec4,0xbf75bf0e3f223f6d
.quad 0xbf6dbf353ec43f80,0x3f6d3f35bec4bf80,0x3e953f7b3f22bec4,0xbf62bf553dc93f6d,0x3f0ebec4bf7bbf35,0x3f553f6d3e48bf35,0xbf7fbf0e3e953f6d,0xbf46bf7bbef13ec4
.quad 0x3f353f803f350000,0x3f353f803f350000,0x3dc9bf0ebf75bf6d,0xbf22bf7bbf62bec4,0xbf55bec43e483f35,0x3f0e3f6d3f7b3f35,0x3f753f7b3f463ec4,0xbef1bf55bf7fbf6d
.quad 0xbec4bf35bf6dbf80,0x3ec43f353f6d3f80,0xbef1be483dc93ec4,0xbe95bf0ebf46bf6d,0x3f7b3f6d3f553f35,0x3e483ec43f0e3f35,0xbf46bf55bf62bf6d,0xbdc9be48be95bec4
.quad 0x0,0x0,0x3e95be483dc90000,0x3f62bf553f46bf35,0xbf0e3ec4be480000,0xbf553f6dbf7b3f80,0x3f46bf0e3e950000,0xbdc9be483ef1bf35
.quad 0xbf6d3f35bec40000,0x3f6dbf353ec40000,0x3f7fbf553ef10000,0xbf463f7bbf753f35,0xbf7b3f6dbf0e0000,0xbe48bec43f55bf80,0x3f62bf7b3f220000,0x3f75bf0ebdc93f35
.quad 0xbf353f80bf350000,0xbf353f80bf350000,0x3ef1bf7b3f460000,0xbe95bf0e3f7fbf35,0xbe483f6dbf550000,0x3f7bbec4bf0e3f80,0xbdc9bf553f620000,0xbf223f7bbe95bf35
.quad 0x3ec43f35bf6d0000,0xbec4bf353f6d0000,0xbf22bf0e3f750000,0x3f7fbe48bf623f35,0x3f553ec4bf7b0000,0xbf0e3f6d3e48bf80,0xbf75be483f7f0000,0xbef1bf553f223f35
.quad 0x3f800000bf800000,0x3f800000bf800000,0xbf753e483f7f0000,0xbef13f553f22bf35,0x3f55bec4bf7b0000,0xbf0ebf6d3e483f80,0xbf223f0e3f750000,0x3f7f3e48bf62bf35
.quad 0x3ec4bf35bf6d0000,0xbec43f353f6d0000,0xbdc93f553f620000,0xbf22bf7bbe953f35,0xbe48bf6dbf550000,0x3f7b3ec4bf0ebf80,0x3ef13f7b3f460000,0xbe953f0e3f7f3f35
.quad 0xbf35bf80bf350000,0xbf35bf80bf350000,0x3f623f7b3f220000,0x3f753f0ebdc9bf35,0xbf7bbf6dbf0e0000,0xbe483ec43f553f80,0x3f7f3f553ef10000,0xbf46bf7bbf75bf35
.quad 0xbf6dbf35bec40000,0x3f6d3f353ec40000,0x3f463f0e3e950000,0xbdc93e483ef13f35,0xbf0ebec4be480000,0xbf55bf6dbf7bbf80,0x3e953e483dc90000,0x3f623f553f463f35
.quad 0x0,0x0,0x3f22bf0e3ef1bec4,0x3f7fbf7b3f75bf6d,0xbf7b3f6dbf553f35,0xbe483ec4bf0e3f35,0x3f62bf7b3f7fbf6d,0xbf753f55bf223ec4
.quad 0xbec43f35bf6d3f80,0x3ec4bf353f6dbf80,0xbe95be483f22bf6d,0x3f62bf0e3dc93ec4,0x3f55bec4be483f35,0xbf0e3f6dbf7b3f35,0xbf7f3f55be95bec4,0xbf463e483ef1bf6d
.quad 0x3f35bf803f350000,0x3f35bf803f350000,0xbdc93f55bf753ec4,0x3f223e48bf623f6d,0xbf0ebec43f7bbf35,0xbf553f6dbe48bf35,0x3f75be48bf463f6d,0xbef1bf0e3f7fbec4
.quad 0xbf6d3f353ec4bf80,0x3f6dbf35bec43f80,0x3ef1bf7b3dc93f6d,0x3e953f55bf46bec4,0x3e483f6dbf0ebf35,0xbf7b3ec43f55bf35,0xbf46bf0e3f623ec4,0xbdc9bf7b3e953f6d
.quad 0x3f800000bf800000,0x3f800000bf800000,0xbf463f0e3f62bec4,0xbdc93f7b3e95bf6d,0x3e48bf6dbf0e3f35,0xbf7bbec43f553f35,0x3ef13f7b3dc9bf6d,0x3e95bf55bf463ec4
.quad 0xbf6dbf353ec43f80,0x3f6d3f35bec4bf80,0x3f753e48bf46bf6d,0xbef13f0e3f7f3ec4,0xbf0e3ec43f7b3f35,0xbf55bf6dbe483f35,0xbdc9bf55bf75bec4,0x3f22be48bf62bf6d
.quad 0x3f353f803f350000,0x3f353f803f350000,0xbf7fbf55be953ec4,0xbf46be483ef13f6d,0x3f553ec4be48bf35,0xbf0ebf6dbf7bbf35,0xbe953e483f223f6d,0x3f623f0e3dc9bec4
.quad 0xbec4bf35bf6dbf80,0x3ec43f353f6d3f80,0x3f623f7b3f7f3f6d,0xbf75bf55bf22bec4,0xbf7bbf6dbf55bf35,0xbe48bec4bf0ebf35,0x3f223f0e3ef13ec4,0x3f7f3f7b3f753f6d
.quad 0x0,0x0,0x3f75bf7b3f7fbf80,0x3ef1bf0e3f22bf35,0x3f0ebec43e480000,0x3f55bf6d3f7bbf80,0xbf223f55bf753f80,0x3f7fbf7b3f62bf35
.quad 0xbf6d3f35bec40000,0x3f6dbf353ec40000,0x3dc9bf0e3f62bf80,0x3f22be48be953f35,0x3f7bbf6d3f0e0000,0x3e483ec4bf553f80,0x3ef13e48bf463f80,0xbe953f55bf7f3f35
.quad 0xbf353f80bf350000,0xbf353f80bf350000,0xbf623e483f22bf80,0xbf753f55bdc9bf35,0x3e48bf6d3f550000,0xbf7b3ec43f0ebf80,0x3f7fbf0ebef13f80,0xbf46be483f75bf35
.quad 0x3ec43f35bf6d0000,0xbec4bf353f6d0000,0xbf463f553e95bf80,0x3dc9bf7b3ef13f35,0xbf55bec43f7b0000,0x3f0ebf6dbe483f80,0x3e95bf7bbdc93f80,0x3f62bf0ebf463f35
.quad 0x3f800000bf800000,0x3f800000bf800000,0x3e953f7bbdc9bf80,0x3f623f0ebf46bf35,0xbf553ec43f7b0000,0x3f0e3f6dbe48bf80,0xbf46bf553e953f80,0x3dc93f7b3ef1bf35
.quad 0x3ec4bf35bf6d0000,0xbec43f353f6d0000,0x3f7f3f0ebef1bf80,0xbf463e483f753f35,0x3e483f6d3f550000,0xbf7bbec43f0e3f80,0xbf62be483f223f80,0xbf75bf55bdc93f35
.quad 0xbf35bf80bf350000,0xbf35bf80bf350000,0x3ef1be48bf46bf80,0xbe95bf55bf7fbf35,0x3f7b3f6d3f0e0000,0x3e48bec4bf55bf80,0x3dc93f0e3f623f80,0x3f223e48be95bf35
.quad 0xbf6dbf35bec40000,0x3f6d3f353ec40000,0xbf22bf55bf75bf80,0x3f7f3f7b3f623f35,0x3f0e3ec43e480000,0x3f553f6d3f7b3f80,0x3f753f7b3f7f3f80,0x3ef13f0e3f223f35
.quad 0x0,0x0,0x3f46bf553f62bf6d,0x3dc9be483e95bec4,0x3f7bbf6d3f55bf35,0x3e48bec43f0ebf35,0x3ef1be48bdc93ec4,0x3e95bf0e3f46bf6d
.quad 0xbec43f35bf6d3f80,0x3ec4bf353f6dbf80,0xbf753f7bbf463ec4,0x3ef1bf553f7fbf6d,0xbf553ec43e48bf35,0x3f0ebf6d3f7bbf35,0xbdc9bf0e3f75bf6d,0x3f22bf7b3f62bec4
.quad 0x3f35bf803f350000,0x3f35bf803f350000,0x3f7fbf0ebe953f6d,0x3f46bf7b3ef13ec4,0x3f0e3ec4bf7b3f35,0x3f55bf6d3e483f35,0xbe953f7bbf22bec4,0x3f62bf55bdc93f6d
.quad 0xbf6d3f353ec4bf80,0x3f6dbf35bec43f80,0xbf62be483f7fbec4,0x3f75bf0ebf223f6d,0xbe48bf6d3f0e3f35,0x3f7bbec4bf553f35,0x3f22bf55bef13f6d,0x3f7fbe48bf753ec4
.quad 0x3f800000bf800000,0x3f800000bf800000,0x3f223f55bef1bf6d,0x3f7f3e48bf75bec4,0xbe483f6d3f0ebf35,0x3f7b3ec4bf55bf35,0xbf623e483f7f3ec4,0x3f753f0ebf22bf6d
.quad 0xbf6dbf353ec43f80,0x3f6d3f35bec4bf80,0xbe95bf7bbf223ec4,0x3f623f55bdc9bf6d,0x3f0ebec4bf7bbf35,0x3f553f6d3e48bf35,0x3f7f3f0ebe95bf6d,0x3f463f7b3ef1bec4
.quad 0x3f353f803f350000,0x3f353f803f350000,0xbdc93f0e3f753f6d,0x3f223f7b3f623ec4,0xbf55bec43e483f35,0x3f0e3f6d3f7b3f35,0xbf75bf7bbf46bec4,0x3ef13f553f7f3f6d
.quad 0xbec4bf35bf6dbf80,0x3ec43f353f6d3f80,0x3ef13e48bdc9bec4,0x3e953f0e3f463f6d,0x3f7b3f6d3f553f35,0x3e483ec43f0e3f35,0x3f463f553f623f6d,0x3dc93e483e953ec4
.quad 0x8000800080008000,0x8000800080008000,0xbe95be48bdc98000,0xbf62bf55bf46bf35,0xbf0ebec4be488000,0xbf55bf6dbf7bbf80,0xbf46bf0ebe958000,0x3dc9be48bef1bf35
.quad 0xbf6dbf35bec48000,0x3f6d3f353ec48000,0xbf7fbf55bef18000,0x3f463f7b3f753f35,0xbf7bbf6dbf0e8000,0xbe483ec43f553f80,0xbf62bf7bbf228000,0xbf75bf0e3dc93f35
.quad 0xbf35bf80bf358000,0xbf35bf80bf358000,0xbef1bf7bbf468000,0x3e95bf0ebf7fbf35,0xbe48bf6dbf558000,0x3f7b3ec4bf0ebf80,0x3dc9bf55bf628000,0x3f223f7b3e95bf35
.quad 0x3ec4bf35bf6d8000,0xbec43f353f6d8000,0x3f22bf0ebf758000,0xbf7fbe483f623f35,0x3f55bec4bf7b8000,0xbf0ebf6d3e483f80,0x3f75be48bf7f8000,0x3ef1bf55bf223f35
.quad 0x3f808000bf808000,0x3f808000bf808000,0x3f753e48bf7f8000,0x3ef13f55bf22bf35,0x3f553ec4bf7b8000,0xbf0e3f6d3e48bf80,0x3f223f0ebf758000,0xbf7f3e483f62bf35
.quad 0x3ec43f35bf6d8000,0xbec4bf353f6d8000,0x3dc93f55bf628000,0x3f22bf7b3e953f35,0xbe483f6dbf558000,0x3f7bbec4bf0e3f80,0xbef13f7bbf468000,0x3e953f0ebf7f3f35
.quad 0xbf353f80bf358000,0xbf353f80bf358000,0xbf623f7bbf228000,0xbf753f0e3dc9bf35,0xbf7b3f6dbf0e8000,0xbe48bec43f55bf80,0xbf7f3f55bef18000,0x3f46bf7b3f75bf35
.quad 0xbf6d3f35bec48000,0x3f6dbf353ec48000,0xbf463f0ebe958000,0x3dc93e48bef13f35,0xbf0e3ec4be488000,0xbf553f6dbf7b3f80,0xbe953e48bdc98000,0xbf623f55bf463f35
.quad 0x8000800080008000,0x8000800080008000,0xbf22bf0ebef1bec4,0xbf7fbf7bbf75bf6d,0xbf7bbf6dbf55bf35,0xbe48bec4bf0ebf35,0xbf62bf7bbf7fbf6d,0x3f753f553f223ec4
.quad 0xbec4bf35bf6dbf80,0x3ec43f353f6d3f80,0x3e95be48bf22bf6d,0xbf62bf0ebdc93ec4,0x3f553ec4be48bf35,0xbf0ebf6dbf7bbf35,0x3f7f3f553e95bec4,0x3f463e48bef1bf6d
.quad 0x3f353f803f358000,0x3f353f803f358000,0x3dc93f553f753ec4,0xbf223e483f623f6d,0xbf0e3ec43f7b3f35,0xbf55bf6dbe483f35,0xbf75be483f463f6d,0x3ef1bf0ebf7fbec4
.quad 0xbf6dbf353ec43f80,0x3f6d3f35bec4bf80,0xbef1bf7bbdc93f6d,0xbe953f553f46bec4,0x3e48bf6dbf0e3f35,0xbf7bbec43f553f35,0x3f46bf0ebf623ec4,0x3dc9bf7bbe953f6d
.quad 0x3f808000bf808000,0x3f808000bf808000,0x3f463f0ebf62bec4,0x3dc93f7bbe95bf6d,0x3e483f6dbf0ebf35,0xbf7b3ec43f55bf35,0xbef13f7bbdc9bf6d,0xbe95bf553f463ec4
.quad 0xbf6d3f353ec4bf80,0x3f6dbf35bec43f80,0xbf753e483f46bf6d,0x3ef13f0ebf7f3ec4,0xbf0ebec43f7bbf35,0xbf553f6dbe48bf35,0x3dc9bf553f75bec4,0xbf22be483f62bf6d
.quad 0x3f35bf803f358000,0x3f35bf803f358000,0x3f7fbf553e953ec4,0x3f46be48bef13f6d,0x3f55bec4be483f35,0xbf0e3f6dbf7b3f35,0x3e953e48bf223f6d,0xbf623f0ebdc9bec4
.quad 0xbec43f35bf6d3f80,0x3ec4bf353f6dbf80,0xbf623f7bbf7f3f6d,0x3f75bf553f22bec4,0xbf7b3f6dbf553f35,0xbe483ec4bf0e3f35,0xbf223f0ebef13ec4,0xbf7f3f7bbf753f6d
.quad 0x8000800080008000,0x8000800080008000,0xbf75bf7bbf7fbf80,0xbef1bf0ebf22bf35,0x3f0e3ec43e488000,0x3f553f6d3f7b3f80,0x3f223f553f753f80,0xbf7fbf7bbf62bf35
.quad 0xbf6dbf35bec48000,0x3f6d3f353ec48000,0xbdc9bf0ebf62bf80,0xbf22be483e953f35,0x3f7b3f6d3f0e8000,0x3e48bec4bf55bf80,0xbef13e483f463f80,0x3e953f553f7f3f35
.quad 0xbf35bf80bf358000,0xbf35bf80bf358000,0x3f623e48bf22bf80,0x3f753f553dc9bf35,0x3e483f6d3f558000,0xbf7bbec43f0e3f80,0xbf7fbf0e3ef13f80,0x3f46be48bf75bf35
.quad 0x3ec4bf35bf6d8000,0xbec43f353f6d8000,0x3f463f55be95bf80,0xbdc9bf7bbef13f35,0xbf553ec43f7b8000,0x3f0e3f6dbe48bf80,0xbe95bf7b3dc93f80,0xbf62bf0e3f463f35
.quad 0x3f808000bf808000,0x3f808000bf808000,0xbe953f7b3dc9bf80,0xbf623f0e3f46bf35,0xbf55bec43f7b8000,0x3f0ebf6dbe483f80,0x3f46bf55be953f80,0xbdc93f7bbef1bf35
.quad 0x3ec43f35bf6d8000,0xbec4bf353f6d8000,0xbf7f3f0e3ef1bf80,0x3f463e48bf753f35,0x3e48bf6d3f558000,0xbf7b3ec43f0ebf80,0x3f62be48bf223f80,0x3f75bf553dc93f35
.quad 0xbf353f80bf358000,0xbf353f80bf358000,0xbef1be483f46bf80,0x3e95bf553f7fbf35,0x3f7bbf6d3f0e8000,0x3e483ec4bf553f80,0xbdc93f0ebf623f80,0xbf223e483e95bf35
.quad 0xbf6d3f35bec48000,0x3f6dbf353ec48000,0x3f22bf553f75bf80,0xbf7f3f7bbf623f35,0x3f0ebec43e488000,0x3f55bf6d3f7bbf80,0xbf753f7bbf7f3f80,0xbef13f0ebf223f35
.quad 0x8000800080008000,0x8000800080008000,0xbf46bf55bf62bf6d,0xbdc9be48be95bec4,0x3f7b3f6d3f553f35,0x3e483ec43f0e3f35,0xbef1be483dc93ec4,0xbe95bf0ebf46bf6d
.quad 0xbec4bf35bf6dbf80,0x3ec43f353f6d3f80,0x3f753f7b3f463ec4,0xbef1bf55bf7fbf6d,0xbf55bec43e483f35,0x3f0e3f6d3f7b3f35,0x3dc9bf0ebf75bf6d,0xbf22bf7bbf62bec4
.quad 0x3f353f803f358000,0x3f353f803f358000,0xbf7fbf0e3e953f6d,0xbf46bf7bbef13ec4,0x3f0ebec4bf7bbf35,0x3f553f6d3e48bf35,0x3e953f7b3f22bec4,0xbf62bf553dc93f6d
.quad 0xbf6dbf353ec43f80,0x3f6d3f35bec4bf80,0x3f62be48bf7fbec4,0xbf75bf0e3f223f6d,0xbe483f6d3f0ebf35,0x3f7b3ec4bf55bf35,0xbf22bf553ef13f6d,0xbf7fbe483f753ec4
.quad 0x3f808000bf808000,0x3f808000bf808000,0xbf223f553ef1bf6d,0xbf7f3e483f75bec4,0xbe48bf6d3f0e3f35,0x3f7bbec4bf553f35,0x3f623e48bf7f3ec4,0xbf753f0e3f22bf6d
.quad 0xbf6d3f353ec4bf80,0x3f6dbf35bec43f80,0x3e95bf7b3f223ec4,0xbf623f553dc9bf6d,0x3f0e3ec4bf7b3f35,0x3f55bf6d3e483f35,0xbf7f3f0e3e95bf6d,0xbf463f7bbef1bec4
.quad 0x3f35bf803f358000,0x3f35bf803f358000,0x3dc93f0ebf753f6d,0xbf223f7bbf623ec4,0xbf553ec43e48bf35,0x3f0ebf6d3f7bbf35,0x3f75bf7b3f46bec4,0xbef13f55bf7f3f6d
.quad 0xbec43f35bf6d3f80,0x3ec4bf353f6dbf80,0xbef13e483dc9bec4,0xbe953f0ebf463f6d,0x3f7bbf6d3f55bf35,0x3e48bec43f0ebf35,0xbf463f55bf623f6d,0xbdc93e48be953ec4
.quad 0x8000800080008000,0x8000800080008000,0x3e953e483dc98000,0x3f623f553f463f35,0xbf0ebec4be488000,0xbf55bf6dbf7bbf80,0x3f463f0e3e958000,0xbdc93e483ef13f35
.quad 0xbf6dbf35bec48000,0x3f6d3f353ec48000,0x3f7f3f553ef18000,0xbf46bf7bbf75bf35,0xbf7bbf6dbf0e8000,0xbe483ec43f553f80,0x3f623f7b3f228000,0x3f753f0ebdc9bf35
.quad 0xbf35bf80bf358000,0xbf35bf80bf358000,0x3ef13f7b3f468000,0xbe953f0e3f7f3f35,0xbe48bf6dbf558000,0x3f7b3ec4bf0ebf80,0xbdc93f553f628000,0xbf22bf7bbe953f35
.quad 0x3ec4bf35bf6d8000,0xbec43f353f6d8000,0xbf223f0e3f758000,0x3f7f3e48bf62bf35,0x3f55bec4bf7b8000,0xbf0ebf6d3e483f80,0xbf753e483f7f8000,0xbef13f553f22bf35
.quad 0x3f808000bf808000,0x3f808000bf808000,0xbf75be483f7f8000,0xbef1bf553f223f35,0x3f553ec4bf7b8000,0xbf0e3f6d3e48bf80,0xbf22bf0e3f758000,0x3f7fbe48bf623f35
.quad 0x3ec43f35bf6d8000,0xbec4bf353f6d8000,0xbdc9bf553f628000,0xbf223f7bbe95bf35,0xbe483f6dbf558000,0x3f7bbec4bf0e3f80,0x3ef1bf7b3f468000,0xbe95bf0e3f7fbf35
.quad 0xbf353f80bf358000,0xbf353f80bf358000,0x3f62bf7b3f228000,0x3f75bf0ebdc93f35,0xbf7b3f6dbf0e8000,0xbe48bec43f55bf80,0x3f7fbf553ef18000,0xbf463f7bbf753f35
.quad 0xbf6d3f35bec48000,0x3f6dbf353ec48000,0x3f46bf0e3e958000,0xbdc9be483ef1bf35,0xbf0e3ec4be488000,0xbf553f6dbf7b3f80,0x3e95be483dc98000,0x3f62bf553f46bf35
.quad 0x8000800080008000,0x8000800080008000,0x3f223f0e3ef13ec4,0x3f7f3f7b3f753f6d,0xbf7bbf6dbf55bf35,0xbe48bec4bf0ebf35,0x3f623f7b3f7f3f6d,0xbf75bf55bf22bec4
.quad 0xbec4bf35bf6dbf80,0x3ec43f353f6d3f80,0xbe953e483f223f6d,0x3f623f0e3dc9bec4,0x3f553ec4be48bf35,0xbf0ebf6dbf7bbf35,0xbf7fbf55be953ec4,0xbf46be483ef13f6d
.quad 0x3f353f803f358000,0x3f353f803f358000,0xbdc9bf55bf75bec4,0x3f22be48bf62bf6d,0xbf0e3ec43f7b3f35,0xbf55bf6dbe483f35,0x3f753e48bf46bf6d,0xbef13f0e3f7f3ec4
.quad 0xbf6dbf353ec43f80,0x3f6d3f35bec4bf80,0x3ef13f7b3dc9bf6d,0x3e95bf55bf463ec4,0x3e48bf6dbf0e3f35,0xbf7bbec43f553f35,0xbf463f0e3f62bec4,0xbdc93f7b3e95bf6d
.quad 0x3f808000bf808000,0x3f808000bf808000,0xbf46bf0e3f623ec4,0xbdc9bf7b3e953f6d,0x3e483f6dbf0ebf35,0xbf7b3ec43f55bf35,0x3ef1bf7b3dc93f6d,0x3e953f55bf46bec4
.quad 0xbf6d3f353ec4bf80,0x3f6dbf35bec43f80,0x3f75be48bf463f6d,0xbef1bf0e3f7fbec4,0xbf0ebec43f7bbf35,0xbf553f6dbe48bf35,0xbdc93f55bf753ec4,0x3f223e48bf623f6d
.quad 0x3f35bf803f358000,0x3f35bf803f358000,0xbf7f3f55be95bec4,0xbf463e483ef1bf6d,0x3f55bec4be483f35,0xbf0e3f6dbf7b3f35,0xbe95be483f22bf6d,0x3f62bf0e3dc93ec4
.quad 0xbec43f35bf6d3f80,0x3ec4bf353f6dbf80,0x3f62bf7b3f7fbf6d,0xbf753f55bf223ec4,0xbf7b3f6dbf553f35,0xbe483ec4bf0e3f35,0x3f22bf0e3ef1bec4,0x3f7fbf7b3f75bf6d
.quad 0x8000800080008000,0x8000800080008000,0x3f753f7b3f7f3f80,0x3ef13f0e3f223f35,0x3f0e3ec43e488000,0x3f553f6d3f7b3f80,0xbf22bf55bf75bf80,0x3f7f3f7b3f623f35
.quad 0xbf6dbf35bec48000,0x3f6d3f353ec48000,0x3dc93f0e3f623f80,0x3f223e48be95bf35,0x3f7b3f6d3f0e8000,0x3e48bec4bf55bf80,0x3ef1be48bf46bf80,0xbe95bf55bf7fbf35
.quad 0xbf35bf80bf358000,0xbf35bf80bf358000,0xbf62be483f223f80,0xbf75bf55bdc93f35,0x3e483f6d3f558000,0xbf7bbec43f0e3f80,0x3f7f3f0ebef1bf80,0xbf463e483f753f35
.quad 0x3ec4bf35bf6d8000,0xbec43f353f6d8000,0xbf46bf553e953f80,0x3dc93f7b3ef1bf35,0xbf553ec43f7b8000,0x3f0e3f6dbe48bf80,0x3e953f7bbdc9bf80,0x3f623f0ebf46bf35
.quad 0x3f808000bf808000,0x3f808000bf808000,0x3e95bf7bbdc93f80,0x3f62bf0ebf463f35,0xbf55bec43f7b8000,0x3f0ebf6dbe483f80,0xbf463f553e95bf80,0x3dc9bf7b3ef13f35
.quad 0x3ec43f35bf6d8000,0xbec4bf353f6d8000,0x3f7fbf0ebef13f80,0xbf46be483f75bf35,0x3e48bf6d3f558000,0xbf7b3ec43f0ebf80,0xbf623e483f22bf80,0xbf753f55bdc9bf35
.quad 0xbf353f80bf358000,0xbf353f80bf358000,0x3ef13e48bf463f80,0xbe953f55bf7f3f35,0x3f7bbf6d3f0e8000,0x3e483ec4bf553f80,0x3dc9bf0e3f62bf80,0x3f22be48be953f35
.quad 0xbf6d3f35bec48000,0x3f6dbf353ec48000,0xbf223f55bf753f80,0x3f7fbf7b3f62bf35,0x3f0ebec43e488000,0x3f55bf6d3f7bbf80,0x3f75bf7b3f7fbf80,0x3ef1bf0e3f22bf35
.quad 0x8000800080008000,0x8000800080008000,0x3f463f553f623f6d,0x3dc93e483e953ec4,0x3f7b3f6d3f553f35,0x3e483ec43f0e3f35,0x3ef13e48bdc9bec4,0x3e953f0e3f463f6d
.quad 0xbec4bf35bf6dbf80,0x3ec43f353f6d3f80,0xbf75bf7bbf46bec4,0x3ef13f553f7f3f6d,0xbf55bec43e483f35,0x3f0e3f6d3f7b3f35,0xbdc93f0e3f753f6d,0x3f223f7b3f623ec4
.quad 0x3f353f803f358000,0x3f353f803f358000,0x3f7f3f0ebe95bf6d,0x3f463f7b3ef1bec4,0x3f0ebec4bf7bbf35,0x3f553f6d3e48bf35,0xbe95bf7bbf223ec4,0x3f623f55bdc9bf6d
.quad 0xbf6dbf353ec43f80,0x3f6d3f35bec4bf80,0xbf623e483f7f3ec4,0x3f753f0ebf22bf6d,0xbe483f6d3f0ebf35,0x3f7b3ec4bf55bf35,0x3f223f55bef1bf6d,0x3f7f3e48bf75bec4
.quad 0x3f808000bf808000,0x3f808000bf808000,0x3f22bf55bef13f6d,0x3f7fbe48bf753ec4,0xbe48bf6d3f0e3f35,0x3f7bbec4bf553f35,0xbf62be483f7fbec4,0x3f75bf0ebf223f6d
.quad 0xbf6d3f353ec4bf80,0x3f6dbf35bec43f80,0xbe953f7bbf22bec4,0x3f62bf55bdc93f6d,0x3f0e3ec4bf7b3f35,0x3f55bf6d3e483f35,0x3f7fbf0ebe953f6d,0x3f46bf7b3ef13ec4
.quad 0x3f35bf803f358000,0x3f35bf803f358000,0xbdc9bf0e3f75bf6d,0x3f22bf7b3f62bec4,0xbf553ec43e48bf35,0x3f0ebf6d3f7bbf35,0xbf753f7bbf463ec4,0x3ef1bf553f7fbf6d
.quad 0xbec43f35bf6d3f80,0x3ec4bf353f6dbf80,0x3ef1be48bdc93ec4,0x3e95bf0e3f46bf6d,0x3f7bbf6d3f55bf35,0x3e48bec43f0ebf35,0x3f46bf553f62bf6d,0x3dc9be483e95bec4
.quad 0x8000800080008000,0x8000800080008000,0x3e95be483dc98000,0x3f62bf553f46bf35,0x3f0ebec43e488000,0x3f55bf6d3f7bbf80,0x3f46bf0e3e958000,0xbdc9be483ef1bf35
.quad 0x3f6dbf353ec48000,0xbf6d3f35bec48000,0x3f7fbf553ef18000,0xbf463f7bbf753f35,0x3f7bbf6d3f0e8000,0x3e483ec4bf553f80,0x3f62bf7b3f228000,0x3f75bf0ebdc93f35
.quad 0x3f35bf803f358000,0x3f35bf803f358000,0x3ef1bf7b3f468000,0xbe95bf0e3f7fbf35,0x3e48bf6d3f558000,0xbf7b3ec43f0ebf80,0xbdc9bf553f628000,0xbf223f7bbe95bf35
.quad 0xbec4bf353f6d8000,0x3ec43f35bf6d8000,0xbf22bf0e3f758000,0x3f7fbe48bf623f35,0xbf55bec43f7b8000,0x3f0ebf6dbe483f80,0xbf75be483f7f8000,0xbef1bf553f223f35
.quad 0xbf8080003f808000,0xbf8080003f808000,0xbf753e483f7f8000,0xbef13f553f22bf35,0xbf553ec43f7b8000,0x3f0e3f6dbe48bf80,0xbf223f0e3f758000,0x3f7f3e48bf62bf35
.quad 0xbec43f353f6d8000,0x3ec4bf35bf6d8000,0xbdc93f553f628000,0xbf22bf7bbe953f35,0x3e483f6d3f558000,0xbf7bbec43f0e3f80,0x3ef13f7b3f468000,0xbe953f0e3f7f3f35
.quad 0x3f353f803f358000,0x3f353f803f358000,0x3f623f7b3f228000,0x3f753f0ebdc9bf35,0x3f7b3f6d3f0e8000,0x3e48bec4bf55bf80,0x3f7f3f553ef18000,0xbf46bf7bbf75bf35
.quad 0x3f6d3f353ec48000,0xbf6dbf35bec48000,0x3f463f0e3e958000,0xbdc93e483ef13f35,0x3f0e3ec43e488000,0x3f553f6d3f7b3f80,0x3e953e483dc98000,0x3f623f553f463f35
.quad 0x8000800080008000,0x8000800080008000,0x3f22bf0e3ef1bec4,0x3f7fbf7b3f75bf6d,0x3f7bbf6d3f55bf35,0x3e48bec43f0ebf35,0x3f62bf7b3f7fbf6d,0xbf753f55bf223ec4
.quad 0x3ec4bf353f6dbf80,0xbec43f35bf6d3f80,0xbe95be483f22bf6d,0x3f62bf0e3dc93ec4,0xbf553ec43e48bf35,0x3f0ebf6d3f7bbf35,0xbf7f3f55be95bec4,0xbf463e483ef1bf6d
.quad 0xbf353f80bf358000,0xbf353f80bf358000,0xbdc93f55bf753ec4,0x3f223e48bf623f6d,0x3f0e3ec4bf7b3f35,0x3f55bf6d3e483f35,0x3f75be48bf463f6d,0xbef1bf0e3f7fbec4
.quad 0x3f6dbf35bec43f80,0xbf6d3f353ec4bf80,0x3ef1bf7b3dc93f6d,0x3e953f55bf46bec4,0xbe48bf6d3f0e3f35,0x3f7bbec4bf553f35,0xbf46bf0e3f623ec4,0xbdc9bf7b3e953f6d
.quad 0xbf8080003f808000,0xbf8080003f808000,0xbf463f0e3f62bec4,0xbdc93f7b3e95bf6d,0xbe483f6d3f0ebf35,0x3f7b3ec4bf55bf35,0x3ef13f7b3dc9bf6d,0x3e95bf55bf463ec4
.quad 0x3f6d3f35bec4bf80,0xbf6dbf353ec43f80,0x3f753e48bf46bf6d,0xbef13f0e3f7f3ec4,0x3f0ebec4bf7bbf35,0x3f553f6d3e48bf35,0xbdc9bf55bf75bec4,0x3f22be48bf62bf6d
.quad 0xbf35bf80bf358000,0xbf35bf80bf358000,0xbf7fbf55be953ec4,0xbf46be483ef13f6d,0xbf55bec43e483f35,0x3f0e3f6d3f7b3f35,0xbe953e483f223f6d,0x3f623f0e3dc9bec4
.quad 0x3ec43f353f6d3f80,0xbec4bf35bf6dbf80,0x3f623f7b3f7f3f6d,0xbf75bf55bf22bec4,0x3f7b3f6d3f553f35,0x3e483ec43f0e3f35,0x3f223f0e3ef13ec4,0x3f7f3f7b3f753f6d
.quad 0x8000800080008000,0x8000800080008000,0x3f75bf7b3f7fbf80,0x3ef1bf0e3f22bf35,0xbf0e3ec4be488000,0xbf553f6dbf7b3f80,0xbf223f55bf753f80,0x3f7fbf7b3f62bf35
.quad 0x3f6dbf353ec48000,0xbf6d3f35bec48000,0x3dc9bf0e3f62bf80,0x3f22be48be953f35,0xbf7b3f6dbf0e8000,0xbe48bec43f55bf80,0x3ef13e48bf463f80,0xbe953f55bf7f3f35
.quad 0x3f35bf803f358000,0x3f35bf803f358000,0xbf623e483f22bf80,0xbf753f55bdc9bf35,0xbe483f6dbf558000,0x3f7bbec4bf0e3f80,0x3f7fbf0ebef13f80,0xbf46be483f75bf35
.quad 0xbec4bf353f6d8000,0x3ec43f35bf6d8000,0xbf463f553e95bf80,0x3dc9bf7b3ef13f35,0x3f553ec4bf7b8000,0xbf0e3f6d3e48bf80,0x3e95bf7bbdc93f80,0x3f62bf0ebf463f35
.quad 0xbf8080003f808000,0xbf8080003f808000,0x3e953f7bbdc9bf80,0x3f623f0ebf46bf35,0x3f55bec4bf7b8000,0xbf0ebf6d3e483f80,0xbf46bf553e953f80,0x3dc93f7b3ef1bf35
.quad 0xbec43f353f6d8000,0x3ec4bf35bf6d8000,0x3f7f3f0ebef1bf80,0xbf463e483f753f35,0xbe48bf6dbf558000,0x3f7b3ec4bf0ebf80,0xbf62be483f223f80,0xbf75bf55bdc93f35
.quad 0x3f353f803f358000,0x3f353f803f358000,0x3ef1be48bf46bf80,0xbe95bf55bf7fbf35,0xbf7bbf6dbf0e8000,0xbe483ec43f553f80,0x3dc93f0e3f623f80,0x3f223e48be95bf35
.quad 0x3f6d3f353ec48000,0xbf6dbf35bec48000,0xbf22bf55bf75bf80,0x3f7f3f7b3f623f35,0xbf0ebec4be488000,0xbf55bf6dbf7bbf80,0x3f753f7b3f7f3f80,0x3ef13f0e3f223f35
.quad 0x8000800080008000,0x8000800080008000,0x3f46bf553f62bf6d,0x3dc9be483e95bec4,0xbf7b3f6dbf553f35,0xbe483ec4bf0e3f35,0x3ef1be48bdc93ec4,0x3e95bf0e3f46bf6d
.quad 0x3ec4bf353f6dbf80,0xbec43f35bf6d3f80,0xbf753f7bbf463ec4,0x3ef1bf553f7fbf6d,0x3f55bec4be483f35,0xbf0e3f6dbf7b3f35,0xbdc9bf0e3f75bf6d,0x3f22bf7b3f62bec4
.quad 0xbf353f80bf358000,0xbf353f80bf358000,0x3f7fbf0ebe953f6d,0x3f46bf7b3ef13ec4,0xbf0ebec43f7bbf35,0xbf553f6dbe48bf35,0xbe953f7bbf22bec4,0x3f62bf55bdc93f6d
.quad 0x3f6dbf35bec43f80,0xbf6d3f353ec4bf80,0xbf62be483f7fbec4,0x3f75bf0ebf223f6d,0x3e483f6dbf0ebf35,0xbf7b3ec43f55bf35,0x3f22bf55bef13f6d,0x3f7fbe48bf753ec4
.quad 0xbf8080003f808000,0xbf8080003f808000,0x3f223f55bef1bf6d,0x3f7f3e48bf75bec4,0x3e48bf6dbf0e3f35,0xbf7bbec43f553f35,0xbf623e483f7f3ec4,0x3f753f0ebf22bf6d
.quad 0x3f6d3f35bec4bf80,0xbf6dbf353ec43f80,0xbe95bf7bbf223ec4,0x3f623f55bdc9bf6d,0xbf0e3ec43f7b3f35,0xbf55bf6dbe483f35,0x3f7f3f0ebe95bf6d,0x3f463f7b3ef1bec4
.quad 0xbf35bf80bf358000,0xbf35bf80bf358000,0xbdc93f0e3f753f6d,0x3f223f7b3f623ec4,0x3f553ec4be48bf35,0xbf0ebf6dbf7bbf35,0xbf75bf7bbf46bec4,0x3ef13f553f7f3f6d
.quad 0x3ec43f353f6d3f80,0xbec4bf35bf6dbf80,0x3ef13e48bdc9bec4,0x3e953f0e3f463f6d,0xbf7bbf6dbf55bf35,0xbe48bec4bf0ebf35,0x3f463f553f623f6d,0x3dc93e483e953ec4
.quad 0x8000800080008000,0x8000800080008000,0xbe953e48bdc98000,0xbf623f55bf463f35,0x3f0ebec43e488000,0x3f55bf6d3f7bbf80,0xbf463f0ebe958000,0x3dc93e48bef13f35
.quad 0x3f6dbf353ec48000,0xbf6d3f35bec48000,0xbf7f3f55bef18000,0x3f46bf7b3f75bf35,0x3f7bbf6d3f0e8000,0x3e483ec4bf553f80,0xbf623f7bbf228000,0xbf753f0e3dc9bf35
.quad 0x3f35bf803f358000,0x3f35bf803f358000,0xbef13f7bbf468000,0x3e953f0ebf7f3f35,0x3e48bf6d3f558000,0xbf7b3ec43f0ebf80,0x3dc93f55bf628000,0x3f22bf7b3e953f35
.quad 0xbec4bf353f6d8000,0x3ec43f35bf6d8000,0x3f223f0ebf758000,0xbf7f3e483f62bf35,0xbf55bec43f7b8000,0x3f0ebf6dbe483f80,0x3f753e48bf7f8000,0x3ef13f55bf22bf35
.quad 0xbf8080003f808000,0xbf8080003f808000,0x3f75be48bf7f8000,0x3ef1bf55bf223f35,0xbf553ec43f7b8000,0x3f0e3f6dbe48bf80,0x3f22bf0ebf758000,0xbf7fbe483f623f35
.quad 0xbec43f353f6d8000,0x3ec4bf35bf6d8000,0x3dc9bf55bf628000,0x3f223f7b3e95bf35,0x3e483f6d3f558000,0xbf7bbec43f0e3f80,0xbef1bf7bbf468000,0x3e95bf0ebf7fbf35
.quad 0x3f353f803f358000,0x3f353f803f358000,0xbf62bf7bbf228000,0xbf75bf0e3dc93f35,0x3f7b3f6d3f0e8000,0x3e48bec4bf55bf80,0xbf7fbf55bef18000,0x3f463f7b3f753f35
.quad 0x3f6d3f353ec48000,0xbf6dbf35bec48000,0xbf46bf0ebe958000,0x3dc9be48bef1bf35,0x3f0e3ec43e488000,0x3f553f6d3f7b3f80,0xbe95be48bdc98000,0xbf62bf55bf46bf35
.quad 0x8000800080008000,0x8000800080008000,0xbf223f0ebef13ec4,0xbf7f3f7bbf753f6d,0x3f7bbf6d3f55bf35,0x3e48bec43f0ebf35,0xbf623f7bbf7f3f6d,0x3f75bf553f22bec4
.quad 0x3ec4bf353f6dbf80,0xbec43f35bf6d3f80,0x3e953e48bf223f6d,0xbf623f0ebdc9bec4,0xbf553ec43e48bf35,0x3f0ebf6d3f7bbf35,0x3f7fbf553e953ec4,0x3f46be48bef13f6d
.quad 0xbf353f80bf358000,0xbf353f80bf358000,0x3dc9bf553f75bec4,0xbf22be483f62bf6d,0x3f0e3ec4bf7b3f35,0x3f55bf6d3e483f35,0xbf753e483f46bf6d,0x3ef13f0ebf7f3ec4
.quad 0x3f6dbf35bec43f80,0xbf6d3f353ec4bf80,0xbef13f7bbdc9bf6d,0xbe95bf553f463ec4,0xbe48bf6d3f0e3f35,0x3f7bbec4bf553f35,0x3f463f0ebf62bec4,0x3dc93f7bbe95bf6d
.quad 0xbf8080003f808000,0xbf8080003f808000,0x3f46bf0ebf623ec4,0x3dc9bf7bbe953f6d,0xbe483f6d3f0ebf35,0x3f7b3ec4bf55bf35,0xbef1bf7bbdc93f6d,0xbe953f553f46bec4
.quad 0x3f6d3f35bec4bf80,0xbf6dbf353ec43f80,0xbf75be483f463f6d,0x3ef1bf0ebf7fbec4,0x3f0ebec4bf7bbf35,0x3f553f6d3e48bf35,0x3dc93f553f753ec4,0xbf223e483f623f6d
.quad 0xbf35bf80bf358000,0xbf35bf80bf358000,0x3f7f3f553e95bec4,0x3f463e48bef1bf6d,0xbf55bec43e483f35,0x3f0e3f6d3f7b3f35,0x3e95be48bf22bf6d,0xbf62bf0ebdc93ec4
.quad 0x3ec43f353f6d3f80,0xbec4bf35bf6dbf80,0xbf62bf7bbf7fbf6d,0x3f753f553f223ec4,0x3f7b3f6d3f553f35,0x3e483ec43f0e3f35,0xbf22bf0ebef1bec4,0xbf7fbf7bbf75bf6d
.quad 0x8000800080008000,0x8000800080008000,0xbf753f7bbf7f3f80,0xbef13f0ebf223f35,0xbf0e3ec4be488000,0xbf553f6dbf7b3f80,0x3f22bf553f75bf80,0xbf7f3f7bbf623f35
.quad 0x3f6dbf353ec48000,0xbf6d3f35bec48000,0xbdc93f0ebf623f80,0xbf223e483e95bf35,0xbf7b3f6dbf0e8000,0xbe48bec43f55bf80,0xbef1be483f46bf80,0x3e95bf553f7fbf35
.quad 0x3f35bf803f358000,0x3f35bf803f358000,0x3f62be48bf223f80,0x3f75bf553dc93f35,0xbe483f6dbf558000,0x3f7bbec4bf0e3f80,0xbf7f3f0e3ef1bf80,0x3f463e48bf753f35
.quad 0xbec4bf353f6d8000,0x3ec43f35bf6d8000,0x3f46bf55be953f80,0xbdc93f7bbef1bf35,0x3f553ec4bf7b8000,0xbf0e3f6d3e48bf80,0xbe953f7b3dc9bf80,0xbf623f0e3f46bf35
.quad 0xbf8080003f808000,0xbf8080003f808000,0xbe95bf7b3dc93f80,0xbf62bf0e3f463f35,0x3f55bec4bf7b8000,0xbf0ebf6d3e483f80,0x3f463f55be95bf80,0xbdc9bf7bbef13f35
.quad 0xbec43f353f6d8000,0x3ec4bf35bf6d8000,0xbf7fbf0e3ef13f80,0x3f46be48bf75bf35,0xbe48bf6dbf558000,0x3f7b3ec4bf0ebf80,0x3f623e48bf22bf80,0x3f753f553dc9bf35
.quad 0x3f353f803f358000,0x3f353f803f358000,0xbef13e483f463f80,0x3e953f553f7f3f35,0xbf7bbf6dbf0e8000,0xbe483ec43f553f80,0xbdc9bf0ebf62bf80,0xbf22be483e953f35
.quad 0x3f6d3f353ec48000,0xbf6dbf35bec48000,0x3f223f553f753f80,0xbf7fbf7bbf62bf35,0xbf0ebec4be488000,0xbf55bf6dbf7bbf80,0xbf75bf7bbf7fbf80,0xbef1bf0ebf22bf35
.quad 0x8000800080008000,0x8000800080008000,0xbf463f55bf623f6d,0xbdc93e48be953ec4,0xbf7b3f6dbf553f35,0xbe483ec4bf0e3f35,0xbef13e483dc9bec4,0xbe953f0ebf463f6d
.quad 0x3ec4bf353f6dbf80,0xbec43f35bf6d3f80,0x3f75bf7b3f46bec4,0xbef13f55bf7f3f6d,0x3f55bec4be483f35,0xbf0e3f6dbf7b3f35,0x3dc93f0ebf753f6d,0xbf223f7bbf623ec4
.quad 0xbf353f80bf358000,0xbf353f80bf358000,0xbf7f3f0e3e95bf6d,0xbf463f7bbef1bec4,0xbf0ebec43f7bbf35,0xbf553f6dbe48bf35,0x3e95bf7b3f223ec4,0xbf623f553dc9bf6d
.quad 0x3f6dbf35bec43f80,0xbf6d3f353ec4bf80,0x3f623e48bf7f3ec4,0xbf753f0e3f22bf6d,0x3e483f6dbf0ebf35,0xbf7b3ec43f55bf35,0xbf223f553ef1bf6d,0xbf7f3e483f75bec4
.quad 0xbf8080003f808000,0xbf8080003f808000,0xbf22bf553ef13f6d,0xbf7fbe483f753ec4,0x3e48bf6dbf0e3f35,0xbf7bbec43f553f35,0x3f62be48bf7fbec4,0xbf75bf0e3f223f6d
.quad 0x3f6d3f35bec4bf80,0xbf6dbf353ec43f80,0x3e953f7b3f22bec4,0xbf62bf553dc93f6d,0xbf0e3ec43f7b3f35,0xbf55bf6dbe483f35,0xbf7fbf0e3e953f6d,0xbf46bf7bbef13ec4
.quad 0xbf35bf80bf358000,0xbf35bf80bf358000,0x3dc9bf0ebf75bf6d,0xbf22bf7bbf62bec4,0x3f553ec4be48bf35,0xbf0ebf6dbf7bbf35,0x3f753f7b3f463ec4,0xbef1bf55bf7fbf6d
.quad 0x3ec43f353f6d3f80,0xbec4bf35bf6dbf80,0xbef1be483dc93ec4,0xbe95bf0ebf46bf6d,0xbf7bbf6dbf55bf35,0xbe48bec4bf0ebf35,0xbf46bf55bf62bf6d,0xbdc9be48be95bec4
.quad 0x35cccccd35cccccd,0x35cccccd35cccccd,0x35cccc8e35cccccd,0x35ccca9435cccbd0,0x35cccbd035cccccd,0x35ccc3eb35ccc8da,0x35ccca9435cccccd,0x35ccb8d135ccc3eb
.quad 0x35ccc8da35cccccd,0x35cca94635ccbd02,0x35ccc6a235cccccd,0x35cc954b35ccb421,0x35ccc3eb35cccccd,0x35cc7ce035cca946,0x35ccc0b635cccccd,0x35cc600635cc9c72
.quad 0x35ccbd0235cccccd,0x35cc3ebe35cc8da6,0x35ccb8d135cccccd,0x35cc190735cc7ce0,0x35ccb42135cccccd,0x35cbeee435cc6a23,0x35ccaef335cccccd,0x35cbc05435cc556c
.quad 0x35cca94635cccccd,0x35cb8d5a35cc3ebe,0x35cca31b35cccccd,0x35cb55f535cc2618,0x35cc9c7235cccccd,0x35cb1a2735cc0b7a,0x35cc954b35cccccd,0x35cad9f235cbeee4
.quad 0x35cc8da635cccccd,0x35ca955635cbd057,0x35cc858235cccccd,0x35ca4c5635cbafd4,0x35cc7ce035cccccd,0x35c9fef335cb8d5a,0x35cc73c135cccccd,0x35c9ad2f35cb68e9
.quad 0x35cc6a2335cccccd,0x35c9570a35cb4283,0x35cc600635cccccd,0x35c8fc8935cb1a27,0x35cc556c35cccccd,0x35c89dab35caefd6,0x35cc4a5435cccccd,0x35c83a7335cac390
.quad 0x35cc3ebe35cccccd,0x35c7d2e435ca9556,0x35cc32aa35cccccd,0x35c7670035ca6529,0x35cc261835cccccd,0x35c6f6c835ca3307,0x35cc190735cccccd,0x35c6824135c9fef3
.quad 0x35cc0b7a35cccccd,0x35c6096a35c9c8ed,0x35cbfd6e35cccccd,0x35c58c4935c990f4,0x35cbeee435cccccd,0x35c50adf35c9570a,0x35cbdfdd35cccccd,0x35c4852f35c91b30
.quad 0x35cccccd35cccccd,0x35cccccd35cccccd,0x35ccc6a235ccc8da,0x35ccc0b635ccc3eb,0x35ccb42135ccbd02,0x35cc9c7235cca946,0x35cc954b35cca946,0x35cc600635cc7ce0
.quad 0x35cc6a2335cc8da6,0x35cc0b7a35cc3ebe,0x35cc32aa35cc6a23,0x35cb9ed535cbeee4,0x35cbeee435cc3ebe,0x35cb1a2735cb8d5a,0x35cb9ed535cc0b7a,0x35ca7d7e35cb1a27
.quad 0x35cb428335cbd057,0x35c9c8ed35ca9556,0x35cad9f235cb8d5a,0x35c8fc8935c9fef3,0x35ca652935cb4283,0x35c8186a35c9570a,0x35c9e42e35caefd6,0x35c71cab35c89dab
.quad 0x35c9570a35ca9556,0x35c6096a35c7d2e4,0x35c8bdc635ca3307,0x35c4dec835c6f6c8,0x35c8186a35c9c8ed,0x35c39ce835c6096a,0x35c7670035c9570a,0x35c243ef35c50adf
.quad 0x35c6a99335c8dd65,0x35c0d40735c3fb3c,0x35c5e02f35c85c01,0x35bf4d5a35c2da99,0x35c50adf35c7d2e4,0x35bdb01735c1a90f,0x35c429b035c74213,0x35bbfc7035c066b8
.quad 0x35c33cb135c6a993,0x35ba329635bf13b1,0x35c243ef35c6096a,0x35b852c135bdb017,0x35c13f7935c5619f,0x35b65d2835bc3c09,0x35c02f5f35c4b238,0x35b4520835bab7a7
.quad 0x35bf13b135c3fb3c,0x35b2319e35b92313,0x35bdec8135c33cb1,0x35affc2a35b77e6f,0x35bcb9e035c276a0,0x35adb1ef35b5c9e1,0x35bb7be135c1a90f,0x35ab533235b4058e
.quad 0x35ba329635c0d407,0x35a8e03a35b2319e,0x35b8de1435bff78f,0x35a6595335b04e38,0x35b77e6f35bf13b1,0x35a3bec835ae5b88,0x35b613bd35be2876,0x35a110e735ac59b8
.quad 0x0,0x0,0x31a0d96b00000000,0x3271455a3220d93a,0x3220d93a00000000,0x32f142bd32a0d873,0x3271455a00000000,0x3334eec832f142bd
.quad 0x32a0d87300000000,0x337138463320d559,0x32c90dd600000000,0x3396be44334907c8,0x32f142bd00000000,0x33b4dd2033713846,0x330cbb8700000000,0x33d2f811338cb338
.quad 0x3320d55900000000,0x33f10e6e33a0c8f3,0x3334eec800000000,0x34078fc833b4dd20,0x334907c800000000,0x3416956933c8ef90,0x335d204b00000000,0x342597c633dd000f
.quad 0x3371384600000000,0x3434968b33f10e6e,0x3382a7d600000000,0x3443916634028d3d,0x338cb33800000000,0x34528804340c9200,0x3396be4400000000,0x34617a1034169569
.quad 0x33a0c8f300000000,0x347067393420975e,0x33aad33e00000000,0x347f4f2b342a97c7,0x33b4dd2000000000,0x348718ca3434968b,0x33bee69300000000,0x348e8710343e9392
.quad 0x33c8ef9000000000,0x3495f23f34488ec2,0x33d2f81100000000,0x349d5a2e34528804,0x33dd000f00000000,0x34a4beb3345c7f3e,0x33e7078600000000,0x34ac1fa534667457
.quad 0x33f10e6e00000000,0x34b37cdc34706739,0x33fb14c100000000,0x34bad62f347a57c9,0x34028d3d00000000,0x34c22b74348222f8,0x34078fc800000000,0x34c97c83348718ca
.quad 0x340c920000000000,0x34d0c934348c0d4f,0x341193e200000000,0x34d8115e3491007a,0x3416956900000000,0x34df54d83495f23f,0x341b969400000000,0x34e6937a349ae293
.quad 0x0,0x0,0x32c90dd632a0d873,0x330cbb8732f142bd,0x334907c83320d559,0x338cb33833713846,0x3396be4433713846,0x33d2f81133b4dd20
.quad 0x33c8ef9033a0c8f3,0x340c920033f10e6e,0x33fb14c133c8ef90,0x342f976034169569,0x3416956933f10e6e,0x345288043434968b,0x342f9760340c9200,0x34755fcc34528804
.quad 0x34488ec23420975e,0x348c0d4f34706739,0x34617a103434968b,0x349d5a2e348718ca,0x347a57c934488ec2,0x34ae94793495f23f,0x34899337345c7f3e,0x34bfba2834a4beb3
.quad 0x3495f23f34706739,0x34d0c93434b37cdc,0x34a2483f348222f8,0x34e1bf9934c22b74,0x34ae9479348c0d4f,0x34f29b5834d0c934,0x34bad62f3495f23f,0x3501ad3934df54d8
.quad 0x34c70ca3349fd168,0x3509fd7634edcd1c,0x34d3371a34a9aa67,0x35123d6934fc30c0,0x34df54d834b37cdc,0x351a6c1835053f42,0x34eb652134bd4866,0x3522888b350c5a95
.quad 0x34f7673d34c70ca3,0x352a91ce351369bb,0x3501ad3934d0c934,0x353286ed351a6c18,0x35079f0334da7db8,0x353a66f93521610f,0x350d88a234e429d0,0x3542310335284807
.quad 0x351369bb34edcd1c,0x3549e41f352f2067,0x351941f234f7673d,0x35517f653535e995,0x351f10ee35007bea,0x355901f0353ca2fc,0x3524d65535053f42,0x35606adb35434c06
.quad 0x352a91ce3509fd76,0x3567b9483549e41f,0x35304301350eb659,0x356eec5835506ab5,0x3535e995351369bb,0x357603343556df37,0x353b85343518176e,0x357cfd04355d4116
.quad 0x35cccccd35cccccd,0x35cccccd35cccccd,0x35ccb8d135ccbd02,0x35ccaef335ccb421,0x35cc7ce035cc8da6,0x35cc556c35cc6a23,0x35cc190735cc3ebe,0x35cbc05435cbeee4
.quad 0x35cb8d5a35cbd057,0x35caefd635cb4283,0x35cad9f235cb4283,0x35c9e42e35ca6529,0x35c9fef335ca9556,0x35c89dab35c9570a,0x35c8fc8935c9c8ed,0x35c71cab35c8186a
.quad 0x35c7d2e435c8dd65,0x35c5619f35c6a993,0x35c6824135c7d2e4,0x35c36d0935c50adf,0x35c50adf35c6a993,0x35c13f7935c33cb1,0x35c36d0935c5619f,0x35bed99335c13f79
.quad 0x35c1a90f35c3fb3c,0x35bc3c0935bf13b1,0x35bfbf4935c276a0,0x35b9679f35bcb9e0,0x35bdb01735c0d407,0x35b65d2835ba3296,0x35bb7be135bf13b1,0x35b31d8735b77e6f
.quad 0x35b9231335bd35e5,0x35afa9af35b49e13,0x35b6a62335bb3aec,0x35ac02a035b19232,0x35b4058e35b92313,0x35a8296b35ae5b88,0x35b141d735b6eeae,0x35a41f3135aafadc
.quad 0x35ae5b8835b49e13,0x359fe51e35a770fe,0x35ab533235b2319e,0x359b7c6d35a3bec8,0x35a8296b35afa9af,0x3596e669359fe51e,0x35a4ded435ad06a9,0x35922466359be4ed
.quad 0x35a1740f35aa48f4,0x358d37c93597bf2e,0x359de9c735a770fe,0x35882200359374de,0x359a40ae35a47f35,0x3582e487358f0707,0x3596797a35a1740f,0x357b01cb358a76bb
.quad 0x359294e9359e5003,0x356ff15b3585c511,0x358e93bb359b138d,0x35649af83580f32d,0x358a76bb3597bf2e,0x355901f03578046f,0x35863eb435945368,0x354d29a4356de6c2
.quad 0x35cccccd35cccccd,0x35cccccd35cccccd,0x35cca31b35cca946,0x35cc954b35cc9c72,0x35cc261835cc3ebe,0x35cbeee435cc0b7a,0x35cb55f535cb8d5a,0x35cad9f235cb1a27
.quad 0x35ca330735ca9556,0x35c9570a35c9c8ed,0x35c8bdc635c9570a,0x35c7670035c8186a,0x35c6f6c835c7d2e4,0x35c50adf35c6096a,0x35c4dec835c6096a,0x35c243ef35c39ce8
.quad 0x35c276a035c3fb3c,0x35bf13b135c0d407,0x35bfbf4935c1a90f,0x35bb7be135bdb017,0x35bcb9e035bf13b1,0x35b77e6f35ba3296,0x35b9679f35bc3c09,0x35b31d8735b65d28
.quad 0x35b5c9e135b92313,0x35ae5b8835b2319e,0x35b1e21f35b5c9e1,0x35a93b0635adb1ef,0x35adb1ef35b2319e,0x35a3bec835a8e03a,0x35a93b0635ae5b88,0x359de9c735a3bec8
.quad 0x35a47f3535aa48f4,0x3597bf2e359e5003,0x359f806a35a5fb4c,0x359142533598967c,0x359a40ae35a1740f,0x358a76bb359294e9,0x3594c224359cb4cd,0x35836014358c4e1d
.quad 0x358f07073597bf2e,0x3578046f3585c511,0x358911af359294e9,0x3568c245357df9b6,0x3582e487358d37c9,0x355901f0356ff15b,0x357904283587a9aa,0x3548cbf9356177b4
.quad 0x356bd9dd3581ec7b,0x3538292a35529394,0x355e4f8b3578046f,0x3527228835434c06,0x35506ab5356bd9dd,0x3515c14d3533a83f,0x35423103355f5d78,0x35040ee53523afa2
.quad 0x3533a83f35529394,0x34e429d0351369bb,0x3524d655354580a2,0x34bfba283502de37,0x3515c14d3538292a,0x349ae29334e429d0,0x35066f4c352a91ce,0x346b6e1134c22b74
.quad 0x0,0x0,0x3334eec83320d559,0x335d204b334907c8,0x33b4dd2033a0c8f3,0x33dd000f33c8ef90,0x34078fc833f10e6e,0x342597c634169569
.quad 0x3434968b3420975e,0x345c7f3e34488ec2,0x34617a1034488ec2,0x34899337347a57c9,0x348718ca34706739,0x34a4beb33495f23f,0x349d5a2e348c0d4f,0x34bfba2834ae9479
.quad 0x34b37cdc349fd168,0x34da7db834c70ca3,0x34c97c8334b37cdc,0x34f5019634df54d8,0x34df54d834c70ca3,0x35079f0334f7673d,0x34f5019634da7db8,0x351495b235079f03
.quad 0x35053f4234edcd1c,0x3521610f351369bb,0x350fe3b735007bea,0x352dfd61351f10ee,0x351a6c183509fd76,0x353a66f9352a91ce,0x3524d655351369bb,0x35469a3a3535e995
.quad 0x352f2067351cbf44,0x3552939435411588,0x3539484b3525fca2,0x355e4f8b354c12f5,0x35434c06352f2067,0x3569cab33556df37,0x354d29a43538292a,0x357501b2356177b4
.quad 0x3556df3735411588,0x357ff144356bd9dd,0x35606adb3549e41f,0x35854b1c35760334,0x3569cab335529394,0x358a76bb357ff144,0x3572fcea355b2291,0x358f79fb3584d0d5
.quad 0x357bffb535638fc3,0x3594536835898908,0x358268a9356bd9dd,0x35990197358e2017,0x3586b8043573ff99,0x359d832a359294e9,0x358aed14357bffb5,0x35a1d6d23596e669
.quad 0x358f07073581ec7b,0x35a5fb4c359b138d,0x359305113585c511,0x35a9ef63359f1b54,0x3596e66935898908,0x35adb1ef35a2fcc6,0x359aaa4d358d37c9,0x35b141d735a6b6f3
.quad 0x0,0x0,0x3382a7d633713846,0x3396be44338cb338,0x34028d3d33f10e6e,0x34169569340c9200,0x344391663434968b,0x34617a1034528804
.quad 0x348222f834706739,0x3495f23f348c0d4f,0x34a2483f3495f23f,0x34bad62f34ae9479,0x34c22b7434b37cdc,0x34df54d834d0c934,0x34e1bf9934d0c934,0x3501ad3934f29b58
.quad 0x35007bea34edcd1c,0x351369bb3509fd76,0x350fe3b735053f42,0x3524d655351a6c18,0x351f10ee351369bb,0x3535e995352a91ce,0x352dfd613521610f,0x35469a3a353a66f9
.quad 0x353ca2fc352f2067,0x3556df373549e41f,0x354afbc9353ca2fc,0x3566afbb355901f0,0x355901f03549e41f,0x357603343567b948,0x3566afbb3556df37,0x358268a935760334
.quad 0x3573ff9935638fc3,0x358989083581ec7b,0x3580760f356ff15b,0x35905ed935889a01,0x3586b804357bffb5,0x3596e669358f0707,0x358cc31e3583db51,0x359d1c2c35953084
.quad 0x359294e935898908,0x35a2fcc6359b138d,0x35982b04358f0707,0x35a8850735a0ad5c,0x359d832a35945368,0x35adb1ef35a5fb4c,0x35a29b2e35996c52,0x35b280af35aafadc
.quad 0x35a770fe359e5003,0x35b6eeae35afa9af,0x35ac02a035a2fcc6,0x35baf98335b4058e,0x35b04e3835a770fe,0x35be9eff35b80c6c,0x35b4520835abab1e,0x35c1dd2635bbbc62
.quad 0x35b80c6c35afa9af,0x35c4b23835bf13b1,0x35bb7be135b36b4e,0x35c71cab35c210c7,0x35be9eff35b6eeae,0x35c91b3035c4b238,0x35c1748035ba3296,0x35caacb235c6f6c8
.quad 0x35cccccd35cccccd,0x35cccccd35cccccd,0x35cc858235cc8da6,0x35cc73c135cc7ce0,0x35cbafd435cbd057,0x35cb68e935cb8d5a,0x35ca4c5635ca9556,0x35c9ad2f35c9fef3
.quad 0x35c85c0135c8dd65,0x35c7421335c7d2e4,0x35c5e02f35c6a993,0x35c429b035c50adf,0x35c2da9935c3fb3c,0x35c066b835c1a90f,0x35bf4d5a35c0d407,0x35bbfc7035bdb017
.quad 0x35bb3aec35bd35e5,0x35b6eeae35b92313,0x35b6a62335b92313,0x35b141d735b4058e,0x35b1923235b49e13,0x35aafadc35ae5b88,0x35ac02a035afa9af,0x35a41f3135a8296b
.quad 0x35a5fb4c35aa48f4,0x359cb4cd35a1740f,0x359f806a35a47f35,0x3594c224359a40ae,0x3598967c359e5003,0x358c4e1d359294e9,0x359142533597bf2e,0x35836014358a76bb
.quad 0x358989083590d0c3,0x3573ff993581ec7b,0x35816ffc35898908,0x35606adb3571f9a5,0x3571f9a53581ec7b,0x354c12f5355f5d78,0x35606adb3573ff99,0x35370998354c12f5
.quad 0x354e3fd435638fc3,0x3521610f3538292a,0x353b853435529394,0x350b2c303523afa2,0x3528480735411588,0x34e8fc95350eb659,0x351495b2352f2067,0x34bad62f34f29b58
.quad 0x35007bea351cbf44,0x348c0d4f34c70ca3,0x34d8115e3509fd76,0x34399548349ae293,0x34ae947934edcd1c,0x33b4dd20345c7f3e,0x34849e0a34c70ca3,0xb1a0d96b34028d3d
.quad 0x3434968b349fd168,0xb3c8ef903320d559,0x33bee69334706739,0xb4439166b34907c8,0x3220d93a3420975e,0xb491007ab40c9200,0xb396be4433a0c8f3,0xb4bfba28b4667457
.quad 0x35cccccd35cccccd,0x35cccccd35cccccd,0x35cc600635cc6a23,0x35cc4a5435cc556c,0x35cb1a2735cb4283,0x35cac39035caefd6,0x35c8fc8935c9570a,0x35c83a7335c89dab
.quad 0x35c6096a35c6a993,0x35c4b23835c5619f,0x35c243ef35c33cb1,0x35c02f5f35c13f79,0x35bdb01735bf13b1,0x35bab7a735bc3c09,0x35b852c135ba3296,0x35b4520835b65d28
.quad 0x35b2319e35b49e13,0x35ad06a935afa9af,0x35ab533235ae5b88,0x35a4ded435a8296b,0x35a3bec835a770fe,0x359be4ed359fe51e,0x359b7c6d359fe51e,0x359224663596e669
.quad 0x359294e93597bf2e,0x3587a9aa358d37c9,0x358911af358f0707,0x357904283582e487,0x357df9b63585c511,0x356177b4356ff15b,0x3568c2453578046f,0x3548cbf9355901f0
.quad 0x3552939435638fc3,0x352f206735411588,0x353b8534354e3fd4,0x351495b235284807,0x3523afa23538292a,0x34f29b58350eb659,0x350b2c303521610f,0x34bad62f34e8fc95
.quad 0x34e429d03509fd76,0x348222f834b37cdc,0x34b108e134e429d0,0x341193e2347a57c9,0x347a57c934b37cdc,0x32f142bd340c9200,0x341193e2348222f8,0xb3aad33e32f142bd
.quad 0x3320d5593420975e,0xb4488ec2b3a0c8f3,0xb382a7d633713846,0xb49d5a2eb43e9392,0xb42a97c7b320d559,0xb4d5a47eb495f23f,0xb4899337b40c9200,0xb5066f4cb4cbebe7
.quad 0xb4bd4866b4706739,0xb521610fb5007bea,0xb4f03484b4a9aa67,0xb53b8534b51a6c18,0xb51110bdb4da7db8,0xb554ba6cb533a83f,0xb5296d1fb5053f42,0xb56ce099b54c12f5
.quad 0x0,0x0,0x33aad33e33a0c8f3,0x33bee69333b4dd20,0x342a97c73420975e,0x343e93923434968b,0x347f4f2b34706739,0x348e8710348718ca
.quad 0x34a9aa67349fd168,0x34bd486634b37cdc,0x34d3371a34c70ca3,0x34eb652134df54d8,0x34fc30c034edcd1c,0x350c5a9535053f42,0x35123d693509fd76,0x3522888b351a6c18
.quad 0x3525fca2351cbf44,0x3538292a352f2067,0x3539484b352f2067,0x354d29a435434c06,0x354c12f535411588,0x356177b43556df37,0x355e4f8b35529394,0x357501b23569cab3
.quad 0x356ff15b35638fc3,0x3583db51357bffb5,0x3580760f3573ff99,0x358cc31e3586b804,0x35889a013581ec7b,0x35953084358f0707,0x35905ed935898908,0x359d1c2c3596e669
.quad 0x3597bf2e3590d0c3,0x35a47f35359e5003,0x359eb5dd3597bf2e,0x35ab533235a53e0d,0x35a53e0d359e5003,0x35b1923235abab1e,0x35ab533235a47f35,0x35b736c735b19232
.quad 0x35b0f10f35aa48f4,0x35bc3c0935b6eeae,0x35b613bd35afa9af,0x35c09d9b35bbbc62,0x35bab7a735b49e13,0x35c457ac35bff78f,0x35bed99335b92313,0x35c7670035c39ce8
.quad 0x35c276a035bd35e5,0x35c9c8ed35c6a993,0x35c58c4935c0d407,0x35cb7b6035c91b30,0x35c8186a35c3fb3c,0x35cc7ce035caefd6,0x35ca193c35c6a993,0x35cccc8e35cc2618
.quad 0x35cb8d5a35c8dd65,0x35cc6a2335ccbd02,0x35cc73c135ca9556,0x35cb55f535ccb421,0x35cccbd035cbd057,0x35c990f435cc0b7a,0x35cc954b35cc8da6,0x35c71cab35cac390
.quad 0x0,0x0,0x33d2f81133c8ef90,0x33e7078633dd000f,0x3452880434488ec2,0x34667457345c7f3e,0x349d5a2e3495f23f,0x34ac1fa534a4beb3
.quad 0x34d0c93434c70ca3,0x34e429d034da7db8,0x3501ad3934f7673d,0x350d88a235079f03,0x351a6c18351369bb,0x352848073521610f,0x353286ed352a91ce,0x35423103353a66f9
.quad 0x3549e41f35411588,0x355b229135529394,0x35606adb3556df37,0x3572fcea3569cab3,0x35760334356bd9dd,0x3584d0d5357ff144,0x35854b1c357ff144,0x358f79fb358a76bb
.quad 0x358f070735898908,0x35996c5235945368,0x35982b04359294e9,0x35a29b2e359d832a,0x35a0ad5c359b138d,0x35aafadc35a5fb4c,0x35a8850735a2fcc6,0x35b280af35adb1ef
.quad 0x35afa9af35aa48f4,0x35b9231335b49e13,0x35b613bd35b0f10f,0x35bed99335bab7a7,0x35bbbc6235b6eeae,0x35c39ce835bff78f,0x35c09d9b35bc3c09,0x35c7670035c457ac
.quad 0x35c4b23835c0d407,0x35ca330735c7d2e4,0x35c7f5e535c4b238,0x35cbfd6e35ca6529,0x35ca652935c7d2e4,0x35ccc3eb35cc0b7a,0x35cbfd6e35ca3307,0x35cc858235ccc3eb
.quad 0x35ccbd0235cbd057,0x35cb428335cc8da6,0x35cca31b35cca946,0x35c8fc8935cb68e9,0x35cbafd435ccbd02,0x35c5b67935c9570a,0x35c9e42e35cc0b7a,0x35c1748035c65a74
.quad 0x35c7421335ca9556,0x35bc3c0935c276a0,0x35c3cc4e35c85c01,0x35b613bd35bdb017,0x35bf868d35c5619f,0x35af037335b80c6c,0x35ba755835c1a90f,0x35a7142c35b19232
.quad 0x35cccccd35cccccd,0x35cccccd35cccccd,0x35cc32aa35cc3ebe,0x35cc190735cc2618,0x35ca652935ca9556,0x35c9fef335ca3307,0x35c7670035c7d2e4,0x35c6824135c6f6c8
.quad 0x35c33cb135c3fb3c,0x35c1a90f35c276a0,0x35bdec8135bf13b1,0x35bb7be135bcb9e0,0x35b77e6f35b92313,0x35b4058e35b5c9e1,0x35affc2a35b2319e,0x35ab533235adb1ef
.quad 0x35a770fe35aa48f4,0x35a1740f35a47f35,0x359de9c735a1740f,0x3596797a359a40ae,0x359374de3597bf2e,0x358a76bb358f0707,0x35882200358d37c9,0x357b01cb3582e487
.quad 0x3578046f3581ec7b,0x355f5d78356bd9dd,0x355e4f8b356bd9dd,0x3542310335506ab5,0x35434c0635529394,0x3523afa23533a83f,0x352722883538292a,0x35040ee53515c14d
.quad 0x3509fd76351cbf44,0x34c70ca334edcd1c,0x34d8115e35007bea,0x34849e0a34ae9479,0x349ae29334c70ca3,0x34028d3d345c7f3e,0x34399548348c0d4f,0xb1a0d96b33b4dd20
.quad 0x337138463420975e,0xb40c9200b320d559,0xb382a7d63320d559,0xb4899337b42a97c7,0xb43e9392b3a0c8f3,0xb4cbebe7b495f23f,0xb49d5a2eb4488ec2,0xb5066f4cb4d5a47e
.quad 0xb4da7db8b49fd168,0xb525fca2b509fd76,0xb50b2c30b4da7db8,0xb5446691b5284807,0xb5284807b509fd76,0xb56177b4b54580a2,0xb5446691b525fca2,0xb57cfd04b56177b4
.quad 0xb55f5d78b5411588,0xb58b6318b57bffb5,0xb5790428b55b2291,0xb59752fab58a76bb,0xb5889a01b573ff99,0xb5a23933b5960c2f,0xb593e451b585c511,0xb5ac02a0b5a0ad5c
.quad 0x35cccccd35cccccd,0x35cccccd35cccccd,0x35cbfd6e35cc0b7a,0x35cbdfdd35cbeee4,0x35c990f435c9c8ed,0x35c91b3035c9570a,0x35c58c4935c6096a,0x35c4852f35c50adf
.quad 0x35bff78f35c0d407,0x35be287635bf13b1,0x35b8de1435ba3296,0x35b613bd35b77e6f,0x35b04e3835b2319e,0x35ac59b835ae5b88,0x35a6595335a8e03a,0x35a110e735a3bec8
.quad 0x359b138d359e5003,0x359453683597bf2e,0x358e93bb359294e9,0x35863eb4358a76bb,0x3580f32d3585c511,0x356de6c23578046f,0x35649af8356ff15b,0x354d29a4355901f0
.quad 0x354580a235529394,0x352a91ce3538292a,0x3524d6553533a83f,0x35066f4c3515c14d,0x3502de37351369bb,0x34c22b7434e429d0,0x34bfba2834e429d0,0x346b6e11349ae293
.quad 0x34706739349fd168,0x33a0c8f33420975e,0x33bee6933434968b,0xb396be443220d93a,0xb34907c83320d559,0xb4667457b40c9200,0xb4439166b3c8ef90,0xb4bfba28b491007a
.quad 0xb4a9aa67b4706739,0xb5053f42b4da7db8,0xb4f03484b4bd4866,0xb5296d1fb51110bd,0xb51a6c18b5007bea,0xb54c12f5b533a83f,0xb53b8534b521610f,0xb56ce099b554ba6c
.quad 0xb55b2291b5411588,0xb585c511b573ff99,0xb5790428b55f5d78,0xb593e451b5889a01,0xb58a76bbb57bffb5,0xb5a0ad5cb5960c2f,0xb59752fab58b6318,0xb5ac02a0b5a23933
.quad 0xb5a2fcc6b597bf2e,0xb5b5c9e1b5ad06a9,0xb5ad5c81b5a2fcc6,0xb5bdec81b5b65d28,0xb5b65d28b5ad06a9,0xb5c457acb5be2876,0xb5bdec81b5b5c9e1,0xb5c8fc89b5c457ac
.quad 0x0,0x0,0x33fb14c133f10e6e,0x34078fc834028d3d,0x347a57c934706739,0x348718ca348222f8,0x34bad62f34b37cdc,0x34c97c8334c22b74
.quad 0x34f7673d34edcd1c,0x35053f4235007bea,0x351941f2351369bb,0x3524d655351f10ee,0x3535e995352f2067,0x35434c06353ca2fc,0x35517f653549e41f,0x35606adb355901f0
.quad 0x356bd9dd35638fc3,0x357bffb53573ff99,0x358268a9357bffb5,0x358aed143586b804,0x358e201735898908,0x3596e669359294e9,0x3599019735945368,0x35a1d6d2359d832a
.quad 0x35a2fcc6359e5003,0x35abab1e35a770fe,0x35ac02a035a770fe,0x35b4520835b04e38,0x35b4058e35afa9af,0x35bbbc6235b80c6c,0x35baf98335b6eeae,0x35c1dd2635be9eff
.quad 0x35c0d40735bd35e5,0x35c6a99335c3fb3c,0x35c58c4935c276a0,0x35ca193c35c8186a,0x35c91b3035c6a993,0x35cc261835caefd6,0x35cb7b6035c9c8ed,0x35cccc8e35cc7ce0
.quad 0x35cca94635cbd057,0x35cc0b7a35ccbd02,0x35cca31b35ccbd02,0x35c9e42e35cbafd4,0x35cb68e935cc8da6,0x35c65a7435c9570a,0x35c8fc8935cb4283,0x35c1748035c5b679
.quad 0x35c5619f35c8dd65,0x35bb3aec35c0d407,0x35c09d9b35c5619f,0x35b3b8a635bab7a7,0x35bab7a735c0d407,0x35aafadc35b36b4e,0x35b3b8a635bb3aec,0x35a110e735aafadc
.quad 0x35abab1e35b49e13,0x35960c2f35a1740f,0x35a29b2e35ad06a9,0x358a000c3596e669,0x3598967c35a47f35,0x357a0347358b6318,0x358dac1c359b138d,0x355e4f8b357df9b6
.quad 0x0,0x0,0x341193e2340c9200,0x341b969434169569,0x3491007a348c0d4f,0x349ae2933495f23f,0x34d8115e34d0c934,0x34e6937a34df54d8
.quad 0x350eb6593509fd76,0x3518176e351369bb,0x35304301352a91ce,0x353b85343535e995,0x35506ab53549e41f,0x355d41163556df37,0x356eec583567b948,0x357cfd0435760334
.quad 0x3585c5113581ec7b,0x358d37c935898908,0x35930511358f0707,0x359aaa4d3596e669,0x359f1b54359b138d,0x35a6b6f335a2fcc6,0x35a9ef6335a5fb4c,0x35b141d735adb1ef
.quad 0x35b36b4e35afa9af,0x35ba329635b6eeae,0x35bb7be135b80c6c,0x35c1748035be9eff,0x35c210c735bf13b1,0x35c6f6c835c4b238,0x35c71cab35c4b238,0x35caacb235c91b30
.quad 0x35ca955635c8dd65,0x35cc8da635cbd057,0x35cc73c135cb8d5a,0x35cc954b35cccbd0,0x35ccb42135ccbd02,0x35cac39035cc0b7a,0x35cb55f535cc6a23,0x35c71cab35c990f4
.quad 0x35c85c0135ca9556,0x35c1a90f35c5619f,0x35c3cc4e35c74213,0x35ba755835bf868d,0x35bdb01735c276a0,0x35b1923235b80c6c,0x35b613bd35bc3c09,0x35a7142c35af0373
.quad 0x35ad06a935b49e13,0x359b138d35a47f35,0x35a29b2e35abab1e,0x358dac1c3598967c,0x3596e66935a1740f,0x357df9b6358b6318,0x358a000c35960c2f,0x355e4f8b357a0347
.quad 0x3578046f35898908,0x353ca2fc355b2291,0x355a12843578046f,0x351941f2353a66f9,0x353a66f9355b2291,0x34e8fc953518176e,0x351941f2353ca2fc,0x349d5a2e34e8fc95
.quad 0x35cbd05735cccccd,0x35c3fb3c35c8dd65,0x35cbc05435cccccd,0x35c36d0935c89dab,0x35cbafd435cccccd,0x35c2da9935c85c01,0x35cb9ed535cccccd,0x35c243ef35c8186a
.quad 0x35cb8d5a35cccccd,0x35c1a90f35c7d2e4,0x35cb7b6035cccccd,0x35c109fb35c78b72,0x35cb68e935cccccd,0x35c066b835c74213,0x35cb55f535cccccd,0x35bfbf4935c6f6c8
.quad 0x35cb428335cccccd,0x35bf13b135c6a993,0x35cb2e9435cccccd,0x35be63f535c65a74,0x35cb1a2735cccccd,0x35bdb01735c6096a,0x35cb053d35cccccd,0x35bcf81d35c5b679
.quad 0x35caefd635cccccd,0x35bc3c0935c5619f,0x35cad9f235cccccd,0x35bb7be135c50adf,0x35cac39035cccccd,0x35bab7a735c4b238,0x35caacb235cccccd,0x35b9ef6135c457ac
.quad 0x35ca955635cccccd,0x35b9231335c3fb3c,0x35ca7d7e35cccccd,0x35b852c135c39ce8,0x35ca652935cccccd,0x35b77e6f35c33cb1,0x35ca4c5635cccccd,0x35b6a62335c2da99
.quad 0x35ca330735cccccd,0x35b5c9e135c276a0,0x35ca193c35cccccd,0x35b4e9ae35c210c7,0x35c9fef335cccccd,0x35b4058e35c1a90f,0x35c9e42e35cccccd,0x35b31d8735c13f79
.quad 0x35c9c8ed35cccccd,0x35b2319e35c0d407,0x35c9ad2f35cccccd,0x35b141d735c066b8,0x35c990f435cccccd,0x35b04e3835bff78f,0x35c9743e35cccccd,0x35af56c735bf868d
.quad 0x35c9570a35cccccd,0x35ae5b8835bf13b1,0x35c9395b35cccccd,0x35ad5c8135be9eff,0x35c91b3035cccccd,0x35ac59b835be2876,0x35c8fc8935cccccd,0x35ab533235bdb017
.quad 0x35b49e1335bd35e5,0x359e500335aa48f4,0x35b31d8735bc3c09,0x359b7c6d35a8296b,0x35b1923235bb3aec,0x3598967c35a5fb4c,0x35affc2a35ba3296,0x35959e8835a3bec8
.quad 0x35ae5b8835b92313,0x359294e935a1740f,0x35acb06535b80c6c,0x358f79fb359f1b54,0x35aafadc35b6eeae,0x358c4e1d359cb4cd,0x35a93b0635b5c9e1,0x358911af359a40ae
.quad 0x35a770fe35b49e13,0x3585c5113597bf2e,0x35a59ce035b36b4e,0x358268a935953084,0x35a3bec835b2319e,0x357df9b6359294e9,0x35a1d6d235b0f10f,0x3577041e358fec97
.quad 0x359fe51e35afa9af,0x356ff15b358d37c9,0x359de9c735ae5b88,0x3568c245358a76bb,0x359be4ed35ad06a9,0x356177b43587a9aa,0x3599d6b035abab1e,0x355a12843584d0d5
.quad 0x3597bf2e35aa48f4,0x355293943581ec7b,0x35959e8835a8e03a,0x354afbc9357df9b6,0x359374de35a770fe,0x35434c063578046f,0x3591425335a5fb4c,0x353b85343571f9a5
.quad 0x358f070735a47f35,0x3533a83f356bd9dd,0x358cc31e35a2fcc6,0x352bb6143565a5a1,0x358a76bb35a1740f,0x3523afa2355f5d78,0x35882200359fe51e,0x351b95de355901f0
.quad 0x3585c511359e5003,0x351369bb35529394,0x35836014359cb4cd,0x350b2c30354c12f5,0x3580f32d359b138d,0x3502de37354580a2,0x357cfd0435996c52,0x34f50196353edd2d
.quad 0x3578046f3597bf2e,0x34e429d03538292a,0x3572fcea35960c2f,0x34d3371a3531652e,0x356de6c235945368,0x34c22b74352a91ce,0x3568c245359294e9,0x34b108e13523afa2
.quad 0x3420975e00000000,0x34edcd1c349fd168,0x342597c600000000,0x34f5019634a4beb3,0x342a97c700000000,0x34fc30c034a9aa67,0x342f976000000000,0x3501ad3934ae9479
.quad 0x3434968b00000000,0x35053f4234b37cdc,0x3439954800000000,0x3508ce6734b86384,0x343e939200000000,0x350c5a9534bd4866,0x3443916600000000,0x350fe3b734c22b74
.quad 0x34488ec200000000,0x351369bb34c70ca3,0x344d8ba200000000,0x3516ec8c34cbebe7,0x3452880400000000,0x351a6c1834d0c934,0x345783e300000000,0x351de84a34d5a47e
.quad 0x345c7f3e00000000,0x3521610f34da7db8,0x34617a1000000000,0x3524d65534df54d8,0x3466745700000000,0x3528480734e429d0,0x346b6e1100000000,0x352bb61434e8fc95
.quad 0x3470673900000000,0x352f206734edcd1c,0x34755fcc00000000,0x353286ed34f29b58,0x347a57c900000000,0x3535e99534f7673d,0x347f4f2b00000000,0x3539484b34fc30c0
.quad 0x348222f800000000,0x353ca2fc35007bea,0x34849e0a00000000,0x353ff9963502de37,0x348718ca00000000,0x35434c0635053f42,0x3489933700000000,0x35469a3a35079f03
.quad 0x348c0d4f00000000,0x3549e41f3509fd76,0x348e871000000000,0x354d29a4350c5a95,0x3491007a00000000,0x35506ab5350eb659,0x3493798a00000000,0x3553a742351110bd
.quad 0x3495f23f00000000,0x3556df37351369bb,0x34986a9800000000,0x355a12843515c14d,0x349ae29300000000,0x355d41163518176e,0x349d5a2e00000000,0x35606adb351a6c18
.quad 0x35411588351cbf44,0x3581ec7b35638fc3,0x35469a3a3521610f,0x35854b1c3569cab3,0x354c12f53525fca2,0x35889a01356ff15b,0x35517f65352a91ce,0x358bd8c635760334
.quad 0x3556df37352f2067,0x358f0707357bffb5,0x355c32173533a83f,0x359224663580f32d,0x356177b43538292a,0x359530843583db51,0x3566afbb353ca2fc,0x35982b043586b804
.quad 0x356bd9dd35411588,0x359b138d35898908,0x3570f5cb354580a2,0x359de9c7358c4e1d,0x357603343549e41f,0x35a0ad5c358f0707,0x357b01cb354e3fd4,0x35a35df93591b389
.quad 0x357ff14435529394,0x35a5fb4c35945368,0x358268a93556df37,0x35a885073596e669,0x3584d0d5355b2291,0x35aafadc35996c52,0x35873101355f5d78,0x35ad5c81359be4ed
.quad 0x3589890835638fc3,0x35afa9af359e5003,0x358bd8c63567b948,0x35b1e21f35a0ad5c,0x358e2017356bd9dd,0x35b4058e35a2fcc6,0x35905ed9356ff15b,0x35b613bd35a53e0d
.quad 0x359294e93573ff99,0x35b80c6c35a770fe,0x3594c2243578046f,0x35b9ef6135a99568,0x3596e669357bffb5,0x35bbbc6235abab1e,0x35990197357ff144,0x35bd733935adb1ef
.quad 0x359b138d3581ec7b,0x35bf13b135afa9af,0x359d1c2c3583db51,0x35c09d9b35b19232,0x359f1b543585c511,0x35c210c735b36b4e,0x35a110e73587a9aa,0x35c36d0935b534da
.quad 0x35a2fcc635898908,0x35c4b23835b6eeae,0x35a4ded4358b6318,0x35c5e02f35b898a3,0x35a6b6f3358d37c9,0x35c6f6c835ba3296,0x35a88507358f0707,0x35c7f5e535bbbc62
.quad 0x3581ec7b3590d0c3,0x3541158835638fc3,0x357b01cb358d37c9,0x3534c922355901f0,0x3571f9a535898908,0x35284807354e3fd4,0x3568c2453585c511,0x351b95de35434c06
.quad 0x355f5d783581ec7b,0x350eb6593538292a,0x3555cd14357bffb5,0x3501ad39352cd9f0,0x354c12f53573ff99,0x34e8fc953521610f,0x35423103356bd9dd,0x34ce5acd3515c14d
.quad 0x3538292a35638fc3,0x34b37cdc3509fd76,0x352dfd61355b2291,0x34986a9834fc30c0,0x3523afa235529394,0x347a57c934e429d0,0x351941f23549e41f,0x3443916634cbebe7
.quad 0x350eb65935411588,0x340c920034b37cdc,0x35040ee53538292a,0x33aad33e349ae293,0x34f29b58352f2067,0x32f142bd348222f8,0x34dce98c3525fca2,0xb2c90dd634528804
.quad 0x34c70ca3351cbf44,0xb3a0c8f33420975e,0x34b108e1351369bb,0xb4078fc833dd000f,0x349ae2933509fd76,0xb43e939233713846,0x34849e0a35007bea,0xb4755fcc3220d93a
.quad 0x345c7f3e34edcd1c,0xb495f23fb320d559,0x342f976034da7db8,0xb4b108e1b3b4dd20,0x34028d3d34c70ca3,0xb4cbebe7b40c9200,0x33aad33e34b37cdc,0xb4e6937ab43e9392
.quad 0x3320d559349fd168,0xb5007beab4706739,0xb1a0d96b348c0d4f,0xb50d88a2b491007a,0xb34907c834706739,0xb51a6c18b4a9aa67,0xb3bee69334488ec2,0xb5272288b4c22b74
.quad 0xb40c92003420975e,0xb533a83fb4da7db8,0xb439954833f10e6e,0xb53ff996b4f29b58,0xb466745733a0c8f3,0xb54c12f5b5053f42,0xb48993373320d559,0xb557f0d6b51110bd
.quad 0x34edcd1c351cbf44,0x3420975e349fd168,0x34ce5acd350eb659,0x33aad33e347a57c9,0x34ae947935007bea,0x3220d93a3434968b,0x348e871034e429d0,0xb382a7d633dd000f
.quad 0x345c7f3e34c70ca3,0xb40c92003320d559,0x341b969434a9aa67,0xb45783e3b2f142bd,0x33b4dd20348c0d4f,0xb491007ab3c8ef90,0x32c90dd6345c7f3e,0xb4b5f068b42a97c7
.quad 0xb320d5593420975e,0xb4da7db8b4706739,0xb3d2f81133c8ef90,0xb4fe9498b49ae293,0xb42a97c73320d559,0xb51110bdb4bd4866,0xb46b6e11b2a0d873,0xb522888bb4df54d8
.quad 0xb495f23fb3a0c8f3,0xb533a83fb5007bea,0xb4b5f068b40c9200,0xb5446691b51110bd,0xb4d5a47eb4488ec2,0xb554ba6cb521610f,0xb4f50196b48222f8,0xb5649af8b531652e
.quad 0xb509fd76b49fd168,0xb573ff99b5411588,0xb51941f2b4bd4866,0xb5816ffcb5506ab5,0xb5284807b4da7db8,0xb5889a01b55f5d78,0xb5370998b4f7673d,0xb58f79fbb56de6c2
.quad 0xb54580a2b509fd76,0xb5960c2fb57bffb5,0xb553a742b518176e,0xb59c4d0eb584d0d5,0xb56177b4b525fca2,0xb5a23933b58b6318,0xb56eec58b533a83f,0xb5a7cd68b591b389
.quad 0xb57bffb5b5411588,0xb5ad06a9b597bf2e,0xb584563cb54e3fd4,0xb5b1e21fb59d832a,0xb58a76bbb55b2291,0xb5b65d28b5a2fcc6,0xb5905ed9b567b948,0xb5ba7558b5a8296b
.quad 0xb5960c2fb573ff99,0xb5be2876b5ad06a9,0xb59b7c6db57ff144,0xb5c17480b5b19232,0xb5a0ad5cb585c511,0xb5c457acb5b5c9e1,0xb5a59ce0b58b6318,0xb5c6d06bb5b9abba
.quad 0x359e50033590d0c3,0x35b49e1335aa48f4,0x35a1d6d235945368,0x35b7c5a735adb1ef,0x35a53e0d3597bf2e,0x35bab7a735b0f10f,0x35a88507359b138d,0x35bd733935b4058e
.quad 0x35abab1e359e5003,0x35bff78f35b6eeae,0x35aeafb335a1740f,0x35c243ef35b9abba,0x35b1923235a47f35,0x35c457ac35bc3c09,0x35b4520835a770fe,0x35c6322c35be9eff
.quad 0x35b6eeae35aa48f4,0x35c7d2e435c0d407,0x35b9679f35ad06a9,0x35c9395b35c2da99,0x35bbbc6235afa9af,0x35ca652935c4b238,0x35bdec8135b2319e,0x35cb55f535c65a74
.quad 0x35bff78f35b49e13,0x35cc0b7a35c7d2e4,0x35c1dd2635b6eeae,0x35cc858235c91b30,0x35c39ce835b92313,0x35ccc3eb35ca3307,0x35c5367c35bb3aec,0x35ccc6a235cb1a27
.quad 0x35c6a99335bd35e5,0x35cc8da635cbd057,0x35c7f5e535bf13b1,0x35cc190735cc556c,0x35c91b3035c0d407,0x35cb68e935cca946,0x35ca193c35c276a0,0x35ca7d7e35cccbd0
.quad 0x35caefd635c3fb3c,0x35c9570a35ccbd02,0x35cb9ed535c5619f,0x35c7f5e535cc7ce0,0x35cc261835c6a993,0x35c65a7435cc0b7a,0x35cc858235c7d2e4,0x35c4852f35cb68e9
.quad 0x35ccbd0235c8dd65,0x35c276a035ca9556,0x35cccc8e35c9c8ed,0x35c02f5f35c990f4,0x35ccb42135ca9556,0x35bdb01735c85c01,0x35cc73c135cb4283,0x35baf98335c6f6c8
.quad 0x35cc0b7a35cbd057,0x35b80c6c35c5619f,0x35cb7b6035cc3ebe,0x35b4e9ae35c39ce8,0x35cac39035cc8da6,0x35b1923235c1a90f,0x35c9e42e35ccbd02,0x35ae06f135bf868d
.quad 0x35c3fb3c35bd35e5,0x35cbd05735c8dd65,0x35c6322c35bff78f,0x35cc858235ca6529,0x35c8186a35c276a0,0x35cccbd035cb8d5a,0x35c9ad2f35c4b238,0x35cca31b35cc556c
.quad 0x35caefd635c6a993,0x35cc0b7a35ccbd02,0x35cbdfdd35c85c01,0x35cb053d35ccc3eb,0x35cc7ce035c9c8ed,0x35c990f435cc6a23,0x35ccc6a235caefd6,0x35c7af6935cbafd4
.quad 0x35ccbd0235cbd057,0x35c5619f35ca9556,0x35cc600635cc6a23,0x35c2a8d835c91b30,0x35cbafd435ccbd02,0x35bf868d35c74213,0x35caacb235ccc8da,0x35bbfc7035c50adf
.quad 0x35c9570a35cc8da6,0x35b80c6c35c276a0,0x35c7af6935cc0b7a,0x35b3b8a635bf868d,0x35c5b67935cb4283,0x35af037335bc3c09,0x35c36d0935ca3307,0x35a9ef6335b898a3
.quad 0x35c0d40735c8dd65,0x35a47f3535b49e13,0x35bdec8135c74213,0x359eb5dd35b04e38,0x35bab7a735c5619f,0x3598967c35abab1e,0x35b736c735c33cb1,0x3592246635a6b6f3
.quad 0x35b36b4e35c0d407,0x358b631835a1740f,0x35af56c735be2876,0x3584563c359be4ed,0x35aafadc35bb3aec,0x357a034735960c2f,0x35a6595335b80c6c,0x356ad291358fec97
.quad 0x35a1740f35b49e13,0x355b229135898908,0x359c4d0e35b0f10f,0x354afbc93582e487,0x3596e66935ad06a9,0x353a66f93578046f,0x3591425335a8e03a,0x35296d1f3569cab3
.quad 0x358b631835a47f35,0x3518176e355b2291,0x35854b1c359fe51e,0x35066f4c354c12f5,0x357df9b6359b138d,0x34e8fc95353ca2fc,0x3570f5cb35960c2f,0x34c49c48352cd9f0
.quad 0xb420975e1ae1e84f,0xb4edcd1cb49fd168,0xb4755fccb3a0c8f3,0xb50d88a2b4cbebe7,0xb4a4beb3b420975e,0xb523afa2b4f7673d,0xb4ce5acdb4706739,0xb539484bb51110bd
.quad 0xb4f7673db49fd168,0xb54e3fd4b525fca2,0xb50fe3b7b4c70ca3,0xb5628401b53a66f9,0xb523afa2b4edcd1c,0xb5760334b54e3fd4,0xb5370998b509fd76,0xb584563cb56177b4
.quad 0xb549e41fb51cbf44,0xb58d37c9b573ff99,0xb55c3217b52f2067,0xb5959e88b582e487,0xb56de6c2b5411588,0xb59d832ab58b6318,0xb57ef5ccb5529394,0xb5a4ded4b59374de
.quad 0xb587a9aab5638fc3,0xb5abab1eb59b138d,0xb58f79fbb573ff99,0xb5b1e21fb5a23933,0xb596e669b581ec7b,0xb5b77e6fb5a8e03a,0xb59de9c7b5898908,0xb5bc7b2fb5af0373
.quad 0xb5a47f35b590d0c3,0xb5c0d407b5b49e13,0xb5aaa21db597bf2e,0xb5c4852fb5b9abba,0xb5b04e38b59e5003,0xb5c78b72b5be2876,0xb5b57f95b5a47f35,0xb5c9e42eb5c210c7
.quad 0xb5ba3296b5aa48f4,0xb5cb8d5ab5c5619f,0xb5be63f5b5afa9af,0xb5cc8582b5c8186a,0xb5c210c7b5b49e13,0xb5cccbd0b5ca3307,0xb5c5367cb5b92313,0xb5cc6006b5cbafd4
.quad 0xb5c7d2e4b5bd35e5,0xb5cb4283b5cc8da6,0xb5c9e42eb5c0d407,0xb5c9743eb5cccbd0,0xb5cb68e9b5c3fb3c,0xb5c6f6c8b5cc6a23,0xb5cc6006b5c6a993,0xb5c3cc4eb5cb68e9
.quad 0xb5ccc8dab5c8dd65,0xb5bff78fb5c9c8ed,0xb5cca31bb5ca9556,0xb5bb7be1b5c78b72,0xb5cbeee4b5cbd057,0xb5b65d28b5c4b238,0xb5caacb2b5cc8da6,0xb5b09fdab5c13f79
.quad 0xb5411588b51cbf44,0xb581ec7bb5638fc3,0xb557f0d6b533a83f,0xb58cc31eb57a0347,0xb56de6c2b549e41f,0xb596e669b587a9aa,0xb5816ffcb55f5d78,0xb5a0496eb591b389
.quad 0xb58b6318b573ff99,0xb5a8e03ab59b138d,0xb594c224b583db51,0xb5b09fdab5a3bec8,0xb59d832ab58d37c9,0xb5b77e6fb5abab1e,0xb5a59ce0b5960c2f,0xb5bd7339b5b2cf52
.quad 0xb5ad06a9b59e5003,0xb5c276a0b5b92313,0xb5b3b8a6b5a5fb4c,0xb5c68241b5be9eff,0xb5b9abbab5ad06a9,0xb5c990f4b5c33cb1,0xb5bed993b5b36b4e,0xb5cb9ed5b5c6f6c8
.quad 0xb5c33cb1b5b92313,0xb5cca946b5c9c8ed,0xb5c6d06bb5be2876,0xb5ccaef3b5cbafd4,0xb5c990f4b5c276a0,0xb5cbafd4b5cca946,0xb5cb7b60b5c6096a,0xb5c9ad2fb5ccb421
.quad 0xb5cc8da6b5c8dd65,0xb5c6a993b5cbd057,0xb5ccc6a2b5caefd6,0xb5c2a8d8b5c9fef3,0xb5cc2618b5cc3ebe,0xb5bdb017b5c74213,0xb5caacb2b5ccc8da,0xb5b7c5a7b5c39ce8
.quad 0xb5c85c01b5cc8da6,0xb5b0f10fb5bf13b1,0xb5c5367cb5cb8d5a,0xb5a93b06b5b9abba,0xb5c13f79b5c9c8ed,0xb5a0ad5cb5b36b4e,0xb5bc7b2fb5c74213,0xb59752fab5ac59b8
.quad 0xb5b6eeaeb5c3fb3c,0xb58d37c9b5a47f35,0xb5b09fdab5bff78f,0xb58268a9b59be4ed,0xb5a99568b5bb3aec,0xb56de6c2b59294e9,0xb5a1d6d2b5b5c9e1,0xb555cd14b5889a01
.quad 0xb5996c52b5afa9af,0xb53ca2fcb57bffb5,0xb5905ed9b5a8e03a,0xb522888bb565a5a1,0xb586b804b5a1740f,0xb5079f03b54e3fd4,0xb5790428b5996c52,0xb4d8115eb535e995
.quad 0x35cbd05735cccccd,0x35c3fb3c35c8dd65,0x35ca7d7e35cc8da6,0x35c02f5f35c65a74,0x35c89dab35cbd057,0x35bbbc6235c33cb1,0x35c6322c35ca9556,0x35b6a62335bf868d
.quad 0x35c33cb135c8dd65,0x35b0f10f35bb3aec,0x35bfbf4935c6a993,0x35aaa21d35b65d28,0x35bbbc6235c3fb3c,0x35a3bec835b0f10f,0x35b736c735c0d407,0x359c4d0e35aafadc
.quad 0x35b2319e35bd35e5,0x3594536835a47f35,0x35acb06535b92313,0x358bd8c6359d832a,0x35a6b6f335b49e13,0x3582e48735960c2f,0x35a0496e35afa9af,0x3572fcea358e2017
.quad 0x35996c5235aa48f4,0x355f5d783585c511,0x3592246635a47f35,0x354afbc9357a0347,0x358a76bb359e5003,0x3535e9953567b948,0x358268a93597bf2e,0x352039303554ba6c
.quad 0x3573ff993590d0c3,0x3509fd7635411588,0x3562840135898908,0x34e6937a352cd9f0,0x35506ab53581ec7b,0x34b863843518176e,0x353dc04f3573ff99,0x348993373502de37
.quad 0x352a91ce35638fc3,0x3434968b34da7db8,0x3516ec8c35529394,0x33aad33e34ae9479,0x3502de3735411588,0xb220d93a348222f8,0x34dce98c352f2067,0xb3d2f811342a97c7
.quad 0x34b37cdc351cbf44,0xb4488ec233a0c8f3,0x348993373509fd76,0xb493798ab220d93a,0x343e939234edcd1c,0xb4c22b74b3c8ef90,0x33d2f81134c70ca3,0xb4f03484b43e9392
.quad 0x32a0d873349fd168,0xb50eb659b48c0d4f,0xb382a7d634706739,0xb524d655b4b86384,0xb41695693420975e,0xb53a66f9b4e429d0,0xb46b6e1133a0c8f3,0xb54f5584b5079f03
.quad 0x35b49e1335bd35e5,0x359e500335aa48f4,0x35ae06f135b80c6c,0x3594c22435a23933,0x35a6b6f335b2319e,0x358a76bb35996c52,0x359eb5dd35abab1e,0x357ef5cc358fec97
.quad 0x35960c2f35a47f35,0x3567b9483585c511,0x358cc31e359cb4cd,0x354f558435760334,0x3582e48735945368,0x3535e995355f5d78,0x3570f5cb358b6318,0x351b95de3547b357
.quad 0x355b22913581ec7b,0x35007bea352f2067,0x35446691356ff15b,0x34c97c833515c14d,0x352cd9f0355b2291,0x3491007a34f7673d,0x351495b2354580a2,0x342f976034c22b74
.quad 0x34f7673d352f2067,0x33713846348c0d4f,0x34c49c483518176e,0xb35d204b342a97c7,0x3491007a35007bea,0xb42a97c733713846,0x3439954834d0c934,0xb48e8710b34907c8
.quad 0x33a0c8f3349fd168,0xb4c70ca3b420975e,0xb2c90dd6345c7f3e,0xb4fe9498b48718ca,0xb4028d3d33f10e6e,0xb51a6c18b4bd4866,0xb46b6e1132a0d873,0xb534c922b4f29b58
.quad 0xb4a9aa67b3a0c8f3,0xb54e3fd4b51369bb,0xb4dce98cb434968b,0xb566afbbb52cd9f0,0xb5079f03b48c0d4f,0xb57df9b6b54580a2,0xb5203930b4bd4866,0xb58a000cb55d4116
.quad 0xb538292ab4edcd1c,0xb5945368b573ff99,0xb54f5584b50eb659,0xb59de9c7b584d0d5,0xb565a5a1b525fca2,0xb5a6b6f3b58f0707,0xb57b01cbb53ca2fc,0xb5aeafb3b598967c
.quad 0xb587a9aab5529394,0xb5b5c9e1b5a1740f,0xb5914253b567b948,0xb5bbfc70b5a99568,0xb59a40aeb57bffb5,0xb5c13f79b5b0f10f,0xb5a29b2eb587a9aa,0xb5c58c49b5b77e6f
.quad 0xb59e5003b590d0c3,0xb5b49e13b5aa48f4,0xb5a7cd68b59b138d,0xb5bbfc70b5b2cf52,0xb5b04e38b5a47f35,0xb5c210c7b5ba3296,0xb5b7c5a7b5ad06a9,0xb5c6d06bb5c066b8
.quad 0xb5be2876b5b49e13,0xb5ca3307b5c5619f,0xb5c36d09b5bb3aec,0xb5cc32aab5c91b30,0xb5c78b72b5c0d407,0xb5cccbd0b5cb8d5a,0xb5ca7d7eb5c5619f,0xb5cbfd6eb5ccb421
.quad 0xb5cc3ebeb5c8dd65,0xb5c9c8edb5cc8da6,0xb5cccc8eb5cb4283,0xb5c6322cb5cb1a27,0xb5cc2618b5cc8da6,0xb5c13f79b5c85c01,0xb5ca4c56b5ccbd02,0xb5baf983b5c457ac
.quad 0xb5c74213b5cbd057,0xb5b36b4eb5bf13b1,0xb5c30be1b5c9c8ed,0xb5aaa21db5b898a3,0xb5bdb017b5c6a993,0xb5a0ad5cb5b0f10f,0xb5b736c7b5c276a0,0xb5959e88b5a8296b
.quad 0xb5afa9afb5bd35e5,0xb5898908b59e5003,0xb5a7142cb5b6eeae,0xb5790428b59374de,0xb59d832ab5afa9af,0xb55d4116b587a9aa,0xb5930511b5a770fe,0xb53ff996b5760334
.quad 0xb587a9aab59e5003,0xb521610fb55b2291,0xb577041eb5945368,0xb501ad39b53edd2d,0xb55d4116b5898908,0xb4c22b74b521610f,0xb5423103b57bffb5,0xb47f4f2bb502de37
.quad 0xb525fca2b5638fc3,0xb3f10e6eb4c70ca3,0xb508ce67b549e41f,0x3271455ab48718ca,0xb4d5a47eb52f2067,0x34169569b40c9200,0xb4986a98b51369bb,0x348e8710b220d93a
.quad 0xb434968bb4edcd1c,0x34d0c93433f10e6e,0xb35d204bb4b37cdc,0x3508ce67347a57c9,0x338cb338b4706739,0x3528480734bd4866,0x34439166b3f10e6e,0x35469a3a34fc30c0
.quad 0xb5c3fb3cb5bd35e5,0xb5cbd057b5c8dd65,0xb5c87d14b5c33cb1,0xb5cccc8eb5cbafd4,0xb5cb68e9b5c7d2e4,0xb5cbeee4b5ccc8da,0xb5ccb8d1b5caefd6,0xb5c9395bb5cc2618
.quad 0xb5cc6a23b5cc8da6,0xb5c4b238b5c9c8ed,0xb5ca7d7eb5cca946,0xb5be63f5b5c5b679,0xb5c6f6c8b5cb4283,0xb5b65d28b5bff78f,0xb5c1dd26b5c85c01,0xb5acb065b5b898a3
.quad 0xb5bb3aecb5c3fb3c,0xb5a1740fb5afa9af,0xb5b31d87b5be2876,0xb594c224b5a53e0d,0xb5a99568b5b6eeae,0xb586b804b5996c52,0xb59eb5ddb5ae5b88,0xb56eec58b58c4e1d
.quad 0xb59294e9b5a47f35,0xb54e3fd4b57bffb5,0xb5854b1cb5996c52,0xb52bb614b55d4116,0xb56de6c2b58d37c9,0xb5079f03b53ca2fc,0xb54f5584b57ff144,0xb4c49c48b51a6c18
.quad 0xb52f2067b5638fc3,0xb4706739b4edcd1c,0xb50d88a2b54580a2,0xb3aad33eb4a4beb3,0xb4d5a47eb525fca2,0x338cb338b434968b,0xb48e8710b5053f42,0x34617a10b2f142bd
.quad 0xb40c9200b4c70ca3,0x34bd486633f10e6e,0x31a0d96bb48222f8,0x35040ee5348718ca,0x34169569b3f10e6e,0x3528480734d0c934,0x3493798a32a0d873,0x354afbc9350c5a95
.quad 0x34da7db83420975e,0x356bd9dd352f2067,0x350fe3b73495f23f,0x35854b1c35506ab5,0x3531652e34da7db8,0x359374de356ff15b,0x35517f65350eb659,0x35a0496e3586b804
.quad 0x356ff15b352f2067,0x35abab1e35945368,0x35863eb4354e3fd4,0x35b57f9535a0ad5c,0x359374de356bd9dd,0x35bdb01735abab1e,0x359f806a3583db51,0x35c429b035b534da
.quad 0x3581ec7b3590d0c3,0x3541158835638fc3,0x356ad2913585c511,0x3522888b3547b357,0x35506ab53573ff99,0x3502de37352a91ce,0x3534c922355b2291,0x34c49c48350c5a95
.quad 0x3518176e35411588,0x348222f834da7db8,0x34f501963525fca2,0x33fb14c1349ae293,0x34b863843509fd76,0xb220d93a3434968b,0x34755fcc34da7db8,0xb41193e2334907c8
.quad 0x33f10e6e349fd168,0xb48c0d4fb3a0c8f3,0xb1a0d96b34488ec2,0xb4ce5acdb4528804,0xb4028d3d33a0c8f3,0xb5079f03b4a9aa67,0xb47f4f2bb320d559,0xb5272288b4e8fc95
.quad 0xb4bd4866b420975e,0xb54580a2b51369bb,0xb4f9cc4bb48c0d4f,0xb5628401b531652e,0xb51a6c18b4c70ca3,0xb57df9b6b54e3fd4,0xb5370998b5007bea,0xb58bd8c6b569cab3
.quad 0xb5529394b51cbf44,0xb597bf2eb581ec7b,0xb56ce099b538292a,0xb5a29b2eb58e2017,0xb582e487b5529394,0xb5ac59b8b5996c52,0xb58e93bbb56bd9dd,0xb5b4e9aeb5a3bec8
.quad 0xb5996c52b581ec7b,0xb5bc3c09b5ad06a9,0xb5a35df9b58d37c9,0xb5c243efb5b534da,0xb5ac59b8b597bf2e,0xb5c6f6c8b5bc3c09,0xb5b45208b5a1740f,0xb5ca4c56b5c210c7
.quad 0xb5bb3aecb5aa48f4,0xb5cc3ebeb5c6a993,0xb5c109fbb5b2319e,0xb5ccca94b5c9fef3,0xb5c5b679b5b92313,0xb5cbeee4b5cc0b7a,0xb5c9395bb5bf13b1,0xb5c9ad2fb5cccbd0
.quad 0xb5cb8d5ab5c3fb3c,0xb5c6096ab5cc3ebe,0xb5ccaef3b5c7d2e4,0xb5c109fbb5ca6529,0xb5cc9c72b5ca9556,0xb5bab7a7b5c74213,0xb5cb55f5b5cc3ebe,0xb5b31d87b5c2da99
.quad 0x34edcd1c351cbf44,0x3420975e349fd168,0x34a734c134f7673d,0x31a0d96b342a97c7,0x343e939234b37cdc,0xb416956932a0d873,0x3334eec8345c7f3e,0xb4986a98b4028d3d
.quad 0xb3c8ef9033a0c8f3,0xb4e429d0b48c0d4f,0xb4755fccb3713846,0xb516ec8cb4d5a47e,0xb4c22b74b4488ec2,0xb53a66f9b50eb659,0xb5040ee5b4a9aa67,0xb55c3217b531652e
.quad 0xb525fca2b4edcd1c,0xb57bffb5b5529394,0xb5469a3ab518176e,0xb58cc31eb571f9a5,0xb565a5a1b538292a,0xb59a40aeb587a9aa,0xb5816ffcb556df37,0xb5a65953b5953084
.quad 0xb58f0707b573ff99,0xb5b0f10fb5a1740f,0xb59b7c6db587a9aa,0xb5b9ef61b5ac59b8,0xb5a6b6f3b5945368,0xb5c13f79b5b5c9e1,0xb5b09fdab59fe51e,0xb5c6d06bb5bdb017
.quad 0xb5b92313b5aa48f4,0xb5ca9556b5c3fb3c,0xb5c02f5fb5b36b4e,0xb5cc8582b5c89dab,0xb5c5b679b5bb3aec,0xb5cc9c72b5cb8d5a,0xb5c9ad2fb5c1a90f,0xb5cad9f2b5ccc3eb
.quad 0xb5cc0b7ab5c6a993,0xb5c74213b5cc3ebe,0xb5cccc8eb5ca3307,0xb5c1dd26b5c9fef3,0xb5cbeee4b5cc3ebe,0xb5bab7a7b5c6096a,0xb5c9743eb5ccc8da,0xb5b1e21fb5c066b8
.quad 0xb5c5619fb5cbd057,0xb5a770feb5b92313,0xb5bfbf49b5c9570a,0xb59b7c6db5b04e38,0xb5b898a3b5c5619f,0xb58e2017b5a5fb4c,0xb5affc2ab5bff78f,0xb57ef5ccb59a40ae
.quad 0xb5a5fb4cb5b92313,0xb55f5d78b58d37c9,0xb59aaa4db5b0f10f,0xb53dc04fb57df9b6,0xb58e2017b5a770fe,0xb51a6c18b55f5d78,0xb580760fb59cb4cd,0xb4eb6521b53edd2d
```
